```python
import torch

def _softmax(x, axis=-1):
    return torch.softmax(x, dim=axis)
def _gelu(x):
    return torch.nn.functional.gelu(x, approximate="tanh")
def _silu(x):
    return torch.nn.functional.silu(x)
def _sigmoid(x):
    return torch.sigmoid(x)
def _layernorm(x, axis=-1, eps=1e-5):
    m = x.mean(dim=axis, keepdim=True)
    v = x.var(dim=axis, keepdim=True, unbiased=False)
    return (x - m) / torch.sqrt(v + eps)
def _scatter_add(tgt, idx, src, axis=0):
    return tgt.clone().index_add_(axis, idx, src)
def _segment_sum(src, seg, n):
    out = torch.zeros((n,) + src.shape[1:], dtype=src.dtype)
    return out.index_add_(0, seg, src)
def _pad(x, pw):
    flat = tuple(v for pair in reversed(pw) for v in pair)
    return torch.nn.functional.pad(x, flat)

kernel_name = 'recurrent_scan__sliding_local_dilated__glu_gated_glu__prompt'

def setup_inputs():

    _w = (lambda a: (lambda t: t.to(torch.bfloat16) if t.is_floating_point() else t)(torch.as_tensor(a)))
    def _A_setup():
        B, S, D = 1, 2048, 576
        return {
            "x": _w((lambda *s: torch.randn(*s, dtype=torch.bfloat16) * 0.05)(B, S, D)),
            "wqkv": _w((lambda *s: torch.randn(*s, dtype=torch.bfloat16) * 0.05)(D, 3 * D)),
            "wo": _w((lambda *s: torch.randn(*s, dtype=torch.bfloat16) * 0.05)(D, D)),
        }
    _A_in = _A_setup()

    def _B_setup():
        B, S, D, F = 1, 2048, 576, 4608
        return {
            "x": _w((lambda *s: torch.randn(*s, dtype=torch.bfloat16) * 0.05)(B, S, D)),
            "w_gate": _w((lambda *s: torch.randn(*s, dtype=torch.bfloat16) * 0.05)(D, F)),
            "w_up": _w((lambda *s: torch.randn(*s, dtype=torch.bfloat16) * 0.05)(D, F)),
            "w_down": _w((lambda *s: torch.randn(*s, dtype=torch.bfloat16) * 0.05)(F, D)),
        }
    _B_in = _B_setup()

    return {
        "A_x": _A_in["x"],
        "A_wqkv": _A_in["wqkv"],
        "A_wo": _A_in["wo"],
        "B_x": _B_in["x"],
        "B_w_gate": _B_in["w_gate"],
        "B_w_up": _B_in["w_up"],
        "B_w_down": _B_in["w_down"],
    }

def reference(A_x, A_wqkv, A_wo, B_x, B_w_gate, B_w_up, B_w_down):
    def _A_ref(x, wqkv, wo):
        B, S, D = x.shape
        H = 32; Dh = D // H
        W, dil = 8, 2
        qkv = (lambda x, *d: x.permute(*d))((x @ wqkv).reshape(B, S, 3, H, Dh), 2, 0, 3, 1, 4)
        q, k, v = qkv[0], qkv[1], qkv[2]
        scale = Dh ** -0.5
        pos = torch.arange(S)
        off = torch.arange(W) * dil
        idx = pos[:, None] - off[None, :]
        mask = idx >= 0
        idx_c = torch.where(mask, idx, 0).reshape(-1)
        kg = k[:, :, idx_c, :].reshape(B, H, S, W, Dh)
        vg = v[:, :, idx_c, :].reshape(B, H, S, W, Dh)
        logits = torch.einsum("bhsd,bhswd->bhsw", q, kg) * scale
        logits = torch.where(mask[None, None, :, :], logits, -1e9)
        attn = _softmax(logits, axis=-1)
        o = torch.einsum("bhsw,bhswd->bhsd", attn, vg)
        return (lambda x, *d: x.permute(*d))(o, 0, 2, 1, 3).reshape(B, S, D) @ wo

    def _B_ref(x, w_gate, w_up, w_down):
        g = torch.einsum("bsd,df->bsf", x, w_gate)
        u = torch.einsum("bsd,df->bsf", x, w_up)
        h = _sigmoid(g) * u
        return torch.einsum("bsf,fd->bsd", h, w_down)

    x = A_x
    xn = _layernorm(x, axis=-1)
    s = _A_ref(xn, A_wqkv, A_wo)
    g = _silu(_B_ref(xn, B_w_gate, B_w_up, B_w_down))
    return x + s * g
```

```asm
; @launch grid=(256,1,1) block=(256,1,1) lds=163840
.amdgcn_target "amdgcn-amd-amdhsa--gfx950"
.text
.globl recurrent_scan__sliding_local_dilated__glu_gated_glu__prompt_kernel
.p2align 8
.type recurrent_scan__sliding_local_dilated__glu_gated_glu__prompt_kernel,@function
recurrent_scan__sliding_local_dilated__glu_gated_glu__prompt_kernel:
L_code_beg:
  s_load_dwordx16 s[8:23], s[0:1], 0
  s_lshr_b32 s47, s2, 6
  s_cmp_ge_u32 s47, 4
  s_cbranch_scc1 L_exit
  v_lshrrev_b32 v2, 6, v0
  v_and_b32 v1, 63, v0
  s_lshr_b32 s59, s2, 3
  s_getpc_b64 s[6:7]
  v_lshrrev_b32 v0, 3, v0
  v_lshl_add_u32 v0, s59, 5, v0
  v_min_u32 v0, (L_code_end-L_code_beg-128)/128, v0
  v_lshlrev_b32 v0, 7, v0
  global_load_dword a255, v0, s[6:7]
  v_readfirstlane_b32 s44, v2
  s_and_b32 s58, s59, 7
  s_and_b32 s59, s2, 1
  s_lshl3_add_u32 s45, s59, s58
  s_and_b32 s60, s2, 2
  s_bitcmp1_b32 s2, 6
  s_addc_u32 s60, s60, 0
  s_cmp_eq_u32 s47, 3
  s_cselect_b32 s60, 3, s60
  s_lshl2_add_u32 s59, s45, s44
  s_lshl2_add_u32 s59, s59, s60
  s_mulk_i32 s59, 9216
  v_lshrrev_b32 v3, 3, v1
  v_mul_u32_u24 v3, 1152, v3
  v_and_b32 v4, 7, v1
  v_lshl_add_u32 v3, v4, 4, v3
  s_mov_b32 s30, 0x240000
  s_mov_b32 s31, 0x20000
  s_waitcnt lgkmcnt(0)
  s_mov_b64 s[28:29], s[8:9]
  buffer_load_dwordx4 v[76:79], v3, s[28:31], s59 offen offset:0
  buffer_load_dwordx4 v[80:83], v3, s[28:31], s59 offen offset:128
  buffer_load_dwordx4 v[84:87], v3, s[28:31], s59 offen offset:256
  buffer_load_dwordx4 v[88:91], v3, s[28:31], s59 offen offset:384
  buffer_load_dwordx4 v[92:95], v3, s[28:31], s59 offen offset:512
  buffer_load_dwordx4 v[96:99], v3, s[28:31], s59 offen offset:640
  buffer_load_dwordx4 v[100:103], v3, s[28:31], s59 offen offset:768
  buffer_load_dwordx4 v[104:107], v3, s[28:31], s59 offen offset:896
  buffer_load_dwordx4 v[108:111], v3, s[28:31], s59 offen offset:1024
  s_load_dwordx4 s[24:27], s[0:1], 64
  v_add_u32 v2, s59, v3
  s_mul_i32 s80, s58, 128
  s_add_u32 s81, s80, 128
  s_cmp_eq_u32 s81, 1152
  s_cselect_b32 s81, 0, s81
  s_add_u32 s82, s81, 128
  s_cmp_eq_u32 s82, 1152
  s_cselect_b32 s82, 0, s82
  s_add_u32 s83, s82, 128
  s_cmp_eq_u32 s83, 1152
  s_cselect_b32 s83, 0, s83
  s_add_u32 s84, s83, 128
  s_cmp_eq_u32 s84, 1152
  s_cselect_b32 s84, 0, s84
  s_add_u32 s85, s84, 128
  s_cmp_eq_u32 s85, 1152
  s_cselect_b32 s85, 0, s85
  s_add_u32 s86, s85, 128
  s_cmp_eq_u32 s86, 1152
  s_cselect_b32 s86, 0, s86
  s_add_u32 s87, s86, 128
  s_cmp_eq_u32 s87, 1152
  s_cselect_b32 s87, 0, s87
  s_add_u32 s88, s87, 128
  s_cmp_eq_u32 s88, 1152
  s_cselect_b32 s88, 0, s88
  s_sub_u32 s58, 9, s58
  s_lshl_b32 s89, s58, 11
  s_bfe_u32 s59, s2, 0x20001
  s_mov_b32 s48, 0x00003f80
  s_mov_b32 s3, 0xffff0000
  s_mov_b32 s49, 0x3f800000
  s_add_u32 s46, s59, 12
  s_cmp_eq_u32 s47, 3
  s_cbranch_scc1 L_apath
  s_mul_i32 s46, s59, 3
  s_add_u32 s46, s46, s47
  s_mov_b32 s47, s60
  s_and_b32 s59, s44, 1
  s_mul_i32 s60, s59, 294912
  s_mul_i32 s58, s46, 128
  s_add_u32 s60, s60, s58
  s_cmp_ge_u32 s44, 2
  s_cselect_b32 s52, s18, s16
  s_cselect_b32 s53, s19, s17
  s_add_u32 s52, s52, s60
  s_addc_u32 s53, s53, 0
  s_lshl_b32 s50, s44, 12
  s_lshr_b32 s61, s45, 3
  s_mul_i32 s61, s61, 3
  s_mul_i32 s71, s61, 1536
  s_mul_i32 s8, s80, 4608
  v_lshrrev_b32 v216, 3, v1
  v_and_b32 v217, 6, v216
  v_xor_b32 v217, v217, v1
  v_and_b32 v217, 7, v217
  v_and_b32 v218, 4, v216
  v_add_u32 v216, v216, v218
  v_mul_u32_u24 v216, 9216, v216
  v_lshl_add_u32 v9, v217, 4, v216
  v_add_u32 v10, 146432, v9
  v_add_u32 v11, 34816, v9
  v_add_u32 v12, 181248, v9
  s_lshl2_add_u32 s60, s45, s44
  s_xor_b32 s58, s47, 1
  s_lshl2_add_u32 s58, s60, s58
  s_mul_i32 s58, s58, 9216
  v_add_u32 v199, s58, v3
  s_xor_b32 s58, s47, 2
  s_lshl2_add_u32 s58, s60, s58
  s_mul_i32 s58, s58, 9216
  v_add_u32 v214, s58, v3
  s_xor_b32 s58, s47, 3
  s_lshl2_add_u32 s58, s60, s58
  s_mul_i32 s58, s58, 9216
  v_add_u32 v215, s58, v3
  v_lshrrev_b32 v216, 4, v1
  v_bfe_u32 v217, v1, 2, 2
  v_cmp_eq_u32 vcc, v216, v217
  v_mov_b32 v216, 0x3f803f80
  v_and_b32 v217, 1, v1
  v_cndmask_b32 v194, 0, v216, vcc
  v_lshlrev_b32 v217, 4, v217
  v_mov_b32 v216, 0xffff
  v_lshlrev_b32 v216, v217, v216
  v_and_b32 v216, v216, v194
  v_and_b32 v217, 2, v1
  v_cmp_eq_u32 vcc, 0, v217
  v_mov_b32 v195, v194
  v_mov_b32 v196, v194
  v_cndmask_b32 v190, 0, v216, vcc
  v_mov_b32 v197, v194
  v_xor_b32 v191, v216, v190
  v_mov_b32 v188, 0
  v_mov_b32 v189, 0
  v_mov_b32 v192, 0
  v_mov_b32 v193, 0
  s_mul_i32 s60, s44, 18432
  s_and_b32 s58, s47, 1
  s_lshl_b32 s58, s58, 7
  s_add_u32 s60, s60, s58
  s_add_u32 s60, s60, 16384
  s_and_b32 s61, s44, 2
  s_mul_i32 s61, s61, 18432
  s_add_u32 s61, s61, 16384
  v_lshrrev_b32 v216, 3, v1
  v_xor_b32 v216, v216, v1
  v_and_b32 v216, 7, v216
  v_and_b32 v217, 7, v1
  v_lshlrev_b32 v217, 8, v217
  v_lshl_add_u32 v216, v216, 4, v217
  v_add_u32 v3, s60, v216
  v_xor_b32 v4, 128, v3
  v_lshrrev_b32 v216, 4, v1
  v_xor_b32 v216, v216, v1
  v_lshl_add_u32 v5, v216, 4, s61
  v_xor_b32 v6, 64, v5
  s_mul_i32 s9, s81, 4608
  s_mul_i32 s10, s82, 4608
  s_mul_i32 s11, s83, 4608
  s_mul_i32 s12, s84, 4608
  s_mul_i32 s13, s85, 4608
  s_mul_i32 s14, s86, 4608
  s_mul_i32 s15, s87, 4608
  s_mul_i32 s16, s88, 4608
  s_and_b32 s60, s44, 1
  s_lshl_b32 s60, s60, 1
  v_bfe_u32 v216, v1, 3, 2
  v_xor_b32 v216, s60, v216
  v_lshlrev_b32 v216, 5, v216
  v_lshrrev_b32 v217, 2, v1
  v_lshl_add_u32 v216, v217, 7, v216
  v_and_b32 v217, 3, v1
  v_lshl_add_u32 v7, v217, 3, v216
  v_xor_b32 v8, 32, v7
  v_mov_b32 v200, 0
  v_mov_b32 v198, 0
  s_mov_b32 s70, 0x3f803f80
  s_cmp_eq_u32 s89, 18432
  s_cselect_b32 s89, 0, s89
  v_add_u32 v224, s89, v3
  s_add_u32 s89, s89, 2048
  s_cmp_eq_u32 s89, 18432
  s_cselect_b32 s89, 0, s89
  v_add_u32 v225, s89, v3
  s_add_u32 s89, s89, 2048
  s_cmp_eq_u32 s89, 18432
  s_cselect_b32 s89, 0, s89
  v_add_u32 v226, s89, v3
  s_add_u32 s89, s89, 2048
  s_cmp_eq_u32 s89, 18432
  s_cselect_b32 s89, 0, s89
  v_add_u32 v227, s89, v3
  s_add_u32 s89, s89, 2048
  s_cmp_eq_u32 s89, 18432
  s_cselect_b32 s89, 0, s89
  v_add_u32 v228, s89, v3
  s_add_u32 s89, s89, 2048
  s_cmp_eq_u32 s89, 18432
  s_cselect_b32 s89, 0, s89
  v_add_u32 v229, s89, v3
  s_add_u32 s89, s89, 2048
  s_cmp_eq_u32 s89, 18432
  s_cselect_b32 s89, 0, s89
  v_add_u32 v230, s89, v3
  s_add_u32 s89, s89, 2048
  s_cmp_eq_u32 s89, 18432
  s_cselect_b32 s89, 0, s89
  v_add_u32 v231, s89, v3
  s_add_u32 s89, s89, 2048
  s_cmp_eq_u32 s89, 18432
  s_cselect_b32 s89, 0, s89
  v_add_u32 v232, s89, v3
  s_and_b32 s58, s47, 1
  s_lshl2_add_u32 s58, s44, s58
  s_lshl_b32 s58, s58, 5
  s_add_u32 s58, s58, 81920
  v_lshrrev_b32 v216, 3, v1
  v_lshl_add_u32 v212, v216, 2, s58
  v_xor_b32 v213, 32, v212
  v_and_b32 v218, 15, v1
  s_lshr_b32 s58, s44, 1
  s_lshl_b32 s58, s58, 8
  s_add_u32 s58, s58, 81920
  v_lshl_add_u32 v218, v218, 2, s58
  s_add_u32 s72, s71, 1536
  s_cmp_eq_u32 s72, 9216
  s_cselect_b32 s72, 0, s72
  s_add_u32 s73, s72, 1536
  s_cmp_eq_u32 s73, 9216
  s_cselect_b32 s73, 0, s73
  s_add_u32 s74, s73, 1536
  s_cmp_eq_u32 s74, 9216
  s_cselect_b32 s74, 0, s74
  s_add_u32 s75, s74, 1536
  s_cmp_eq_u32 s75, 9216
  s_cselect_b32 s75, 0, s75
  s_add_u32 s76, s75, 1536
  s_cmp_eq_u32 s76, 9216
  s_cselect_b32 s76, 0, s76
  s_cmp_ge_u32 s44, 2
  s_cselect_b32 s77, s72, s71
  s_cselect_b32 s78, s74, s73
  s_cselect_b32 s79, s76, s75
  s_mul_i32 s77, s77, 576
  s_mul_i32 s78, s78, 576
  s_mul_i32 s79, s79, 576
  s_lshr_b32 s58, s44, 1
  s_lshl_b32 s58, s58, 12
  s_add_u32 s58, s58, 65536
  v_lshl_add_u32 v14, v1, 4, s58
  s_and_b32 s59, s44, 1
  s_lshl_b32 s60, s59, 13
  v_add_u32 v13, s60, v14
  v_bfe_u32 v216, v1, 4, 1
  v_lshl_add_u32 v13, v216, 3, v13
  s_mul_i32 s61, s46, 2
  s_add_u32 s61, s61, s59
  s_mul_i32 s61, s61, 36864
  s_add_u32 s54, s20, s61
  s_addc_u32 s55, s21, 0
  s_waitcnt lgkmcnt(0)
  s_mov_b32 s40, s26
  s_and_b32 s41, s27, 0xffff
  s_mov_b32 s42, 0x10000000
  s_mov_b32 s43, 0x20000
  s_mov_b32 s32, s22
  s_and_b32 s33, s23, 0xffff
  s_mov_b32 s34, 0x240000
  s_mov_b32 s35, 0x20000
  s_mov_b32 s36, s24
  s_and_b32 s37, s25, 0xffff
  s_mov_b32 s38, 0x100
  s_mov_b32 s39, 0x20000
  s_lshl2_add_u32 s58, s45, s44
  s_lshl_b32 s58, s58, 7
  s_add_u32 s58, s58, 41943040
  v_lshrrev_b32 v15, 0, v1
  v_min_u32 v15, 1, v15
  v_lshl_add_u32 v15, v15, 15, v1
  v_lshl_add_u32 v15, v15, 13, s58
  s_lshr_b32 s58, s44, 1
  s_lshl1_add_u32 s58, s45, s58
  s_mul_i32 s58, s58, 72
  s_add_u32 s58, s58, s59
  s_lshl4_add_u32 s58, s58, s46
  s_lshl_b32 s67, s58, 10
  s_lshr_b32 s58, s47, 1
  s_mul_i32 s58, s58, 294912
  s_add_u32 s59, s67, s58
  v_lshl_add_u32 v184, v1, 4, s59
  s_sub_u32 s59, s67, s58
  s_add_u32 s59, s59, 294912
  v_lshl_add_u32 v185, v1, 4, s59
  v_add_u32 v186, 589824, v184
  v_add_u32 v187, 589824, v185
  v_lshrrev_b32 v216, 3, v1
  v_and_b32 v217, 6, v216
  v_xor_b32 v217, v217, v1
  v_and_b32 v217, 7, v217
  v_mul_u32_u24 v216, 1152, v216
  v_lshl_add_u32 v220, v217, 4, v216
  v_add_u32 v221, 8192, v220
  v_add_u32 v222, 16384, v220
  v_add_u32 v223, 24576, v220
  v_lshrrev_b32 v216, 5, v1
  v_mul_u32_u24 v216, 18432, v216
  v_add_u32 v220, v220, v216
  v_add_u32 v221, v221, v216
  v_sub_u32 v222, v222, v216
  v_sub_u32 v223, v223, v216
  s_lshr_b32 s58, s46, 1
  s_lshl3_add_u32 s58, s45, s58
  s_mul_i32 s22, s58, 294912
  s_and_b32 s59, s44, 1
  s_lshr_b32 s60, s44, 1
  s_lshl_b32 s58, s59, 5
  s_add_u32 s58, s58, s60
  s_and_b32 s23, s46, 1
  s_lshl2_add_u32 s58, s58, s23
  s_lshl_b32 s58, s58, 7
  s_add_u32 s22, s22, s58
  s_lshl4_add_u32 s58, s45, s46
  s_mul_i32 s23, s58, 9216
  s_lshl2_add_u32 s60, s59, s60
  s_lshl4_add_u32 s23, s60, s23
  s_lshr_b32 s58, s58, 2
  s_and_b32 s58, s58, 62
  s_add_u32 s58, s58, s59
  s_lshl_b32 s24, s58, 7
  s_add_u32 s24, s24, 41943040
  s_bfe_u32 s58, s46, 0x18001
  s_lshl1_add_u32 s58, s59, s58
  s_lshl2_add_u32 s58, s45, s58
  s_lshl_b32 s58, s58, 7
  s_and_b32 s60, s46, 12
  s_add_u32 s58, s58, s60
  s_add_u32 s25, s58, 41951196
  s_mul_i32 s64, s85, 256
  s_mul_i32 s65, s86, 256
  s_mul_i32 s66, s87, 256
  s_mul_i32 s67, s88, 256
  s_add_u32 s68, s50, 32768
  s_mov_b32 s19, s50
  s_mov_b32 s69, s81
  s_mov_b32 s17, 60
  s_mov_b32 s18, 0
  buffer_load_dwordx4 v[112:115], v199, s[28:31], s80 offen
  buffer_load_dwordx4 v[116:119], v199, s[28:31], s81 offen
  buffer_load_dwordx4 v[120:123], v199, s[28:31], s82 offen
  s_waitcnt vmcnt(11)
  buffer_load_dwordx4 v[124:127], v199, s[28:31], s83 offen
  v_dot2c_f32_bf16 v200, s70, v76
  v_dot2c_f32_bf16 v198, v76, v76
  v_dot2c_f32_bf16 v200, s70, v77
  v_dot2c_f32_bf16 v198, v77, v77
  v_dot2c_f32_bf16 v200, s70, v78
  v_dot2c_f32_bf16 v198, v78, v78
  v_dot2c_f32_bf16 v200, s70, v79
  v_dot2c_f32_bf16 v198, v79, v79
  s_waitcnt vmcnt(11)
  buffer_load_dwordx4 v[128:131], v199, s[28:31], s84 offen
  v_dot2c_f32_bf16 v200, s70, v80
  v_dot2c_f32_bf16 v198, v80, v80
  v_dot2c_f32_bf16 v200, s70, v81
  v_dot2c_f32_bf16 v198, v81, v81
  v_dot2c_f32_bf16 v200, s70, v82
  v_dot2c_f32_bf16 v198, v82, v82
  v_dot2c_f32_bf16 v200, s70, v83
  v_dot2c_f32_bf16 v198, v83, v83
  s_waitcnt vmcnt(11)
  buffer_load_dwordx4 v[132:135], v199, s[28:31], s85 offen
  v_dot2c_f32_bf16 v200, s70, v84
  v_dot2c_f32_bf16 v198, v84, v84
  v_dot2c_f32_bf16 v200, s70, v85
  v_dot2c_f32_bf16 v198, v85, v85
  v_dot2c_f32_bf16 v200, s70, v86
  v_dot2c_f32_bf16 v198, v86, v86
  v_dot2c_f32_bf16 v200, s70, v87
  v_dot2c_f32_bf16 v198, v87, v87
  s_waitcnt vmcnt(11)
  buffer_load_dwordx4 v[136:139], v199, s[28:31], s86 offen
  v_dot2c_f32_bf16 v200, s70, v88
  v_dot2c_f32_bf16 v198, v88, v88
  v_dot2c_f32_bf16 v200, s70, v89
  v_dot2c_f32_bf16 v198, v89, v89
  v_dot2c_f32_bf16 v200, s70, v90
  v_dot2c_f32_bf16 v198, v90, v90
  v_dot2c_f32_bf16 v200, s70, v91
  v_dot2c_f32_bf16 v198, v91, v91
  s_waitcnt vmcnt(11)
  buffer_load_dwordx4 v[140:143], v199, s[28:31], s87 offen
  v_dot2c_f32_bf16 v200, s70, v92
  v_dot2c_f32_bf16 v198, v92, v92
  v_dot2c_f32_bf16 v200, s70, v93
  v_dot2c_f32_bf16 v198, v93, v93
  v_dot2c_f32_bf16 v200, s70, v94
  v_dot2c_f32_bf16 v198, v94, v94
  v_dot2c_f32_bf16 v200, s70, v95
  v_dot2c_f32_bf16 v198, v95, v95
  s_waitcnt vmcnt(11)
  buffer_load_dwordx4 v[144:147], v199, s[28:31], s88 offen
  v_dot2c_f32_bf16 v200, s70, v96
  v_dot2c_f32_bf16 v198, v96, v96
  v_dot2c_f32_bf16 v200, s70, v97
  v_dot2c_f32_bf16 v198, v97, v97
  v_dot2c_f32_bf16 v200, s70, v98
  v_dot2c_f32_bf16 v198, v98, v98
  v_dot2c_f32_bf16 v200, s70, v99
  v_dot2c_f32_bf16 v198, v99, v99
  s_waitcnt vmcnt(11)
  buffer_load_dwordx4 v[148:151], v214, s[28:31], s80 offen
  v_dot2c_f32_bf16 v200, s70, v100
  v_dot2c_f32_bf16 v198, v100, v100
  v_dot2c_f32_bf16 v200, s70, v101
  v_dot2c_f32_bf16 v198, v101, v101
  v_dot2c_f32_bf16 v200, s70, v102
  v_dot2c_f32_bf16 v198, v102, v102
  v_dot2c_f32_bf16 v200, s70, v103
  v_dot2c_f32_bf16 v198, v103, v103
  s_waitcnt vmcnt(11)
  buffer_load_dwordx4 v[152:155], v214, s[28:31], s81 offen
  v_dot2c_f32_bf16 v200, s70, v104
  v_dot2c_f32_bf16 v198, v104, v104
  v_dot2c_f32_bf16 v200, s70, v105
  v_dot2c_f32_bf16 v198, v105, v105
  v_dot2c_f32_bf16 v200, s70, v106
  v_dot2c_f32_bf16 v198, v106, v106
  v_dot2c_f32_bf16 v200, s70, v107
  v_dot2c_f32_bf16 v198, v107, v107
  s_waitcnt vmcnt(11)
  buffer_load_dwordx4 v[156:159], v214, s[28:31], s82 offen
  v_dot2c_f32_bf16 v200, s70, v108
  v_dot2c_f32_bf16 v198, v108, v108
  v_dot2c_f32_bf16 v200, s70, v109
  v_dot2c_f32_bf16 v198, v109, v109
  v_dot2c_f32_bf16 v200, s70, v110
  v_dot2c_f32_bf16 v198, v110, v110
  v_dot2c_f32_bf16 v200, s70, v111
  v_dot2c_f32_bf16 v198, v111, v111
  s_nop 1
  v_add_f32_dpp v200, v200, v200 quad_perm:[1,0,3,2] row_mask:0xf bank_mask:0xf
  s_nop 1
  v_add_f32_dpp v200, v200, v200 quad_perm:[2,3,0,1] row_mask:0xf bank_mask:0xf
  s_nop 1
  v_add_f32_dpp v200, v200, v200 row_half_mirror row_mask:0xf bank_mask:0xf
  v_mul_f32 v200, 0xbae38e39, v200
  v_cvt_pk_bf16_f32 v201, v200, v200
  v_lshlrev_b32 v208, 16, v201
  v_lshlrev_b32 v209, 16, v201
  v_lshlrev_b32 v210, 16, v201
  v_lshlrev_b32 v211, 16, v201
  v_mul_f32 v219, v200, v200
  s_nop 0
  v_mfma_f32_16x16x32_bf16 v[16:19], v[190:193], v[76:79], v[208:211]
  s_nop 0
  s_nop 0
  v_mfma_f32_16x16x32_bf16 v[20:23], v[188:191], v[76:79], v[208:211]
  s_nop 0
  s_nop 0
  v_mfma_f32_16x16x32_bf16 v[24:27], v[190:193], v[80:83], v[208:211]
  s_nop 0
  s_nop 0
  v_mfma_f32_16x16x32_bf16 v[28:31], v[188:191], v[80:83], v[208:211]
  s_nop 0
  v_mfma_f32_16x16x32_bf16 v[32:35], v[190:193], v[84:87], v[208:211]
  v_cvt_pk_bf16_f32 v76, v16, v17
  v_cvt_pk_bf16_f32 v77, v18, v19
  v_mfma_f32_16x16x32_bf16 v[36:39], v[188:191], v[84:87], v[208:211]
  v_cvt_pk_bf16_f32 v78, v20, v21
  s_waitcnt vmcnt(11)
  v_mfma_f32_16x16x32_bf16 v[200:203], v[194:197], v[112:115], 0
  buffer_load_dwordx4 v[160:163], v214, s[28:31], s83 offen
  v_cvt_pk_bf16_f32 v79, v22, v23
  v_mfma_f32_16x16x32_bf16 v[16:19], v[190:193], v[88:91], v[208:211]
  ds_write_b128 v224, v[76:79]
  v_cvt_pk_bf16_f32 v80, v24, v25
  v_cvt_pk_bf16_f32 v81, v26, v27
  v_mfma_f32_16x16x32_bf16 v[20:23], v[188:191], v[88:91], v[208:211]
  v_cvt_pk_bf16_f32 v82, v28, v29
  s_waitcnt vmcnt(11)
  v_mfma_f32_16x16x32_bf16 v[200:203], v[194:197], v[116:119], v[200:203]
  buffer_load_dwordx4 v[164:167], v214, s[28:31], s84 offen
  v_cvt_pk_bf16_f32 v83, v30, v31
  v_mfma_f32_16x16x32_bf16 v[24:27], v[190:193], v[92:95], v[208:211]
  ds_write_b128 v225, v[80:83]
  v_cvt_pk_bf16_f32 v84, v32, v33
  v_cvt_pk_bf16_f32 v85, v34, v35
  v_mfma_f32_16x16x32_bf16 v[28:31], v[188:191], v[92:95], v[208:211]
  v_cvt_pk_bf16_f32 v86, v36, v37
  s_waitcnt vmcnt(11)
  v_mfma_f32_16x16x32_bf16 v[200:203], v[194:197], v[120:123], v[200:203]
  buffer_load_dwordx4 v[168:171], v214, s[28:31], s85 offen
  v_cvt_pk_bf16_f32 v87, v38, v39
  v_mfma_f32_16x16x32_bf16 v[32:35], v[190:193], v[96:99], v[208:211]
  ds_write_b128 v226, v[84:87]
  v_cvt_pk_bf16_f32 v88, v16, v17
  v_cvt_pk_bf16_f32 v89, v18, v19
  v_mfma_f32_16x16x32_bf16 v[36:39], v[188:191], v[96:99], v[208:211]
  v_cvt_pk_bf16_f32 v90, v20, v21
  s_waitcnt vmcnt(11)
  v_mfma_f32_16x16x32_bf16 v[200:203], v[194:197], v[124:127], v[200:203]
  buffer_load_dwordx4 v[172:175], v214, s[28:31], s86 offen
  v_cvt_pk_bf16_f32 v91, v22, v23
  v_mfma_f32_16x16x32_bf16 v[16:19], v[190:193], v[100:103], v[208:211]
  ds_write_b128 v227, v[88:91]
  v_cvt_pk_bf16_f32 v92, v24, v25
  v_cvt_pk_bf16_f32 v93, v26, v27
  v_mfma_f32_16x16x32_bf16 v[20:23], v[188:191], v[100:103], v[208:211]
  v_cvt_pk_bf16_f32 v94, v28, v29
  s_waitcnt vmcnt(11)
  v_mfma_f32_16x16x32_bf16 v[200:203], v[194:197], v[128:131], v[200:203]
  buffer_load_dwordx4 v[176:179], v214, s[28:31], s87 offen
  v_cvt_pk_bf16_f32 v95, v30, v31
  v_mfma_f32_16x16x32_bf16 v[24:27], v[190:193], v[104:107], v[208:211]
  ds_write_b128 v228, v[92:95]
  v_cvt_pk_bf16_f32 v96, v32, v33
  v_cvt_pk_bf16_f32 v97, v34, v35
  v_mfma_f32_16x16x32_bf16 v[28:31], v[188:191], v[104:107], v[208:211]
  v_cvt_pk_bf16_f32 v98, v36, v37
  s_waitcnt vmcnt(11)
  v_mfma_f32_16x16x32_bf16 v[200:203], v[194:197], v[132:135], v[200:203]
  buffer_load_dwordx4 v[180:183], v214, s[28:31], s88 offen
  v_cvt_pk_bf16_f32 v99, v38, v39
  v_mfma_f32_16x16x32_bf16 v[32:35], v[190:193], v[108:111], v[208:211]
  ds_write_b128 v229, v[96:99]
  v_cvt_pk_bf16_f32 v100, v16, v17
  v_cvt_pk_bf16_f32 v101, v18, v19
  v_mfma_f32_16x16x32_bf16 v[36:39], v[188:191], v[108:111], v[208:211]
  v_cvt_pk_bf16_f32 v102, v20, v21
  s_waitcnt vmcnt(11)
  v_mfma_f32_16x16x32_bf16 v[200:203], v[194:197], v[136:139], v[200:203]
  buffer_load_dwordx4 v[40:43], v215, s[28:31], s80 offen
  v_cvt_pk_bf16_f32 v103, v22, v23
  ds_write_b128 v230, v[100:103]
  v_cvt_pk_bf16_f32 v104, v24, v25
  v_cvt_pk_bf16_f32 v105, v26, v27
  v_cvt_pk_bf16_f32 v106, v28, v29
  s_waitcnt vmcnt(11)
  v_mfma_f32_16x16x32_bf16 v[200:203], v[194:197], v[140:143], v[200:203]
  buffer_load_dwordx4 v[44:47], v215, s[28:31], s81 offen
  v_cvt_pk_bf16_f32 v107, v30, v31
  ds_write_b128 v231, v[104:107]
  v_cvt_pk_bf16_f32 v108, v32, v33
  v_cvt_pk_bf16_f32 v109, v34, v35
  v_cvt_pk_bf16_f32 v110, v36, v37
  s_waitcnt vmcnt(11)
  v_mfma_f32_16x16x32_bf16 v[200:203], v[194:197], v[144:147], v[200:203]
  buffer_load_dwordx4 v[48:51], v215, s[28:31], s82 offen
  v_cvt_pk_bf16_f32 v111, v38, v39
  ds_write_b128 v232, v[108:111]
  s_nop 4
  v_add_f32_dpp v200, v200, v200 quad_perm:[1,0,3,2] row_mask:0xf bank_mask:0xf
  s_nop 1
  v_add_f32_dpp v198, v198, v198 quad_perm:[1,0,3,2] row_mask:0xf bank_mask:0xf
  s_nop 0
  v_add_f32_dpp v200, v200, v200 quad_perm:[2,3,0,1] row_mask:0xf bank_mask:0xf
  v_add_f32_dpp v198, v198, v198 quad_perm:[2,3,0,1] row_mask:0xf bank_mask:0xf
  s_nop 0
  v_add_f32_dpp v200, v200, v200 row_half_mirror row_mask:0xf bank_mask:0xf
  v_add_f32_dpp v198, v198, v198 row_half_mirror row_mask:0xf bank_mask:0xf
  v_mul_f32 v200, 0xbae38e39, v200
  v_mul_f32 v198, 0x3ae38e39, v198
  v_cvt_pk_bf16_f32 v201, v200, v200
  v_sub_f32 v198, v198, v219
  v_lshlrev_b32 v208, 16, v201
  v_lshlrev_b32 v209, 16, v201
  v_lshlrev_b32 v210, 16, v201
  v_lshlrev_b32 v211, 16, v201
  v_sub_f32 v219, v208, v200
  s_nop 0
  v_mfma_f32_16x16x32_bf16 v[16:19], v[190:193], v[112:115], v[208:211]
  v_max_f32 v204, 0, v198
  v_cvt_pk_bf16_f32 v204, v204, v204
  v_lshlrev_b32 v204, 16, v204
  v_mfma_f32_16x16x32_bf16 v[20:23], v[188:191], v[112:115], v[208:211]
  v_add_f32 v204, 0x3727c5ac, v204
  v_cvt_pk_bf16_f32 v204, v204, v204
  v_lshlrev_b32 v204, 16, v204
  v_mfma_f32_16x16x32_bf16 v[24:27], v[190:193], v[116:119], v[208:211]
  v_sqrt_f32 v204, v204
  s_nop 0
  v_cvt_pk_bf16_f32 v204, v204, v204
  v_mfma_f32_16x16x32_bf16 v[28:31], v[188:191], v[116:119], v[208:211]
  v_lshlrev_b32 v204, 16, v204
  v_mfma_f32_16x16x32_bf16 v[32:35], v[190:193], v[120:123], v[208:211]
  v_cvt_pk_bf16_f32 v112, v16, v17
  v_cvt_pk_bf16_f32 v113, v18, v19
  v_mfma_f32_16x16x32_bf16 v[36:39], v[188:191], v[120:123], v[208:211]
  v_cvt_pk_bf16_f32 v114, v20, v21
  s_waitcnt vmcnt(11)
  v_mfma_f32_16x16x32_bf16 v[200:203], v[194:197], v[148:151], 0
  buffer_load_dwordx4 v[52:55], v215, s[28:31], s83 offen
  v_cvt_pk_bf16_f32 v115, v22, v23
  v_mfma_f32_16x16x32_bf16 v[16:19], v[190:193], v[124:127], v[208:211]
  ds_write_b128 v4, v[112:115] offset:0
  v_cvt_pk_bf16_f32 v116, v24, v25
  v_cvt_pk_bf16_f32 v117, v26, v27
  v_mfma_f32_16x16x32_bf16 v[20:23], v[188:191], v[124:127], v[208:211]
  v_cvt_pk_bf16_f32 v118, v28, v29
  s_waitcnt vmcnt(11)
  v_mfma_f32_16x16x32_bf16 v[200:203], v[194:197], v[152:155], v[200:203]
  buffer_load_dwordx4 v[56:59], v215, s[28:31], s84 offen
  v_cvt_pk_bf16_f32 v119, v30, v31
  v_mfma_f32_16x16x32_bf16 v[24:27], v[190:193], v[128:131], v[208:211]
  ds_write_b128 v4, v[116:119] offset:2048
  v_cvt_pk_bf16_f32 v120, v32, v33
  v_cvt_pk_bf16_f32 v121, v34, v35
  v_mfma_f32_16x16x32_bf16 v[28:31], v[188:191], v[128:131], v[208:211]
  v_cvt_pk_bf16_f32 v122, v36, v37
  s_waitcnt vmcnt(11)
  v_mfma_f32_16x16x32_bf16 v[200:203], v[194:197], v[156:159], v[200:203]
  buffer_load_dwordx4 v[60:63], v215, s[28:31], s85 offen
  v_cvt_pk_bf16_f32 v123, v38, v39
  v_mfma_f32_16x16x32_bf16 v[32:35], v[190:193], v[132:135], v[208:211]
  ds_write_b128 v4, v[120:123] offset:4096
  v_cvt_pk_bf16_f32 v124, v16, v17
  v_cvt_pk_bf16_f32 v125, v18, v19
  v_mfma_f32_16x16x32_bf16 v[36:39], v[188:191], v[132:135], v[208:211]
  v_cvt_pk_bf16_f32 v126, v20, v21
  s_waitcnt vmcnt(11)
  v_mfma_f32_16x16x32_bf16 v[200:203], v[194:197], v[160:163], v[200:203]
  buffer_load_dwordx4 v[64:67], v215, s[28:31], s86 offen
  v_cvt_pk_bf16_f32 v127, v22, v23
  v_mfma_f32_16x16x32_bf16 v[16:19], v[190:193], v[136:139], v[208:211]
  ds_write_b128 v4, v[124:127] offset:6144
  v_cvt_pk_bf16_f32 v128, v24, v25
  v_cvt_pk_bf16_f32 v129, v26, v27
  v_mfma_f32_16x16x32_bf16 v[20:23], v[188:191], v[136:139], v[208:211]
  v_cvt_pk_bf16_f32 v130, v28, v29
  s_waitcnt vmcnt(11)
  v_mfma_f32_16x16x32_bf16 v[200:203], v[194:197], v[164:167], v[200:203]
  buffer_load_dwordx4 v[68:71], v215, s[28:31], s87 offen
  v_cvt_pk_bf16_f32 v131, v30, v31
  v_mfma_f32_16x16x32_bf16 v[24:27], v[190:193], v[140:143], v[208:211]
  ds_write_b128 v4, v[128:131] offset:8192
  v_cvt_pk_bf16_f32 v132, v32, v33
  v_cvt_pk_bf16_f32 v133, v34, v35
  v_mfma_f32_16x16x32_bf16 v[28:31], v[188:191], v[140:143], v[208:211]
  v_cvt_pk_bf16_f32 v134, v36, v37
  s_waitcnt vmcnt(11)
  v_mfma_f32_16x16x32_bf16 v[200:203], v[194:197], v[168:171], v[200:203]
  buffer_load_dwordx4 v[72:75], v215, s[28:31], s88 offen
  v_cvt_pk_bf16_f32 v135, v38, v39
  v_mfma_f32_16x16x32_bf16 v[32:35], v[190:193], v[144:147], v[208:211]
  ds_write_b128 v4, v[132:135] offset:10240
  v_cvt_pk_bf16_f32 v136, v16, v17
  v_cvt_pk_bf16_f32 v137, v18, v19
  v_mfma_f32_16x16x32_bf16 v[36:39], v[188:191], v[144:147], v[208:211]
  v_cvt_pk_bf16_f32 v138, v20, v21
  s_waitcnt vmcnt(11)
  v_mfma_f32_16x16x32_bf16 v[200:203], v[194:197], v[172:175], v[200:203]
  v_cvt_pk_bf16_f32 v139, v22, v23
  ds_write_b128 v4, v[136:139] offset:12288
  v_cvt_pk_bf16_f32 v140, v24, v25
  v_cvt_pk_bf16_f32 v141, v26, v27
  v_cvt_pk_bf16_f32 v142, v28, v29
  s_waitcnt vmcnt(10)
  v_mfma_f32_16x16x32_bf16 v[200:203], v[194:197], v[176:179], v[200:203]
  v_cvt_pk_bf16_f32 v143, v30, v31
  ds_write_b128 v4, v[140:143] offset:14336
  v_cvt_pk_bf16_f32 v144, v32, v33
  v_cvt_pk_bf16_f32 v145, v34, v35
  v_cvt_pk_bf16_f32 v146, v36, v37
  s_waitcnt vmcnt(9)
  v_mfma_f32_16x16x32_bf16 v[200:203], v[194:197], v[180:183], v[200:203]
  v_cvt_pk_bf16_f32 v147, v38, v39
  ds_write_b128 v4, v[144:147] offset:16384
  s_add_u32 m0, s50, 0
  s_add_u32 s62, s52, s71
  s_addc_u32 s63, s53, 0
  s_add_u32 s56, s62, s8
  s_addc_u32 s57, s63, 0
  global_load_lds_dwordx4 v9, s[56:57] offset:0
  v_mul_f32 v219, v219, v219
  v_mov_b32 v198, 0
  v_dot2c_f32_bf16 v198, v112, v112
  v_dot2c_f32_bf16 v198, v113, v113
  v_dot2c_f32_bf16 v198, v114, v114
  v_dot2c_f32_bf16 v198, v115, v115
  v_dot2c_f32_bf16 v198, v116, v116
  v_dot2c_f32_bf16 v198, v117, v117
  v_dot2c_f32_bf16 v198, v118, v118
  global_load_lds_dwordx4 v10, s[56:57] offset:1024
  v_dot2c_f32_bf16 v198, v119, v119
  v_dot2c_f32_bf16 v198, v120, v120
  v_dot2c_f32_bf16 v198, v121, v121
  v_dot2c_f32_bf16 v198, v122, v122
  v_dot2c_f32_bf16 v198, v123, v123
  v_dot2c_f32_bf16 v198, v124, v124
  v_dot2c_f32_bf16 v198, v125, v125
  v_dot2c_f32_bf16 v198, v126, v126
  v_dot2c_f32_bf16 v198, v127, v127
  v_dot2c_f32_bf16 v198, v128, v128
  global_load_lds_dwordx4 v11, s[56:57] offset:2048
  v_dot2c_f32_bf16 v198, v129, v129
  v_dot2c_f32_bf16 v198, v130, v130
  v_dot2c_f32_bf16 v198, v131, v131
  v_dot2c_f32_bf16 v198, v132, v132
  v_dot2c_f32_bf16 v198, v133, v133
  v_dot2c_f32_bf16 v198, v134, v134
  v_dot2c_f32_bf16 v198, v135, v135
  v_dot2c_f32_bf16 v198, v136, v136
  v_dot2c_f32_bf16 v198, v137, v137
  global_load_lds_dwordx4 v12, s[56:57] offset:3072
  v_dot2c_f32_bf16 v198, v138, v138
  v_dot2c_f32_bf16 v198, v139, v139
  v_dot2c_f32_bf16 v198, v140, v140
  v_dot2c_f32_bf16 v198, v141, v141
  v_dot2c_f32_bf16 v198, v142, v142
  v_dot2c_f32_bf16 v198, v143, v143
  v_dot2c_f32_bf16 v198, v144, v144
  v_dot2c_f32_bf16 v198, v145, v145
  v_dot2c_f32_bf16 v198, v146, v146
  v_dot2c_f32_bf16 v198, v147, v147
  v_add_u32 v3, 73728, v3
  v_add_u32 v4, 73728, v4
  s_waitcnt lgkmcnt(0)
  s_barrier
  v_add_f32_dpp v200, v200, v200 quad_perm:[1,0,3,2] row_mask:0xf bank_mask:0xf
  s_nop 1
  v_add_f32_dpp v198, v198, v198 quad_perm:[1,0,3,2] row_mask:0xf bank_mask:0xf
  s_nop 0
  v_add_f32_dpp v200, v200, v200 quad_perm:[2,3,0,1] row_mask:0xf bank_mask:0xf
  v_add_f32_dpp v198, v198, v198 quad_perm:[2,3,0,1] row_mask:0xf bank_mask:0xf
  s_nop 0
  v_add_f32_dpp v200, v200, v200 row_half_mirror row_mask:0xf bank_mask:0xf
  v_add_f32_dpp v198, v198, v198 row_half_mirror row_mask:0xf bank_mask:0xf
  v_mul_f32 v200, 0xbae38e39, v200
  v_mul_f32 v198, 0x3ae38e39, v198
  v_cvt_pk_bf16_f32 v201, v200, v200
  v_sub_f32 v198, v198, v219
  v_lshlrev_b32 v208, 16, v201
  v_lshlrev_b32 v209, 16, v201
  v_lshlrev_b32 v210, 16, v201
  v_lshlrev_b32 v211, 16, v201
  v_sub_f32 v219, v208, v200
  s_nop 0
  v_mfma_f32_16x16x32_bf16 v[16:19], v[190:193], v[148:151], v[208:211]
  v_max_f32 v205, 0, v198
  v_cvt_pk_bf16_f32 v205, v205, v205
  v_lshlrev_b32 v205, 16, v205
  v_mfma_f32_16x16x32_bf16 v[20:23], v[188:191], v[148:151], v[208:211]
  v_add_f32 v205, 0x3727c5ac, v205
  v_cvt_pk_bf16_f32 v205, v205, v205
  v_lshlrev_b32 v205, 16, v205
  v_mfma_f32_16x16x32_bf16 v[24:27], v[190:193], v[152:155], v[208:211]
  v_sqrt_f32 v205, v205
  s_nop 0
  v_cvt_pk_bf16_f32 v205, v205, v205
  v_mfma_f32_16x16x32_bf16 v[28:31], v[188:191], v[152:155], v[208:211]
  v_lshlrev_b32 v205, 16, v205
  v_mfma_f32_16x16x32_bf16 v[32:35], v[190:193], v[156:159], v[208:211]
  v_cvt_pk_bf16_f32 v148, v16, v17
  v_cvt_pk_bf16_f32 v149, v18, v19
  v_mfma_f32_16x16x32_bf16 v[36:39], v[188:191], v[156:159], v[208:211]
  ds_read_b128 a[0:3], v5 offset:0
  ds_read_b128 a[8:11], v5 offset:18432
  v_cvt_pk_bf16_f32 v150, v20, v21
  s_waitcnt vmcnt(12)
  v_mfma_f32_16x16x32_bf16 v[200:203], v[194:197], v[40:43], 0
  ds_read_b128 a[16:19], v6 offset:1024
  ds_read_b128 a[24:27], v6 offset:19456
  v_cvt_pk_bf16_f32 v151, v22, v23
  v_mfma_f32_16x16x32_bf16 v[16:19], v[190:193], v[160:163], v[208:211]
  ds_write_b128 v3, v[148:151] offset:0
  v_cvt_pk_bf16_f32 v152, v24, v25
  v_cvt_pk_bf16_f32 v153, v26, v27
  v_mfma_f32_16x16x32_bf16 v[20:23], v[188:191], v[160:163], v[208:211]
  ds_read_b128 a[32:35], v5 offset:2048
  ds_read_b128 a[40:43], v5 offset:20480
  v_cvt_pk_bf16_f32 v154, v28, v29
  s_waitcnt vmcnt(11)
  v_mfma_f32_16x16x32_bf16 v[200:203], v[194:197], v[44:47], v[200:203]
  ds_read_b128 a[48:51], v6 offset:3072
  ds_read_b128 a[56:59], v6 offset:21504
  v_cvt_pk_bf16_f32 v155, v30, v31
  v_mfma_f32_16x16x32_bf16 v[24:27], v[190:193], v[164:167], v[208:211]
  ds_write_b128 v3, v[152:155] offset:2048
  v_cvt_pk_bf16_f32 v156, v32, v33
  v_cvt_pk_bf16_f32 v157, v34, v35
  v_mfma_f32_16x16x32_bf16 v[28:31], v[188:191], v[164:167], v[208:211]
  ds_read_b128 a[64:67], v5 offset:4096
  ds_read_b128 a[72:75], v5 offset:22528
  v_cvt_pk_bf16_f32 v158, v36, v37
  s_waitcnt vmcnt(10)
  v_mfma_f32_16x16x32_bf16 v[200:203], v[194:197], v[48:51], v[200:203]
  ds_read_b128 a[80:83], v6 offset:5120
  ds_read_b128 a[88:91], v6 offset:23552
  v_cvt_pk_bf16_f32 v159, v38, v39
  v_mfma_f32_16x16x32_bf16 v[32:35], v[190:193], v[168:171], v[208:211]
  ds_write_b128 v3, v[156:159] offset:4096
  v_cvt_pk_bf16_f32 v160, v16, v17
  v_cvt_pk_bf16_f32 v161, v18, v19
  v_mfma_f32_16x16x32_bf16 v[36:39], v[188:191], v[168:171], v[208:211]
  ds_read_b128 a[96:99], v5 offset:6144
  ds_read_b128 a[104:107], v5 offset:24576
  v_cvt_pk_bf16_f32 v162, v20, v21
  s_waitcnt vmcnt(9)
  v_mfma_f32_16x16x32_bf16 v[200:203], v[194:197], v[52:55], v[200:203]
  ds_read_b128 a[112:115], v6 offset:7168
  ds_read_b128 a[120:123], v6 offset:25600
  v_cvt_pk_bf16_f32 v163, v22, v23
  v_mfma_f32_16x16x32_bf16 v[16:19], v[190:193], v[172:175], v[208:211]
  ds_write_b128 v3, v[160:163] offset:6144
  v_cvt_pk_bf16_f32 v164, v24, v25
  v_cvt_pk_bf16_f32 v165, v26, v27
  v_mfma_f32_16x16x32_bf16 v[20:23], v[188:191], v[172:175], v[208:211]
  ds_read_b128 a[128:131], v5 offset:8192
  ds_read_b128 a[136:139], v5 offset:26624
  v_cvt_pk_bf16_f32 v166, v28, v29
  s_waitcnt vmcnt(8)
  v_mfma_f32_16x16x32_bf16 v[200:203], v[194:197], v[56:59], v[200:203]
  ds_read_b128 a[144:147], v6 offset:9216
  ds_read_b128 a[152:155], v6 offset:27648
  v_cvt_pk_bf16_f32 v167, v30, v31
  v_mfma_f32_16x16x32_bf16 v[24:27], v[190:193], v[176:179], v[208:211]
  ds_write_b128 v3, v[164:167] offset:8192
  v_cvt_pk_bf16_f32 v168, v32, v33
  v_cvt_pk_bf16_f32 v169, v34, v35
  v_mfma_f32_16x16x32_bf16 v[28:31], v[188:191], v[176:179], v[208:211]
  ds_read_b128 a[160:163], v5 offset:10240
  ds_read_b128 a[168:171], v5 offset:28672
  v_cvt_pk_bf16_f32 v170, v36, v37
  s_waitcnt vmcnt(7)
  v_mfma_f32_16x16x32_bf16 v[200:203], v[194:197], v[60:63], v[200:203]
  ds_read_b128 a[176:179], v6 offset:11264
  ds_read_b128 a[184:187], v6 offset:29696
  v_cvt_pk_bf16_f32 v171, v38, v39
  v_mfma_f32_16x16x32_bf16 v[32:35], v[190:193], v[180:183], v[208:211]
  ds_write_b128 v3, v[168:171] offset:10240
  v_cvt_pk_bf16_f32 v172, v16, v17
  v_cvt_pk_bf16_f32 v173, v18, v19
  v_mfma_f32_16x16x32_bf16 v[36:39], v[188:191], v[180:183], v[208:211]
  ds_read_b128 a[192:195], v5 offset:12288
  ds_read_b128 a[200:203], v5 offset:30720
  v_cvt_pk_bf16_f32 v174, v20, v21
  s_waitcnt vmcnt(6)
  v_mfma_f32_16x16x32_bf16 v[200:203], v[194:197], v[64:67], v[200:203]
  ds_read_b128 a[208:211], v6 offset:13312
  ds_read_b128 a[216:219], v6 offset:31744
  v_cvt_pk_bf16_f32 v175, v22, v23
  ds_write_b128 v3, v[172:175] offset:12288
  v_cvt_pk_bf16_f32 v176, v24, v25
  v_cvt_pk_bf16_f32 v177, v26, v27
  ds_read_b128 a[224:227], v5 offset:14336
  ds_read_b128 a[232:235], v5 offset:32768
  v_cvt_pk_bf16_f32 v178, v28, v29
  s_waitcnt vmcnt(5)
  v_mfma_f32_16x16x32_bf16 v[200:203], v[194:197], v[68:71], v[200:203]
  ds_read_b128 a[240:243], v6 offset:15360
  ds_read_b128 a[248:251], v6 offset:33792
  v_cvt_pk_bf16_f32 v179, v30, v31
  ds_write_b128 v3, v[176:179] offset:14336
  v_cvt_pk_bf16_f32 v180, v32, v33
  v_cvt_pk_bf16_f32 v181, v34, v35
  ds_read_b128 v[224:227], v5 offset:16384
  ds_read_b128 v[232:235], v5 offset:34816
  v_cvt_pk_bf16_f32 v182, v36, v37
  s_waitcnt vmcnt(4)
  v_mfma_f32_16x16x32_bf16 v[200:203], v[194:197], v[72:75], v[200:203]
  ds_read_b128 v[240:243], v6 offset:17408
  ds_read_b128 v[248:251], v6 offset:35840
  v_cvt_pk_bf16_f32 v183, v38, v39
  ds_write_b128 v3, v[180:183] offset:16384
  v_mul_f32 v219, v219, v219
  v_mov_b32 v198, 0
  v_dot2c_f32_bf16 v198, v148, v148
  v_dot2c_f32_bf16 v198, v149, v149
  v_dot2c_f32_bf16 v198, v150, v150
  v_dot2c_f32_bf16 v198, v151, v151
  v_dot2c_f32_bf16 v198, v152, v152
  v_dot2c_f32_bf16 v198, v153, v153
  v_dot2c_f32_bf16 v198, v154, v154
  v_dot2c_f32_bf16 v198, v155, v155
  v_dot2c_f32_bf16 v198, v156, v156
  v_dot2c_f32_bf16 v198, v157, v157
  v_dot2c_f32_bf16 v198, v158, v158
  v_dot2c_f32_bf16 v198, v159, v159
  v_dot2c_f32_bf16 v198, v160, v160
  v_dot2c_f32_bf16 v198, v161, v161
  v_dot2c_f32_bf16 v198, v162, v162
  v_dot2c_f32_bf16 v198, v163, v163
  v_dot2c_f32_bf16 v198, v164, v164
  v_dot2c_f32_bf16 v198, v165, v165
  v_dot2c_f32_bf16 v198, v166, v166
  v_dot2c_f32_bf16 v198, v167, v167
  v_dot2c_f32_bf16 v198, v168, v168
  v_dot2c_f32_bf16 v198, v169, v169
  v_dot2c_f32_bf16 v198, v170, v170
  v_dot2c_f32_bf16 v198, v171, v171
  v_dot2c_f32_bf16 v198, v172, v172
  v_dot2c_f32_bf16 v198, v173, v173
  v_dot2c_f32_bf16 v198, v174, v174
  v_dot2c_f32_bf16 v198, v175, v175
  v_dot2c_f32_bf16 v198, v176, v176
  v_dot2c_f32_bf16 v198, v177, v177
  v_dot2c_f32_bf16 v198, v178, v178
  v_dot2c_f32_bf16 v198, v179, v179
  v_dot2c_f32_bf16 v198, v180, v180
  v_dot2c_f32_bf16 v198, v181, v181
  v_dot2c_f32_bf16 v198, v182, v182
  v_dot2c_f32_bf16 v198, v183, v183
  v_add_u32 v5, 73728, v5
  v_add_u32 v6, 73728, v6
  s_waitcnt lgkmcnt(0)
  s_barrier
  s_add_u32 m0, s50, 16384
  s_add_u32 s56, s62, s9
  s_addc_u32 s57, s63, 0
  global_load_lds_dwordx4 v9, s[56:57] offset:0
  v_add_f32_dpp v200, v200, v200 quad_perm:[1,0,3,2] row_mask:0xf bank_mask:0xf
  s_nop 1
  v_add_f32_dpp v198, v198, v198 quad_perm:[1,0,3,2] row_mask:0xf bank_mask:0xf
  s_nop 0
  v_add_f32_dpp v200, v200, v200 quad_perm:[2,3,0,1] row_mask:0xf bank_mask:0xf
  v_add_f32_dpp v198, v198, v198 quad_perm:[2,3,0,1] row_mask:0xf bank_mask:0xf
  s_nop 0
  v_add_f32_dpp v200, v200, v200 row_half_mirror row_mask:0xf bank_mask:0xf
  v_add_f32_dpp v198, v198, v198 row_half_mirror row_mask:0xf bank_mask:0xf
  v_mul_f32 v200, 0xbae38e39, v200
  v_mul_f32 v198, 0x3ae38e39, v198
  v_cvt_pk_bf16_f32 v201, v200, v200
  v_sub_f32 v198, v198, v219
  v_lshlrev_b32 v208, 16, v201
  v_lshlrev_b32 v209, 16, v201
  v_lshlrev_b32 v210, 16, v201
  v_lshlrev_b32 v211, 16, v201
  v_sub_f32 v219, v208, v200
  s_nop 0
  v_mfma_f32_16x16x32_bf16 v[16:19], v[190:193], v[40:43], v[208:211]
  v_max_f32 v206, 0, v198
  v_cvt_pk_bf16_f32 v206, v206, v206
  v_lshlrev_b32 v206, 16, v206
  v_mfma_f32_16x16x32_bf16 v[20:23], v[188:191], v[40:43], v[208:211]
  v_add_f32 v206, 0x3727c5ac, v206
  v_cvt_pk_bf16_f32 v206, v206, v206
  v_lshlrev_b32 v206, 16, v206
  v_mfma_f32_16x16x32_bf16 v[24:27], v[190:193], v[44:47], v[208:211]
  v_sqrt_f32 v206, v206
  s_nop 0
  v_cvt_pk_bf16_f32 v206, v206, v206
  v_mfma_f32_16x16x32_bf16 v[28:31], v[188:191], v[44:47], v[208:211]
  v_lshlrev_b32 v206, 16, v206
  v_mfma_f32_16x16x32_bf16 v[32:35], v[190:193], v[48:51], v[208:211]
  v_cvt_pk_bf16_f32 v40, v16, v17
  v_cvt_pk_bf16_f32 v41, v18, v19
  v_mfma_f32_16x16x32_bf16 v[36:39], v[188:191], v[48:51], v[208:211]
  v_cvt_pk_bf16_f32 v42, v20, v21
  global_load_lds_dwordx4 v10, s[56:57] offset:1024
  v_cvt_pk_bf16_f32 v43, v22, v23
  v_mfma_f32_16x16x32_bf16 v[16:19], v[190:193], v[52:55], v[208:211]
  ds_write_b128 v4, v[40:43] offset:0
  v_cvt_pk_bf16_f32 v44, v24, v25
  v_cvt_pk_bf16_f32 v45, v26, v27
  v_mfma_f32_16x16x32_bf16 v[20:23], v[188:191], v[52:55], v[208:211]
  v_cvt_pk_bf16_f32 v46, v28, v29
  global_load_lds_dwordx4 v11, s[56:57] offset:2048
  v_cvt_pk_bf16_f32 v47, v30, v31
  v_mfma_f32_16x16x32_bf16 v[24:27], v[190:193], v[56:59], v[208:211]
  ds_write_b128 v4, v[44:47] offset:2048
  v_cvt_pk_bf16_f32 v48, v32, v33
  v_cvt_pk_bf16_f32 v49, v34, v35
  v_mfma_f32_16x16x32_bf16 v[28:31], v[188:191], v[56:59], v[208:211]
  v_cvt_pk_bf16_f32 v50, v36, v37
  global_load_lds_dwordx4 v12, s[56:57] offset:3072
  v_cvt_pk_bf16_f32 v51, v38, v39
  v_mfma_f32_16x16x32_bf16 v[32:35], v[190:193], v[60:63], v[208:211]
  ds_write_b128 v4, v[48:51] offset:4096
  v_cvt_pk_bf16_f32 v52, v16, v17
  v_cvt_pk_bf16_f32 v53, v18, v19
  v_mfma_f32_16x16x32_bf16 v[36:39], v[188:191], v[60:63], v[208:211]
  v_cvt_pk_bf16_f32 v54, v20, v21
  s_add_u32 m0, s50, 32768
  s_add_u32 s56, s62, s10
  s_addc_u32 s57, s63, 0
  global_load_lds_dwordx4 v9, s[56:57] offset:0
  v_cvt_pk_bf16_f32 v55, v22, v23
  v_mfma_f32_16x16x32_bf16 v[16:19], v[190:193], v[64:67], v[208:211]
  ds_write_b128 v4, v[52:55] offset:6144
  v_cvt_pk_bf16_f32 v56, v24, v25
  v_cvt_pk_bf16_f32 v57, v26, v27
  v_mfma_f32_16x16x32_bf16 v[20:23], v[188:191], v[64:67], v[208:211]
  v_cvt_pk_bf16_f32 v58, v28, v29
  global_load_lds_dwordx4 v10, s[56:57] offset:1024
  v_cvt_pk_bf16_f32 v59, v30, v31
  v_mfma_f32_16x16x32_bf16 v[24:27], v[190:193], v[68:71], v[208:211]
  ds_write_b128 v4, v[56:59] offset:8192
  v_cvt_pk_bf16_f32 v60, v32, v33
  v_cvt_pk_bf16_f32 v61, v34, v35
  v_mfma_f32_16x16x32_bf16 v[28:31], v[188:191], v[68:71], v[208:211]
  v_cvt_pk_bf16_f32 v62, v36, v37
  global_load_lds_dwordx4 v11, s[56:57] offset:2048
  v_cvt_pk_bf16_f32 v63, v38, v39
  v_mfma_f32_16x16x32_bf16 v[32:35], v[190:193], v[72:75], v[208:211]
  ds_write_b128 v4, v[60:63] offset:10240
  v_cvt_pk_bf16_f32 v64, v16, v17
  v_cvt_pk_bf16_f32 v65, v18, v19
  v_mfma_f32_16x16x32_bf16 v[36:39], v[188:191], v[72:75], v[208:211]
  v_cvt_pk_bf16_f32 v66, v20, v21
  global_load_lds_dwordx4 v12, s[56:57] offset:3072
  v_cvt_pk_bf16_f32 v67, v22, v23
  ds_write_b128 v4, v[64:67] offset:12288
  v_cvt_pk_bf16_f32 v68, v24, v25
  v_cvt_pk_bf16_f32 v69, v26, v27
  v_cvt_pk_bf16_f32 v70, v28, v29
  v_cvt_pk_bf16_f32 v71, v30, v31
  ds_write_b128 v4, v[68:71] offset:14336
  v_cvt_pk_bf16_f32 v72, v32, v33
  v_cvt_pk_bf16_f32 v73, v34, v35
  v_cvt_pk_bf16_f32 v74, v36, v37
  v_cvt_pk_bf16_f32 v75, v38, v39
  ds_write_b128 v4, v[72:75] offset:16384
  v_mul_f32 v219, v219, v219
  v_mov_b32 v198, 0
  v_dot2c_f32_bf16 v198, v40, v40
  v_dot2c_f32_bf16 v198, v41, v41
  v_dot2c_f32_bf16 v198, v42, v42
  v_dot2c_f32_bf16 v198, v43, v43
  v_dot2c_f32_bf16 v198, v44, v44
  v_dot2c_f32_bf16 v198, v45, v45
  v_dot2c_f32_bf16 v198, v46, v46
  v_dot2c_f32_bf16 v198, v47, v47
  v_dot2c_f32_bf16 v198, v48, v48
  v_dot2c_f32_bf16 v198, v49, v49
  v_dot2c_f32_bf16 v198, v50, v50
  v_dot2c_f32_bf16 v198, v51, v51
  s_waitcnt vmcnt(8) lgkmcnt(0)
  s_barrier
  ds_read_b64_tr_b16 v[16:17], v7 offset:0
  v_dot2c_f32_bf16 v198, v52, v52
  ds_read_b64_tr_b16 v[18:19], v7 offset:2048
  v_dot2c_f32_bf16 v198, v53, v53
  ds_read_b64_tr_b16 v[20:21], v7 offset:4096
  v_dot2c_f32_bf16 v198, v54, v54
  ds_read_b64_tr_b16 v[22:23], v7 offset:6144
  v_dot2c_f32_bf16 v198, v55, v55
  ds_read_b128 a[4:7], v5 offset:0
  v_dot2c_f32_bf16 v198, v56, v56
  ds_read_b128 a[12:15], v5 offset:18432
  v_dot2c_f32_bf16 v198, v57, v57
  ds_read_b128 a[20:23], v6 offset:1024
  v_dot2c_f32_bf16 v198, v58, v58
  ds_read_b128 a[28:31], v6 offset:19456
  v_dot2c_f32_bf16 v198, v59, v59
  ds_read_b64_tr_b16 v[24:25], v8 offset:0
  v_dot2c_f32_bf16 v198, v60, v60
  ds_read_b64_tr_b16 v[26:27], v8 offset:2048
  v_dot2c_f32_bf16 v198, v61, v61
  ds_read_b64_tr_b16 v[28:29], v8 offset:4096
  v_dot2c_f32_bf16 v198, v62, v62
  ds_read_b64_tr_b16 v[30:31], v8 offset:6144
  v_dot2c_f32_bf16 v198, v63, v63
  v_dot2c_f32_bf16 v198, v64, v64
  v_dot2c_f32_bf16 v198, v65, v65
  v_dot2c_f32_bf16 v198, v66, v66
  v_dot2c_f32_bf16 v198, v67, v67
  v_dot2c_f32_bf16 v198, v68, v68
  v_dot2c_f32_bf16 v198, v69, v69
  v_dot2c_f32_bf16 v198, v70, v70
  v_dot2c_f32_bf16 v198, v71, v71
  v_dot2c_f32_bf16 v198, v72, v72
  v_dot2c_f32_bf16 v198, v73, v73
  v_dot2c_f32_bf16 v198, v74, v74
  v_dot2c_f32_bf16 v198, v75, v75
  s_waitcnt lgkmcnt(4)
  v_mfma_f32_16x16x32_bf16 v[40:43], v[16:19], a[0:3], 0
  ds_read_b64_tr_b16 v[32:33], v7 offset:8192
  s_add_u32 m0, s50, 49152
  v_mfma_f32_16x16x32_bf16 v[40:43], v[20:23], a[16:19], v[40:43]
  ds_read_b64_tr_b16 v[34:35], v7 offset:10240
  s_add_u32 s56, s62, s11
  v_mfma_f32_16x16x32_bf16 v[44:47], v[16:19], a[4:7], 0
  ds_read_b64_tr_b16 v[36:37], v7 offset:12288
  s_addc_u32 s57, s63, 0
  v_mfma_f32_16x16x32_bf16 v[44:47], v[20:23], a[20:23], v[44:47]
  ds_read_b64_tr_b16 v[38:39], v7 offset:14336
  v_add_f32_dpp v198, v198, v198 quad_perm:[1,0,3,2] row_mask:0xf bank_mask:0xf
  v_mfma_f32_16x16x32_bf16 v[48:51], v[16:19], a[8:11], 0
  global_load_lds_dwordx4 v9, s[56:57] offset:0
  v_mfma_f32_16x16x32_bf16 v[48:51], v[20:23], a[24:27], v[48:51]
  ds_read_b128 a[36:39], v5 offset:2048
  v_add_f32_dpp v198, v198, v198 quad_perm:[2,3,0,1] row_mask:0xf bank_mask:0xf
  v_mfma_f32_16x16x32_bf16 v[52:55], v[16:19], a[12:15], 0
  ds_read_b128 a[44:47], v5 offset:20480
  v_mfma_f32_16x16x32_bf16 v[52:55], v[20:23], a[28:31], v[52:55]
  global_load_lds_dwordx4 v10, s[56:57] offset:1024
  s_waitcnt lgkmcnt(6)
  v_mfma_f32_16x16x32_bf16 v[56:59], v[24:27], a[0:3], 0
  ds_read_b64_tr_b16 v[16:17], v8 offset:8192
  v_add_f32_dpp v198, v198, v198 row_half_mirror row_mask:0xf bank_mask:0xf
  v_mfma_f32_16x16x32_bf16 v[56:59], v[28:31], a[16:19], v[56:59]
  ds_read_b64_tr_b16 v[18:19], v8 offset:10240
  v_mfma_f32_16x16x32_bf16 v[60:63], v[24:27], a[4:7], 0
  ds_read_b64_tr_b16 v[20:21], v8 offset:12288
  v_mul_f32 v198, 0x3ae38e39, v198
  v_mfma_f32_16x16x32_bf16 v[60:63], v[28:31], a[20:23], v[60:63]
  ds_read_b64_tr_b16 v[22:23], v8 offset:14336
  v_mfma_f32_16x16x32_bf16 v[64:67], v[24:27], a[8:11], 0
  global_load_lds_dwordx4 v11, s[56:57] offset:2048
  v_sub_f32 v198, v198, v219
  v_mfma_f32_16x16x32_bf16 v[64:67], v[28:31], a[24:27], v[64:67]
  ds_read_b128 a[52:55], v6 offset:3072
  v_mfma_f32_16x16x32_bf16 v[68:71], v[24:27], a[12:15], 0
  ds_read_b128 a[60:63], v6 offset:21504
  v_max_f32 v207, 0, v198
  v_mfma_f32_16x16x32_bf16 v[68:71], v[28:31], a[28:31], v[68:71]
  global_load_lds_dwordx4 v12, s[56:57] offset:3072
  s_waitcnt lgkmcnt(8)
  v_mfma_f32_16x16x32_bf16 v[72:75], v[32:35], a[0:3], 0
  v_cvt_pk_bf16_f32 v207, v207, v207
  v_mfma_f32_16x16x32_bf16 v[72:75], v[36:39], a[16:19], v[72:75]
  s_waitcnt vmcnt(8) lgkmcnt(2)
  s_barrier
  v_mfma_f32_16x16x32_bf16 v[76:79], v[32:35], a[4:7], 0
  ds_read_b64_tr_b16 v[24:25], v7 offset:16384
  s_add_u32 m0, s50, 65536
  v_mfma_f32_16x16x32_bf16 v[76:79], v[36:39], a[20:23], v[76:79]
  ds_read_b64_tr_b16 v[26:27], v7 offset:18432
  s_add_u32 s56, s62, s12
  v_mfma_f32_16x16x32_bf16 v[80:83], v[32:35], a[8:11], 0
  ds_read_b64_tr_b16 v[28:29], v7 offset:20480
  s_addc_u32 s57, s63, 0
  v_mfma_f32_16x16x32_bf16 v[80:83], v[36:39], a[24:27], v[80:83]
  ds_read_b64_tr_b16 v[30:31], v7 offset:22528
  v_lshlrev_b32 v207, 16, v207
  v_mfma_f32_16x16x32_bf16 v[84:87], v[32:35], a[12:15], 0
  global_load_lds_dwordx4 v9, s[56:57] offset:0
  v_mfma_f32_16x16x32_bf16 v[84:87], v[36:39], a[28:31], v[84:87]
  v_mfma_f32_16x16x32_bf16 v[88:91], v[16:19], a[0:3], 0
  ds_read_b64_tr_b16 v[32:33], v8 offset:16384
  v_add_f32 v207, 0x3727c5ac, v207
  v_mfma_f32_16x16x32_bf16 v[88:91], v[20:23], a[16:19], v[88:91]
  ds_read_b64_tr_b16 v[34:35], v8 offset:18432
  v_mfma_f32_16x16x32_bf16 v[92:95], v[16:19], a[4:7], 0
  ds_read_b64_tr_b16 v[36:37], v8 offset:20480
  v_cvt_pk_bf16_f32 v207, v207, v207
  v_mfma_f32_16x16x32_bf16 v[92:95], v[20:23], a[20:23], v[92:95]
  ds_read_b64_tr_b16 v[38:39], v8 offset:22528
  v_mfma_f32_16x16x32_bf16 v[96:99], v[16:19], a[8:11], 0
  v_mfma_f32_16x16x32_bf16 v[96:99], v[20:23], a[24:27], v[96:99]
  global_load_lds_dwordx4 v10, s[56:57] offset:1024
  v_lshlrev_b32 v207, 16, v207
  v_mfma_f32_16x16x32_bf16 v[100:103], v[16:19], a[12:15], 0
  v_mfma_f32_16x16x32_bf16 v[100:103], v[20:23], a[28:31], v[100:103]
  v_sqrt_f32 v207, v207
  s_waitcnt lgkmcnt(4)
  v_mfma_f32_16x16x32_bf16 v[40:43], v[24:27], a[32:35], v[40:43]
  ds_read_b64_tr_b16 v[16:17], v7 offset:24576
  v_mfma_f32_16x16x32_bf16 v[40:43], v[28:31], a[48:51], v[40:43]
  ds_read_b64_tr_b16 v[18:19], v7 offset:26624
  v_cvt_pk_bf16_f32 v207, v207, v207
  v_mfma_f32_16x16x32_bf16 v[44:47], v[24:27], a[36:39], v[44:47]
  ds_read_b64_tr_b16 v[20:21], v7 offset:28672
  v_mfma_f32_16x16x32_bf16 v[44:47], v[28:31], a[52:55], v[44:47]
  ds_read_b64_tr_b16 v[22:23], v7 offset:30720
  v_lshlrev_b32 v207, 16, v207
  v_mfma_f32_16x16x32_bf16 v[48:51], v[24:27], a[40:43], v[48:51]
  global_load_lds_dwordx4 v11, s[56:57] offset:2048
  v_mfma_f32_16x16x32_bf16 v[48:51], v[28:31], a[56:59], v[48:51]
  ds_read_b128 a[68:71], v5 offset:4096
  v_mfma_f32_16x16x32_bf16 v[52:55], v[24:27], a[44:47], v[52:55]
  ds_read_b128 a[76:79], v5 offset:22528
  v_mfma_f32_16x16x32_bf16 v[52:55], v[28:31], a[60:63], v[52:55]
  s_waitcnt lgkmcnt(6)
  v_mfma_f32_16x16x32_bf16 v[56:59], v[32:35], a[32:35], v[56:59]
  ds_read_b64_tr_b16 v[24:25], v8 offset:24576
  v_mfma_f32_16x16x32_bf16 v[56:59], v[36:39], a[48:51], v[56:59]
  ds_read_b64_tr_b16 v[26:27], v8 offset:26624
  global_load_lds_dwordx4 v12, s[56:57] offset:3072
  v_mfma_f32_16x16x32_bf16 v[60:63], v[32:35], a[36:39], v[60:63]
  ds_read_b64_tr_b16 v[28:29], v8 offset:28672
  s_add_u32 m0, s50, 0
  v_mfma_f32_16x16x32_bf16 v[60:63], v[36:39], a[52:55], v[60:63]
  ds_read_b64_tr_b16 v[30:31], v8 offset:30720
  s_add_u32 s56, s62, s13
  v_mfma_f32_16x16x32_bf16 v[64:67], v[32:35], a[40:43], v[64:67]
  ds_read_b128 a[84:87], v6 offset:5120
  s_addc_u32 s57, s63, 0
  v_mfma_f32_16x16x32_bf16 v[64:67], v[36:39], a[56:59], v[64:67]
  ds_read_b128 a[92:95], v6 offset:23552
  v_mfma_f32_16x16x32_bf16 v[68:71], v[32:35], a[44:47], v[68:71]
  ds_write_b32 v212, v204 offset:0
  v_mfma_f32_16x16x32_bf16 v[68:71], v[36:39], a[60:63], v[68:71]
  global_load_lds_dwordx4 v9, s[56:57] offset:0
  s_waitcnt lgkmcnt(9)
  v_mfma_f32_16x16x32_bf16 v[72:75], v[16:19], a[32:35], v[72:75]
  ds_write_b32 v213, v205 offset:0
  v_mfma_f32_16x16x32_bf16 v[72:75], v[20:23], a[48:51], v[72:75]
  s_waitcnt vmcnt(9) lgkmcnt(4)
  s_barrier
  v_mfma_f32_16x16x32_bf16 v[76:79], v[16:19], a[36:39], v[76:79]
  ds_read_b64_tr_b16 v[32:33], v7 offset:32768
  v_mfma_f32_16x16x32_bf16 v[76:79], v[20:23], a[52:55], v[76:79]
  ds_read_b64_tr_b16 v[34:35], v7 offset:34816
  v_mfma_f32_16x16x32_bf16 v[80:83], v[16:19], a[40:43], v[80:83]
  ds_read_b64_tr_b16 v[36:37], v7 offset:36864
  v_mfma_f32_16x16x32_bf16 v[80:83], v[20:23], a[56:59], v[80:83]
  ds_read_b64_tr_b16 v[38:39], v7 offset:38912
  v_mfma_f32_16x16x32_bf16 v[84:87], v[16:19], a[44:47], v[84:87]
  global_load_lds_dwordx4 v10, s[56:57] offset:1024
  v_mfma_f32_16x16x32_bf16 v[84:87], v[20:23], a[60:63], v[84:87]
  v_mfma_f32_16x16x32_bf16 v[88:91], v[24:27], a[32:35], v[88:91]
  ds_read_b64_tr_b16 v[16:17], v8 offset:32768
  v_mfma_f32_16x16x32_bf16 v[88:91], v[28:31], a[48:51], v[88:91]
  ds_read_b64_tr_b16 v[18:19], v8 offset:34816
  v_mfma_f32_16x16x32_bf16 v[92:95], v[24:27], a[36:39], v[92:95]
  ds_read_b64_tr_b16 v[20:21], v8 offset:36864
  v_mfma_f32_16x16x32_bf16 v[92:95], v[28:31], a[52:55], v[92:95]
  ds_read_b64_tr_b16 v[22:23], v8 offset:38912
  v_mfma_f32_16x16x32_bf16 v[96:99], v[24:27], a[40:43], v[96:99]
  ds_write_b32 v212, v206 offset:64
  v_mfma_f32_16x16x32_bf16 v[96:99], v[28:31], a[56:59], v[96:99]
  global_load_lds_dwordx4 v11, s[56:57] offset:2048
  v_mfma_f32_16x16x32_bf16 v[100:103], v[24:27], a[44:47], v[100:103]
  ds_write_b32 v213, v207 offset:64
  v_mfma_f32_16x16x32_bf16 v[100:103], v[28:31], a[60:63], v[100:103]
  s_waitcnt lgkmcnt(6)
  v_mfma_f32_16x16x32_bf16 v[40:43], v[32:35], a[64:67], v[40:43]
  ds_read_b64_tr_b16 v[24:25], v7 offset:40960
  v_add_u32 v2, 65536, v7
  v_mfma_f32_16x16x32_bf16 v[40:43], v[36:39], a[80:83], v[40:43]
  ds_read_b64_tr_b16 v[26:27], v7 offset:43008
  v_add_u32 v3, 65536, v8
  v_mfma_f32_16x16x32_bf16 v[44:47], v[32:35], a[68:71], v[44:47]
  ds_read_b64_tr_b16 v[28:29], v7 offset:45056
  v_mov_b32 v4, 1
  v_mfma_f32_16x16x32_bf16 v[44:47], v[36:39], a[84:87], v[44:47]
  ds_read_b64_tr_b16 v[30:31], v7 offset:47104
  v_add_u32 v215, 65536, v14
  v_mfma_f32_16x16x32_bf16 v[48:51], v[32:35], a[72:75], v[48:51]
  global_load_lds_dwordx4 v12, s[56:57] offset:3072
  v_and_b32 v216, 48, v1
  v_mfma_f32_16x16x32_bf16 v[48:51], v[36:39], a[88:91], v[48:51]
  ds_read_b128 a[100:103], v5 offset:6144
  v_lshlrev_b32 v216, 2, v216
  v_mfma_f32_16x16x32_bf16 v[52:55], v[32:35], a[76:79], v[52:55]
  ds_read_b128 a[108:111], v5 offset:24576
  v_lshrrev_b32 v195, 4, v1
  v_mfma_f32_16x16x32_bf16 v[52:55], v[36:39], a[92:95], v[52:55]
  s_add_u32 m0, s50, 16384
  s_waitcnt lgkmcnt(8)
  v_mfma_f32_16x16x32_bf16 v[56:59], v[16:19], a[64:67], v[56:59]
  ds_read_b64_tr_b16 v[32:33], v8 offset:40960
  s_add_u32 s56, s62, s14
  s_addc_u32 s57, s63, 0
  v_mfma_f32_16x16x32_bf16 v[56:59], v[20:23], a[80:83], v[56:59]
  ds_read_b64_tr_b16 v[34:35], v8 offset:43008
  global_load_lds_dwordx4 v9, s[56:57] offset:0
  v_mfma_f32_16x16x32_bf16 v[60:63], v[16:19], a[68:71], v[60:63]
  ds_read_b64_tr_b16 v[36:37], v8 offset:45056
  v_lshl_add_u32 v188, v195, 10, s22
  v_mfma_f32_16x16x32_bf16 v[60:63], v[20:23], a[84:87], v[60:63]
  ds_read_b64_tr_b16 v[38:39], v8 offset:47104
  v_bfe_u32 v194, v1, 3, 1
  v_mfma_f32_16x16x32_bf16 v[64:67], v[16:19], a[72:75], v[64:67]
  ds_read_b128 a[116:119], v6 offset:7168
  v_lshl_add_u32 v188, v194, 8, v188
  v_mfma_f32_16x16x32_bf16 v[64:67], v[20:23], a[88:91], v[64:67]
  ds_read_b128 a[124:127], v6 offset:25600
  v_lshl_add_u32 v191, v194, 3, s23
  v_mfma_f32_16x16x32_bf16 v[68:71], v[16:19], a[76:79], v[68:71]
  v_mfma_f32_16x16x32_bf16 v[68:71], v[20:23], a[92:95], v[68:71]
  global_load_lds_dwordx4 v10, s[56:57] offset:1024
  s_waitcnt lgkmcnt(8)
  v_mfma_f32_16x16x32_bf16 v[72:75], v[24:27], a[64:67], v[72:75]
  v_mfma_f32_16x16x32_bf16 v[72:75], v[28:31], a[80:83], v[72:75]
  s_waitcnt vmcnt(10) lgkmcnt(2)
  s_barrier
  v_mfma_f32_16x16x32_bf16 v[76:79], v[24:27], a[68:71], v[76:79]
  ds_read_b64_tr_b16 v[16:17], v7 offset:49152
  v_and_b32 v194, 7, v1
  v_mfma_f32_16x16x32_bf16 v[76:79], v[28:31], a[84:87], v[76:79]
  ds_read_b64_tr_b16 v[18:19], v7 offset:51200
  v_lshl_add_u32 v188, v194, 4, v188
  v_mfma_f32_16x16x32_bf16 v[80:83], v[24:27], a[72:75], v[80:83]
  ds_read_b64_tr_b16 v[20:21], v7 offset:53248
  v_mul_u32_u24 v194, 1152, v194
  v_mfma_f32_16x16x32_bf16 v[80:83], v[28:31], a[88:91], v[80:83]
  ds_read_b64_tr_b16 v[22:23], v7 offset:55296
  v_add_u32 v191, v191, v194
  v_mfma_f32_16x16x32_bf16 v[84:87], v[24:27], a[76:79], v[84:87]
  global_load_lds_dwordx4 v11, s[56:57] offset:2048
  v_and_b32 v194, 32, v1
  v_mfma_f32_16x16x32_bf16 v[84:87], v[28:31], a[92:95], v[84:87]
  v_mfma_f32_16x16x32_bf16 v[88:91], v[32:35], a[64:67], v[88:91]
  ds_read_b64_tr_b16 v[24:25], v8 offset:49152
  v_add_u32 v191, v191, v194
  v_mfma_f32_16x16x32_bf16 v[88:91], v[36:39], a[80:83], v[88:91]
  ds_read_b64_tr_b16 v[26:27], v8 offset:51200
  v_and_b32 v195, 1, v195
  v_mfma_f32_16x16x32_bf16 v[92:95], v[32:35], a[68:71], v[92:95]
  ds_read_b64_tr_b16 v[28:29], v8 offset:53248
  v_lshl_add_u32 v191, v195, 2, v191
  v_mfma_f32_16x16x32_bf16 v[92:95], v[36:39], a[84:87], v[92:95]
  ds_read_b64_tr_b16 v[30:31], v8 offset:55296
  v_add_u32 v192, 46137344, v191
  v_mfma_f32_16x16x32_bf16 v[96:99], v[32:35], a[72:75], v[96:99]
  v_mfma_f32_16x16x32_bf16 v[96:99], v[36:39], a[88:91], v[96:99]
  global_load_lds_dwordx4 v12, s[56:57] offset:3072
  v_add_u32 v189, 4096, v188
  v_mfma_f32_16x16x32_bf16 v[100:103], v[32:35], a[76:79], v[100:103]
  v_mfma_f32_16x16x32_bf16 v[100:103], v[36:39], a[92:95], v[100:103]
  s_add_u32 m0, s50, 32768
  s_waitcnt lgkmcnt(4)
  v_mfma_f32_16x16x32_bf16 v[40:43], v[16:19], a[96:99], v[40:43]
  ds_read_b64_tr_b16 v[32:33], v7 offset:57344
  s_add_u32 s56, s62, s15
  v_mfma_f32_16x16x32_bf16 v[40:43], v[20:23], a[112:115], v[40:43]
  ds_read_b64_tr_b16 v[34:35], v7 offset:59392
  s_addc_u32 s57, s63, 0
  v_mfma_f32_16x16x32_bf16 v[44:47], v[16:19], a[100:103], v[44:47]
  ds_read_b64_tr_b16 v[36:37], v7 offset:61440
  v_add_u32 v190, 8192, v188
  v_mfma_f32_16x16x32_bf16 v[44:47], v[20:23], a[116:119], v[44:47]
  ds_read_b64_tr_b16 v[38:39], v7 offset:63488
  v_cmp_eq_u32 vcc, 9, v1
  v_mfma_f32_16x16x32_bf16 v[48:51], v[16:19], a[104:107], v[48:51]
  global_load_lds_dwordx4 v9, s[56:57] offset:0
  v_mov_b32 v193, s24
  v_mfma_f32_16x16x32_bf16 v[48:51], v[20:23], a[120:123], v[48:51]
  ds_read_b128 a[132:135], v5 offset:8192
  v_mov_b32 v195, s25
  v_mfma_f32_16x16x32_bf16 v[52:55], v[16:19], a[108:111], v[52:55]
  ds_read_b128 a[140:143], v5 offset:26624
  v_cndmask_b32 v193, v193, v195, vcc
  v_mfma_f32_16x16x32_bf16 v[52:55], v[20:23], a[124:127], v[52:55]
  v_cndmask_b32 v194, 12, 1, vcc
  s_waitcnt lgkmcnt(6)
  v_mfma_f32_16x16x32_bf16 v[56:59], v[24:27], a[96:99], v[56:59]
  ds_read_b64_tr_b16 v[16:17], v8 offset:57344
  v_lshl_add_u32 v193, v1, 2, v193
  v_mfma_f32_16x16x32_bf16 v[56:59], v[28:31], a[112:115], v[56:59]
  ds_read_b64_tr_b16 v[18:19], v8 offset:59392
  global_load_lds_dwordx4 v10, s[56:57] offset:1024
  v_mfma_f32_16x16x32_bf16 v[60:63], v[24:27], a[100:103], v[60:63]
  ds_read_b64_tr_b16 v[20:21], v8 offset:61440
  v_add_u32 v195, 6, v1
  v_mfma_f32_16x16x32_bf16 v[60:63], v[28:31], a[116:119], v[60:63]
  ds_read_b64_tr_b16 v[22:23], v8 offset:63488
  v_lshrrev_b32 v195, 4, v195
  v_mfma_f32_16x16x32_bf16 v[64:67], v[24:27], a[104:107], v[64:67]
  ds_read_b128 a[148:151], v6 offset:9216
  v_lshl_or_b32 v193, v195, 28, v193
  v_mfma_f32_16x16x32_bf16 v[64:67], v[28:31], a[120:123], v[64:67]
  ds_read_b128 a[156:159], v6 offset:27648
  v_mfma_f32_16x16x32_bf16 v[68:71], v[24:27], a[108:111], v[68:71]
  v_mfma_f32_16x16x32_bf16 v[68:71], v[28:31], a[124:127], v[68:71]
  global_load_lds_dwordx4 v11, s[56:57] offset:2048
  s_waitcnt lgkmcnt(8)
  v_mfma_f32_16x16x32_bf16 v[72:75], v[32:35], a[96:99], v[72:75]
  buffer_load_dword v196, v191, s[28:31], s85 offen
  v_mfma_f32_16x16x32_bf16 v[72:75], v[36:39], a[112:115], v[72:75]
  s_waitcnt vmcnt(12) lgkmcnt(2)
  s_barrier
  v_mfma_f32_16x16x32_bf16 v[76:79], v[32:35], a[100:103], v[76:79]
  ds_read_b64_tr_b16 v[24:25], v2 offset:0
  v_mfma_f32_16x16x32_bf16 v[76:79], v[36:39], a[116:119], v[76:79]
  ds_read_b64_tr_b16 v[26:27], v2 offset:2048
  v_mfma_f32_16x16x32_bf16 v[80:83], v[32:35], a[104:107], v[80:83]
  ds_read_b64_tr_b16 v[28:29], v2 offset:4096
  v_mfma_f32_16x16x32_bf16 v[80:83], v[36:39], a[120:123], v[80:83]
  ds_read_b64_tr_b16 v[30:31], v2 offset:6144
  v_mfma_f32_16x16x32_bf16 v[84:87], v[32:35], a[108:111], v[84:87]
  global_load_lds_dwordx4 v12, s[56:57] offset:3072
  v_mfma_f32_16x16x32_bf16 v[84:87], v[36:39], a[124:127], v[84:87]
  buffer_load_dword v197, v191, s[28:31], s86 offen
  v_mfma_f32_16x16x32_bf16 v[88:91], v[16:19], a[96:99], v[88:91]
  ds_read_b64_tr_b16 v[32:33], v3 offset:0
  s_add_u32 m0, s50, 49152
  v_mfma_f32_16x16x32_bf16 v[88:91], v[20:23], a[112:115], v[88:91]
  ds_read_b64_tr_b16 v[34:35], v3 offset:2048
  s_add_u32 s56, s62, s16
  v_mfma_f32_16x16x32_bf16 v[92:95], v[16:19], a[100:103], v[92:95]
  ds_read_b64_tr_b16 v[36:37], v3 offset:4096
  s_addc_u32 s57, s63, 0
  v_mfma_f32_16x16x32_bf16 v[92:95], v[20:23], a[116:119], v[92:95]
  ds_read_b64_tr_b16 v[38:39], v3 offset:6144
  buffer_load_dword v198, v191, s[28:31], s87 offen
  v_mfma_f32_16x16x32_bf16 v[96:99], v[16:19], a[104:107], v[96:99]
  ds_read_b32 v180, v218 offset:0
  v_mfma_f32_16x16x32_bf16 v[96:99], v[20:23], a[120:123], v[96:99]
  global_load_lds_dwordx4 v9, s[56:57] offset:0
  v_mfma_f32_16x16x32_bf16 v[100:103], v[16:19], a[108:111], v[100:103]
  ds_read_b32 v181, v218 offset:64
  v_mfma_f32_16x16x32_bf16 v[100:103], v[20:23], a[124:127], v[100:103]
  ds_read_b32 v182, v218 offset:128
  s_waitcnt lgkmcnt(7)
  v_mfma_f32_16x16x32_bf16 v[40:43], v[24:27], a[128:131], v[40:43]
  ds_read_b64_tr_b16 v[16:17], v2 offset:8192
  buffer_load_dword v199, v191, s[28:31], s88 offen
  v_mfma_f32_16x16x32_bf16 v[40:43], v[28:31], a[144:147], v[40:43]
  ds_read_b64_tr_b16 v[18:19], v2 offset:10240
  v_mfma_f32_16x16x32_bf16 v[44:47], v[24:27], a[132:135], v[44:47]
  ds_read_b64_tr_b16 v[20:21], v2 offset:12288
  v_mfma_f32_16x16x32_bf16 v[44:47], v[28:31], a[148:151], v[44:47]
  ds_read_b64_tr_b16 v[22:23], v2 offset:14336
  v_mfma_f32_16x16x32_bf16 v[48:51], v[24:27], a[136:139], v[48:51]
  global_load_lds_dwordx4 v10, s[56:57] offset:1024
  v_mfma_f32_16x16x32_bf16 v[48:51], v[28:31], a[152:155], v[48:51]
  ds_read_b128 a[164:167], v5 offset:10240
  v_mfma_f32_16x16x32_bf16 v[52:55], v[24:27], a[140:143], v[52:55]
  ds_read_b128 a[172:175], v5 offset:28672
  v_mfma_f32_16x16x32_bf16 v[52:55], v[28:31], a[156:159], v[52:55]
  ds_read_b32 v183, v218 offset:192
  s_waitcnt lgkmcnt(10)
  v_mfma_f32_16x16x32_bf16 v[56:59], v[32:35], a[128:131], v[56:59]
  ds_read_b64_tr_b16 v[24:25], v3 offset:8192
  v_mfma_f32_16x16x32_bf16 v[56:59], v[36:39], a[144:147], v[56:59]
  ds_read_b64_tr_b16 v[26:27], v3 offset:10240
  global_load_lds_dwordx4 v11, s[56:57] offset:2048
  v_mfma_f32_16x16x32_bf16 v[60:63], v[32:35], a[132:135], v[60:63]
  ds_read_b64_tr_b16 v[28:29], v3 offset:12288
  v_mfma_f32_16x16x32_bf16 v[60:63], v[36:39], a[148:151], v[60:63]
  ds_read_b64_tr_b16 v[30:31], v3 offset:14336
  v_mfma_f32_16x16x32_bf16 v[64:67], v[32:35], a[136:139], v[64:67]
  ds_read_b128 a[180:183], v6 offset:11264
  v_mfma_f32_16x16x32_bf16 v[64:67], v[36:39], a[152:155], v[64:67]
  ds_read_b128 a[188:191], v6 offset:29696
  v_mfma_f32_16x16x32_bf16 v[68:71], v[32:35], a[140:143], v[68:71]
  v_mfma_f32_16x16x32_bf16 v[68:71], v[36:39], a[156:159], v[68:71]
  global_load_lds_dwordx4 v12, s[56:57] offset:3072
  s_waitcnt lgkmcnt(9)
  v_mfma_f32_16x16x32_bf16 v[72:75], v[16:19], a[128:131], v[72:75]
  v_mfma_f32_16x16x32_bf16 v[72:75], v[20:23], a[144:147], v[72:75]
  s_waitcnt vmcnt(16) lgkmcnt(2)
  s_barrier
  v_mfma_f32_16x16x32_bf16 v[76:79], v[16:19], a[132:135], v[76:79]
  ds_read_b64_tr_b16 v[32:33], v7 offset:0
  s_add_u32 m0, s50, 65536
  v_mfma_f32_16x16x32_bf16 v[76:79], v[20:23], a[148:151], v[76:79]
  ds_read_b64_tr_b16 v[34:35], v7 offset:2048
  s_add_u32 s62, s52, s72
  v_mfma_f32_16x16x32_bf16 v[80:83], v[16:19], a[136:139], v[80:83]
  ds_read_b64_tr_b16 v[36:37], v7 offset:4096
  s_addc_u32 s63, s53, 0
  v_mfma_f32_16x16x32_bf16 v[80:83], v[20:23], a[152:155], v[80:83]
  ds_read_b64_tr_b16 v[38:39], v7 offset:6144
  s_add_u32 s56, s62, s8
  v_mfma_f32_16x16x32_bf16 v[84:87], v[16:19], a[140:143], v[84:87]
  s_addc_u32 s57, s63, 0
  v_mfma_f32_16x16x32_bf16 v[84:87], v[20:23], a[156:159], v[84:87]
  global_load_lds_dwordx4 v9, s[56:57] offset:0
  v_mfma_f32_16x16x32_bf16 v[88:91], v[24:27], a[128:131], v[88:91]
  ds_read_b64_tr_b16 v[16:17], v8 offset:0
  v_mfma_f32_16x16x32_bf16 v[88:91], v[28:31], a[144:147], v[88:91]
  ds_read_b64_tr_b16 v[18:19], v8 offset:2048
  v_mfma_f32_16x16x32_bf16 v[92:95], v[24:27], a[132:135], v[92:95]
  ds_read_b64_tr_b16 v[20:21], v8 offset:4096
  v_mfma_f32_16x16x32_bf16 v[92:95], v[28:31], a[148:151], v[92:95]
  ds_read_b64_tr_b16 v[22:23], v8 offset:6144
  v_mfma_f32_16x16x32_bf16 v[96:99], v[24:27], a[136:139], v[96:99]
  v_mfma_f32_16x16x32_bf16 v[96:99], v[28:31], a[152:155], v[96:99]
  v_mfma_f32_16x16x32_bf16 v[100:103], v[24:27], a[140:143], v[100:103]
  v_mfma_f32_16x16x32_bf16 v[100:103], v[28:31], a[156:159], v[100:103]
  global_load_lds_dwordx4 v10, s[56:57] offset:1024
  s_waitcnt lgkmcnt(4)
  v_mfma_f32_16x16x32_bf16 v[40:43], v[32:35], a[160:163], v[40:43]
  ds_read_b64_tr_b16 v[24:25], v7 offset:8192
  v_rcp_f32 v176, v180
  v_mfma_f32_16x16x32_bf16 v[40:43], v[36:39], a[176:179], v[40:43]
  ds_read_b64_tr_b16 v[26:27], v7 offset:10240
  v_mfma_f32_16x16x32_bf16 v[44:47], v[32:35], a[164:167], v[44:47]
  ds_read_b64_tr_b16 v[28:29], v7 offset:12288
  v_mfma_f32_16x16x32_bf16 v[44:47], v[36:39], a[180:183], v[44:47]
  ds_read_b64_tr_b16 v[30:31], v7 offset:14336
  v_mfma_f32_16x16x32_bf16 v[48:51], v[32:35], a[168:171], v[48:51]
  ds_read_b128 a[196:199], v5 offset:12288
  v_mfma_f32_16x16x32_bf16 v[48:51], v[36:39], a[184:187], v[48:51]
  ds_read_b128 a[204:207], v5 offset:30720
  v_mfma_f32_16x16x32_bf16 v[52:55], v[32:35], a[172:175], v[52:55]
  ds_read_b128 a[212:215], v6 offset:13312
  v_mul_f32 v176, 0xbfb8aa3b, v176
  v_mfma_f32_16x16x32_bf16 v[52:55], v[36:39], a[188:191], v[52:55]
  global_load_lds_dwordx4 v11, s[56:57] offset:2048
  s_waitcnt lgkmcnt(7)
  v_mfma_f32_16x16x32_bf16 v[56:59], v[16:19], a[160:163], v[56:59]
  ds_read_b64_tr_b16 v[32:33], v8 offset:8192
  v_mfma_f32_16x16x32_bf16 v[56:59], v[20:23], a[176:179], v[56:59]
  ds_read_b64_tr_b16 v[34:35], v8 offset:10240
  v_mfma_f32_16x16x32_bf16 v[60:63], v[16:19], a[164:167], v[60:63]
  ds_read_b64_tr_b16 v[36:37], v8 offset:12288
  v_mfma_f32_16x16x32_bf16 v[60:63], v[20:23], a[180:183], v[60:63]
  ds_read_b64_tr_b16 v[38:39], v8 offset:14336
  v_mfma_f32_16x16x32_bf16 v[64:67], v[16:19], a[168:171], v[64:67]
  ds_read_b128 a[220:223], v6 offset:31744
  v_mfma_f32_16x16x32_bf16 v[64:67], v[20:23], a[184:187], v[64:67]
  v_rcp_f32 v177, v181
  v_mfma_f32_16x16x32_bf16 v[68:71], v[16:19], a[172:175], v[68:71]
  v_mfma_f32_16x16x32_bf16 v[68:71], v[20:23], a[188:191], v[68:71]
  global_load_lds_dwordx4 v12, s[56:57] offset:3072
  s_waitcnt lgkmcnt(8)
  v_mfma_f32_16x16x32_bf16 v[72:75], v[24:27], a[160:163], v[72:75]
  v_mfma_f32_16x16x32_bf16 v[72:75], v[28:31], a[176:179], v[72:75]
  s_waitcnt vmcnt(16) lgkmcnt(1)
  s_barrier
  v_mfma_f32_16x16x32_bf16 v[76:79], v[24:27], a[164:167], v[76:79]
  ds_read_b64_tr_b16 v[16:17], v7 offset:16384
  s_add_u32 m0, s50, 0
  v_mfma_f32_16x16x32_bf16 v[76:79], v[28:31], a[180:183], v[76:79]
  ds_read_b64_tr_b16 v[18:19], v7 offset:18432
  s_add_u32 s56, s62, s9
  v_mfma_f32_16x16x32_bf16 v[80:83], v[24:27], a[168:171], v[80:83]
  ds_read_b64_tr_b16 v[20:21], v7 offset:20480
  s_addc_u32 s57, s63, 0
  v_mfma_f32_16x16x32_bf16 v[80:83], v[28:31], a[184:187], v[80:83]
  ds_read_b64_tr_b16 v[22:23], v7 offset:22528
  v_mul_f32 v177, 0xbfb8aa3b, v177
  v_mfma_f32_16x16x32_bf16 v[84:87], v[24:27], a[172:175], v[84:87]
  v_mfma_f32_16x16x32_bf16 v[84:87], v[28:31], a[188:191], v[84:87]
  global_load_lds_dwordx4 v9, s[56:57] offset:0
  v_mfma_f32_16x16x32_bf16 v[88:91], v[32:35], a[160:163], v[88:91]
  ds_read_b64_tr_b16 v[24:25], v8 offset:16384
  v_mfma_f32_16x16x32_bf16 v[88:91], v[36:39], a[176:179], v[88:91]
  ds_read_b64_tr_b16 v[26:27], v8 offset:18432
  v_mfma_f32_16x16x32_bf16 v[92:95], v[32:35], a[164:167], v[92:95]
  ds_read_b64_tr_b16 v[28:29], v8 offset:20480
  v_mfma_f32_16x16x32_bf16 v[92:95], v[36:39], a[180:183], v[92:95]
  ds_read_b64_tr_b16 v[30:31], v8 offset:22528
  v_mfma_f32_16x16x32_bf16 v[96:99], v[32:35], a[168:171], v[96:99]
  v_rcp_f32 v178, v182
  v_mfma_f32_16x16x32_bf16 v[96:99], v[36:39], a[184:187], v[96:99]
  v_mfma_f32_16x16x32_bf16 v[100:103], v[32:35], a[172:175], v[100:103]
  v_mfma_f32_16x16x32_bf16 v[100:103], v[36:39], a[188:191], v[100:103]
  global_load_lds_dwordx4 v10, s[56:57] offset:1024
  s_waitcnt lgkmcnt(4)
  v_mfma_f32_16x16x32_bf16 v[40:43], v[16:19], a[192:195], v[40:43]
  ds_read_b64_tr_b16 v[32:33], v7 offset:24576
  v_mfma_f32_16x16x32_bf16 v[40:43], v[20:23], a[208:211], v[40:43]
  ds_read_b64_tr_b16 v[34:35], v7 offset:26624
  v_mul_f32 v178, 0xbfb8aa3b, v178
  v_mfma_f32_16x16x32_bf16 v[44:47], v[16:19], a[196:199], v[44:47]
  ds_read_b64_tr_b16 v[36:37], v7 offset:28672
  v_mfma_f32_16x16x32_bf16 v[44:47], v[20:23], a[212:215], v[44:47]
  ds_read_b64_tr_b16 v[38:39], v7 offset:30720
  v_mfma_f32_16x16x32_bf16 v[48:51], v[16:19], a[200:203], v[48:51]
  ds_read_b128 a[228:231], v5 offset:14336
  v_mfma_f32_16x16x32_bf16 v[48:51], v[20:23], a[216:219], v[48:51]
  ds_read_b128 a[236:239], v5 offset:32768
  v_mfma_f32_16x16x32_bf16 v[52:55], v[16:19], a[204:207], v[52:55]
  ds_read_b128 a[244:247], v6 offset:15360
  v_mfma_f32_16x16x32_bf16 v[52:55], v[20:23], a[220:223], v[52:55]
  global_load_lds_dwordx4 v11, s[56:57] offset:2048
  s_waitcnt lgkmcnt(7)
  v_mfma_f32_16x16x32_bf16 v[56:59], v[24:27], a[192:195], v[56:59]
  ds_read_b64_tr_b16 v[16:17], v8 offset:24576
  v_mfma_f32_16x16x32_bf16 v[56:59], v[28:31], a[208:211], v[56:59]
  ds_read_b64_tr_b16 v[18:19], v8 offset:26624
  v_mfma_f32_16x16x32_bf16 v[60:63], v[24:27], a[196:199], v[60:63]
  ds_read_b64_tr_b16 v[20:21], v8 offset:28672
  v_mfma_f32_16x16x32_bf16 v[60:63], v[28:31], a[212:215], v[60:63]
  ds_read_b64_tr_b16 v[22:23], v8 offset:30720
  v_mfma_f32_16x16x32_bf16 v[64:67], v[24:27], a[200:203], v[64:67]
  ds_read_b128 a[252:255], v6 offset:33792
  v_mfma_f32_16x16x32_bf16 v[64:67], v[28:31], a[216:219], v[64:67]
  v_rcp_f32 v179, v183
  v_mfma_f32_16x16x32_bf16 v[68:71], v[24:27], a[204:207], v[68:71]
  v_mul_f32 v179, 0xbfb8aa3b, v179
  v_mfma_f32_16x16x32_bf16 v[68:71], v[28:31], a[220:223], v[68:71]
  global_load_lds_dwordx4 v12, s[56:57] offset:3072
  s_waitcnt lgkmcnt(8)
  v_mfma_f32_16x16x32_bf16 v[72:75], v[32:35], a[192:195], v[72:75]
  v_mfma_f32_16x16x32_bf16 v[72:75], v[36:39], a[208:211], v[72:75]
  s_waitcnt vmcnt(15) lgkmcnt(1)
  s_barrier
  v_mfma_f32_16x16x32_bf16 v[76:79], v[32:35], a[196:199], v[76:79]
  ds_read_b64_tr_b16 v[24:25], v7 offset:32768
  s_add_u32 m0, s50, 16384
  v_mfma_f32_16x16x32_bf16 v[76:79], v[36:39], a[212:215], v[76:79]
  ds_read_b64_tr_b16 v[26:27], v7 offset:34816
  s_add_u32 s56, s62, s10
  v_mfma_f32_16x16x32_bf16 v[80:83], v[32:35], a[200:203], v[80:83]
  ds_read_b64_tr_b16 v[28:29], v7 offset:36864
  s_addc_u32 s57, s63, 0
  v_mfma_f32_16x16x32_bf16 v[80:83], v[36:39], a[216:219], v[80:83]
  ds_read_b64_tr_b16 v[30:31], v7 offset:38912
  v_mfma_f32_16x16x32_bf16 v[84:87], v[32:35], a[204:207], v[84:87]
  v_mfma_f32_16x16x32_bf16 v[84:87], v[36:39], a[220:223], v[84:87]
  global_load_lds_dwordx4 v9, s[56:57] offset:0
  v_mfma_f32_16x16x32_bf16 v[88:91], v[16:19], a[192:195], v[88:91]
  ds_read_b64_tr_b16 v[32:33], v8 offset:32768
  v_mfma_f32_16x16x32_bf16 v[88:91], v[20:23], a[208:211], v[88:91]
  ds_read_b64_tr_b16 v[34:35], v8 offset:34816
  v_mfma_f32_16x16x32_bf16 v[92:95], v[16:19], a[196:199], v[92:95]
  ds_read_b64_tr_b16 v[36:37], v8 offset:36864
  v_mfma_f32_16x16x32_bf16 v[92:95], v[20:23], a[212:215], v[92:95]
  ds_read_b64_tr_b16 v[38:39], v8 offset:38912
  v_mfma_f32_16x16x32_bf16 v[96:99], v[16:19], a[200:203], v[96:99]
  v_mfma_f32_16x16x32_bf16 v[96:99], v[20:23], a[216:219], v[96:99]
  v_mfma_f32_16x16x32_bf16 v[100:103], v[16:19], a[204:207], v[100:103]
  v_mfma_f32_16x16x32_bf16 v[100:103], v[20:23], a[220:223], v[100:103]
  global_load_lds_dwordx4 v10, s[56:57] offset:1024
  s_waitcnt lgkmcnt(4)
  v_mfma_f32_16x16x32_bf16 v[40:43], v[24:27], a[224:227], v[40:43]
  ds_read_b64_tr_b16 v[16:17], v7 offset:40960
  v_mfma_f32_16x16x32_bf16 v[40:43], v[28:31], a[240:243], v[40:43]
  ds_read_b64_tr_b16 v[18:19], v7 offset:43008
  v_mfma_f32_16x16x32_bf16 v[44:47], v[24:27], a[228:231], v[44:47]
  ds_read_b64_tr_b16 v[20:21], v7 offset:45056
  v_mfma_f32_16x16x32_bf16 v[44:47], v[28:31], a[244:247], v[44:47]
  ds_read_b64_tr_b16 v[22:23], v7 offset:47104
  v_mfma_f32_16x16x32_bf16 v[48:51], v[24:27], a[232:235], v[48:51]
  ds_read_b128 v[228:231], v5 offset:16384
  v_mfma_f32_16x16x32_bf16 v[48:51], v[28:31], a[248:251], v[48:51]
  ds_read_b128 v[236:239], v5 offset:34816
  v_mfma_f32_16x16x32_bf16 v[52:55], v[24:27], a[236:239], v[52:55]
  ds_read_b128 v[244:247], v6 offset:17408
  v_mfma_f32_16x16x32_bf16 v[52:55], v[28:31], a[252:255], v[52:55]
  global_load_lds_dwordx4 v11, s[56:57] offset:2048
  s_waitcnt lgkmcnt(7)
  v_mfma_f32_16x16x32_bf16 v[56:59], v[32:35], a[224:227], v[56:59]
  ds_read_b64_tr_b16 v[24:25], v8 offset:40960
  v_mfma_f32_16x16x32_bf16 v[56:59], v[36:39], a[240:243], v[56:59]
  ds_read_b64_tr_b16 v[26:27], v8 offset:43008
  v_mfma_f32_16x16x32_bf16 v[60:63], v[32:35], a[228:231], v[60:63]
  ds_read_b64_tr_b16 v[28:29], v8 offset:45056
  v_mfma_f32_16x16x32_bf16 v[60:63], v[36:39], a[244:247], v[60:63]
  ds_read_b64_tr_b16 v[30:31], v8 offset:47104
  v_mfma_f32_16x16x32_bf16 v[64:67], v[32:35], a[232:235], v[64:67]
  ds_read_b128 v[252:255], v6 offset:35840
  v_mfma_f32_16x16x32_bf16 v[64:67], v[36:39], a[248:251], v[64:67]
  v_mfma_f32_16x16x32_bf16 v[68:71], v[32:35], a[236:239], v[68:71]
  v_mfma_f32_16x16x32_bf16 v[68:71], v[36:39], a[252:255], v[68:71]
  global_load_lds_dwordx4 v12, s[56:57] offset:3072
  s_waitcnt lgkmcnt(8)
  v_mfma_f32_16x16x32_bf16 v[72:75], v[16:19], a[224:227], v[72:75]
  v_mfma_f32_16x16x32_bf16 v[72:75], v[20:23], a[240:243], v[72:75]
  s_waitcnt vmcnt(12) lgkmcnt(1)
  s_barrier
  v_mfma_f32_16x16x32_bf16 v[76:79], v[16:19], a[228:231], v[76:79]
  ds_read_b64_tr_b16 v[32:33], v7 offset:49152
  s_add_u32 m0, s50, 32768
  v_mfma_f32_16x16x32_bf16 v[76:79], v[20:23], a[244:247], v[76:79]
  ds_read_b64_tr_b16 v[34:35], v7 offset:51200
  s_add_u32 s56, s62, s11
  v_mfma_f32_16x16x32_bf16 v[80:83], v[16:19], a[232:235], v[80:83]
  ds_read_b64_tr_b16 v[36:37], v7 offset:53248
  s_addc_u32 s57, s63, 0
  v_mfma_f32_16x16x32_bf16 v[80:83], v[20:23], a[248:251], v[80:83]
  ds_read_b64_tr_b16 v[38:39], v7 offset:55296
  v_mfma_f32_16x16x32_bf16 v[84:87], v[16:19], a[236:239], v[84:87]
  v_mfma_f32_16x16x32_bf16 v[84:87], v[20:23], a[252:255], v[84:87]
  global_load_lds_dwordx4 v9, s[56:57] offset:0
  v_mfma_f32_16x16x32_bf16 v[88:91], v[24:27], a[224:227], v[88:91]
  ds_read_b64_tr_b16 v[16:17], v8 offset:49152
  v_mfma_f32_16x16x32_bf16 v[88:91], v[28:31], a[240:243], v[88:91]
  ds_read_b64_tr_b16 v[18:19], v8 offset:51200
  v_mfma_f32_16x16x32_bf16 v[92:95], v[24:27], a[228:231], v[92:95]
  ds_read_b64_tr_b16 v[20:21], v8 offset:53248
  v_mfma_f32_16x16x32_bf16 v[92:95], v[28:31], a[244:247], v[92:95]
  ds_read_b64_tr_b16 v[22:23], v8 offset:55296
  v_mfma_f32_16x16x32_bf16 v[96:99], v[24:27], a[232:235], v[96:99]
  v_mfma_f32_16x16x32_bf16 v[96:99], v[28:31], a[248:251], v[96:99]
  v_mfma_f32_16x16x32_bf16 v[100:103], v[24:27], a[236:239], v[100:103]
  v_mfma_f32_16x16x32_bf16 v[100:103], v[28:31], a[252:255], v[100:103]
  global_load_lds_dwordx4 v10, s[56:57] offset:1024
  s_waitcnt lgkmcnt(4)
  v_mfma_f32_16x16x32_bf16 v[40:43], v[32:35], v[224:227], v[40:43]
  ds_read_b64_tr_b16 v[24:25], v7 offset:57344
  v_add_u32 v5, 32768, v7
  v_mfma_f32_16x16x32_bf16 v[40:43], v[36:39], v[240:243], v[40:43]
  ds_read_b64_tr_b16 v[26:27], v7 offset:59392
  v_add_u32 v6, 32768, v8
  v_mfma_f32_16x16x32_bf16 v[44:47], v[32:35], v[228:231], v[44:47]
  ds_read_b64_tr_b16 v[28:29], v7 offset:61440
  v_mfma_f32_16x16x32_bf16 v[44:47], v[36:39], v[244:247], v[44:47]
  ds_read_b64_tr_b16 v[30:31], v7 offset:63488
  v_mfma_f32_16x16x32_bf16 v[48:51], v[32:35], v[232:235], v[48:51]
  v_mfma_f32_16x16x32_bf16 v[48:51], v[36:39], v[248:251], v[48:51]
  v_mfma_f32_16x16x32_bf16 v[52:55], v[32:35], v[236:239], v[52:55]
  v_mfma_f32_16x16x32_bf16 v[52:55], v[36:39], v[252:255], v[52:55]
  global_load_lds_dwordx4 v11, s[56:57] offset:2048
  s_waitcnt lgkmcnt(4)
  v_mfma_f32_16x16x32_bf16 v[56:59], v[16:19], v[224:227], v[56:59]
  ds_read_b64_tr_b16 v[32:33], v8 offset:57344
  v_mfma_f32_16x16x32_bf16 v[56:59], v[20:23], v[240:243], v[56:59]
  ds_read_b64_tr_b16 v[34:35], v8 offset:59392
  v_mfma_f32_16x16x32_bf16 v[60:63], v[16:19], v[228:231], v[60:63]
  ds_read_b64_tr_b16 v[36:37], v8 offset:61440
  v_mfma_f32_16x16x32_bf16 v[60:63], v[20:23], v[244:247], v[60:63]
  ds_read_b64_tr_b16 v[38:39], v8 offset:63488
  v_mfma_f32_16x16x32_bf16 v[64:67], v[16:19], v[232:235], v[64:67]
  v_mfma_f32_16x16x32_bf16 v[64:67], v[20:23], v[248:251], v[64:67]
  v_mfma_f32_16x16x32_bf16 v[68:71], v[16:19], v[236:239], v[68:71]
  v_mfma_f32_16x16x32_bf16 v[68:71], v[20:23], v[252:255], v[68:71]
  global_load_lds_dwordx4 v12, s[56:57] offset:3072
  s_waitcnt lgkmcnt(4)
  v_mfma_f32_16x16x32_bf16 v[72:75], v[24:27], v[224:227], v[72:75]
  v_mfma_f32_16x16x32_bf16 v[72:75], v[28:31], v[240:243], v[72:75]
  s_waitcnt vmcnt(12) lgkmcnt(0)
  s_barrier
  v_mfma_f32_16x16x32_bf16 v[76:79], v[24:27], v[228:231], v[76:79]
  ds_read_b64_tr_b16 v[16:17], v2 offset:0
  s_add_u32 m0, s50, 49152
  v_mfma_f32_16x16x32_bf16 v[76:79], v[28:31], v[244:247], v[76:79]
  ds_read_b64_tr_b16 v[18:19], v2 offset:2048
  s_add_u32 s56, s62, s12
  v_mfma_f32_16x16x32_bf16 v[80:83], v[24:27], v[232:235], v[80:83]
  ds_read_b64_tr_b16 v[20:21], v2 offset:4096
  s_addc_u32 s57, s63, 0
  v_mfma_f32_16x16x32_bf16 v[80:83], v[28:31], v[248:251], v[80:83]
  ds_read_b64_tr_b16 v[22:23], v2 offset:6144
  v_add_u32 v13, 16384, v13
  v_mfma_f32_16x16x32_bf16 v[84:87], v[24:27], v[236:239], v[84:87]
  v_mul_f32 v41, v176, v41
  v_mul_f32 v42, v176, v42
  v_mfma_f32_16x16x32_bf16 v[84:87], v[28:31], v[252:255], v[84:87]
  global_load_lds_dwordx4 v9, s[56:57] offset:0
  v_xor_b32 v214, 8, v13
  v_mfma_f32_16x16x32_bf16 v[88:91], v[32:35], v[224:227], v[88:91]
  ds_read_b64_tr_b16 v[24:25], v3 offset:0
  v_mul_f32 v40, v176, v40
  v_mfma_f32_16x16x32_bf16 v[88:91], v[36:39], v[240:243], v[88:91]
  ds_read_b64_tr_b16 v[26:27], v3 offset:2048
  v_mul_f32 v43, v176, v43
  v_mfma_f32_16x16x32_bf16 v[92:95], v[32:35], v[228:231], v[92:95]
  ds_read_b64_tr_b16 v[28:29], v3 offset:4096
  v_mfma_f32_16x16x32_bf16 v[92:95], v[36:39], v[244:247], v[92:95]
  ds_read_b64_tr_b16 v[30:31], v3 offset:6144
  v_mfma_f32_16x16x32_bf16 v[96:99], v[32:35], v[232:235], v[96:99]
  v_exp_f32 v40, v40
  v_mfma_f32_16x16x32_bf16 v[96:99], v[36:39], v[248:251], v[96:99]
  v_exp_f32 v41, v41
  v_mfma_f32_16x16x32_bf16 v[100:103], v[32:35], v[236:239], v[100:103]
  v_exp_f32 v42, v42
  v_mfma_f32_16x16x32_bf16 v[100:103], v[36:39], v[252:255], v[100:103]
  global_load_lds_dwordx4 v10, s[56:57] offset:1024
  s_waitcnt lgkmcnt(4)
  v_mfma_f32_16x16x32_bf16 v[104:107], v[16:19], a[0:3], 0
  ds_read_b64_tr_b16 v[32:33], v2 offset:8192
  v_fma_f32 v40, v40, v180, v180
  v_mfma_f32_16x16x32_bf16 v[104:107], v[20:23], a[16:19], v[104:107]
  ds_read_b64_tr_b16 v[34:35], v2 offset:10240
  v_fma_f32 v41, v41, v180, v180
  v_mfma_f32_16x16x32_bf16 v[108:111], v[16:19], a[4:7], 0
  ds_read_b64_tr_b16 v[36:37], v2 offset:12288
  v_fma_f32 v42, v42, v180, v180
  v_mfma_f32_16x16x32_bf16 v[108:111], v[20:23], a[20:23], v[108:111]
  ds_read_b64_tr_b16 v[38:39], v2 offset:14336
  v_mfma_f32_16x16x32_bf16 v[112:115], v[16:19], a[8:11], 0
  v_exp_f32 v43, v43
  v_mfma_f32_16x16x32_bf16 v[112:115], v[20:23], a[24:27], v[112:115]
  v_rcp_f32 v40, v40
  v_mfma_f32_16x16x32_bf16 v[116:119], v[16:19], a[12:15], 0
  v_rcp_f32 v41, v41
  v_mfma_f32_16x16x32_bf16 v[116:119], v[20:23], a[28:31], v[116:119]
  global_load_lds_dwordx4 v11, s[56:57] offset:2048
  s_waitcnt lgkmcnt(4)
  v_mfma_f32_16x16x32_bf16 v[120:123], v[24:27], a[0:3], 0
  ds_read_b64_tr_b16 v[16:17], v3 offset:8192
  v_fma_f32 v43, v43, v180, v180
  v_mfma_f32_16x16x32_bf16 v[120:123], v[28:31], a[16:19], v[120:123]
  ds_read_b64_tr_b16 v[18:19], v3 offset:10240
  v_mfma_f32_16x16x32_bf16 v[124:127], v[24:27], a[4:7], 0
  ds_read_b64_tr_b16 v[20:21], v3 offset:12288
  v_mfma_f32_16x16x32_bf16 v[124:127], v[28:31], a[20:23], v[124:127]
  ds_read_b64_tr_b16 v[22:23], v3 offset:14336
  v_mfma_f32_16x16x32_bf16 v[128:131], v[24:27], a[8:11], 0
  v_rcp_f32 v42, v42
  v_mfma_f32_16x16x32_bf16 v[128:131], v[28:31], a[24:27], v[128:131]
  v_rcp_f32 v43, v43
  v_mfma_f32_16x16x32_bf16 v[132:135], v[24:27], a[12:15], 0
  v_mul_f32 v40, v40, v72
  v_mul_f32 v41, v41, v73
  v_mfma_f32_16x16x32_bf16 v[132:135], v[28:31], a[28:31], v[132:135]
  global_load_lds_dwordx4 v12, s[56:57] offset:3072
  s_waitcnt lgkmcnt(4)
  v_mfma_f32_16x16x32_bf16 v[136:139], v[32:35], a[0:3], 0
  v_mul_f32 v42, v42, v74
  v_mul_f32 v43, v43, v75
  v_mfma_f32_16x16x32_bf16 v[136:139], v[36:39], a[16:19], v[136:139]
  s_waitcnt vmcnt(12) lgkmcnt(0)
  s_barrier
  v_mfma_f32_16x16x32_bf16 v[140:143], v[32:35], a[4:7], 0
  ds_read_b64_tr_b16 v[24:25], v7 offset:0
  v_mfma_f32_16x16x32_bf16 v[140:143], v[36:39], a[20:23], v[140:143]
  ds_read_b64_tr_b16 v[26:27], v7 offset:2048
  v_mfma_f32_16x16x32_bf16 v[144:147], v[32:35], a[8:11], 0
  ds_read_b64_tr_b16 v[28:29], v7 offset:4096
  v_mfma_f32_16x16x32_bf16 v[144:147], v[36:39], a[24:27], v[144:147]
  ds_read_b64_tr_b16 v[30:31], v7 offset:6144
  v_cvt_pk_bf16_f32 v168, v40, v41
  v_mfma_f32_16x16x32_bf16 v[148:151], v[32:35], a[12:15], 0
  v_cvt_pk_bf16_f32 v169, v42, v43
  v_mul_f32 v56, v176, v56
  v_mfma_f32_16x16x32_bf16 v[148:151], v[36:39], a[28:31], v[148:151]
  v_mul_f32 v57, v176, v57
  v_mfma_f32_16x16x32_bf16 v[152:155], v[16:19], a[0:3], 0
  ds_read_b64_tr_b16 v[32:33], v8 offset:0
  v_mul_f32 v58, v176, v58
  v_mfma_f32_16x16x32_bf16 v[152:155], v[20:23], a[16:19], v[152:155]
  ds_read_b64_tr_b16 v[34:35], v8 offset:2048
  v_mul_f32 v59, v176, v59
  v_mfma_f32_16x16x32_bf16 v[156:159], v[16:19], a[4:7], 0
  ds_read_b64_tr_b16 v[36:37], v8 offset:4096
  v_mfma_f32_16x16x32_bf16 v[156:159], v[20:23], a[20:23], v[156:159]
  ds_read_b64_tr_b16 v[38:39], v8 offset:6144
  v_mfma_f32_16x16x32_bf16 v[160:163], v[16:19], a[8:11], 0
  v_exp_f32 v56, v56
  v_mfma_f32_16x16x32_bf16 v[160:163], v[20:23], a[24:27], v[160:163]
  ds_write_b32 v13, v168 offset:0
  v_mfma_f32_16x16x32_bf16 v[164:167], v[16:19], a[12:15], 0
  ds_write_b32 v13, v169 offset:4
  v_mfma_f32_16x16x32_bf16 v[164:167], v[20:23], a[28:31], v[164:167]
  s_waitcnt lgkmcnt(6)
  v_mfma_f32_16x16x32_bf16 v[104:107], v[24:27], a[32:35], v[104:107]
  ds_read_b64_tr_b16 v[16:17], v7 offset:8192
  v_mfma_f32_16x16x32_bf16 v[104:107], v[28:31], a[48:51], v[104:107]
  ds_read_b64_tr_b16 v[18:19], v7 offset:10240
  v_mfma_f32_16x16x32_bf16 v[108:111], v[24:27], a[36:39], v[108:111]
  ds_read_b64_tr_b16 v[20:21], v7 offset:12288
  v_fma_f32 v56, v56, v180, v180
  v_mfma_f32_16x16x32_bf16 v[108:111], v[28:31], a[52:55], v[108:111]
  ds_read_b64_tr_b16 v[22:23], v7 offset:14336
  v_mfma_f32_16x16x32_bf16 v[112:115], v[24:27], a[40:43], v[112:115]
  v_exp_f32 v57, v57
  v_mfma_f32_16x16x32_bf16 v[112:115], v[28:31], a[56:59], v[112:115]
  v_exp_f32 v58, v58
  v_mfma_f32_16x16x32_bf16 v[116:119], v[24:27], a[44:47], v[116:119]
  v_exp_f32 v59, v59
  v_rcp_f32 v56, v56
  v_mfma_f32_16x16x32_bf16 v[116:119], v[28:31], a[60:63], v[116:119]
  v_fma_f32 v59, v59, v180, v180
  s_waitcnt lgkmcnt(6)
  v_mfma_f32_16x16x32_bf16 v[120:123], v[32:35], a[32:35], v[120:123]
  ds_read_b64_tr_b16 v[24:25], v8 offset:8192
  v_mfma_f32_16x16x32_bf16 v[120:123], v[36:39], a[48:51], v[120:123]
  ds_read_b64_tr_b16 v[26:27], v8 offset:10240
  v_mfma_f32_16x16x32_bf16 v[124:127], v[32:35], a[36:39], v[124:127]
  ds_read_b64_tr_b16 v[28:29], v8 offset:12288
  v_mfma_f32_16x16x32_bf16 v[124:127], v[36:39], a[52:55], v[124:127]
  ds_read_b64_tr_b16 v[30:31], v8 offset:14336
  v_mfma_f32_16x16x32_bf16 v[128:131], v[32:35], a[40:43], v[128:131]
  v_mfma_f32_16x16x32_bf16 v[128:131], v[36:39], a[56:59], v[128:131]
  v_mfma_f32_16x16x32_bf16 v[132:135], v[32:35], a[44:47], v[132:135]
  v_fma_f32 v57, v57, v180, v180
  v_fma_f32 v58, v58, v180, v180
  v_mfma_f32_16x16x32_bf16 v[132:135], v[36:39], a[60:63], v[132:135]
  s_waitcnt lgkmcnt(4)
  v_mfma_f32_16x16x32_bf16 v[136:139], v[16:19], a[32:35], v[136:139]
L_loop1:
  v_mfma_f32_16x16x32_bf16 v[136:139], v[20:23], a[48:51], v[136:139]
  s_waitcnt vmcnt(8) lgkmcnt(0)
  s_barrier
  v_mfma_f32_16x16x32_bf16 v[140:143], v[16:19], a[36:39], v[140:143]
  ds_read_b64_tr_b16 v[32:33], v7 offset:16384
  s_add_u32 m0, s50, 0
  v_mfma_f32_16x16x32_bf16 v[140:143], v[20:23], a[52:55], v[140:143]
  ds_read_b64_tr_b16 v[34:35], v7 offset:18432
  s_add_u32 s56, s62, s13
  v_mfma_f32_16x16x32_bf16 v[144:147], v[16:19], a[40:43], v[144:147]
  ds_read_b64_tr_b16 v[36:37], v7 offset:20480
  s_addc_u32 s57, s63, 0
  v_mfma_f32_16x16x32_bf16 v[144:147], v[20:23], a[56:59], v[144:147]
  ds_read_b64_tr_b16 v[38:39], v7 offset:22528
  v_rcp_f32 v57, v57
  v_mfma_f32_16x16x32_bf16 v[148:151], v[16:19], a[44:47], v[148:151]
  v_rcp_f32 v58, v58
  v_mfma_f32_16x16x32_bf16 v[148:151], v[20:23], a[60:63], v[148:151]
  global_load_lds_dwordx4 v9, s[56:57] offset:0
  v_rcp_f32 v59, v59
  v_mfma_f32_16x16x32_bf16 v[152:155], v[24:27], a[32:35], v[152:155]
  ds_read_b64_tr_b16 v[16:17], v8 offset:16384
  v_mul_f32 v56, v56, v88
  v_mfma_f32_16x16x32_bf16 v[152:155], v[28:31], a[48:51], v[152:155]
  ds_read_b64_tr_b16 v[18:19], v8 offset:18432
  v_mul_f32 v57, v57, v89
  v_mfma_f32_16x16x32_bf16 v[156:159], v[24:27], a[36:39], v[156:159]
  ds_read_b64_tr_b16 v[20:21], v8 offset:20480
  v_mul_f32 v58, v58, v90
  v_mfma_f32_16x16x32_bf16 v[156:159], v[28:31], a[52:55], v[156:159]
  ds_read_b64_tr_b16 v[22:23], v8 offset:22528
  v_mul_f32 v59, v59, v91
  v_mfma_f32_16x16x32_bf16 v[160:163], v[24:27], a[40:43], v[160:163]
  v_cvt_pk_bf16_f32 v170, v56, v57
  v_cvt_pk_bf16_f32 v171, v58, v59
  v_mfma_f32_16x16x32_bf16 v[160:163], v[28:31], a[56:59], v[160:163]
  ds_write_b32 v214, v170 offset:0
  v_mul_f32 v44, v177, v44
  v_mfma_f32_16x16x32_bf16 v[164:167], v[24:27], a[44:47], v[164:167]
  ds_write_b32 v214, v171 offset:4
  v_mul_f32 v45, v177, v45
  v_mfma_f32_16x16x32_bf16 v[164:167], v[28:31], a[60:63], v[164:167]
  global_load_lds_dwordx4 v10, s[56:57] offset:1024
  s_waitcnt lgkmcnt(6)
  v_mfma_f32_16x16x32_bf16 v[104:107], v[32:35], a[64:67], v[104:107]
  ds_read_b64_tr_b16 v[24:25], v7 offset:24576
  v_mul_f32 v46, v177, v46
  v_mfma_f32_16x16x32_bf16 v[104:107], v[36:39], a[80:83], v[104:107]
  ds_read_b64_tr_b16 v[26:27], v7 offset:26624
  v_mul_f32 v47, v177, v47
  v_mfma_f32_16x16x32_bf16 v[108:111], v[32:35], a[68:71], v[108:111]
  ds_read_b64_tr_b16 v[28:29], v7 offset:28672
  v_mfma_f32_16x16x32_bf16 v[108:111], v[36:39], a[84:87], v[108:111]
  ds_read_b64_tr_b16 v[30:31], v7 offset:30720
  v_mfma_f32_16x16x32_bf16 v[112:115], v[32:35], a[72:75], v[112:115]
  v_exp_f32 v44, v44
  v_mfma_f32_16x16x32_bf16 v[112:115], v[36:39], a[88:91], v[112:115]
  v_exp_f32 v45, v45
  v_mfma_f32_16x16x32_bf16 v[116:119], v[32:35], a[76:79], v[116:119]
  v_exp_f32 v46, v46
  v_mfma_f32_16x16x32_bf16 v[116:119], v[36:39], a[92:95], v[116:119]
  global_load_lds_dwordx4 v11, s[56:57] offset:2048
  s_waitcnt lgkmcnt(6)
  v_mfma_f32_16x16x32_bf16 v[120:123], v[16:19], a[64:67], v[120:123]
  ds_read_b64_tr_b16 v[32:33], v8 offset:24576
  v_fma_f32 v44, v44, v181, v181
  v_mfma_f32_16x16x32_bf16 v[120:123], v[20:23], a[80:83], v[120:123]
  ds_read_b64_tr_b16 v[34:35], v8 offset:26624
  v_fma_f32 v45, v45, v181, v181
  v_mfma_f32_16x16x32_bf16 v[124:127], v[16:19], a[68:71], v[124:127]
  ds_read_b64_tr_b16 v[36:37], v8 offset:28672
  v_fma_f32 v46, v46, v181, v181
  v_mfma_f32_16x16x32_bf16 v[124:127], v[20:23], a[84:87], v[124:127]
  ds_read_b64_tr_b16 v[38:39], v8 offset:30720
  v_mfma_f32_16x16x32_bf16 v[128:131], v[16:19], a[72:75], v[128:131]
  v_exp_f32 v47, v47
  v_mfma_f32_16x16x32_bf16 v[128:131], v[20:23], a[88:91], v[128:131]
  v_fma_f32 v47, v47, v181, v181
  v_mfma_f32_16x16x32_bf16 v[132:135], v[16:19], a[76:79], v[132:135]
  v_rcp_f32 v44, v44
  v_mfma_f32_16x16x32_bf16 v[132:135], v[20:23], a[92:95], v[132:135]
  global_load_lds_dwordx4 v12, s[56:57] offset:3072
  s_waitcnt lgkmcnt(4)
  v_mfma_f32_16x16x32_bf16 v[136:139], v[24:27], a[64:67], v[136:139]
  v_rcp_f32 v45, v45
  v_mfma_f32_16x16x32_bf16 v[136:139], v[28:31], a[80:83], v[136:139]
  s_waitcnt vmcnt(8) lgkmcnt(0)
  s_barrier
  v_mfma_f32_16x16x32_bf16 v[140:143], v[24:27], a[68:71], v[140:143]
  ds_read_b64_tr_b16 v[16:17], v5 offset:0
  s_add_u32 m0, s50, 16384
  v_mfma_f32_16x16x32_bf16 v[140:143], v[28:31], a[84:87], v[140:143]
  ds_read_b64_tr_b16 v[18:19], v5 offset:2048
  s_add_u32 s56, s62, s14
  v_mfma_f32_16x16x32_bf16 v[144:147], v[24:27], a[72:75], v[144:147]
  ds_read_b64_tr_b16 v[20:21], v5 offset:4096
  s_addc_u32 s57, s63, 0
  v_mfma_f32_16x16x32_bf16 v[144:147], v[28:31], a[88:91], v[144:147]
  ds_read_b64_tr_b16 v[22:23], v5 offset:6144
  v_rcp_f32 v47, v47
  v_mfma_f32_16x16x32_bf16 v[148:151], v[24:27], a[76:79], v[148:151]
  v_rcp_f32 v46, v46
  v_mfma_f32_16x16x32_bf16 v[148:151], v[28:31], a[92:95], v[148:151]
  global_load_lds_dwordx4 v9, s[56:57] offset:0
  v_mul_f32 v44, v44, v76
  v_mfma_f32_16x16x32_bf16 v[152:155], v[32:35], a[64:67], v[152:155]
  ds_read_b64_tr_b16 v[24:25], v6 offset:0
  v_mul_f32 v45, v45, v77
  v_mfma_f32_16x16x32_bf16 v[152:155], v[36:39], a[80:83], v[152:155]
  ds_read_b64_tr_b16 v[26:27], v6 offset:2048
  v_mul_f32 v46, v46, v78
  v_mfma_f32_16x16x32_bf16 v[156:159], v[32:35], a[68:71], v[156:159]
  ds_read_b64_tr_b16 v[28:29], v6 offset:4096
  v_mul_f32 v47, v47, v79
  v_mfma_f32_16x16x32_bf16 v[156:159], v[36:39], a[84:87], v[156:159]
  ds_read_b64_tr_b16 v[30:31], v6 offset:6144
  v_cvt_pk_bf16_f32 v172, v44, v45
  v_mfma_f32_16x16x32_bf16 v[160:163], v[32:35], a[72:75], v[160:163]
  global_load_dword v219, v0, s[6:7]
  v_cvt_pk_bf16_f32 v173, v46, v47
  v_mfma_f32_16x16x32_bf16 v[160:163], v[36:39], a[88:91], v[160:163]
  ds_write_b32 v13, v172 offset:1024
  v_mul_f32 v60, v177, v60
  v_mfma_f32_16x16x32_bf16 v[164:167], v[32:35], a[76:79], v[164:167]
  ds_write_b32 v13, v173 offset:1028
  v_mul_f32 v61, v177, v61
  v_mfma_f32_16x16x32_bf16 v[164:167], v[36:39], a[92:95], v[164:167]
  global_load_lds_dwordx4 v10, s[56:57] offset:1024
  s_waitcnt lgkmcnt(6)
  v_mfma_f32_16x16x32_bf16 v[104:107], v[16:19], a[96:99], v[104:107]
  ds_read_b64_tr_b16 v[32:33], v5 offset:8192
  v_mul_f32 v62, v177, v62
  v_mfma_f32_16x16x32_bf16 v[104:107], v[20:23], a[112:115], v[104:107]
  ds_read_b64_tr_b16 v[34:35], v5 offset:10240
  v_mul_f32 v63, v177, v63
  v_mfma_f32_16x16x32_bf16 v[108:111], v[16:19], a[100:103], v[108:111]
  ds_read_b64_tr_b16 v[36:37], v5 offset:12288
  v_mfma_f32_16x16x32_bf16 v[108:111], v[20:23], a[116:119], v[108:111]
  ds_read_b64_tr_b16 v[38:39], v5 offset:14336
  v_mfma_f32_16x16x32_bf16 v[112:115], v[16:19], a[104:107], v[112:115]
  v_exp_f32 v60, v60
  v_mfma_f32_16x16x32_bf16 v[112:115], v[20:23], a[120:123], v[112:115]
  v_exp_f32 v61, v61
  v_mfma_f32_16x16x32_bf16 v[116:119], v[16:19], a[108:111], v[116:119]
  v_exp_f32 v62, v62
  v_mfma_f32_16x16x32_bf16 v[116:119], v[20:23], a[124:127], v[116:119]
  global_load_lds_dwordx4 v11, s[56:57] offset:2048
  s_waitcnt lgkmcnt(6)
  v_mfma_f32_16x16x32_bf16 v[120:123], v[24:27], a[96:99], v[120:123]
  ds_read_b64_tr_b16 v[16:17], v6 offset:8192
  v_fma_f32 v60, v60, v181, v181
  v_mfma_f32_16x16x32_bf16 v[120:123], v[28:31], a[112:115], v[120:123]
  ds_read_b64_tr_b16 v[18:19], v6 offset:10240
  v_fma_f32 v61, v61, v181, v181
  v_mfma_f32_16x16x32_bf16 v[124:127], v[24:27], a[100:103], v[124:127]
  ds_read_b64_tr_b16 v[20:21], v6 offset:12288
  v_fma_f32 v62, v62, v181, v181
  v_mfma_f32_16x16x32_bf16 v[124:127], v[28:31], a[116:119], v[124:127]
  ds_read_b64_tr_b16 v[22:23], v6 offset:14336
  v_mfma_f32_16x16x32_bf16 v[128:131], v[24:27], a[104:107], v[128:131]
  v_exp_f32 v63, v63
  v_mfma_f32_16x16x32_bf16 v[128:131], v[28:31], a[120:123], v[128:131]
  v_fma_f32 v63, v63, v181, v181
  v_mfma_f32_16x16x32_bf16 v[132:135], v[24:27], a[108:111], v[132:135]
  v_rcp_f32 v60, v60
  v_mfma_f32_16x16x32_bf16 v[132:135], v[28:31], a[124:127], v[132:135]
  global_load_lds_dwordx4 v12, s[56:57] offset:3072
  s_waitcnt lgkmcnt(4)
  v_mfma_f32_16x16x32_bf16 v[136:139], v[32:35], a[96:99], v[136:139]
  v_rcp_f32 v61, v61
  v_mfma_f32_16x16x32_bf16 v[136:139], v[36:39], a[112:115], v[136:139]
  s_waitcnt vmcnt(9) lgkmcnt(0)
  s_barrier
  v_mfma_f32_16x16x32_bf16 v[140:143], v[32:35], a[100:103], v[140:143]
  ds_read_b64_tr_b16 v[24:25], v5 offset:16384
  s_add_u32 m0, s68, 0
  v_mfma_f32_16x16x32_bf16 v[140:143], v[36:39], a[116:119], v[140:143]
  ds_read_b64_tr_b16 v[26:27], v5 offset:18432
  s_add_u32 s56, s62, s15
  v_mfma_f32_16x16x32_bf16 v[144:147], v[32:35], a[104:107], v[144:147]
  ds_read_b64_tr_b16 v[28:29], v5 offset:20480
  s_addc_u32 s57, s63, 0
  v_mfma_f32_16x16x32_bf16 v[144:147], v[36:39], a[120:123], v[144:147]
  ds_read_b64_tr_b16 v[30:31], v5 offset:22528
  v_mul_f32 v60, v60, v92
  v_mfma_f32_16x16x32_bf16 v[148:151], v[32:35], a[108:111], v[148:151]
  v_rcp_f32 v62, v62
  v_mfma_f32_16x16x32_bf16 v[148:151], v[36:39], a[124:127], v[148:151]
  global_load_lds_dwordx4 v9, s[56:57] offset:0
  v_mul_f32 v61, v61, v93
  v_mfma_f32_16x16x32_bf16 v[152:155], v[16:19], a[96:99], v[152:155]
  ds_read_b64_tr_b16 v[32:33], v6 offset:16384
  v_mul_f32 v62, v62, v94
  v_mfma_f32_16x16x32_bf16 v[152:155], v[20:23], a[112:115], v[152:155]
  ds_read_b64_tr_b16 v[34:35], v6 offset:18432
  v_cvt_pk_bf16_f32 v174, v60, v61
  v_mfma_f32_16x16x32_bf16 v[156:159], v[16:19], a[100:103], v[156:159]
  ds_read_b64_tr_b16 v[36:37], v6 offset:20480
  v_mfma_f32_16x16x32_bf16 v[156:159], v[20:23], a[116:119], v[156:159]
  ds_read_b64_tr_b16 v[38:39], v6 offset:22528
  v_mfma_f32_16x16x32_bf16 v[160:163], v[16:19], a[104:107], v[160:163]
  v_rcp_f32 v63, v63
  v_mfma_f32_16x16x32_bf16 v[160:163], v[20:23], a[120:123], v[160:163]
  ds_write_b32 v214, v174 offset:1024
  v_mul_f32 v48, v178, v48
  v_mfma_f32_16x16x32_bf16 v[164:167], v[16:19], a[108:111], v[164:167]
  v_mul_f32 v49, v178, v49
  v_mul_f32 v50, v178, v50
  v_mfma_f32_16x16x32_bf16 v[164:167], v[20:23], a[124:127], v[164:167]
  global_load_lds_dwordx4 v10, s[56:57] offset:1024
  s_waitcnt lgkmcnt(5)
  v_mfma_f32_16x16x32_bf16 v[104:107], v[24:27], a[128:131], v[104:107]
  ds_read_b64_tr_b16 v[16:17], v5 offset:24576
  v_mul_f32 v63, v63, v95
  v_mfma_f32_16x16x32_bf16 v[104:107], v[28:31], a[144:147], v[104:107]
  ds_read_b64_tr_b16 v[18:19], v5 offset:26624
  v_cvt_pk_bf16_f32 v175, v62, v63
  v_mfma_f32_16x16x32_bf16 v[108:111], v[24:27], a[132:135], v[108:111]
  ds_read_b64_tr_b16 v[20:21], v5 offset:28672
  v_mul_f32 v51, v178, v51
  v_mfma_f32_16x16x32_bf16 v[108:111], v[28:31], a[148:151], v[108:111]
  ds_read_b64_tr_b16 v[22:23], v5 offset:30720
  v_mfma_f32_16x16x32_bf16 v[112:115], v[24:27], a[136:139], v[112:115]
  v_exp_f32 v48, v48
  v_mfma_f32_16x16x32_bf16 v[112:115], v[28:31], a[152:155], v[112:115]
  ds_write_b32 v214, v175 offset:1028
  v_mfma_f32_16x16x32_bf16 v[116:119], v[24:27], a[140:143], v[116:119]
  v_exp_f32 v49, v49
  v_mfma_f32_16x16x32_bf16 v[116:119], v[28:31], a[156:159], v[116:119]
  global_load_lds_dwordx4 v11, s[56:57] offset:2048
  s_waitcnt lgkmcnt(6)
  v_mfma_f32_16x16x32_bf16 v[120:123], v[32:35], a[128:131], v[120:123]
  ds_read_b64_tr_b16 v[24:25], v6 offset:24576
  v_fma_f32 v48, v48, v182, v182
  v_mfma_f32_16x16x32_bf16 v[120:123], v[36:39], a[144:147], v[120:123]
  ds_read_b64_tr_b16 v[26:27], v6 offset:26624
  v_fma_f32 v49, v49, v182, v182
  v_mfma_f32_16x16x32_bf16 v[124:127], v[32:35], a[132:135], v[124:127]
  ds_read_b64_tr_b16 v[28:29], v6 offset:28672
  v_mfma_f32_16x16x32_bf16 v[124:127], v[36:39], a[148:151], v[124:127]
  ds_read_b64_tr_b16 v[30:31], v6 offset:30720
  v_mfma_f32_16x16x32_bf16 v[128:131], v[32:35], a[136:139], v[128:131]
  v_exp_f32 v50, v50
  v_mfma_f32_16x16x32_bf16 v[128:131], v[36:39], a[152:155], v[128:131]
  v_exp_f32 v51, v51
  v_mfma_f32_16x16x32_bf16 v[132:135], v[32:35], a[140:143], v[132:135]
  v_fma_f32 v50, v50, v182, v182
  v_fma_f32 v51, v51, v182, v182
  v_mfma_f32_16x16x32_bf16 v[132:135], v[36:39], a[156:159], v[132:135]
  global_load_lds_dwordx4 v12, s[56:57] offset:3072
  s_waitcnt lgkmcnt(5)
  v_mfma_f32_16x16x32_bf16 v[136:139], v[16:19], a[128:131], v[136:139]
  v_rcp_f32 v48, v48
  v_mfma_f32_16x16x32_bf16 v[136:139], v[20:23], a[144:147], v[136:139]
  s_waitcnt vmcnt(9) lgkmcnt(0)
  s_barrier
  v_mfma_f32_16x16x32_bf16 v[140:143], v[16:19], a[132:135], v[140:143]
  ds_read_b64_tr_b16 v[32:33], v7 offset:0
  s_add_u32 m0, s68, 16384
  v_mfma_f32_16x16x32_bf16 v[140:143], v[20:23], a[148:151], v[140:143]
  ds_read_b64_tr_b16 v[34:35], v7 offset:2048
  s_add_u32 s56, s62, s16
  v_mfma_f32_16x16x32_bf16 v[144:147], v[16:19], a[136:139], v[144:147]
  ds_read_b64_tr_b16 v[36:37], v7 offset:4096
  s_addc_u32 s57, s63, 0
  v_mfma_f32_16x16x32_bf16 v[144:147], v[20:23], a[152:155], v[144:147]
  ds_read_b64_tr_b16 v[38:39], v7 offset:6144
  v_mul_f32 v48, v48, v80
  v_mfma_f32_16x16x32_bf16 v[148:151], v[16:19], a[140:143], v[148:151]
  v_rcp_f32 v49, v49
  v_mfma_f32_16x16x32_bf16 v[148:151], v[20:23], a[156:159], v[148:151]
  global_load_lds_dwordx4 v9, s[56:57] offset:0
  v_mul_f32 v49, v49, v81
  v_mfma_f32_16x16x32_bf16 v[152:155], v[24:27], a[128:131], v[152:155]
  ds_read_b64_tr_b16 v[16:17], v8 offset:0
  v_mfma_f32_16x16x32_bf16 v[152:155], v[28:31], a[144:147], v[152:155]
  ds_read_b64_tr_b16 v[18:19], v8 offset:2048
  v_mfma_f32_16x16x32_bf16 v[156:159], v[24:27], a[132:135], v[156:159]
  ds_read_b64_tr_b16 v[20:21], v8 offset:4096
  v_cvt_pk_bf16_f32 v168, v48, v49
  v_mfma_f32_16x16x32_bf16 v[156:159], v[28:31], a[148:151], v[156:159]
  ds_read_b64_tr_b16 v[22:23], v8 offset:6144
  v_mfma_f32_16x16x32_bf16 v[160:163], v[24:27], a[136:139], v[160:163]
  v_rcp_f32 v50, v50
  v_mfma_f32_16x16x32_bf16 v[160:163], v[28:31], a[152:155], v[160:163]
  v_rcp_f32 v51, v51
  v_mfma_f32_16x16x32_bf16 v[164:167], v[24:27], a[140:143], v[164:167]
  ds_write_b32 v13, v168 offset:2048
  v_mul_f32 v64, v178, v64
  v_mfma_f32_16x16x32_bf16 v[164:167], v[28:31], a[156:159], v[164:167]
  global_load_lds_dwordx4 v10, s[56:57] offset:1024
  s_waitcnt lgkmcnt(5)
  v_mfma_f32_16x16x32_bf16 v[104:107], v[32:35], a[160:163], v[104:107]
  ds_read_b64_tr_b16 v[24:25], v7 offset:8192
  v_mul_f32 v50, v50, v82
  v_mfma_f32_16x16x32_bf16 v[104:107], v[36:39], a[176:179], v[104:107]
  ds_read_b64_tr_b16 v[26:27], v7 offset:10240
  v_mul_f32 v51, v51, v83
  v_mfma_f32_16x16x32_bf16 v[108:111], v[32:35], a[164:167], v[108:111]
  ds_read_b64_tr_b16 v[28:29], v7 offset:12288
  v_cvt_pk_bf16_f32 v169, v50, v51
  v_mfma_f32_16x16x32_bf16 v[108:111], v[36:39], a[180:183], v[108:111]
  ds_read_b64_tr_b16 v[30:31], v7 offset:14336
  v_mul_f32 v65, v178, v65
  v_mfma_f32_16x16x32_bf16 v[112:115], v[32:35], a[168:171], v[112:115]
  v_mul_f32 v66, v178, v66
  v_mul_f32 v67, v178, v67
  v_mfma_f32_16x16x32_bf16 v[112:115], v[36:39], a[184:187], v[112:115]
  ds_write_b32 v13, v169 offset:2052
  v_mfma_f32_16x16x32_bf16 v[116:119], v[32:35], a[172:175], v[116:119]
  v_exp_f32 v64, v64
  v_mfma_f32_16x16x32_bf16 v[116:119], v[36:39], a[188:191], v[116:119]
  global_load_lds_dwordx4 v11, s[56:57] offset:2048
  s_waitcnt lgkmcnt(6)
  v_mfma_f32_16x16x32_bf16 v[120:123], v[16:19], a[160:163], v[120:123]
  ds_read_b64_tr_b16 v[32:33], v8 offset:8192
  v_mfma_f32_16x16x32_bf16 v[120:123], v[20:23], a[176:179], v[120:123]
  ds_read_b64_tr_b16 v[34:35], v8 offset:10240
  v_mfma_f32_16x16x32_bf16 v[124:127], v[16:19], a[164:167], v[124:127]
  ds_read_b64_tr_b16 v[36:37], v8 offset:12288
  v_mfma_f32_16x16x32_bf16 v[124:127], v[20:23], a[180:183], v[124:127]
  ds_read_b64_tr_b16 v[38:39], v8 offset:14336
  v_fma_f32 v64, v64, v182, v182
  v_mfma_f32_16x16x32_bf16 v[128:131], v[16:19], a[168:171], v[128:131]
  v_exp_f32 v65, v65
  v_mfma_f32_16x16x32_bf16 v[128:131], v[20:23], a[184:187], v[128:131]
  v_exp_f32 v66, v66
  v_mfma_f32_16x16x32_bf16 v[132:135], v[16:19], a[172:175], v[132:135]
  v_exp_f32 v67, v67
  v_mfma_f32_16x16x32_bf16 v[132:135], v[20:23], a[188:191], v[132:135]
  global_load_lds_dwordx4 v12, s[56:57] offset:3072
  s_waitcnt lgkmcnt(5)
  v_mfma_f32_16x16x32_bf16 v[136:139], v[24:27], a[160:163], v[136:139]
  v_fma_f32 v65, v65, v182, v182
  v_fma_f32 v66, v66, v182, v182
  v_mfma_f32_16x16x32_bf16 v[136:139], v[28:31], a[176:179], v[136:139]
  s_waitcnt vmcnt(8) lgkmcnt(0)
  s_barrier
  v_mfma_f32_16x16x32_bf16 v[140:143], v[24:27], a[164:167], v[140:143]
  ds_read_b64_tr_b16 v[16:17], v7 offset:16384
  s_add_u32 m0, s50, 0
  v_mfma_f32_16x16x32_bf16 v[140:143], v[28:31], a[180:183], v[140:143]
  ds_read_b64_tr_b16 v[18:19], v7 offset:18432
  s_add_u32 s62, s52, s73
  v_mfma_f32_16x16x32_bf16 v[144:147], v[24:27], a[168:171], v[144:147]
  ds_read_b64_tr_b16 v[20:21], v7 offset:20480
  s_addc_u32 s63, s53, 0
  v_mfma_f32_16x16x32_bf16 v[144:147], v[28:31], a[184:187], v[144:147]
  ds_read_b64_tr_b16 v[22:23], v7 offset:22528
  s_add_u32 s56, s62, s8
  v_mfma_f32_16x16x32_bf16 v[148:151], v[24:27], a[172:175], v[148:151]
  s_addc_u32 s57, s63, 0
  v_fma_f32 v67, v67, v182, v182
  v_mfma_f32_16x16x32_bf16 v[148:151], v[28:31], a[188:191], v[148:151]
  global_load_lds_dwordx4 v9, s[56:57] offset:0
  v_rcp_f32 v67, v67
  v_mfma_f32_16x16x32_bf16 v[152:155], v[32:35], a[160:163], v[152:155]
  ds_read_b64_tr_b16 v[24:25], v8 offset:16384
  v_mfma_f32_16x16x32_bf16 v[152:155], v[36:39], a[176:179], v[152:155]
  ds_read_b64_tr_b16 v[26:27], v8 offset:18432
  v_mfma_f32_16x16x32_bf16 v[156:159], v[32:35], a[164:167], v[156:159]
  ds_read_b64_tr_b16 v[28:29], v8 offset:20480
  v_mfma_f32_16x16x32_bf16 v[156:159], v[36:39], a[180:183], v[156:159]
  ds_read_b64_tr_b16 v[30:31], v8 offset:22528
  v_mul_f32 v67, v67, v99
  v_mfma_f32_16x16x32_bf16 v[160:163], v[32:35], a[168:171], v[160:163]
  v_rcp_f32 v64, v64
  v_mfma_f32_16x16x32_bf16 v[160:163], v[36:39], a[184:187], v[160:163]
  v_rcp_f32 v65, v65
  v_mfma_f32_16x16x32_bf16 v[164:167], v[32:35], a[172:175], v[164:167]
  v_rcp_f32 v66, v66
  v_mfma_f32_16x16x32_bf16 v[164:167], v[36:39], a[188:191], v[164:167]
  global_load_lds_dwordx4 v10, s[56:57] offset:1024
  s_waitcnt lgkmcnt(4)
  v_mfma_f32_16x16x32_bf16 v[104:107], v[16:19], a[192:195], v[104:107]
  ds_read_b64_tr_b16 v[32:33], v7 offset:24576
  v_mul_f32 v64, v64, v96
  v_mfma_f32_16x16x32_bf16 v[104:107], v[20:23], a[208:211], v[104:107]
  ds_read_b64_tr_b16 v[34:35], v7 offset:26624
  v_mul_f32 v65, v65, v97
  v_mfma_f32_16x16x32_bf16 v[108:111], v[16:19], a[196:199], v[108:111]
  ds_read_b64_tr_b16 v[36:37], v7 offset:28672
  v_mul_f32 v66, v66, v98
  v_mfma_f32_16x16x32_bf16 v[108:111], v[20:23], a[212:215], v[108:111]
  ds_read_b64_tr_b16 v[38:39], v7 offset:30720
  v_cvt_pk_bf16_f32 v170, v64, v65
  v_mfma_f32_16x16x32_bf16 v[112:115], v[16:19], a[200:203], v[112:115]
  v_cvt_pk_bf16_f32 v171, v66, v67
  v_mul_f32 v52, v179, v52
  v_mfma_f32_16x16x32_bf16 v[112:115], v[20:23], a[216:219], v[112:115]
  ds_write_b32 v214, v170 offset:2048
  v_mul_f32 v53, v179, v53
  v_mfma_f32_16x16x32_bf16 v[116:119], v[16:19], a[204:207], v[116:119]
  ds_write_b32 v214, v171 offset:2052
  v_mul_f32 v54, v179, v54
  v_mfma_f32_16x16x32_bf16 v[116:119], v[20:23], a[220:223], v[116:119]
  global_load_lds_dwordx4 v11, s[56:57] offset:2048
  s_waitcnt lgkmcnt(6)
  v_mfma_f32_16x16x32_bf16 v[120:123], v[24:27], a[192:195], v[120:123]
  ds_read_b64_tr_b16 v[16:17], v8 offset:24576
  v_mul_f32 v55, v179, v55
  v_mfma_f32_16x16x32_bf16 v[120:123], v[28:31], a[208:211], v[120:123]
  ds_read_b64_tr_b16 v[18:19], v8 offset:26624
  v_mfma_f32_16x16x32_bf16 v[124:127], v[24:27], a[196:199], v[124:127]
  ds_read_b64_tr_b16 v[20:21], v8 offset:28672
  v_mfma_f32_16x16x32_bf16 v[124:127], v[28:31], a[212:215], v[124:127]
  ds_read_b64_tr_b16 v[22:23], v8 offset:30720
  v_mfma_f32_16x16x32_bf16 v[128:131], v[24:27], a[200:203], v[128:131]
  v_exp_f32 v52, v52
  v_mfma_f32_16x16x32_bf16 v[128:131], v[28:31], a[216:219], v[128:131]
  v_exp_f32 v53, v53
  v_mfma_f32_16x16x32_bf16 v[132:135], v[24:27], a[204:207], v[132:135]
  v_exp_f32 v54, v54
  v_mfma_f32_16x16x32_bf16 v[132:135], v[28:31], a[220:223], v[132:135]
  global_load_lds_dwordx4 v12, s[56:57] offset:3072
  s_waitcnt lgkmcnt(6)
  v_mfma_f32_16x16x32_bf16 v[136:139], v[32:35], a[192:195], v[136:139]
  v_exp_f32 v55, v55
  v_mfma_f32_16x16x32_bf16 v[136:139], v[36:39], a[208:211], v[136:139]
  s_waitcnt vmcnt(8) lgkmcnt(0)
  s_barrier
  v_mfma_f32_16x16x32_bf16 v[140:143], v[32:35], a[196:199], v[140:143]
  ds_read_b64_tr_b16 v[24:25], v5 offset:0
  s_add_u32 m0, s50, 16384
  v_mfma_f32_16x16x32_bf16 v[140:143], v[36:39], a[212:215], v[140:143]
  ds_read_b64_tr_b16 v[26:27], v5 offset:2048
  s_add_u32 s56, s62, s9
  v_mfma_f32_16x16x32_bf16 v[144:147], v[32:35], a[200:203], v[144:147]
  ds_read_b64_tr_b16 v[28:29], v5 offset:4096
  s_addc_u32 s57, s63, 0
  v_mfma_f32_16x16x32_bf16 v[144:147], v[36:39], a[216:219], v[144:147]
  ds_read_b64_tr_b16 v[30:31], v5 offset:6144
  v_fma_f32 v52, v52, v183, v183
  v_mfma_f32_16x16x32_bf16 v[148:151], v[32:35], a[204:207], v[148:151]
  v_fma_f32 v53, v53, v183, v183
  v_fma_f32 v54, v54, v183, v183
  v_mfma_f32_16x16x32_bf16 v[148:151], v[36:39], a[220:223], v[148:151]
  global_load_lds_dwordx4 v9, s[56:57] offset:0
  v_fma_f32 v55, v55, v183, v183
  v_mfma_f32_16x16x32_bf16 v[152:155], v[16:19], a[192:195], v[152:155]
  ds_read_b64_tr_b16 v[32:33], v6 offset:0
  v_mfma_f32_16x16x32_bf16 v[152:155], v[20:23], a[208:211], v[152:155]
  ds_read_b64_tr_b16 v[34:35], v6 offset:2048
  v_mfma_f32_16x16x32_bf16 v[156:159], v[16:19], a[196:199], v[156:159]
  ds_read_b64_tr_b16 v[36:37], v6 offset:4096
  v_mfma_f32_16x16x32_bf16 v[156:159], v[20:23], a[212:215], v[156:159]
  ds_read_b64_tr_b16 v[38:39], v6 offset:6144
  v_mfma_f32_16x16x32_bf16 v[160:163], v[16:19], a[200:203], v[160:163]
  v_rcp_f32 v52, v52
  v_mfma_f32_16x16x32_bf16 v[160:163], v[20:23], a[216:219], v[160:163]
  v_rcp_f32 v53, v53
  v_mfma_f32_16x16x32_bf16 v[164:167], v[16:19], a[204:207], v[164:167]
  v_rcp_f32 v54, v54
  v_mfma_f32_16x16x32_bf16 v[164:167], v[20:23], a[220:223], v[164:167]
  global_load_lds_dwordx4 v10, s[56:57] offset:1024
  s_waitcnt lgkmcnt(4)
  v_mfma_f32_16x16x32_bf16 v[104:107], v[24:27], a[224:227], v[104:107]
  ds_read_b64_tr_b16 v[16:17], v5 offset:8192
  v_mul_f32 v52, v52, v84
  v_mfma_f32_16x16x32_bf16 v[104:107], v[28:31], a[240:243], v[104:107]
  ds_read_b64_tr_b16 v[18:19], v5 offset:10240
  v_mul_f32 v53, v53, v85
  v_mfma_f32_16x16x32_bf16 v[108:111], v[24:27], a[228:231], v[108:111]
  ds_read_b64_tr_b16 v[20:21], v5 offset:12288
  v_mul_f32 v54, v54, v86
  v_mfma_f32_16x16x32_bf16 v[108:111], v[28:31], a[244:247], v[108:111]
  ds_read_b64_tr_b16 v[22:23], v5 offset:14336
  v_cvt_pk_bf16_f32 v172, v52, v53
  v_mfma_f32_16x16x32_bf16 v[112:115], v[24:27], a[232:235], v[112:115]
  v_rcp_f32 v55, v55
  v_mfma_f32_16x16x32_bf16 v[112:115], v[28:31], a[248:251], v[112:115]
  ds_write_b32 v13, v172 offset:3072
  v_mul_f32 v68, v179, v68
  v_mfma_f32_16x16x32_bf16 v[116:119], v[24:27], a[236:239], v[116:119]
  v_mul_f32 v69, v179, v69
  v_mul_f32 v70, v179, v70
  v_mfma_f32_16x16x32_bf16 v[116:119], v[28:31], a[252:255], v[116:119]
  global_load_lds_dwordx4 v11, s[56:57] offset:2048
  s_waitcnt lgkmcnt(5)
  v_mfma_f32_16x16x32_bf16 v[120:123], v[32:35], a[224:227], v[120:123]
  ds_read_b64_tr_b16 v[24:25], v6 offset:8192
  v_mul_f32 v55, v55, v87
  v_mfma_f32_16x16x32_bf16 v[120:123], v[36:39], a[240:243], v[120:123]
  ds_read_b64_tr_b16 v[26:27], v6 offset:10240
  v_cvt_pk_bf16_f32 v173, v54, v55
  v_mfma_f32_16x16x32_bf16 v[124:127], v[32:35], a[228:231], v[124:127]
  ds_read_b64_tr_b16 v[28:29], v6 offset:12288
  v_mul_f32 v71, v179, v71
  v_mfma_f32_16x16x32_bf16 v[124:127], v[36:39], a[244:247], v[124:127]
  ds_read_b64_tr_b16 v[30:31], v6 offset:14336
  v_mfma_f32_16x16x32_bf16 v[128:131], v[32:35], a[232:235], v[128:131]
  v_exp_f32 v68, v68
  v_mfma_f32_16x16x32_bf16 v[128:131], v[36:39], a[248:251], v[128:131]
  ds_write_b32 v13, v173 offset:3076
  v_mfma_f32_16x16x32_bf16 v[132:135], v[32:35], a[236:239], v[132:135]
  v_exp_f32 v69, v69
  v_mfma_f32_16x16x32_bf16 v[132:135], v[36:39], a[252:255], v[132:135]
  global_load_lds_dwordx4 v12, s[56:57] offset:3072
  s_waitcnt lgkmcnt(6)
  v_mfma_f32_16x16x32_bf16 v[136:139], v[16:19], a[224:227], v[136:139]
  v_exp_f32 v70, v70
  v_mfma_f32_16x16x32_bf16 v[136:139], v[20:23], a[240:243], v[136:139]
  s_waitcnt vmcnt(8) lgkmcnt(1)
  s_barrier
  v_mfma_f32_16x16x32_bf16 v[140:143], v[16:19], a[228:231], v[140:143]
  ds_read_b64_tr_b16 v[32:33], v5 offset:16384
  s_add_u32 m0, s68, 0
  v_mfma_f32_16x16x32_bf16 v[140:143], v[20:23], a[244:247], v[140:143]
  ds_read_b64_tr_b16 v[34:35], v5 offset:18432
  s_add_u32 s56, s62, s10
  v_mfma_f32_16x16x32_bf16 v[144:147], v[16:19], a[232:235], v[144:147]
  ds_read_b64_tr_b16 v[36:37], v5 offset:20480
  s_addc_u32 s57, s63, 0
  v_mfma_f32_16x16x32_bf16 v[144:147], v[20:23], a[248:251], v[144:147]
  ds_read_b64_tr_b16 v[38:39], v5 offset:22528
  v_fma_f32 v68, v68, v183, v183
  v_mfma_f32_16x16x32_bf16 v[148:151], v[16:19], a[236:239], v[148:151]
  v_exp_f32 v71, v71
  v_mfma_f32_16x16x32_bf16 v[148:151], v[20:23], a[252:255], v[148:151]
  global_load_lds_dwordx4 v9, s[56:57] offset:0
  v_fma_f32 v69, v69, v183, v183
  v_mfma_f32_16x16x32_bf16 v[152:155], v[24:27], a[224:227], v[152:155]
  ds_read_b64_tr_b16 v[16:17], v6 offset:16384
  v_fma_f32 v70, v70, v183, v183
  v_mfma_f32_16x16x32_bf16 v[152:155], v[28:31], a[240:243], v[152:155]
  ds_read_b64_tr_b16 v[18:19], v6 offset:18432
  v_fma_f32 v71, v71, v183, v183
  v_mfma_f32_16x16x32_bf16 v[156:159], v[24:27], a[228:231], v[156:159]
  ds_read_b64_tr_b16 v[20:21], v6 offset:20480
  v_mfma_f32_16x16x32_bf16 v[156:159], v[28:31], a[244:247], v[156:159]
  ds_read_b64_tr_b16 v[22:23], v6 offset:22528
  v_mfma_f32_16x16x32_bf16 v[160:163], v[24:27], a[232:235], v[160:163]
  v_rcp_f32 v68, v68
  v_mfma_f32_16x16x32_bf16 v[160:163], v[28:31], a[248:251], v[160:163]
  v_rcp_f32 v69, v69
  v_mfma_f32_16x16x32_bf16 v[164:167], v[24:27], a[236:239], v[164:167]
  v_rcp_f32 v70, v70
  v_mfma_f32_16x16x32_bf16 v[164:167], v[28:31], a[252:255], v[164:167]
  global_load_lds_dwordx4 v10, s[56:57] offset:1024
  s_waitcnt lgkmcnt(4)
  v_mfma_f32_16x16x32_bf16 v[104:107], v[32:35], v[224:227], v[104:107]
  ds_read_b64_tr_b16 v[24:25], v5 offset:24576
  v_mul_f32 v68, v68, v100
  v_mfma_f32_16x16x32_bf16 v[104:107], v[36:39], v[240:243], v[104:107]
  ds_read_b64_tr_b16 v[26:27], v5 offset:26624
  v_mul_f32 v69, v69, v101
  v_mfma_f32_16x16x32_bf16 v[108:111], v[32:35], v[228:231], v[108:111]
  ds_read_b64_tr_b16 v[28:29], v5 offset:28672
  v_mul_f32 v70, v70, v102
  v_mfma_f32_16x16x32_bf16 v[108:111], v[36:39], v[244:247], v[108:111]
  ds_read_b64_tr_b16 v[30:31], v5 offset:30720
  v_cvt_pk_bf16_f32 v174, v68, v69
  v_mfma_f32_16x16x32_bf16 v[112:115], v[32:35], v[232:235], v[112:115]
  v_rcp_f32 v71, v71
  v_mfma_f32_16x16x32_bf16 v[112:115], v[36:39], v[248:251], v[112:115]
  ds_write_b32 v214, v174 offset:3072
  v_mfma_f32_16x16x32_bf16 v[116:119], v[32:35], v[236:239], v[116:119]
  v_mfma_f32_16x16x32_bf16 v[116:119], v[36:39], v[252:255], v[116:119]
  global_load_lds_dwordx4 v11, s[56:57] offset:2048
  s_waitcnt lgkmcnt(5)
  v_mfma_f32_16x16x32_bf16 v[120:123], v[16:19], v[224:227], v[120:123]
  ds_read_b64_tr_b16 v[32:33], v6 offset:24576
  v_mul_f32 v71, v71, v103
  v_mfma_f32_16x16x32_bf16 v[120:123], v[20:23], v[240:243], v[120:123]
  ds_read_b64_tr_b16 v[34:35], v6 offset:26624
  v_cvt_pk_bf16_f32 v175, v70, v71
  v_mfma_f32_16x16x32_bf16 v[124:127], v[16:19], v[228:231], v[124:127]
  ds_read_b64_tr_b16 v[36:37], v6 offset:28672
  v_mfma_f32_16x16x32_bf16 v[124:127], v[20:23], v[244:247], v[124:127]
  ds_read_b64_tr_b16 v[38:39], v6 offset:30720
  v_mfma_f32_16x16x32_bf16 v[128:131], v[16:19], v[232:235], v[128:131]
  v_mfma_f32_16x16x32_bf16 v[128:131], v[20:23], v[248:251], v[128:131]
  ds_write_b32 v214, v175 offset:3076
  v_mfma_f32_16x16x32_bf16 v[132:135], v[16:19], v[236:239], v[132:135]
  v_mfma_f32_16x16x32_bf16 v[132:135], v[20:23], v[252:255], v[132:135]
  global_load_lds_dwordx4 v12, s[56:57] offset:3072
  s_waitcnt lgkmcnt(6)
  v_mfma_f32_16x16x32_bf16 v[136:139], v[24:27], v[224:227], v[136:139]
  v_mfma_f32_16x16x32_bf16 v[136:139], v[28:31], v[240:243], v[136:139]
  s_waitcnt vmcnt(8) lgkmcnt(1)
  s_barrier
  v_mfma_f32_16x16x32_bf16 v[140:143], v[24:27], v[228:231], v[140:143]
  ds_read_b64_tr_b16 v[16:17], v7 offset:0
  s_add_u32 m0, s68, 16384
  v_mfma_f32_16x16x32_bf16 v[140:143], v[28:31], v[244:247], v[140:143]
  ds_read_b64_tr_b16 v[18:19], v7 offset:2048
  s_add_u32 s56, s62, s11
  v_mfma_f32_16x16x32_bf16 v[144:147], v[24:27], v[232:235], v[144:147]
  ds_read_b64_tr_b16 v[20:21], v7 offset:4096
  s_addc_u32 s57, s63, 0
  v_mfma_f32_16x16x32_bf16 v[144:147], v[28:31], v[248:251], v[144:147]
  ds_read_b64_tr_b16 v[22:23], v7 offset:6144
  v_add_u32 v13, 16384, v13
  v_mfma_f32_16x16x32_bf16 v[148:151], v[24:27], v[236:239], v[148:151]
  v_mul_f32 v105, v176, v105
  v_mul_f32 v106, v176, v106
  v_mfma_f32_16x16x32_bf16 v[148:151], v[28:31], v[252:255], v[148:151]
  global_load_lds_dwordx4 v9, s[56:57] offset:0
  v_xor_b32 v214, 8, v13
  v_mfma_f32_16x16x32_bf16 v[152:155], v[32:35], v[224:227], v[152:155]
  ds_read_b64_tr_b16 v[24:25], v8 offset:0
  v_mul_f32 v104, v176, v104
  v_mfma_f32_16x16x32_bf16 v[152:155], v[36:39], v[240:243], v[152:155]
  ds_read_b64_tr_b16 v[26:27], v8 offset:2048
  v_mul_f32 v107, v176, v107
  v_mfma_f32_16x16x32_bf16 v[156:159], v[32:35], v[228:231], v[156:159]
  ds_read_b64_tr_b16 v[28:29], v8 offset:4096
  v_mfma_f32_16x16x32_bf16 v[156:159], v[36:39], v[244:247], v[156:159]
  ds_read_b64_tr_b16 v[30:31], v8 offset:6144
  v_mfma_f32_16x16x32_bf16 v[160:163], v[32:35], v[232:235], v[160:163]
  v_exp_f32 v104, v104
  v_mfma_f32_16x16x32_bf16 v[160:163], v[36:39], v[248:251], v[160:163]
  v_exp_f32 v105, v105
  v_mfma_f32_16x16x32_bf16 v[164:167], v[32:35], v[236:239], v[164:167]
  v_exp_f32 v106, v106
  v_mfma_f32_16x16x32_bf16 v[164:167], v[36:39], v[252:255], v[164:167]
  global_load_lds_dwordx4 v10, s[56:57] offset:1024
  s_waitcnt lgkmcnt(4)
  v_mfma_f32_16x16x32_bf16 v[40:43], v[16:19], a[0:3], 0
  ds_read_b64_tr_b16 v[32:33], v7 offset:8192
  v_fma_f32 v104, v104, v180, v180
  v_mfma_f32_16x16x32_bf16 v[40:43], v[20:23], a[16:19], v[40:43]
  ds_read_b64_tr_b16 v[34:35], v7 offset:10240
  v_fma_f32 v105, v105, v180, v180
  v_mfma_f32_16x16x32_bf16 v[44:47], v[16:19], a[4:7], 0
  ds_read_b64_tr_b16 v[36:37], v7 offset:12288
  v_fma_f32 v106, v106, v180, v180
  v_mfma_f32_16x16x32_bf16 v[44:47], v[20:23], a[20:23], v[44:47]
  ds_read_b64_tr_b16 v[38:39], v7 offset:14336
  v_mfma_f32_16x16x32_bf16 v[48:51], v[16:19], a[8:11], 0
  v_exp_f32 v107, v107
  v_mfma_f32_16x16x32_bf16 v[48:51], v[20:23], a[24:27], v[48:51]
  v_rcp_f32 v104, v104
  v_mfma_f32_16x16x32_bf16 v[52:55], v[16:19], a[12:15], 0
  v_rcp_f32 v105, v105
  v_mfma_f32_16x16x32_bf16 v[52:55], v[20:23], a[28:31], v[52:55]
  global_load_lds_dwordx4 v11, s[56:57] offset:2048
  s_waitcnt lgkmcnt(4)
  v_mfma_f32_16x16x32_bf16 v[56:59], v[24:27], a[0:3], 0
  ds_read_b64_tr_b16 v[16:17], v8 offset:8192
  v_fma_f32 v107, v107, v180, v180
  v_mfma_f32_16x16x32_bf16 v[56:59], v[28:31], a[16:19], v[56:59]
  ds_read_b64_tr_b16 v[18:19], v8 offset:10240
  v_mfma_f32_16x16x32_bf16 v[60:63], v[24:27], a[4:7], 0
  ds_read_b64_tr_b16 v[20:21], v8 offset:12288
  v_mfma_f32_16x16x32_bf16 v[60:63], v[28:31], a[20:23], v[60:63]
  ds_read_b64_tr_b16 v[22:23], v8 offset:14336
  v_mfma_f32_16x16x32_bf16 v[64:67], v[24:27], a[8:11], 0
  v_rcp_f32 v106, v106
  v_mfma_f32_16x16x32_bf16 v[64:67], v[28:31], a[24:27], v[64:67]
  v_rcp_f32 v107, v107
  v_mfma_f32_16x16x32_bf16 v[68:71], v[24:27], a[12:15], 0
  v_mul_f32 v104, v104, v136
  v_mul_f32 v105, v105, v137
  v_mfma_f32_16x16x32_bf16 v[68:71], v[28:31], a[28:31], v[68:71]
  global_load_lds_dwordx4 v12, s[56:57] offset:3072
  s_waitcnt lgkmcnt(4)
  v_mfma_f32_16x16x32_bf16 v[72:75], v[32:35], a[0:3], 0
  v_mul_f32 v106, v106, v138
  v_mul_f32 v107, v107, v139
  v_mfma_f32_16x16x32_bf16 v[72:75], v[36:39], a[16:19], v[72:75]
  s_waitcnt vmcnt(8) lgkmcnt(0)
  s_barrier
  v_mfma_f32_16x16x32_bf16 v[76:79], v[32:35], a[4:7], 0
  ds_read_b64_tr_b16 v[24:25], v7 offset:16384
  s_add_u32 m0, s50, 0
  v_mfma_f32_16x16x32_bf16 v[76:79], v[36:39], a[20:23], v[76:79]
  ds_read_b64_tr_b16 v[26:27], v7 offset:18432
  s_add_u32 s56, s62, s12
  v_mfma_f32_16x16x32_bf16 v[80:83], v[32:35], a[8:11], 0
  ds_read_b64_tr_b16 v[28:29], v7 offset:20480
  s_addc_u32 s57, s63, 0
  v_mfma_f32_16x16x32_bf16 v[80:83], v[36:39], a[24:27], v[80:83]
  ds_read_b64_tr_b16 v[30:31], v7 offset:22528
  v_cvt_pk_bf16_f32 v168, v104, v105
  v_mfma_f32_16x16x32_bf16 v[84:87], v[32:35], a[12:15], 0
  v_cvt_pk_bf16_f32 v169, v106, v107
  v_mul_f32 v120, v176, v120
  v_mfma_f32_16x16x32_bf16 v[84:87], v[36:39], a[28:31], v[84:87]
  global_load_lds_dwordx4 v9, s[56:57] offset:0
  v_mul_f32 v121, v176, v121
  v_mfma_f32_16x16x32_bf16 v[88:91], v[16:19], a[0:3], 0
  ds_read_b64_tr_b16 v[32:33], v8 offset:16384
  v_mul_f32 v122, v176, v122
  v_mfma_f32_16x16x32_bf16 v[88:91], v[20:23], a[16:19], v[88:91]
  ds_read_b64_tr_b16 v[34:35], v8 offset:18432
  v_mul_f32 v123, v176, v123
  v_mfma_f32_16x16x32_bf16 v[92:95], v[16:19], a[4:7], 0
  ds_read_b64_tr_b16 v[36:37], v8 offset:20480
  v_mfma_f32_16x16x32_bf16 v[92:95], v[20:23], a[20:23], v[92:95]
  ds_read_b64_tr_b16 v[38:39], v8 offset:22528
  v_mfma_f32_16x16x32_bf16 v[96:99], v[16:19], a[8:11], 0
  v_exp_f32 v120, v120
  v_mfma_f32_16x16x32_bf16 v[96:99], v[20:23], a[24:27], v[96:99]
  ds_write_b32 v13, v168 offset:0
  v_mfma_f32_16x16x32_bf16 v[100:103], v[16:19], a[12:15], 0
  ds_write_b32 v13, v169 offset:4
  v_mfma_f32_16x16x32_bf16 v[100:103], v[20:23], a[28:31], v[100:103]
  global_load_lds_dwordx4 v10, s[56:57] offset:1024
  s_waitcnt lgkmcnt(6)
  v_mfma_f32_16x16x32_bf16 v[40:43], v[24:27], a[32:35], v[40:43]
  ds_read_b64_tr_b16 v[16:17], v7 offset:24576
  v_mfma_f32_16x16x32_bf16 v[40:43], v[28:31], a[48:51], v[40:43]
  ds_read_b64_tr_b16 v[18:19], v7 offset:26624
  v_mfma_f32_16x16x32_bf16 v[44:47], v[24:27], a[36:39], v[44:47]
  ds_read_b64_tr_b16 v[20:21], v7 offset:28672
  v_fma_f32 v120, v120, v180, v180
  v_mfma_f32_16x16x32_bf16 v[44:47], v[28:31], a[52:55], v[44:47]
  ds_read_b64_tr_b16 v[22:23], v7 offset:30720
  v_mfma_f32_16x16x32_bf16 v[48:51], v[24:27], a[40:43], v[48:51]
  v_exp_f32 v121, v121
  v_mfma_f32_16x16x32_bf16 v[48:51], v[28:31], a[56:59], v[48:51]
  v_exp_f32 v122, v122
  v_mfma_f32_16x16x32_bf16 v[52:55], v[24:27], a[44:47], v[52:55]
  v_exp_f32 v123, v123
  v_mfma_f32_16x16x32_bf16 v[52:55], v[28:31], a[60:63], v[52:55]
  global_load_lds_dwordx4 v11, s[56:57] offset:2048
  s_waitcnt lgkmcnt(6)
  v_mfma_f32_16x16x32_bf16 v[56:59], v[32:35], a[32:35], v[56:59]
  ds_read_b64_tr_b16 v[24:25], v8 offset:24576
  v_fma_f32 v121, v121, v180, v180
  v_mfma_f32_16x16x32_bf16 v[56:59], v[36:39], a[48:51], v[56:59]
  ds_read_b64_tr_b16 v[26:27], v8 offset:26624
  v_fma_f32 v122, v122, v180, v180
  v_mfma_f32_16x16x32_bf16 v[60:63], v[32:35], a[36:39], v[60:63]
  ds_read_b64_tr_b16 v[28:29], v8 offset:28672
  v_fma_f32 v123, v123, v180, v180
  v_mfma_f32_16x16x32_bf16 v[60:63], v[36:39], a[52:55], v[60:63]
  ds_read_b64_tr_b16 v[30:31], v8 offset:30720
  v_mfma_f32_16x16x32_bf16 v[64:67], v[32:35], a[40:43], v[64:67]
  v_rcp_f32 v120, v120
  v_mfma_f32_16x16x32_bf16 v[64:67], v[36:39], a[56:59], v[64:67]
  v_rcp_f32 v121, v121
  v_mfma_f32_16x16x32_bf16 v[68:71], v[32:35], a[44:47], v[68:71]
  v_rcp_f32 v122, v122
  v_mfma_f32_16x16x32_bf16 v[68:71], v[36:39], a[60:63], v[68:71]
  global_load_lds_dwordx4 v12, s[56:57] offset:3072
  s_waitcnt lgkmcnt(4)
  v_mfma_f32_16x16x32_bf16 v[72:75], v[16:19], a[32:35], v[72:75]
  v_rcp_f32 v123, v123
  v_mfma_f32_16x16x32_bf16 v[72:75], v[20:23], a[48:51], v[72:75]
  s_waitcnt vmcnt(8) lgkmcnt(0)
  s_barrier
  v_mfma_f32_16x16x32_bf16 v[76:79], v[16:19], a[36:39], v[76:79]
  ds_read_b64_tr_b16 v[32:33], v5 offset:0
  s_add_u32 m0, s50, 16384
  v_mfma_f32_16x16x32_bf16 v[76:79], v[20:23], a[52:55], v[76:79]
  ds_read_b64_tr_b16 v[34:35], v5 offset:2048
  s_add_u32 s56, s62, s13
  v_mfma_f32_16x16x32_bf16 v[80:83], v[16:19], a[40:43], v[80:83]
  ds_read_b64_tr_b16 v[36:37], v5 offset:4096
  s_addc_u32 s57, s63, 0
  v_mfma_f32_16x16x32_bf16 v[80:83], v[20:23], a[56:59], v[80:83]
  ds_read_b64_tr_b16 v[38:39], v5 offset:6144
  v_mul_f32 v120, v120, v152
  v_mfma_f32_16x16x32_bf16 v[84:87], v[16:19], a[44:47], v[84:87]
  v_mul_f32 v121, v121, v153
  v_mul_f32 v122, v122, v154
  v_mfma_f32_16x16x32_bf16 v[84:87], v[20:23], a[60:63], v[84:87]
  global_load_lds_dwordx4 v9, s[56:57] offset:0
  v_mul_f32 v123, v123, v155
  v_mfma_f32_16x16x32_bf16 v[88:91], v[24:27], a[32:35], v[88:91]
  ds_read_b64_tr_b16 v[16:17], v6 offset:0
  v_cvt_pk_bf16_f32 v170, v120, v121
  v_mfma_f32_16x16x32_bf16 v[88:91], v[28:31], a[48:51], v[88:91]
  ds_read_b64_tr_b16 v[18:19], v6 offset:2048
  v_cvt_pk_bf16_f32 v171, v122, v123
  v_mfma_f32_16x16x32_bf16 v[92:95], v[24:27], a[36:39], v[92:95]
  ds_read_b64_tr_b16 v[20:21], v6 offset:4096
  v_mul_f32 v108, v177, v108
  v_mfma_f32_16x16x32_bf16 v[92:95], v[28:31], a[52:55], v[92:95]
  ds_read_b64_tr_b16 v[22:23], v6 offset:6144
  v_mul_f32 v109, v177, v109
  v_mfma_f32_16x16x32_bf16 v[96:99], v[24:27], a[40:43], v[96:99]
  v_exp_f32 v108, v108
  v_mfma_f32_16x16x32_bf16 v[96:99], v[28:31], a[56:59], v[96:99]
  ds_write_b32 v214, v170 offset:0
  v_mul_f32 v110, v177, v110
  v_mfma_f32_16x16x32_bf16 v[100:103], v[24:27], a[44:47], v[100:103]
  ds_write_b32 v214, v171 offset:4
  v_mul_f32 v111, v177, v111
  v_mfma_f32_16x16x32_bf16 v[100:103], v[28:31], a[60:63], v[100:103]
  global_load_lds_dwordx4 v10, s[56:57] offset:1024
  s_waitcnt lgkmcnt(6)
  v_mfma_f32_16x16x32_bf16 v[40:43], v[32:35], a[64:67], v[40:43]
  ds_read_b64_tr_b16 v[24:25], v5 offset:8192
  v_mfma_f32_16x16x32_bf16 v[40:43], v[36:39], a[80:83], v[40:43]
  ds_read_b64_tr_b16 v[26:27], v5 offset:10240
  v_mfma_f32_16x16x32_bf16 v[44:47], v[32:35], a[68:71], v[44:47]
  ds_read_b64_tr_b16 v[28:29], v5 offset:12288
  v_mfma_f32_16x16x32_bf16 v[44:47], v[36:39], a[84:87], v[44:47]
  ds_read_b64_tr_b16 v[30:31], v5 offset:14336
  v_mfma_f32_16x16x32_bf16 v[48:51], v[32:35], a[72:75], v[48:51]
  v_exp_f32 v109, v109
  v_mfma_f32_16x16x32_bf16 v[48:51], v[36:39], a[88:91], v[48:51]
  v_exp_f32 v110, v110
  v_mfma_f32_16x16x32_bf16 v[52:55], v[32:35], a[76:79], v[52:55]
  v_exp_f32 v111, v111
  v_mfma_f32_16x16x32_bf16 v[52:55], v[36:39], a[92:95], v[52:55]
  global_load_lds_dwordx4 v11, s[56:57] offset:2048
  s_waitcnt lgkmcnt(6)
  v_mfma_f32_16x16x32_bf16 v[56:59], v[16:19], a[64:67], v[56:59]
  ds_read_b64_tr_b16 v[32:33], v6 offset:8192
  v_fma_f32 v108, v108, v181, v181
  v_mfma_f32_16x16x32_bf16 v[56:59], v[20:23], a[80:83], v[56:59]
  ds_read_b64_tr_b16 v[34:35], v6 offset:10240
  v_fma_f32 v109, v109, v181, v181
  v_mfma_f32_16x16x32_bf16 v[60:63], v[16:19], a[68:71], v[60:63]
  ds_read_b64_tr_b16 v[36:37], v6 offset:12288
  v_fma_f32 v110, v110, v181, v181
  v_mfma_f32_16x16x32_bf16 v[60:63], v[20:23], a[84:87], v[60:63]
  ds_read_b64_tr_b16 v[38:39], v6 offset:14336
  v_fma_f32 v111, v111, v181, v181
  v_mfma_f32_16x16x32_bf16 v[64:67], v[16:19], a[72:75], v[64:67]
  buffer_load_dword v218, v216, s[36:39], 0 offen sc1
  v_mfma_f32_16x16x32_bf16 v[64:67], v[20:23], a[88:91], v[64:67]
  v_rcp_f32 v108, v108
  v_mfma_f32_16x16x32_bf16 v[68:71], v[16:19], a[76:79], v[68:71]
  v_rcp_f32 v109, v109
  v_mfma_f32_16x16x32_bf16 v[68:71], v[20:23], a[92:95], v[68:71]
  global_load_lds_dwordx4 v12, s[56:57] offset:3072
  s_waitcnt lgkmcnt(4)
  v_mfma_f32_16x16x32_bf16 v[72:75], v[24:27], a[64:67], v[72:75]
  v_rcp_f32 v110, v110
  v_mfma_f32_16x16x32_bf16 v[72:75], v[28:31], a[80:83], v[72:75]
  s_waitcnt vmcnt(9) lgkmcnt(0)
  s_barrier
  v_mfma_f32_16x16x32_bf16 v[76:79], v[24:27], a[68:71], v[76:79]
  ds_read_b64_tr_b16 v[16:17], v5 offset:16384
  s_add_u32 m0, s68, 0
  v_mfma_f32_16x16x32_bf16 v[76:79], v[28:31], a[84:87], v[76:79]
  ds_read_b64_tr_b16 v[18:19], v5 offset:18432
  s_add_u32 s56, s62, s14
  v_mfma_f32_16x16x32_bf16 v[80:83], v[24:27], a[72:75], v[80:83]
  ds_read_b64_tr_b16 v[20:21], v5 offset:20480
  s_addc_u32 s57, s63, 0
  v_mfma_f32_16x16x32_bf16 v[80:83], v[28:31], a[88:91], v[80:83]
  ds_read_b64_tr_b16 v[22:23], v5 offset:22528
  v_mul_f32 v108, v108, v140
  v_mfma_f32_16x16x32_bf16 v[84:87], v[24:27], a[76:79], v[84:87]
  v_rcp_f32 v111, v111
  v_mfma_f32_16x16x32_bf16 v[84:87], v[28:31], a[92:95], v[84:87]
  global_load_lds_dwordx4 v9, s[56:57] offset:0
  v_mul_f32 v109, v109, v141
  v_mfma_f32_16x16x32_bf16 v[88:91], v[32:35], a[64:67], v[88:91]
  ds_read_b64_tr_b16 v[24:25], v6 offset:16384
  v_mul_f32 v110, v110, v142
  v_mfma_f32_16x16x32_bf16 v[88:91], v[36:39], a[80:83], v[88:91]
  ds_read_b64_tr_b16 v[26:27], v6 offset:18432
  v_mul_f32 v111, v111, v143
  v_mfma_f32_16x16x32_bf16 v[92:95], v[32:35], a[68:71], v[92:95]
  ds_read_b64_tr_b16 v[28:29], v6 offset:20480
  v_cvt_pk_bf16_f32 v172, v108, v109
  v_mfma_f32_16x16x32_bf16 v[92:95], v[36:39], a[84:87], v[92:95]
  ds_read_b64_tr_b16 v[30:31], v6 offset:22528
  v_cvt_pk_bf16_f32 v173, v110, v111
  v_mfma_f32_16x16x32_bf16 v[96:99], v[32:35], a[72:75], v[96:99]
  v_mul_f32 v126, v177, v126
  v_mfma_f32_16x16x32_bf16 v[96:99], v[36:39], a[88:91], v[96:99]
  ds_write_b32 v13, v172 offset:1024
  v_mul_f32 v124, v177, v124
  v_mfma_f32_16x16x32_bf16 v[100:103], v[32:35], a[76:79], v[100:103]
  ds_write_b32 v13, v173 offset:1028
  v_mul_f32 v125, v177, v125
  v_mfma_f32_16x16x32_bf16 v[100:103], v[36:39], a[92:95], v[100:103]
  global_load_lds_dwordx4 v10, s[56:57] offset:1024
  s_waitcnt lgkmcnt(6)
  v_mfma_f32_16x16x32_bf16 v[40:43], v[16:19], a[96:99], v[40:43]
  ds_read_b64_tr_b16 v[32:33], v5 offset:24576
  v_mul_f32 v127, v177, v127
  v_mfma_f32_16x16x32_bf16 v[40:43], v[20:23], a[112:115], v[40:43]
  ds_read_b64_tr_b16 v[34:35], v5 offset:26624
  v_mfma_f32_16x16x32_bf16 v[44:47], v[16:19], a[100:103], v[44:47]
  ds_read_b64_tr_b16 v[36:37], v5 offset:28672
  v_mfma_f32_16x16x32_bf16 v[44:47], v[20:23], a[116:119], v[44:47]
  ds_read_b64_tr_b16 v[38:39], v5 offset:30720
  v_mfma_f32_16x16x32_bf16 v[48:51], v[16:19], a[104:107], v[48:51]
  v_exp_f32 v124, v124
  v_mfma_f32_16x16x32_bf16 v[48:51], v[20:23], a[120:123], v[48:51]
  v_exp_f32 v125, v125
  v_mfma_f32_16x16x32_bf16 v[52:55], v[16:19], a[108:111], v[52:55]
  v_exp_f32 v126, v126
  v_mfma_f32_16x16x32_bf16 v[52:55], v[20:23], a[124:127], v[52:55]
  global_load_lds_dwordx4 v11, s[56:57] offset:2048
  s_waitcnt lgkmcnt(6)
  v_mfma_f32_16x16x32_bf16 v[56:59], v[24:27], a[96:99], v[56:59]
  ds_read_b64_tr_b16 v[16:17], v6 offset:24576
  v_fma_f32 v124, v124, v181, v181
  v_mfma_f32_16x16x32_bf16 v[56:59], v[28:31], a[112:115], v[56:59]
  ds_read_b64_tr_b16 v[18:19], v6 offset:26624
  v_fma_f32 v125, v125, v181, v181
  v_mfma_f32_16x16x32_bf16 v[60:63], v[24:27], a[100:103], v[60:63]
  ds_read_b64_tr_b16 v[20:21], v6 offset:28672
  v_fma_f32 v126, v126, v181, v181
  v_mfma_f32_16x16x32_bf16 v[60:63], v[28:31], a[116:119], v[60:63]
  ds_read_b64_tr_b16 v[22:23], v6 offset:30720
  v_mfma_f32_16x16x32_bf16 v[64:67], v[24:27], a[104:107], v[64:67]
  v_exp_f32 v127, v127
  v_mfma_f32_16x16x32_bf16 v[64:67], v[28:31], a[120:123], v[64:67]
  v_fma_f32 v127, v127, v181, v181
  v_mfma_f32_16x16x32_bf16 v[68:71], v[24:27], a[108:111], v[68:71]
  v_rcp_f32 v124, v124
  v_mfma_f32_16x16x32_bf16 v[68:71], v[28:31], a[124:127], v[68:71]
  global_load_lds_dwordx4 v12, s[56:57] offset:3072
  s_waitcnt lgkmcnt(4)
  v_mfma_f32_16x16x32_bf16 v[72:75], v[32:35], a[96:99], v[72:75]
  v_rcp_f32 v125, v125
  v_mfma_f32_16x16x32_bf16 v[72:75], v[36:39], a[112:115], v[72:75]
  s_waitcnt vmcnt(9) lgkmcnt(0)
  s_barrier
  v_mfma_f32_16x16x32_bf16 v[76:79], v[32:35], a[100:103], v[76:79]
  ds_read_b64_tr_b16 v[24:25], v7 offset:0
  s_add_u32 m0, s68, 16384
  v_mfma_f32_16x16x32_bf16 v[76:79], v[36:39], a[116:119], v[76:79]
  ds_read_b64_tr_b16 v[26:27], v7 offset:2048
  s_add_u32 s56, s62, s15
  v_mfma_f32_16x16x32_bf16 v[80:83], v[32:35], a[104:107], v[80:83]
  ds_read_b64_tr_b16 v[28:29], v7 offset:4096
  s_addc_u32 s57, s63, 0
  v_mfma_f32_16x16x32_bf16 v[80:83], v[36:39], a[120:123], v[80:83]
  ds_read_b64_tr_b16 v[30:31], v7 offset:6144
  v_mul_f32 v124, v124, v156
  v_mfma_f32_16x16x32_bf16 v[84:87], v[32:35], a[108:111], v[84:87]
  v_rcp_f32 v126, v126
  v_mfma_f32_16x16x32_bf16 v[84:87], v[36:39], a[124:127], v[84:87]
  global_load_lds_dwordx4 v9, s[56:57] offset:0
  v_mul_f32 v125, v125, v157
  v_mfma_f32_16x16x32_bf16 v[88:91], v[16:19], a[96:99], v[88:91]
  ds_read_b64_tr_b16 v[32:33], v8 offset:0
  v_mul_f32 v126, v126, v158
  v_mfma_f32_16x16x32_bf16 v[88:91], v[20:23], a[112:115], v[88:91]
  ds_read_b64_tr_b16 v[34:35], v8 offset:2048
  v_cvt_pk_bf16_f32 v174, v124, v125
  v_mfma_f32_16x16x32_bf16 v[92:95], v[16:19], a[100:103], v[92:95]
  ds_read_b64_tr_b16 v[36:37], v8 offset:4096
  v_mfma_f32_16x16x32_bf16 v[92:95], v[20:23], a[116:119], v[92:95]
  ds_read_b64_tr_b16 v[38:39], v8 offset:6144
  v_mfma_f32_16x16x32_bf16 v[96:99], v[16:19], a[104:107], v[96:99]
  v_rcp_f32 v127, v127
  v_mfma_f32_16x16x32_bf16 v[96:99], v[20:23], a[120:123], v[96:99]
  ds_write_b32 v214, v174 offset:1024
  v_mul_f32 v112, v178, v112
  v_mfma_f32_16x16x32_bf16 v[100:103], v[16:19], a[108:111], v[100:103]
  v_mul_f32 v113, v178, v113
  v_mul_f32 v114, v178, v114
  v_mfma_f32_16x16x32_bf16 v[100:103], v[20:23], a[124:127], v[100:103]
  global_load_lds_dwordx4 v10, s[56:57] offset:1024
  s_waitcnt lgkmcnt(5)
  v_mfma_f32_16x16x32_bf16 v[40:43], v[24:27], a[128:131], v[40:43]
  ds_read_b64_tr_b16 v[16:17], v7 offset:8192
  v_mul_f32 v127, v127, v159
  v_mfma_f32_16x16x32_bf16 v[40:43], v[28:31], a[144:147], v[40:43]
  ds_read_b64_tr_b16 v[18:19], v7 offset:10240
  v_cvt_pk_bf16_f32 v175, v126, v127
  v_mfma_f32_16x16x32_bf16 v[44:47], v[24:27], a[132:135], v[44:47]
  ds_read_b64_tr_b16 v[20:21], v7 offset:12288
  v_mul_f32 v115, v178, v115
  v_mfma_f32_16x16x32_bf16 v[44:47], v[28:31], a[148:151], v[44:47]
  ds_read_b64_tr_b16 v[22:23], v7 offset:14336
  v_mfma_f32_16x16x32_bf16 v[48:51], v[24:27], a[136:139], v[48:51]
  v_exp_f32 v112, v112
  v_mfma_f32_16x16x32_bf16 v[48:51], v[28:31], a[152:155], v[48:51]
  ds_write_b32 v214, v175 offset:1028
  v_mfma_f32_16x16x32_bf16 v[52:55], v[24:27], a[140:143], v[52:55]
  v_exp_f32 v113, v113
  v_mfma_f32_16x16x32_bf16 v[52:55], v[28:31], a[156:159], v[52:55]
  global_load_lds_dwordx4 v11, s[56:57] offset:2048
  s_waitcnt lgkmcnt(6)
  v_mfma_f32_16x16x32_bf16 v[56:59], v[32:35], a[128:131], v[56:59]
  ds_read_b64_tr_b16 v[24:25], v8 offset:8192
  v_fma_f32 v112, v112, v182, v182
  v_mfma_f32_16x16x32_bf16 v[56:59], v[36:39], a[144:147], v[56:59]
  ds_read_b64_tr_b16 v[26:27], v8 offset:10240
  v_fma_f32 v113, v113, v182, v182
  v_mfma_f32_16x16x32_bf16 v[60:63], v[32:35], a[132:135], v[60:63]
  ds_read_b64_tr_b16 v[28:29], v8 offset:12288
  v_mfma_f32_16x16x32_bf16 v[60:63], v[36:39], a[148:151], v[60:63]
  ds_read_b64_tr_b16 v[30:31], v8 offset:14336
  v_mfma_f32_16x16x32_bf16 v[64:67], v[32:35], a[136:139], v[64:67]
  v_exp_f32 v114, v114
  v_mfma_f32_16x16x32_bf16 v[64:67], v[36:39], a[152:155], v[64:67]
  v_exp_f32 v115, v115
  v_mfma_f32_16x16x32_bf16 v[68:71], v[32:35], a[140:143], v[68:71]
  v_fma_f32 v114, v114, v182, v182
  v_fma_f32 v115, v115, v182, v182
  v_mfma_f32_16x16x32_bf16 v[68:71], v[36:39], a[156:159], v[68:71]
  global_load_lds_dwordx4 v12, s[56:57] offset:3072
  s_waitcnt lgkmcnt(5)
  v_mfma_f32_16x16x32_bf16 v[72:75], v[16:19], a[128:131], v[72:75]
  v_rcp_f32 v112, v112
  v_mfma_f32_16x16x32_bf16 v[72:75], v[20:23], a[144:147], v[72:75]
  s_waitcnt vmcnt(8) lgkmcnt(0)
  s_barrier
  v_mfma_f32_16x16x32_bf16 v[76:79], v[16:19], a[132:135], v[76:79]
  ds_read_b64_tr_b16 v[32:33], v7 offset:16384
  s_add_u32 m0, s50, 0
  v_mfma_f32_16x16x32_bf16 v[76:79], v[20:23], a[148:151], v[76:79]
  ds_read_b64_tr_b16 v[34:35], v7 offset:18432
  s_add_u32 s56, s62, s16
  v_mfma_f32_16x16x32_bf16 v[80:83], v[16:19], a[136:139], v[80:83]
  ds_read_b64_tr_b16 v[36:37], v7 offset:20480
  s_addc_u32 s57, s63, 0
  v_mfma_f32_16x16x32_bf16 v[80:83], v[20:23], a[152:155], v[80:83]
  ds_read_b64_tr_b16 v[38:39], v7 offset:22528
  v_mul_f32 v112, v112, v144
  v_mfma_f32_16x16x32_bf16 v[84:87], v[16:19], a[140:143], v[84:87]
  v_rcp_f32 v113, v113
  v_mfma_f32_16x16x32_bf16 v[84:87], v[20:23], a[156:159], v[84:87]
  global_load_lds_dwordx4 v9, s[56:57] offset:0
  v_mul_f32 v113, v113, v145
  v_mfma_f32_16x16x32_bf16 v[88:91], v[24:27], a[128:131], v[88:91]
  ds_read_b64_tr_b16 v[16:17], v8 offset:16384
  v_mfma_f32_16x16x32_bf16 v[88:91], v[28:31], a[144:147], v[88:91]
  ds_read_b64_tr_b16 v[18:19], v8 offset:18432
  v_mfma_f32_16x16x32_bf16 v[92:95], v[24:27], a[132:135], v[92:95]
  ds_read_b64_tr_b16 v[20:21], v8 offset:20480
  v_cvt_pk_bf16_f32 v168, v112, v113
  v_mfma_f32_16x16x32_bf16 v[92:95], v[28:31], a[148:151], v[92:95]
  ds_read_b64_tr_b16 v[22:23], v8 offset:22528
  v_mfma_f32_16x16x32_bf16 v[96:99], v[24:27], a[136:139], v[96:99]
  v_rcp_f32 v114, v114
  v_mfma_f32_16x16x32_bf16 v[96:99], v[28:31], a[152:155], v[96:99]
  v_rcp_f32 v115, v115
  v_mfma_f32_16x16x32_bf16 v[100:103], v[24:27], a[140:143], v[100:103]
  ds_write_b32 v13, v168 offset:2048
  v_mul_f32 v128, v178, v128
  v_mfma_f32_16x16x32_bf16 v[100:103], v[28:31], a[156:159], v[100:103]
  global_load_lds_dwordx4 v10, s[56:57] offset:1024
  s_waitcnt lgkmcnt(5)
  v_mfma_f32_16x16x32_bf16 v[40:43], v[32:35], a[160:163], v[40:43]
  ds_read_b64_tr_b16 v[24:25], v7 offset:24576
  v_mul_f32 v114, v114, v146
  v_mfma_f32_16x16x32_bf16 v[40:43], v[36:39], a[176:179], v[40:43]
  ds_read_b64_tr_b16 v[26:27], v7 offset:26624
  v_mul_f32 v115, v115, v147
  v_mfma_f32_16x16x32_bf16 v[44:47], v[32:35], a[164:167], v[44:47]
  ds_read_b64_tr_b16 v[28:29], v7 offset:28672
  v_cvt_pk_bf16_f32 v169, v114, v115
  v_mfma_f32_16x16x32_bf16 v[44:47], v[36:39], a[180:183], v[44:47]
  ds_read_b64_tr_b16 v[30:31], v7 offset:30720
  v_mul_f32 v129, v178, v129
  v_mfma_f32_16x16x32_bf16 v[48:51], v[32:35], a[168:171], v[48:51]
  v_mul_f32 v130, v178, v130
  v_mul_f32 v131, v178, v131
  v_mfma_f32_16x16x32_bf16 v[48:51], v[36:39], a[184:187], v[48:51]
  ds_write_b32 v13, v169 offset:2052
  v_mfma_f32_16x16x32_bf16 v[52:55], v[32:35], a[172:175], v[52:55]
  v_exp_f32 v128, v128
  v_mfma_f32_16x16x32_bf16 v[52:55], v[36:39], a[188:191], v[52:55]
  global_load_lds_dwordx4 v11, s[56:57] offset:2048
  s_waitcnt lgkmcnt(6)
  v_mfma_f32_16x16x32_bf16 v[56:59], v[16:19], a[160:163], v[56:59]
  ds_read_b64_tr_b16 v[32:33], v8 offset:24576
  v_mfma_f32_16x16x32_bf16 v[56:59], v[20:23], a[176:179], v[56:59]
  ds_read_b64_tr_b16 v[34:35], v8 offset:26624
  v_mfma_f32_16x16x32_bf16 v[60:63], v[16:19], a[164:167], v[60:63]
  ds_read_b64_tr_b16 v[36:37], v8 offset:28672
  v_mfma_f32_16x16x32_bf16 v[60:63], v[20:23], a[180:183], v[60:63]
  ds_read_b64_tr_b16 v[38:39], v8 offset:30720
  v_fma_f32 v128, v128, v182, v182
  v_mfma_f32_16x16x32_bf16 v[64:67], v[16:19], a[168:171], v[64:67]
  v_exp_f32 v129, v129
  v_mfma_f32_16x16x32_bf16 v[64:67], v[20:23], a[184:187], v[64:67]
  v_exp_f32 v130, v130
  v_mfma_f32_16x16x32_bf16 v[68:71], v[16:19], a[172:175], v[68:71]
  v_exp_f32 v131, v131
  v_mfma_f32_16x16x32_bf16 v[68:71], v[20:23], a[188:191], v[68:71]
  global_load_lds_dwordx4 v12, s[56:57] offset:3072
  s_waitcnt lgkmcnt(5)
  v_mfma_f32_16x16x32_bf16 v[72:75], v[24:27], a[160:163], v[72:75]
  v_fma_f32 v129, v129, v182, v182
  v_fma_f32 v130, v130, v182, v182
  v_mfma_f32_16x16x32_bf16 v[72:75], v[28:31], a[176:179], v[72:75]
  s_waitcnt vmcnt(8) lgkmcnt(0)
  s_barrier
  v_mfma_f32_16x16x32_bf16 v[76:79], v[24:27], a[164:167], v[76:79]
  ds_read_b64_tr_b16 v[16:17], v5 offset:0
  s_add_u32 m0, s50, 16384
  v_mfma_f32_16x16x32_bf16 v[76:79], v[28:31], a[180:183], v[76:79]
  ds_read_b64_tr_b16 v[18:19], v5 offset:2048
  s_add_u32 s62, s52, s74
  v_mfma_f32_16x16x32_bf16 v[80:83], v[24:27], a[168:171], v[80:83]
  ds_read_b64_tr_b16 v[20:21], v5 offset:4096
  s_addc_u32 s63, s53, 0
  v_mfma_f32_16x16x32_bf16 v[80:83], v[28:31], a[184:187], v[80:83]
  ds_read_b64_tr_b16 v[22:23], v5 offset:6144
  s_add_u32 s56, s62, s8
  v_mfma_f32_16x16x32_bf16 v[84:87], v[24:27], a[172:175], v[84:87]
  s_addc_u32 s57, s63, 0
  v_fma_f32 v131, v131, v182, v182
  v_mfma_f32_16x16x32_bf16 v[84:87], v[28:31], a[188:191], v[84:87]
  global_load_lds_dwordx4 v9, s[56:57] offset:0
  v_rcp_f32 v131, v131
  v_mfma_f32_16x16x32_bf16 v[88:91], v[32:35], a[160:163], v[88:91]
  ds_read_b64_tr_b16 v[24:25], v6 offset:0
  v_mfma_f32_16x16x32_bf16 v[88:91], v[36:39], a[176:179], v[88:91]
  ds_read_b64_tr_b16 v[26:27], v6 offset:2048
  v_mfma_f32_16x16x32_bf16 v[92:95], v[32:35], a[164:167], v[92:95]
  ds_read_b64_tr_b16 v[28:29], v6 offset:4096
  v_mfma_f32_16x16x32_bf16 v[92:95], v[36:39], a[180:183], v[92:95]
  ds_read_b64_tr_b16 v[30:31], v6 offset:6144
  v_mul_f32 v131, v131, v163
  v_mfma_f32_16x16x32_bf16 v[96:99], v[32:35], a[168:171], v[96:99]
  v_rcp_f32 v128, v128
  v_mfma_f32_16x16x32_bf16 v[96:99], v[36:39], a[184:187], v[96:99]
  v_rcp_f32 v129, v129
  v_mfma_f32_16x16x32_bf16 v[100:103], v[32:35], a[172:175], v[100:103]
  v_rcp_f32 v130, v130
  v_mfma_f32_16x16x32_bf16 v[100:103], v[36:39], a[188:191], v[100:103]
  global_load_lds_dwordx4 v10, s[56:57] offset:1024
  s_waitcnt lgkmcnt(4)
  v_mfma_f32_16x16x32_bf16 v[40:43], v[16:19], a[192:195], v[40:43]
  ds_read_b64_tr_b16 v[32:33], v5 offset:8192
  v_cmp_eq_u32 vcc, 0, v218
  v_mfma_f32_16x16x32_bf16 v[40:43], v[20:23], a[208:211], v[40:43]
  ds_read_b64_tr_b16 v[34:35], v5 offset:10240
  s_cmp_lg_u64 vcc, 0
  v_mfma_f32_16x16x32_bf16 v[44:47], v[16:19], a[196:199], v[44:47]
  ds_read_b64_tr_b16 v[36:37], v5 offset:12288
  s_cbranch_scc1 L_f_dbg_slow
L_f_dbgok:
  v_mfma_f32_16x16x32_bf16 v[44:47], v[20:23], a[212:215], v[44:47]
  ds_read_b64_tr_b16 v[38:39], v5 offset:14336
  v_mul_f32 v128, v128, v160
  v_mfma_f32_16x16x32_bf16 v[48:51], v[16:19], a[200:203], v[48:51]
  v_mul_f32 v129, v129, v161
  v_mul_f32 v130, v130, v162
  v_mfma_f32_16x16x32_bf16 v[48:51], v[20:23], a[216:219], v[48:51]
  v_mul_f32 v116, v179, v116
  v_mul_f32 v117, v179, v117
  v_mfma_f32_16x16x32_bf16 v[52:55], v[16:19], a[204:207], v[52:55]
  v_mul_f32 v118, v179, v118
  v_mul_f32 v119, v179, v119
  v_mfma_f32_16x16x32_bf16 v[52:55], v[20:23], a[220:223], v[52:55]
  global_load_lds_dwordx4 v11, s[56:57] offset:2048
  s_waitcnt lgkmcnt(4)
  v_mfma_f32_16x16x32_bf16 v[56:59], v[24:27], a[192:195], v[56:59]
  ds_read_b64_tr_b16 v[16:17], v6 offset:8192
  v_cvt_pk_bf16_f32 v170, v128, v129
  v_mfma_f32_16x16x32_bf16 v[56:59], v[28:31], a[208:211], v[56:59]
  ds_read_b64_tr_b16 v[18:19], v6 offset:10240
  v_cvt_pk_bf16_f32 v171, v130, v131
  v_mfma_f32_16x16x32_bf16 v[60:63], v[24:27], a[196:199], v[60:63]
  ds_read_b64_tr_b16 v[20:21], v6 offset:12288
  ds_write_b32 v214, v170 offset:2048
  v_mfma_f32_16x16x32_bf16 v[60:63], v[28:31], a[212:215], v[60:63]
  ds_read_b64_tr_b16 v[22:23], v6 offset:14336
  v_mfma_f32_16x16x32_bf16 v[64:67], v[24:27], a[200:203], v[64:67]
  ds_write_b32 v214, v171 offset:2052
  v_mfma_f32_16x16x32_bf16 v[64:67], v[28:31], a[216:219], v[64:67]
  v_exp_f32 v116, v116
  v_mfma_f32_16x16x32_bf16 v[68:71], v[24:27], a[204:207], v[68:71]
  v_exp_f32 v117, v117
  v_mfma_f32_16x16x32_bf16 v[68:71], v[28:31], a[220:223], v[68:71]
  global_load_lds_dwordx4 v12, s[56:57] offset:3072
  s_waitcnt lgkmcnt(6)
  v_mfma_f32_16x16x32_bf16 v[72:75], v[32:35], a[192:195], v[72:75]
  v_exp_f32 v118, v118
  v_mfma_f32_16x16x32_bf16 v[72:75], v[36:39], a[208:211], v[72:75]
  s_waitcnt vmcnt(8) lgkmcnt(1)
  s_barrier
  v_mfma_f32_16x16x32_bf16 v[76:79], v[32:35], a[196:199], v[76:79]
  ds_read_b64_tr_b16 v[24:25], v5 offset:16384
  s_add_u32 m0, s68, 0
  v_mfma_f32_16x16x32_bf16 v[76:79], v[36:39], a[212:215], v[76:79]
  ds_read_b64_tr_b16 v[26:27], v5 offset:18432
  s_add_u32 s56, s62, s9
  v_mfma_f32_16x16x32_bf16 v[80:83], v[32:35], a[200:203], v[80:83]
  ds_read_b64_tr_b16 v[28:29], v5 offset:20480
  s_addc_u32 s57, s63, 0
  v_mfma_f32_16x16x32_bf16 v[80:83], v[36:39], a[216:219], v[80:83]
  ds_read_b64_tr_b16 v[30:31], v5 offset:22528
  v_fma_f32 v116, v116, v183, v183
  v_mfma_f32_16x16x32_bf16 v[84:87], v[32:35], a[204:207], v[84:87]
  v_exp_f32 v119, v119
  v_mfma_f32_16x16x32_bf16 v[84:87], v[36:39], a[220:223], v[84:87]
  global_load_lds_dwordx4 v9, s[56:57] offset:0
  v_fma_f32 v117, v117, v183, v183
  v_mfma_f32_16x16x32_bf16 v[88:91], v[16:19], a[192:195], v[88:91]
  ds_read_b64_tr_b16 v[32:33], v6 offset:16384
  v_fma_f32 v118, v118, v183, v183
  v_mfma_f32_16x16x32_bf16 v[88:91], v[20:23], a[208:211], v[88:91]
  ds_read_b64_tr_b16 v[34:35], v6 offset:18432
  v_fma_f32 v119, v119, v183, v183
  v_mfma_f32_16x16x32_bf16 v[92:95], v[16:19], a[196:199], v[92:95]
  ds_read_b64_tr_b16 v[36:37], v6 offset:20480
  v_mfma_f32_16x16x32_bf16 v[92:95], v[20:23], a[212:215], v[92:95]
  ds_read_b64_tr_b16 v[38:39], v6 offset:22528
  v_mfma_f32_16x16x32_bf16 v[96:99], v[16:19], a[200:203], v[96:99]
  v_rcp_f32 v116, v116
  v_mfma_f32_16x16x32_bf16 v[96:99], v[20:23], a[216:219], v[96:99]
  v_rcp_f32 v117, v117
  v_mfma_f32_16x16x32_bf16 v[100:103], v[16:19], a[204:207], v[100:103]
  v_rcp_f32 v118, v118
  v_mfma_f32_16x16x32_bf16 v[100:103], v[20:23], a[220:223], v[100:103]
  global_load_lds_dwordx4 v10, s[56:57] offset:1024
  s_waitcnt lgkmcnt(4)
  v_mfma_f32_16x16x32_bf16 v[40:43], v[24:27], a[224:227], v[40:43]
  ds_read_b64_tr_b16 v[16:17], v5 offset:24576
  v_mul_f32 v116, v116, v148
  v_mfma_f32_16x16x32_bf16 v[40:43], v[28:31], a[240:243], v[40:43]
  ds_read_b64_tr_b16 v[18:19], v5 offset:26624
  v_mul_f32 v117, v117, v149
  v_mfma_f32_16x16x32_bf16 v[44:47], v[24:27], a[228:231], v[44:47]
  ds_read_b64_tr_b16 v[20:21], v5 offset:28672
  v_mul_f32 v118, v118, v150
  v_mfma_f32_16x16x32_bf16 v[44:47], v[28:31], a[244:247], v[44:47]
  ds_read_b64_tr_b16 v[22:23], v5 offset:30720
  v_cvt_pk_bf16_f32 v172, v116, v117
  v_mfma_f32_16x16x32_bf16 v[48:51], v[24:27], a[232:235], v[48:51]
  v_rcp_f32 v119, v119
  v_mfma_f32_16x16x32_bf16 v[48:51], v[28:31], a[248:251], v[48:51]
  ds_write_b32 v13, v172 offset:3072
  v_mul_f32 v132, v179, v132
  v_mfma_f32_16x16x32_bf16 v[52:55], v[24:27], a[236:239], v[52:55]
  v_mul_f32 v133, v179, v133
  v_mul_f32 v134, v179, v134
  v_mfma_f32_16x16x32_bf16 v[52:55], v[28:31], a[252:255], v[52:55]
  global_load_lds_dwordx4 v11, s[56:57] offset:2048
  s_waitcnt lgkmcnt(5)
  v_mfma_f32_16x16x32_bf16 v[56:59], v[32:35], a[224:227], v[56:59]
  ds_read_b64_tr_b16 v[24:25], v6 offset:24576
  v_mul_f32 v119, v119, v151
  v_mfma_f32_16x16x32_bf16 v[56:59], v[36:39], a[240:243], v[56:59]
  ds_read_b64_tr_b16 v[26:27], v6 offset:26624
  v_cvt_pk_bf16_f32 v173, v118, v119
  v_mfma_f32_16x16x32_bf16 v[60:63], v[32:35], a[228:231], v[60:63]
  ds_read_b64_tr_b16 v[28:29], v6 offset:28672
  v_mul_f32 v135, v179, v135
  v_mfma_f32_16x16x32_bf16 v[60:63], v[36:39], a[244:247], v[60:63]
  ds_read_b64_tr_b16 v[30:31], v6 offset:30720
  v_mfma_f32_16x16x32_bf16 v[64:67], v[32:35], a[232:235], v[64:67]
  v_exp_f32 v132, v132
  v_mfma_f32_16x16x32_bf16 v[64:67], v[36:39], a[248:251], v[64:67]
  ds_write_b32 v13, v173 offset:3076
  v_mfma_f32_16x16x32_bf16 v[68:71], v[32:35], a[236:239], v[68:71]
  v_exp_f32 v133, v133
  v_mfma_f32_16x16x32_bf16 v[68:71], v[36:39], a[252:255], v[68:71]
  global_load_lds_dwordx4 v12, s[56:57] offset:3072
  s_waitcnt lgkmcnt(6)
  v_mfma_f32_16x16x32_bf16 v[72:75], v[16:19], a[224:227], v[72:75]
  v_exp_f32 v134, v134
  v_mfma_f32_16x16x32_bf16 v[72:75], v[20:23], a[240:243], v[72:75]
  s_waitcnt vmcnt(8) lgkmcnt(1)
  s_barrier
  v_mfma_f32_16x16x32_bf16 v[76:79], v[16:19], a[228:231], v[76:79]
  ds_read_b64_tr_b16 v[32:33], v7 offset:0
  s_add_u32 m0, s68, 16384
  v_mfma_f32_16x16x32_bf16 v[76:79], v[20:23], a[244:247], v[76:79]
  ds_read_b64_tr_b16 v[34:35], v7 offset:2048
  s_add_u32 s56, s62, s10
  v_mfma_f32_16x16x32_bf16 v[80:83], v[16:19], a[232:235], v[80:83]
  ds_read_b64_tr_b16 v[36:37], v7 offset:4096
  s_addc_u32 s57, s63, 0
  v_mfma_f32_16x16x32_bf16 v[80:83], v[20:23], a[248:251], v[80:83]
  ds_read_b64_tr_b16 v[38:39], v7 offset:6144
  v_fma_f32 v132, v132, v183, v183
  v_mfma_f32_16x16x32_bf16 v[84:87], v[16:19], a[236:239], v[84:87]
  v_exp_f32 v135, v135
  v_mfma_f32_16x16x32_bf16 v[84:87], v[20:23], a[252:255], v[84:87]
  global_load_lds_dwordx4 v9, s[56:57] offset:0
  v_fma_f32 v133, v133, v183, v183
  v_mfma_f32_16x16x32_bf16 v[88:91], v[24:27], a[224:227], v[88:91]
  ds_read_b64_tr_b16 v[16:17], v8 offset:0
  v_fma_f32 v134, v134, v183, v183
  v_mfma_f32_16x16x32_bf16 v[88:91], v[28:31], a[240:243], v[88:91]
  ds_read_b64_tr_b16 v[18:19], v8 offset:2048
  v_fma_f32 v135, v135, v183, v183
  v_mfma_f32_16x16x32_bf16 v[92:95], v[24:27], a[228:231], v[92:95]
  ds_read_b64_tr_b16 v[20:21], v8 offset:4096
  v_mfma_f32_16x16x32_bf16 v[92:95], v[28:31], a[244:247], v[92:95]
  ds_read_b64_tr_b16 v[22:23], v8 offset:6144
  v_mfma_f32_16x16x32_bf16 v[96:99], v[24:27], a[232:235], v[96:99]
  v_rcp_f32 v132, v132
  v_mfma_f32_16x16x32_bf16 v[96:99], v[28:31], a[248:251], v[96:99]
  v_rcp_f32 v133, v133
  v_mfma_f32_16x16x32_bf16 v[100:103], v[24:27], a[236:239], v[100:103]
  v_rcp_f32 v134, v134
  v_mfma_f32_16x16x32_bf16 v[100:103], v[28:31], a[252:255], v[100:103]
  global_load_lds_dwordx4 v10, s[56:57] offset:1024
  s_waitcnt lgkmcnt(4)
  v_mfma_f32_16x16x32_bf16 v[40:43], v[32:35], v[224:227], v[40:43]
  ds_read_b64_tr_b16 v[24:25], v7 offset:8192
  v_mul_f32 v132, v132, v164
  v_mfma_f32_16x16x32_bf16 v[40:43], v[36:39], v[240:243], v[40:43]
  ds_read_b64_tr_b16 v[26:27], v7 offset:10240
  v_mul_f32 v133, v133, v165
  v_mfma_f32_16x16x32_bf16 v[44:47], v[32:35], v[228:231], v[44:47]
  ds_read_b64_tr_b16 v[28:29], v7 offset:12288
  v_mul_f32 v134, v134, v166
  v_mfma_f32_16x16x32_bf16 v[44:47], v[36:39], v[244:247], v[44:47]
  ds_read_b64_tr_b16 v[30:31], v7 offset:14336
  v_cvt_pk_bf16_f32 v174, v132, v133
  v_mfma_f32_16x16x32_bf16 v[48:51], v[32:35], v[232:235], v[48:51]
  v_rcp_f32 v135, v135
  v_mfma_f32_16x16x32_bf16 v[48:51], v[36:39], v[248:251], v[48:51]
  ds_write_b32 v214, v174 offset:3072
  v_mfma_f32_16x16x32_bf16 v[52:55], v[32:35], v[236:239], v[52:55]
  v_mfma_f32_16x16x32_bf16 v[52:55], v[36:39], v[252:255], v[52:55]
  global_load_lds_dwordx4 v11, s[56:57] offset:2048
  s_waitcnt lgkmcnt(5)
  v_mfma_f32_16x16x32_bf16 v[56:59], v[16:19], v[224:227], v[56:59]
  ds_read_b64_tr_b16 v[32:33], v8 offset:8192
  v_mul_f32 v135, v135, v167
  v_mfma_f32_16x16x32_bf16 v[56:59], v[20:23], v[240:243], v[56:59]
  ds_read_b64_tr_b16 v[34:35], v8 offset:10240
  v_cvt_pk_bf16_f32 v175, v134, v135
  v_mfma_f32_16x16x32_bf16 v[60:63], v[16:19], v[228:231], v[60:63]
  ds_read_b64_tr_b16 v[36:37], v8 offset:12288
  v_mfma_f32_16x16x32_bf16 v[60:63], v[20:23], v[244:247], v[60:63]
  ds_read_b64_tr_b16 v[38:39], v8 offset:14336
  v_mfma_f32_16x16x32_bf16 v[64:67], v[16:19], v[232:235], v[64:67]
  v_mfma_f32_16x16x32_bf16 v[64:67], v[20:23], v[248:251], v[64:67]
  ds_write_b32 v214, v175 offset:3076
  v_mfma_f32_16x16x32_bf16 v[68:71], v[16:19], v[236:239], v[68:71]
  v_mfma_f32_16x16x32_bf16 v[68:71], v[20:23], v[252:255], v[68:71]
  global_load_lds_dwordx4 v12, s[56:57] offset:3072
  s_waitcnt lgkmcnt(6)
  v_mfma_f32_16x16x32_bf16 v[72:75], v[24:27], v[224:227], v[72:75]
  v_mfma_f32_16x16x32_bf16 v[72:75], v[28:31], v[240:243], v[72:75]
  s_waitcnt vmcnt(8) lgkmcnt(1)
  s_barrier
  v_mfma_f32_16x16x32_bf16 v[76:79], v[24:27], v[228:231], v[76:79]
  ds_read_b64_tr_b16 v[16:17], v7 offset:16384
  s_add_u32 m0, s50, 0
  v_mfma_f32_16x16x32_bf16 v[76:79], v[28:31], v[244:247], v[76:79]
  ds_read_b64_tr_b16 v[18:19], v7 offset:18432
  s_add_u32 s56, s62, s11
  v_mfma_f32_16x16x32_bf16 v[80:83], v[24:27], v[232:235], v[80:83]
  ds_read_b64_tr_b16 v[20:21], v7 offset:20480
  s_addc_u32 s57, s63, 0
  v_mfma_f32_16x16x32_bf16 v[80:83], v[28:31], v[248:251], v[80:83]
  ds_read_b64_tr_b16 v[22:23], v7 offset:22528
  v_add_u32 v13, 16384, v13
  v_mfma_f32_16x16x32_bf16 v[84:87], v[24:27], v[236:239], v[84:87]
  v_mul_f32 v41, v176, v41
  v_mul_f32 v42, v176, v42
  v_mfma_f32_16x16x32_bf16 v[84:87], v[28:31], v[252:255], v[84:87]
  global_load_lds_dwordx4 v9, s[56:57] offset:0
  v_xor_b32 v214, 8, v13
  v_mfma_f32_16x16x32_bf16 v[88:91], v[32:35], v[224:227], v[88:91]
  ds_read_b64_tr_b16 v[24:25], v8 offset:16384
  v_mul_f32 v40, v176, v40
  v_mfma_f32_16x16x32_bf16 v[88:91], v[36:39], v[240:243], v[88:91]
  ds_read_b64_tr_b16 v[26:27], v8 offset:18432
  v_mul_f32 v43, v176, v43
  v_mfma_f32_16x16x32_bf16 v[92:95], v[32:35], v[228:231], v[92:95]
  ds_read_b64_tr_b16 v[28:29], v8 offset:20480
  v_mfma_f32_16x16x32_bf16 v[92:95], v[36:39], v[244:247], v[92:95]
  ds_read_b64_tr_b16 v[30:31], v8 offset:22528
  v_mfma_f32_16x16x32_bf16 v[96:99], v[32:35], v[232:235], v[96:99]
  v_exp_f32 v40, v40
  v_mfma_f32_16x16x32_bf16 v[96:99], v[36:39], v[248:251], v[96:99]
  v_exp_f32 v41, v41
  v_mfma_f32_16x16x32_bf16 v[100:103], v[32:35], v[236:239], v[100:103]
  v_exp_f32 v42, v42
  v_mfma_f32_16x16x32_bf16 v[100:103], v[36:39], v[252:255], v[100:103]
  global_load_lds_dwordx4 v10, s[56:57] offset:1024
  s_waitcnt lgkmcnt(4)
  v_mfma_f32_16x16x32_bf16 v[104:107], v[16:19], a[0:3], 0
  ds_read_b64_tr_b16 v[32:33], v7 offset:24576
  v_fma_f32 v40, v40, v180, v180
  v_mfma_f32_16x16x32_bf16 v[104:107], v[20:23], a[16:19], v[104:107]
  ds_read_b64_tr_b16 v[34:35], v7 offset:26624
  v_fma_f32 v41, v41, v180, v180
  v_mfma_f32_16x16x32_bf16 v[108:111], v[16:19], a[4:7], 0
  ds_read_b64_tr_b16 v[36:37], v7 offset:28672
  v_fma_f32 v42, v42, v180, v180
  v_mfma_f32_16x16x32_bf16 v[108:111], v[20:23], a[20:23], v[108:111]
  ds_read_b64_tr_b16 v[38:39], v7 offset:30720
  v_mfma_f32_16x16x32_bf16 v[112:115], v[16:19], a[8:11], 0
  v_exp_f32 v43, v43
  v_mfma_f32_16x16x32_bf16 v[112:115], v[20:23], a[24:27], v[112:115]
  v_rcp_f32 v40, v40
  v_mfma_f32_16x16x32_bf16 v[116:119], v[16:19], a[12:15], 0
  v_rcp_f32 v41, v41
  v_mfma_f32_16x16x32_bf16 v[116:119], v[20:23], a[28:31], v[116:119]
  global_load_lds_dwordx4 v11, s[56:57] offset:2048
  s_waitcnt lgkmcnt(4)
  v_mfma_f32_16x16x32_bf16 v[120:123], v[24:27], a[0:3], 0
  ds_read_b64_tr_b16 v[16:17], v8 offset:24576
  v_fma_f32 v43, v43, v180, v180
  v_mfma_f32_16x16x32_bf16 v[120:123], v[28:31], a[16:19], v[120:123]
  ds_read_b64_tr_b16 v[18:19], v8 offset:26624
  v_mfma_f32_16x16x32_bf16 v[124:127], v[24:27], a[4:7], 0
  ds_read_b64_tr_b16 v[20:21], v8 offset:28672
  v_mfma_f32_16x16x32_bf16 v[124:127], v[28:31], a[20:23], v[124:127]
  ds_read_b64_tr_b16 v[22:23], v8 offset:30720
  v_mfma_f32_16x16x32_bf16 v[128:131], v[24:27], a[8:11], 0
  v_rcp_f32 v42, v42
  v_mfma_f32_16x16x32_bf16 v[128:131], v[28:31], a[24:27], v[128:131]
  v_rcp_f32 v43, v43
  v_mfma_f32_16x16x32_bf16 v[132:135], v[24:27], a[12:15], 0
  v_mul_f32 v40, v40, v72
  v_mul_f32 v41, v41, v73
  v_mfma_f32_16x16x32_bf16 v[132:135], v[28:31], a[28:31], v[132:135]
  global_load_lds_dwordx4 v12, s[56:57] offset:3072
  s_waitcnt lgkmcnt(4)
  v_mfma_f32_16x16x32_bf16 v[136:139], v[32:35], a[0:3], 0
  v_mul_f32 v42, v42, v74
  v_mul_f32 v43, v43, v75
  v_mfma_f32_16x16x32_bf16 v[136:139], v[36:39], a[16:19], v[136:139]
  s_waitcnt vmcnt(8) lgkmcnt(0)
  s_barrier
  v_mfma_f32_16x16x32_bf16 v[140:143], v[32:35], a[4:7], 0
  ds_read_b64_tr_b16 v[24:25], v5 offset:0
  s_add_u32 m0, s50, 16384
  v_mfma_f32_16x16x32_bf16 v[140:143], v[36:39], a[20:23], v[140:143]
  ds_read_b64_tr_b16 v[26:27], v5 offset:2048
  s_add_u32 s56, s62, s12
  v_mfma_f32_16x16x32_bf16 v[144:147], v[32:35], a[8:11], 0
  ds_read_b64_tr_b16 v[28:29], v5 offset:4096
  s_addc_u32 s57, s63, 0
  v_mfma_f32_16x16x32_bf16 v[144:147], v[36:39], a[24:27], v[144:147]
  ds_read_b64_tr_b16 v[30:31], v5 offset:6144
  v_cvt_pk_bf16_f32 v168, v40, v41
  v_mfma_f32_16x16x32_bf16 v[148:151], v[32:35], a[12:15], 0
  v_cvt_pk_bf16_f32 v169, v42, v43
  v_mul_f32 v56, v176, v56
  v_mfma_f32_16x16x32_bf16 v[148:151], v[36:39], a[28:31], v[148:151]
  global_load_lds_dwordx4 v9, s[56:57] offset:0
  v_mul_f32 v57, v176, v57
  v_mfma_f32_16x16x32_bf16 v[152:155], v[16:19], a[0:3], 0
  ds_read_b64_tr_b16 v[32:33], v6 offset:0
  v_mul_f32 v58, v176, v58
  v_mfma_f32_16x16x32_bf16 v[152:155], v[20:23], a[16:19], v[152:155]
  ds_read_b64_tr_b16 v[34:35], v6 offset:2048
  v_mul_f32 v59, v176, v59
  v_mfma_f32_16x16x32_bf16 v[156:159], v[16:19], a[4:7], 0
  ds_read_b64_tr_b16 v[36:37], v6 offset:4096
  v_mfma_f32_16x16x32_bf16 v[156:159], v[20:23], a[20:23], v[156:159]
  ds_read_b64_tr_b16 v[38:39], v6 offset:6144
  v_mfma_f32_16x16x32_bf16 v[160:163], v[16:19], a[8:11], 0
  v_exp_f32 v56, v56
  v_mfma_f32_16x16x32_bf16 v[160:163], v[20:23], a[24:27], v[160:163]
  ds_write_b32 v13, v168 offset:0
  v_mfma_f32_16x16x32_bf16 v[164:167], v[16:19], a[12:15], 0
  ds_write_b32 v13, v169 offset:4
  v_mfma_f32_16x16x32_bf16 v[164:167], v[20:23], a[28:31], v[164:167]
  global_load_lds_dwordx4 v10, s[56:57] offset:1024
  s_waitcnt lgkmcnt(6)
  v_mfma_f32_16x16x32_bf16 v[104:107], v[24:27], a[32:35], v[104:107]
  ds_read_b64_tr_b16 v[16:17], v5 offset:8192
  v_mfma_f32_16x16x32_bf16 v[104:107], v[28:31], a[48:51], v[104:107]
  ds_read_b64_tr_b16 v[18:19], v5 offset:10240
  v_mfma_f32_16x16x32_bf16 v[108:111], v[24:27], a[36:39], v[108:111]
  ds_read_b64_tr_b16 v[20:21], v5 offset:12288
  v_fma_f32 v56, v56, v180, v180
  v_mfma_f32_16x16x32_bf16 v[108:111], v[28:31], a[52:55], v[108:111]
  ds_read_b64_tr_b16 v[22:23], v5 offset:14336
  v_mfma_f32_16x16x32_bf16 v[112:115], v[24:27], a[40:43], v[112:115]
  v_exp_f32 v57, v57
  v_mfma_f32_16x16x32_bf16 v[112:115], v[28:31], a[56:59], v[112:115]
  v_exp_f32 v58, v58
  v_mfma_f32_16x16x32_bf16 v[116:119], v[24:27], a[44:47], v[116:119]
  v_exp_f32 v59, v59
  v_rcp_f32 v56, v56
  v_mfma_f32_16x16x32_bf16 v[116:119], v[28:31], a[60:63], v[116:119]
  global_load_lds_dwordx4 v11, s[56:57] offset:2048
  v_fma_f32 v59, v59, v180, v180
  s_waitcnt lgkmcnt(6)
  v_mfma_f32_16x16x32_bf16 v[120:123], v[32:35], a[32:35], v[120:123]
  ds_read_b64_tr_b16 v[24:25], v6 offset:8192
  s_mov_b32 s73, s75
  v_mfma_f32_16x16x32_bf16 v[120:123], v[36:39], a[48:51], v[120:123]
  ds_read_b64_tr_b16 v[26:27], v6 offset:10240
  s_mov_b32 s74, s76
  v_mfma_f32_16x16x32_bf16 v[124:127], v[32:35], a[36:39], v[124:127]
  ds_read_b64_tr_b16 v[28:29], v6 offset:12288
  s_xor_b32 s50, s50, 32768
  v_mfma_f32_16x16x32_bf16 v[124:127], v[36:39], a[52:55], v[124:127]
  ds_read_b64_tr_b16 v[30:31], v6 offset:14336
  s_xor_b32 s68, s68, 32768
  v_mfma_f32_16x16x32_bf16 v[128:131], v[32:35], a[40:43], v[128:131]
  v_xor_b32 v7, 32768, v7
  v_xor_b32 v8, 32768, v8
  v_mfma_f32_16x16x32_bf16 v[128:131], v[36:39], a[56:59], v[128:131]
  v_xor_b32 v5, 32768, v5
  v_xor_b32 v6, 32768, v6
  v_mfma_f32_16x16x32_bf16 v[132:135], v[32:35], a[44:47], v[132:135]
  v_fma_f32 v57, v57, v180, v180
  v_fma_f32 v58, v58, v180, v180
  v_mfma_f32_16x16x32_bf16 v[132:135], v[36:39], a[60:63], v[132:135]
  global_load_lds_dwordx4 v12, s[56:57] offset:3072
  s_waitcnt lgkmcnt(4)
  v_mfma_f32_16x16x32_bf16 v[136:139], v[16:19], a[32:35], v[136:139]
  s_xor_b32 s18, s18, 1
  s_cbranch_scc1 L_loop1
  v_mfma_f32_16x16x32_bf16 v[136:139], v[20:23], a[48:51], v[136:139]
  s_waitcnt vmcnt(8) lgkmcnt(0)
  s_barrier
  v_mfma_f32_16x16x32_bf16 v[140:143], v[16:19], a[36:39], v[140:143]
  ds_read_b64_tr_b16 v[32:33], v7 offset:16384
  s_add_u32 m0, s50, 0
  v_mfma_f32_16x16x32_bf16 v[140:143], v[20:23], a[52:55], v[140:143]
  ds_read_b64_tr_b16 v[34:35], v7 offset:18432
  s_add_u32 s56, s62, s13
  v_mfma_f32_16x16x32_bf16 v[144:147], v[16:19], a[40:43], v[144:147]
  ds_read_b64_tr_b16 v[36:37], v7 offset:20480
  s_addc_u32 s57, s63, 0
  v_mfma_f32_16x16x32_bf16 v[144:147], v[20:23], a[56:59], v[144:147]
  ds_read_b64_tr_b16 v[38:39], v7 offset:22528
  v_rcp_f32 v57, v57
  v_mfma_f32_16x16x32_bf16 v[148:151], v[16:19], a[44:47], v[148:151]
  ds_read_b128 a[0:3], v14 offset:16384
  v_rcp_f32 v58, v58
  v_mfma_f32_16x16x32_bf16 v[148:151], v[20:23], a[60:63], v[148:151]
  global_load_lds_dwordx4 v9, s[56:57] offset:0
  v_rcp_f32 v59, v59
  v_mfma_f32_16x16x32_bf16 v[152:155], v[24:27], a[32:35], v[152:155]
  ds_read_b64_tr_b16 v[16:17], v8 offset:16384
  v_mul_f32 v56, v56, v88
  v_mfma_f32_16x16x32_bf16 v[152:155], v[28:31], a[48:51], v[152:155]
  ds_read_b64_tr_b16 v[18:19], v8 offset:18432
  v_mul_f32 v57, v57, v89
  v_mfma_f32_16x16x32_bf16 v[156:159], v[24:27], a[36:39], v[156:159]
  ds_read_b64_tr_b16 v[20:21], v8 offset:20480
  v_mul_f32 v58, v58, v90
  v_mfma_f32_16x16x32_bf16 v[156:159], v[28:31], a[52:55], v[156:159]
  ds_read_b64_tr_b16 v[22:23], v8 offset:22528
  v_mul_f32 v59, v59, v91
  v_mfma_f32_16x16x32_bf16 v[160:163], v[24:27], a[40:43], v[160:163]
  ds_read_b128 a[4:7], v14 offset:17408
  v_cvt_pk_bf16_f32 v170, v56, v57
  v_mfma_f32_16x16x32_bf16 v[160:163], v[28:31], a[56:59], v[160:163]
  ds_write_b32 v214, v170 offset:0
  v_mul_f32 v44, v177, v44
  v_mfma_f32_16x16x32_bf16 v[164:167], v[24:27], a[44:47], v[164:167]
  v_mul_f32 v45, v177, v45
  v_mul_f32 v46, v177, v46
  v_mfma_f32_16x16x32_bf16 v[164:167], v[28:31], a[60:63], v[164:167]
  global_load_lds_dwordx4 v10, s[56:57] offset:1024
  s_waitcnt lgkmcnt(7)
  v_mfma_f32_16x16x32_bf16 v[104:107], v[32:35], a[64:67], v[104:107]
  ds_read_b64_tr_b16 v[24:25], v7 offset:24576
  v_cvt_pk_bf16_f32 v171, v58, v59
  v_mfma_f32_16x16x32_bf16 v[104:107], v[36:39], a[80:83], v[104:107]
  ds_read_b64_tr_b16 v[26:27], v7 offset:26624
  ds_write_b32 v214, v171 offset:4
  v_mfma_f32_16x16x32_bf16 v[108:111], v[32:35], a[68:71], v[108:111]
  ds_read_b64_tr_b16 v[28:29], v7 offset:28672
  v_mul_f32 v47, v177, v47
  v_mfma_f32_16x16x32_bf16 v[108:111], v[36:39], a[84:87], v[108:111]
  ds_read_b64_tr_b16 v[30:31], v7 offset:30720
  v_mfma_f32_16x16x32_bf16 v[112:115], v[32:35], a[72:75], v[112:115]
  ds_read_b128 a[8:11], v14 offset:18432
  v_mfma_f32_16x16x32_bf16 v[112:115], v[36:39], a[88:91], v[112:115]
  v_exp_f32 v44, v44
  v_mfma_f32_16x16x32_bf16 v[116:119], v[32:35], a[76:79], v[116:119]
  v_exp_f32 v45, v45
  v_mfma_f32_16x16x32_bf16 v[116:119], v[36:39], a[92:95], v[116:119]
  global_load_lds_dwordx4 v11, s[56:57] offset:2048
  s_waitcnt lgkmcnt(8)
  v_mfma_f32_16x16x32_bf16 v[120:123], v[16:19], a[64:67], v[120:123]
  ds_read_b64_tr_b16 v[32:33], v8 offset:24576
  v_fma_f32 v44, v44, v181, v181
  v_mfma_f32_16x16x32_bf16 v[120:123], v[20:23], a[80:83], v[120:123]
  ds_read_b64_tr_b16 v[34:35], v8 offset:26624
  v_fma_f32 v45, v45, v181, v181
  v_mfma_f32_16x16x32_bf16 v[124:127], v[16:19], a[68:71], v[124:127]
  ds_read_b64_tr_b16 v[36:37], v8 offset:28672
  v_rcp_f32 v44, v44
  v_mfma_f32_16x16x32_bf16 v[124:127], v[20:23], a[84:87], v[124:127]
  ds_read_b64_tr_b16 v[38:39], v8 offset:30720
  v_rcp_f32 v45, v45
  v_mfma_f32_16x16x32_bf16 v[128:131], v[16:19], a[72:75], v[128:131]
  ds_read_b128 a[12:15], v14 offset:19456
  v_mfma_f32_16x16x32_bf16 v[128:131], v[20:23], a[88:91], v[128:131]
  v_exp_f32 v46, v46
  v_mfma_f32_16x16x32_bf16 v[132:135], v[16:19], a[76:79], v[132:135]
  v_exp_f32 v47, v47
  v_mfma_f32_16x16x32_bf16 v[132:135], v[20:23], a[92:95], v[132:135]
  global_load_lds_dwordx4 v12, s[56:57] offset:3072
  s_waitcnt lgkmcnt(6)
  v_mfma_f32_16x16x32_bf16 v[136:139], v[24:27], a[64:67], v[136:139]
  v_fma_f32 v46, v46, v181, v181
  v_fma_f32 v47, v47, v181, v181
  v_mfma_f32_16x16x32_bf16 v[136:139], v[28:31], a[80:83], v[136:139]
  s_waitcnt vmcnt(8) lgkmcnt(1)
  s_barrier
  v_mfma_f32_16x16x32_bf16 v[140:143], v[24:27], a[68:71], v[140:143]
  ds_read_b64_tr_b16 v[16:17], v7 offset:32768
  s_add_u32 m0, s50, 16384
  v_mfma_f32_16x16x32_bf16 v[140:143], v[28:31], a[84:87], v[140:143]
  ds_read_b64_tr_b16 v[18:19], v7 offset:34816
  s_add_u32 s56, s62, s14
  v_mfma_f32_16x16x32_bf16 v[144:147], v[24:27], a[72:75], v[144:147]
  ds_read_b64_tr_b16 v[20:21], v7 offset:36864
  s_addc_u32 s57, s63, 0
  v_mfma_f32_16x16x32_bf16 v[144:147], v[28:31], a[88:91], v[144:147]
  ds_read_b64_tr_b16 v[22:23], v7 offset:38912
  v_rcp_f32 v46, v46
  v_mfma_f32_16x16x32_bf16 v[148:151], v[24:27], a[76:79], v[148:151]
  ds_read_b128 a[16:19], v14 offset:24576
  v_rcp_f32 v47, v47
  v_mfma_f32_16x16x32_bf16 v[148:151], v[28:31], a[92:95], v[148:151]
  global_load_lds_dwordx4 v9, s[56:57] offset:0
  v_mul_f32 v44, v44, v76
  v_mfma_f32_16x16x32_bf16 v[152:155], v[32:35], a[64:67], v[152:155]
  ds_read_b64_tr_b16 v[24:25], v8 offset:32768
  v_mul_f32 v45, v45, v77
  v_mfma_f32_16x16x32_bf16 v[152:155], v[36:39], a[80:83], v[152:155]
  ds_read_b64_tr_b16 v[26:27], v8 offset:34816
  v_mul_f32 v46, v46, v78
  v_mfma_f32_16x16x32_bf16 v[156:159], v[32:35], a[68:71], v[156:159]
  ds_read_b64_tr_b16 v[28:29], v8 offset:36864
  v_mul_f32 v47, v47, v79
  v_mfma_f32_16x16x32_bf16 v[156:159], v[36:39], a[84:87], v[156:159]
  ds_read_b64_tr_b16 v[30:31], v8 offset:38912
  v_cvt_pk_bf16_f32 v172, v44, v45
  v_mfma_f32_16x16x32_bf16 v[160:163], v[32:35], a[72:75], v[160:163]
  global_load_dword v219, v0, s[6:7]
  ds_read_b128 a[20:23], v14 offset:25600
  v_mfma_f32_16x16x32_bf16 v[160:163], v[36:39], a[88:91], v[160:163]
  ds_write_b32 v13, v172 offset:1024
  v_cvt_pk_bf16_f32 v173, v46, v47
  v_mfma_f32_16x16x32_bf16 v[164:167], v[32:35], a[76:79], v[164:167]
  ds_write_b32 v13, v173 offset:1028
  v_mul_f32 v60, v177, v60
  v_mfma_f32_16x16x32_bf16 v[164:167], v[36:39], a[92:95], v[164:167]
  global_load_lds_dwordx4 v10, s[56:57] offset:1024
  s_waitcnt lgkmcnt(8)
  v_mfma_f32_16x16x32_bf16 v[104:107], v[16:19], a[96:99], v[104:107]
  ds_read_b64_tr_b16 v[32:33], v7 offset:40960
  v_mul_f32 v61, v177, v61
  v_mfma_f32_16x16x32_bf16 v[104:107], v[20:23], a[112:115], v[104:107]
  ds_read_b64_tr_b16 v[34:35], v7 offset:43008
  v_mul_f32 v62, v177, v62
  v_mfma_f32_16x16x32_bf16 v[108:111], v[16:19], a[100:103], v[108:111]
  ds_read_b64_tr_b16 v[36:37], v7 offset:45056
  v_mul_f32 v63, v177, v63
  v_mfma_f32_16x16x32_bf16 v[108:111], v[20:23], a[116:119], v[108:111]
  ds_read_b64_tr_b16 v[38:39], v7 offset:47104
  v_mfma_f32_16x16x32_bf16 v[112:115], v[16:19], a[104:107], v[112:115]
  ds_read_b128 a[24:27], v14 offset:26624
  v_mfma_f32_16x16x32_bf16 v[112:115], v[20:23], a[120:123], v[112:115]
  v_exp_f32 v60, v60
  v_mfma_f32_16x16x32_bf16 v[116:119], v[16:19], a[108:111], v[116:119]
  v_exp_f32 v61, v61
  v_mfma_f32_16x16x32_bf16 v[116:119], v[20:23], a[124:127], v[116:119]
  global_load_lds_dwordx4 v11, s[56:57] offset:2048
  s_waitcnt lgkmcnt(8)
  v_mfma_f32_16x16x32_bf16 v[120:123], v[24:27], a[96:99], v[120:123]
  ds_read_b64_tr_b16 v[16:17], v8 offset:40960
  v_fma_f32 v60, v60, v181, v181
  v_mfma_f32_16x16x32_bf16 v[120:123], v[28:31], a[112:115], v[120:123]
  ds_read_b64_tr_b16 v[18:19], v8 offset:43008
  v_fma_f32 v61, v61, v181, v181
  v_mfma_f32_16x16x32_bf16 v[124:127], v[24:27], a[100:103], v[124:127]
  ds_read_b64_tr_b16 v[20:21], v8 offset:45056
  v_rcp_f32 v60, v60
  v_mfma_f32_16x16x32_bf16 v[124:127], v[28:31], a[116:119], v[124:127]
  ds_read_b64_tr_b16 v[22:23], v8 offset:47104
  v_mfma_f32_16x16x32_bf16 v[128:131], v[24:27], a[104:107], v[128:131]
  ds_read_b128 a[28:31], v14 offset:27648
  v_mfma_f32_16x16x32_bf16 v[128:131], v[28:31], a[120:123], v[128:131]
  v_exp_f32 v62, v62
  v_mfma_f32_16x16x32_bf16 v[132:135], v[24:27], a[108:111], v[132:135]
  v_exp_f32 v63, v63
  v_mfma_f32_16x16x32_bf16 v[132:135], v[28:31], a[124:127], v[132:135]
  global_load_lds_dwordx4 v12, s[56:57] offset:3072
  s_waitcnt lgkmcnt(6)
  v_mfma_f32_16x16x32_bf16 v[136:139], v[32:35], a[96:99], v[136:139]
  v_fma_f32 v62, v62, v181, v181
  v_fma_f32 v63, v63, v181, v181
  v_mfma_f32_16x16x32_bf16 v[136:139], v[36:39], a[112:115], v[136:139]
  s_waitcnt vmcnt(9) lgkmcnt(1)
  s_barrier
  v_mfma_f32_16x16x32_bf16 v[140:143], v[32:35], a[100:103], v[140:143]
  ds_read_b64_tr_b16 v[24:25], v7 offset:49152
  s_add_u32 m0, s50, 32768
  v_mfma_f32_16x16x32_bf16 v[140:143], v[36:39], a[116:119], v[140:143]
  ds_read_b64_tr_b16 v[26:27], v7 offset:51200
  s_add_u32 s56, s62, s15
  v_mfma_f32_16x16x32_bf16 v[144:147], v[32:35], a[104:107], v[144:147]
  ds_read_b64_tr_b16 v[28:29], v7 offset:53248
  s_addc_u32 s57, s63, 0
  v_mfma_f32_16x16x32_bf16 v[144:147], v[36:39], a[120:123], v[144:147]
  ds_read_b64_tr_b16 v[30:31], v7 offset:55296
  v_rcp_f32 v61, v61
  v_mfma_f32_16x16x32_bf16 v[148:151], v[32:35], a[108:111], v[148:151]
  ds_read_b128 a[32:35], v14 offset:32768
  v_rcp_f32 v62, v62
  v_mfma_f32_16x16x32_bf16 v[148:151], v[36:39], a[124:127], v[148:151]
  global_load_lds_dwordx4 v9, s[56:57] offset:0
  v_mul_f32 v60, v60, v92
  v_mfma_f32_16x16x32_bf16 v[152:155], v[16:19], a[96:99], v[152:155]
  ds_read_b64_tr_b16 v[32:33], v8 offset:49152
  v_mul_f32 v61, v61, v93
  v_mfma_f32_16x16x32_bf16 v[152:155], v[20:23], a[112:115], v[152:155]
  ds_read_b64_tr_b16 v[34:35], v8 offset:51200
  v_mul_f32 v62, v62, v94
  v_mfma_f32_16x16x32_bf16 v[156:159], v[16:19], a[100:103], v[156:159]
  ds_read_b64_tr_b16 v[36:37], v8 offset:53248
  v_cvt_pk_bf16_f32 v174, v60, v61
  v_mfma_f32_16x16x32_bf16 v[156:159], v[20:23], a[116:119], v[156:159]
  ds_read_b64_tr_b16 v[38:39], v8 offset:55296
  v_mfma_f32_16x16x32_bf16 v[160:163], v[16:19], a[104:107], v[160:163]
  ds_read_b128 a[36:39], v14 offset:33792
  v_mul_f32 v48, v178, v48
  v_mfma_f32_16x16x32_bf16 v[160:163], v[20:23], a[120:123], v[160:163]
  v_rcp_f32 v63, v63
  v_mfma_f32_16x16x32_bf16 v[164:167], v[16:19], a[108:111], v[164:167]
  ds_write_b32 v214, v174 offset:1024
  v_mul_f32 v49, v178, v49
  v_mfma_f32_16x16x32_bf16 v[164:167], v[20:23], a[124:127], v[164:167]
  global_load_lds_dwordx4 v10, s[56:57] offset:1024
  s_waitcnt lgkmcnt(7)
  v_mfma_f32_16x16x32_bf16 v[104:107], v[24:27], a[128:131], v[104:107]
  ds_read_b64_tr_b16 v[16:17], v7 offset:57344
  v_mul_f32 v63, v63, v95
  v_mfma_f32_16x16x32_bf16 v[104:107], v[28:31], a[144:147], v[104:107]
  ds_read_b64_tr_b16 v[18:19], v7 offset:59392
  v_cvt_pk_bf16_f32 v175, v62, v63
  v_mfma_f32_16x16x32_bf16 v[108:111], v[24:27], a[132:135], v[108:111]
  ds_read_b64_tr_b16 v[20:21], v7 offset:61440
  v_mul_f32 v50, v178, v50
  v_mfma_f32_16x16x32_bf16 v[108:111], v[28:31], a[148:151], v[108:111]
  ds_read_b64_tr_b16 v[22:23], v7 offset:63488
  v_mul_f32 v51, v178, v51
  v_mfma_f32_16x16x32_bf16 v[112:115], v[24:27], a[136:139], v[112:115]
  ds_read_b128 a[40:43], v14 offset:34816
  v_mfma_f32_16x16x32_bf16 v[112:115], v[28:31], a[152:155], v[112:115]
  ds_write_b32 v214, v175 offset:1028
  v_mfma_f32_16x16x32_bf16 v[116:119], v[24:27], a[140:143], v[116:119]
  v_exp_f32 v48, v48
  v_mfma_f32_16x16x32_bf16 v[116:119], v[28:31], a[156:159], v[116:119]
  global_load_lds_dwordx4 v11, s[56:57] offset:2048
  s_waitcnt lgkmcnt(8)
  v_mfma_f32_16x16x32_bf16 v[120:123], v[32:35], a[128:131], v[120:123]
  ds_read_b64_tr_b16 v[24:25], v8 offset:57344
  v_fma_f32 v48, v48, v182, v182
  v_mfma_f32_16x16x32_bf16 v[120:123], v[36:39], a[144:147], v[120:123]
  ds_read_b64_tr_b16 v[26:27], v8 offset:59392
  v_mfma_f32_16x16x32_bf16 v[124:127], v[32:35], a[132:135], v[124:127]
  ds_read_b64_tr_b16 v[28:29], v8 offset:61440
  v_mfma_f32_16x16x32_bf16 v[124:127], v[36:39], a[148:151], v[124:127]
  ds_read_b64_tr_b16 v[30:31], v8 offset:63488
  v_mfma_f32_16x16x32_bf16 v[128:131], v[32:35], a[136:139], v[128:131]
  ds_read_b128 a[44:47], v14 offset:35840
  v_mfma_f32_16x16x32_bf16 v[128:131], v[36:39], a[152:155], v[128:131]
  v_exp_f32 v49, v49
  v_mfma_f32_16x16x32_bf16 v[132:135], v[32:35], a[140:143], v[132:135]
  v_exp_f32 v50, v50
  v_mfma_f32_16x16x32_bf16 v[132:135], v[36:39], a[156:159], v[132:135]
  global_load_lds_dwordx4 v12, s[56:57] offset:3072
  s_waitcnt lgkmcnt(7)
  v_mfma_f32_16x16x32_bf16 v[136:139], v[16:19], a[128:131], v[136:139]
  v_exp_f32 v51, v51
  v_mfma_f32_16x16x32_bf16 v[136:139], v[20:23], a[144:147], v[136:139]
  s_waitcnt vmcnt(9) lgkmcnt(1)
  s_barrier
  v_mfma_f32_16x16x32_bf16 v[140:143], v[16:19], a[132:135], v[140:143]
  ds_read_b64_tr_b16 v[32:33], v7 offset:0
  s_add_u32 m0, s50, 49152
  v_mfma_f32_16x16x32_bf16 v[140:143], v[20:23], a[148:151], v[140:143]
  ds_read_b64_tr_b16 v[34:35], v7 offset:2048
  s_add_u32 s56, s62, s16
  v_mfma_f32_16x16x32_bf16 v[144:147], v[16:19], a[136:139], v[144:147]
  ds_read_b64_tr_b16 v[36:37], v7 offset:4096
  s_addc_u32 s57, s63, 0
  v_mfma_f32_16x16x32_bf16 v[144:147], v[20:23], a[152:155], v[144:147]
  ds_read_b64_tr_b16 v[38:39], v7 offset:6144
  v_fma_f32 v49, v49, v182, v182
  v_mfma_f32_16x16x32_bf16 v[148:151], v[16:19], a[140:143], v[148:151]
  ds_read_b128 a[48:51], v14 offset:40960
  v_fma_f32 v50, v50, v182, v182
  v_mfma_f32_16x16x32_bf16 v[148:151], v[20:23], a[156:159], v[148:151]
  global_load_lds_dwordx4 v9, s[56:57] offset:0
  ds_read_b128 a[52:55], v14 offset:41984
  v_mfma_f32_16x16x32_bf16 v[152:155], v[24:27], a[128:131], v[152:155]
  ds_read_b64_tr_b16 v[16:17], v8 offset:0
  v_fma_f32 v51, v51, v182, v182
  v_mfma_f32_16x16x32_bf16 v[152:155], v[28:31], a[144:147], v[152:155]
  ds_read_b64_tr_b16 v[18:19], v8 offset:2048
  v_rcp_f32 v48, v48
  v_mfma_f32_16x16x32_bf16 v[156:159], v[24:27], a[132:135], v[156:159]
  ds_read_b64_tr_b16 v[20:21], v8 offset:4096
  v_rcp_f32 v49, v49
  v_mfma_f32_16x16x32_bf16 v[156:159], v[28:31], a[148:151], v[156:159]
  ds_read_b64_tr_b16 v[22:23], v8 offset:6144
  v_mul_f32 v48, v48, v80
  v_mfma_f32_16x16x32_bf16 v[160:163], v[24:27], a[136:139], v[160:163]
  ds_read_b128 a[56:59], v14 offset:43008
  v_mul_f32 v49, v49, v81
  v_mfma_f32_16x16x32_bf16 v[160:163], v[28:31], a[152:155], v[160:163]
  v_rcp_f32 v50, v50
  v_mfma_f32_16x16x32_bf16 v[164:167], v[24:27], a[140:143], v[164:167]
  v_rcp_f32 v51, v51
  v_mfma_f32_16x16x32_bf16 v[164:167], v[28:31], a[156:159], v[164:167]
  global_load_lds_dwordx4 v10, s[56:57] offset:1024
  s_waitcnt lgkmcnt(7)
  v_mfma_f32_16x16x32_bf16 v[104:107], v[32:35], a[160:163], v[104:107]
  ds_read_b64_tr_b16 v[24:25], v7 offset:8192
  v_mul_f32 v50, v50, v82
  v_mfma_f32_16x16x32_bf16 v[104:107], v[36:39], a[176:179], v[104:107]
  ds_read_b64_tr_b16 v[26:27], v7 offset:10240
  v_mul_f32 v51, v51, v83
  v_mfma_f32_16x16x32_bf16 v[108:111], v[32:35], a[164:167], v[108:111]
  ds_read_b64_tr_b16 v[28:29], v7 offset:12288
  v_cvt_pk_bf16_f32 v168, v48, v49
  v_mfma_f32_16x16x32_bf16 v[108:111], v[36:39], a[180:183], v[108:111]
  ds_read_b64_tr_b16 v[30:31], v7 offset:14336
  v_cvt_pk_bf16_f32 v169, v50, v51
  v_mfma_f32_16x16x32_bf16 v[112:115], v[32:35], a[168:171], v[112:115]
  ds_read_b128 a[60:63], v14 offset:44032
  v_mul_f32 v64, v178, v64
  v_mfma_f32_16x16x32_bf16 v[112:115], v[36:39], a[184:187], v[112:115]
  ds_write_b32 v13, v168 offset:2048
  v_mul_f32 v65, v178, v65
  v_mfma_f32_16x16x32_bf16 v[116:119], v[32:35], a[172:175], v[116:119]
  ds_write_b32 v13, v169 offset:2052
  v_mul_f32 v66, v178, v66
  v_mfma_f32_16x16x32_bf16 v[116:119], v[36:39], a[188:191], v[116:119]
  global_load_lds_dwordx4 v11, s[56:57] offset:2048
  s_waitcnt lgkmcnt(8)
  v_mfma_f32_16x16x32_bf16 v[120:123], v[16:19], a[160:163], v[120:123]
  ds_read_b64_tr_b16 v[32:33], v8 offset:8192
  v_mul_f32 v67, v178, v67
  v_mfma_f32_16x16x32_bf16 v[120:123], v[20:23], a[176:179], v[120:123]
  ds_read_b64_tr_b16 v[34:35], v8 offset:10240
  v_exp_f32 v67, v67
  v_mfma_f32_16x16x32_bf16 v[124:127], v[16:19], a[164:167], v[124:127]
  ds_read_b64_tr_b16 v[36:37], v8 offset:12288
  v_mfma_f32_16x16x32_bf16 v[124:127], v[20:23], a[180:183], v[124:127]
  ds_read_b64_tr_b16 v[38:39], v8 offset:14336
  v_mfma_f32_16x16x32_bf16 v[128:131], v[16:19], a[168:171], v[128:131]
  ds_read_b128 a[64:67], v14 offset:49152
  v_mfma_f32_16x16x32_bf16 v[128:131], v[20:23], a[184:187], v[128:131]
  v_exp_f32 v64, v64
  v_mfma_f32_16x16x32_bf16 v[132:135], v[16:19], a[172:175], v[132:135]
  v_exp_f32 v65, v65
  v_mfma_f32_16x16x32_bf16 v[132:135], v[20:23], a[188:191], v[132:135]
  global_load_lds_dwordx4 v12, s[56:57] offset:3072
  s_waitcnt lgkmcnt(8)
  v_mfma_f32_16x16x32_bf16 v[136:139], v[24:27], a[160:163], v[136:139]
  v_exp_f32 v66, v66
  v_mfma_f32_16x16x32_bf16 v[136:139], v[28:31], a[176:179], v[136:139]
  s_waitcnt vmcnt(8) lgkmcnt(1)
  s_barrier
  v_mfma_f32_16x16x32_bf16 v[140:143], v[24:27], a[164:167], v[140:143]
  ds_read_b64_tr_b16 v[16:17], v7 offset:16384
  s_add_u32 m0, s50, 0
  v_mfma_f32_16x16x32_bf16 v[140:143], v[28:31], a[180:183], v[140:143]
  ds_read_b64_tr_b16 v[18:19], v7 offset:18432
  s_add_u32 s56, s77, s80
  v_mfma_f32_16x16x32_bf16 v[144:147], v[24:27], a[168:171], v[144:147]
  ds_read_b64_tr_b16 v[20:21], v7 offset:20480
  s_add_u32 s56, s54, s56
  v_mfma_f32_16x16x32_bf16 v[144:147], v[28:31], a[184:187], v[144:147]
  ds_read_b64_tr_b16 v[22:23], v7 offset:22528
  s_addc_u32 s57, s55, 0
  v_mfma_f32_16x16x32_bf16 v[148:151], v[24:27], a[172:175], v[148:151]
  ds_read_b128 a[68:71], v14 offset:50176
  v_fma_f32 v64, v64, v182, v182
  v_mfma_f32_16x16x32_bf16 v[148:151], v[28:31], a[188:191], v[148:151]
  global_load_lds_dwordx4 v220, s[56:57] offset:0
  ds_read_b128 a[72:75], v14 offset:51200
  v_mfma_f32_16x16x32_bf16 v[152:155], v[32:35], a[160:163], v[152:155]
  ds_read_b64_tr_b16 v[24:25], v8 offset:16384
  v_fma_f32 v65, v65, v182, v182
  v_mfma_f32_16x16x32_bf16 v[152:155], v[36:39], a[176:179], v[152:155]
  ds_read_b64_tr_b16 v[26:27], v8 offset:18432
  v_fma_f32 v66, v66, v182, v182
  v_mfma_f32_16x16x32_bf16 v[156:159], v[32:35], a[164:167], v[156:159]
  ds_read_b64_tr_b16 v[28:29], v8 offset:20480
  v_fma_f32 v67, v67, v182, v182
  v_mfma_f32_16x16x32_bf16 v[156:159], v[36:39], a[180:183], v[156:159]
  ds_read_b64_tr_b16 v[30:31], v8 offset:22528
  v_rcp_f32 v64, v64
  v_mfma_f32_16x16x32_bf16 v[160:163], v[32:35], a[168:171], v[160:163]
  ds_read_b128 a[76:79], v14 offset:52224
  v_rcp_f32 v67, v67
  v_mfma_f32_16x16x32_bf16 v[160:163], v[36:39], a[184:187], v[160:163]
  v_rcp_f32 v65, v65
  v_mfma_f32_16x16x32_bf16 v[164:167], v[32:35], a[172:175], v[164:167]
  v_rcp_f32 v66, v66
  v_mfma_f32_16x16x32_bf16 v[164:167], v[36:39], a[188:191], v[164:167]
  global_load_lds_dwordx4 v221, s[56:57] offset:1024
  s_waitcnt lgkmcnt(7)
  v_mfma_f32_16x16x32_bf16 v[104:107], v[16:19], a[192:195], v[104:107]
  ds_read_b64_tr_b16 v[32:33], v7 offset:24576
  v_mul_f32 v64, v64, v96
  v_mfma_f32_16x16x32_bf16 v[104:107], v[20:23], a[208:211], v[104:107]
  ds_read_b64_tr_b16 v[34:35], v7 offset:26624
  v_mul_f32 v65, v65, v97
  v_mfma_f32_16x16x32_bf16 v[108:111], v[16:19], a[196:199], v[108:111]
  ds_read_b64_tr_b16 v[36:37], v7 offset:28672
  v_mul_f32 v66, v66, v98
  v_mfma_f32_16x16x32_bf16 v[108:111], v[20:23], a[212:215], v[108:111]
  ds_read_b64_tr_b16 v[38:39], v7 offset:30720
  v_mul_f32 v67, v67, v99
  v_mfma_f32_16x16x32_bf16 v[112:115], v[16:19], a[200:203], v[112:115]
  ds_read_b128 a[80:83], v14 offset:57344
  v_cvt_pk_bf16_f32 v170, v64, v65
  v_mfma_f32_16x16x32_bf16 v[112:115], v[20:23], a[216:219], v[112:115]
  ds_write_b32 v214, v170 offset:2048
  v_mul_f32 v52, v179, v52
  v_mfma_f32_16x16x32_bf16 v[116:119], v[16:19], a[204:207], v[116:119]
  v_mul_f32 v53, v179, v53
  v_mul_f32 v54, v179, v54
  v_mfma_f32_16x16x32_bf16 v[116:119], v[20:23], a[220:223], v[116:119]
  global_load_lds_dwordx4 v222, s[56:57] offset:2048
  s_waitcnt lgkmcnt(7)
  v_mfma_f32_16x16x32_bf16 v[120:123], v[24:27], a[192:195], v[120:123]
  ds_read_b64_tr_b16 v[16:17], v8 offset:24576
  v_cvt_pk_bf16_f32 v171, v66, v67
  v_mfma_f32_16x16x32_bf16 v[120:123], v[28:31], a[208:211], v[120:123]
  ds_read_b64_tr_b16 v[18:19], v8 offset:26624
  ds_write_b32 v214, v171 offset:2052
  v_mfma_f32_16x16x32_bf16 v[124:127], v[24:27], a[196:199], v[124:127]
  ds_read_b64_tr_b16 v[20:21], v8 offset:28672
  v_mul_f32 v55, v179, v55
  v_mfma_f32_16x16x32_bf16 v[124:127], v[28:31], a[212:215], v[124:127]
  ds_read_b64_tr_b16 v[22:23], v8 offset:30720
  v_exp_f32 v55, v55
  v_mfma_f32_16x16x32_bf16 v[128:131], v[24:27], a[200:203], v[128:131]
  ds_read_b128 a[84:87], v14 offset:58368
  v_mfma_f32_16x16x32_bf16 v[128:131], v[28:31], a[216:219], v[128:131]
  v_exp_f32 v52, v52
  v_mfma_f32_16x16x32_bf16 v[132:135], v[24:27], a[204:207], v[132:135]
  v_exp_f32 v53, v53
  v_mfma_f32_16x16x32_bf16 v[132:135], v[28:31], a[220:223], v[132:135]
  global_load_lds_dwordx4 v223, s[56:57] offset:3072
  s_waitcnt lgkmcnt(8)
  v_mfma_f32_16x16x32_bf16 v[136:139], v[32:35], a[192:195], v[136:139]
  v_exp_f32 v54, v54
  v_mfma_f32_16x16x32_bf16 v[136:139], v[36:39], a[208:211], v[136:139]
  s_waitcnt vmcnt(8) lgkmcnt(1)
  s_barrier
  v_mfma_f32_16x16x32_bf16 v[140:143], v[32:35], a[196:199], v[140:143]
  ds_read_b64_tr_b16 v[24:25], v7 offset:32768
  s_add_u32 m0, s50, 16384
  v_mfma_f32_16x16x32_bf16 v[140:143], v[36:39], a[212:215], v[140:143]
  ds_read_b64_tr_b16 v[26:27], v7 offset:34816
  s_add_u32 s56, s78, s80
  v_mfma_f32_16x16x32_bf16 v[144:147], v[32:35], a[200:203], v[144:147]
  ds_read_b64_tr_b16 v[28:29], v7 offset:36864
  s_add_u32 s56, s54, s56
  v_mfma_f32_16x16x32_bf16 v[144:147], v[36:39], a[216:219], v[144:147]
  ds_read_b64_tr_b16 v[30:31], v7 offset:38912
  s_addc_u32 s57, s55, 0
  v_mfma_f32_16x16x32_bf16 v[148:151], v[32:35], a[204:207], v[148:151]
  ds_read_b128 a[88:91], v14 offset:59392
  v_fma_f32 v52, v52, v183, v183
  v_mfma_f32_16x16x32_bf16 v[148:151], v[36:39], a[220:223], v[148:151]
  global_load_lds_dwordx4 v220, s[56:57] offset:0
  ds_read_b128 a[92:95], v14 offset:60416
  v_mfma_f32_16x16x32_bf16 v[152:155], v[16:19], a[192:195], v[152:155]
  ds_read_b64_tr_b16 v[32:33], v8 offset:32768
  v_fma_f32 v53, v53, v183, v183
  v_mfma_f32_16x16x32_bf16 v[152:155], v[20:23], a[208:211], v[152:155]
  ds_read_b64_tr_b16 v[34:35], v8 offset:34816
  v_fma_f32 v54, v54, v183, v183
  v_mfma_f32_16x16x32_bf16 v[156:159], v[16:19], a[196:199], v[156:159]
  ds_read_b64_tr_b16 v[36:37], v8 offset:36864
  v_fma_f32 v55, v55, v183, v183
  v_mfma_f32_16x16x32_bf16 v[156:159], v[20:23], a[212:215], v[156:159]
  ds_read_b64_tr_b16 v[38:39], v8 offset:38912
  v_rcp_f32 v54, v54
  v_mfma_f32_16x16x32_bf16 v[160:163], v[16:19], a[200:203], v[160:163]
  ds_read_b128 a[96:99], v215 offset:0
  v_mul_f32 v54, v54, v86
  v_mfma_f32_16x16x32_bf16 v[160:163], v[20:23], a[216:219], v[160:163]
  v_rcp_f32 v52, v52
  v_mfma_f32_16x16x32_bf16 v[164:167], v[16:19], a[204:207], v[164:167]
  v_rcp_f32 v53, v53
  v_mfma_f32_16x16x32_bf16 v[164:167], v[20:23], a[220:223], v[164:167]
  global_load_lds_dwordx4 v221, s[56:57] offset:1024
  s_waitcnt lgkmcnt(7)
  v_mfma_f32_16x16x32_bf16 v[104:107], v[24:27], a[224:227], v[104:107]
  ds_read_b64_tr_b16 v[16:17], v7 offset:40960
  v_mul_f32 v52, v52, v84
  v_mfma_f32_16x16x32_bf16 v[104:107], v[28:31], a[240:243], v[104:107]
  ds_read_b64_tr_b16 v[18:19], v7 offset:43008
  v_mul_f32 v53, v53, v85
  v_mfma_f32_16x16x32_bf16 v[108:111], v[24:27], a[228:231], v[108:111]
  ds_read_b64_tr_b16 v[20:21], v7 offset:45056
  v_cvt_pk_bf16_f32 v172, v52, v53
  v_mfma_f32_16x16x32_bf16 v[108:111], v[28:31], a[244:247], v[108:111]
  ds_read_b64_tr_b16 v[22:23], v7 offset:47104
  v_mul_f32 v68, v179, v68
  v_mfma_f32_16x16x32_bf16 v[112:115], v[24:27], a[232:235], v[112:115]
  ds_read_b128 a[100:103], v215 offset:1024
  v_mul_f32 v69, v179, v69
  v_mfma_f32_16x16x32_bf16 v[112:115], v[28:31], a[248:251], v[112:115]
  v_rcp_f32 v55, v55
  v_mfma_f32_16x16x32_bf16 v[116:119], v[24:27], a[236:239], v[116:119]
  ds_write_b32 v13, v172 offset:3072
  v_mul_f32 v70, v179, v70
  v_mfma_f32_16x16x32_bf16 v[116:119], v[28:31], a[252:255], v[116:119]
  global_load_lds_dwordx4 v222, s[56:57] offset:2048
  s_waitcnt lgkmcnt(7)
  v_mfma_f32_16x16x32_bf16 v[120:123], v[32:35], a[224:227], v[120:123]
  ds_read_b64_tr_b16 v[24:25], v8 offset:40960
  v_mul_f32 v55, v55, v87
  v_mfma_f32_16x16x32_bf16 v[120:123], v[36:39], a[240:243], v[120:123]
  ds_read_b64_tr_b16 v[26:27], v8 offset:43008
  v_cvt_pk_bf16_f32 v173, v54, v55
  v_mfma_f32_16x16x32_bf16 v[124:127], v[32:35], a[228:231], v[124:127]
  ds_read_b64_tr_b16 v[28:29], v8 offset:45056
  v_mul_f32 v71, v179, v71
  v_mfma_f32_16x16x32_bf16 v[124:127], v[36:39], a[244:247], v[124:127]
  ds_read_b64_tr_b16 v[30:31], v8 offset:47104
  v_exp_f32 v70, v70
  v_mfma_f32_16x16x32_bf16 v[128:131], v[32:35], a[232:235], v[128:131]
  ds_read_b128 a[104:107], v215 offset:2048
  v_mfma_f32_16x16x32_bf16 v[128:131], v[36:39], a[248:251], v[128:131]
  ds_write_b32 v13, v173 offset:3076
  v_exp_f32 v71, v71
  v_mfma_f32_16x16x32_bf16 v[132:135], v[32:35], a[236:239], v[132:135]
  v_exp_f32 v68, v68
  v_mfma_f32_16x16x32_bf16 v[132:135], v[36:39], a[252:255], v[132:135]
  global_load_lds_dwordx4 v223, s[56:57] offset:3072
  s_waitcnt lgkmcnt(8)
  v_mfma_f32_16x16x32_bf16 v[136:139], v[16:19], a[224:227], v[136:139]
  v_exp_f32 v69, v69
  v_mfma_f32_16x16x32_bf16 v[136:139], v[20:23], a[240:243], v[136:139]
  s_waitcnt vmcnt(8) lgkmcnt(2)
  s_barrier
  v_mfma_f32_16x16x32_bf16 v[140:143], v[16:19], a[228:231], v[140:143]
  ds_read_b64_tr_b16 v[32:33], v7 offset:49152
  s_add_u32 m0, s50, 32768
  v_mfma_f32_16x16x32_bf16 v[140:143], v[20:23], a[244:247], v[140:143]
  ds_read_b64_tr_b16 v[34:35], v7 offset:51200
  s_add_u32 s56, s77, s81
  v_mfma_f32_16x16x32_bf16 v[144:147], v[16:19], a[232:235], v[144:147]
  ds_read_b64_tr_b16 v[36:37], v7 offset:53248
  s_add_u32 s56, s54, s56
  v_mfma_f32_16x16x32_bf16 v[144:147], v[20:23], a[248:251], v[144:147]
  ds_read_b64_tr_b16 v[38:39], v7 offset:55296
  s_addc_u32 s57, s55, 0
  v_mfma_f32_16x16x32_bf16 v[148:151], v[16:19], a[236:239], v[148:151]
  ds_read_b128 a[108:111], v215 offset:3072
  v_fma_f32 v68, v68, v183, v183
  v_mfma_f32_16x16x32_bf16 v[148:151], v[20:23], a[252:255], v[148:151]
  global_load_lds_dwordx4 v220, s[56:57] offset:0
  ds_read_b128 a[112:115], v215 offset:8192
  v_mfma_f32_16x16x32_bf16 v[152:155], v[24:27], a[224:227], v[152:155]
  ds_read_b64_tr_b16 v[16:17], v8 offset:49152
  v_fma_f32 v69, v69, v183, v183
  v_mfma_f32_16x16x32_bf16 v[152:155], v[28:31], a[240:243], v[152:155]
  ds_read_b64_tr_b16 v[18:19], v8 offset:51200
  v_fma_f32 v70, v70, v183, v183
  v_mfma_f32_16x16x32_bf16 v[156:159], v[24:27], a[228:231], v[156:159]
  ds_read_b64_tr_b16 v[20:21], v8 offset:53248
  v_fma_f32 v71, v71, v183, v183
  v_mfma_f32_16x16x32_bf16 v[156:159], v[28:31], a[244:247], v[156:159]
  ds_read_b64_tr_b16 v[22:23], v8 offset:55296
  v_mfma_f32_16x16x32_bf16 v[160:163], v[24:27], a[232:235], v[160:163]
  ds_read_b128 a[116:119], v215 offset:9216
  v_mfma_f32_16x16x32_bf16 v[160:163], v[28:31], a[248:251], v[160:163]
  v_rcp_f32 v68, v68
  v_mfma_f32_16x16x32_bf16 v[164:167], v[24:27], a[236:239], v[164:167]
  v_rcp_f32 v69, v69
  v_mfma_f32_16x16x32_bf16 v[164:167], v[28:31], a[252:255], v[164:167]
  global_load_lds_dwordx4 v221, s[56:57] offset:1024
  s_waitcnt lgkmcnt(7)
  v_mfma_f32_16x16x32_bf16 v[104:107], v[32:35], v[224:227], v[104:107]
  ds_read_b64_tr_b16 v[24:25], v7 offset:57344
  v_mul_f32 v68, v68, v100
  v_mfma_f32_16x16x32_bf16 v[104:107], v[36:39], v[240:243], v[104:107]
  ds_read_b64_tr_b16 v[26:27], v7 offset:59392
  v_mul_f32 v69, v69, v101
  v_mfma_f32_16x16x32_bf16 v[108:111], v[32:35], v[228:231], v[108:111]
  ds_read_b64_tr_b16 v[28:29], v7 offset:61440
  v_cvt_pk_bf16_f32 v174, v68, v69
  v_mfma_f32_16x16x32_bf16 v[108:111], v[36:39], v[244:247], v[108:111]
  ds_read_b64_tr_b16 v[30:31], v7 offset:63488
  v_mfma_f32_16x16x32_bf16 v[112:115], v[32:35], v[232:235], v[112:115]
  ds_read_b128 a[120:123], v215 offset:10240
  v_mfma_f32_16x16x32_bf16 v[112:115], v[36:39], v[248:251], v[112:115]
  v_rcp_f32 v70, v70
  v_mfma_f32_16x16x32_bf16 v[116:119], v[32:35], v[236:239], v[116:119]
  v_rcp_f32 v71, v71
  v_mfma_f32_16x16x32_bf16 v[116:119], v[36:39], v[252:255], v[116:119]
  global_load_lds_dwordx4 v222, s[56:57] offset:2048
  s_waitcnt lgkmcnt(6)
  v_mfma_f32_16x16x32_bf16 v[120:123], v[16:19], v[224:227], v[120:123]
  ds_read_b64_tr_b16 v[32:33], v8 offset:57344
  v_mul_f32 v70, v70, v102
  v_mfma_f32_16x16x32_bf16 v[120:123], v[20:23], v[240:243], v[120:123]
  ds_read_b64_tr_b16 v[34:35], v8 offset:59392
  v_mul_f32 v71, v71, v103
  v_mfma_f32_16x16x32_bf16 v[124:127], v[16:19], v[228:231], v[124:127]
  ds_read_b64_tr_b16 v[36:37], v8 offset:61440
  v_cvt_pk_bf16_f32 v175, v70, v71
  v_mfma_f32_16x16x32_bf16 v[124:127], v[20:23], v[244:247], v[124:127]
  ds_read_b64_tr_b16 v[38:39], v8 offset:63488
  v_mfma_f32_16x16x32_bf16 v[128:131], v[16:19], v[232:235], v[128:131]
  ds_read_b128 a[124:127], v215 offset:11264
  v_mfma_f32_16x16x32_bf16 v[128:131], v[20:23], v[248:251], v[128:131]
  ds_write_b32 v214, v174 offset:3072
  v_mfma_f32_16x16x32_bf16 v[132:135], v[16:19], v[236:239], v[132:135]
  ds_write_b32 v214, v175 offset:3076
  v_mfma_f32_16x16x32_bf16 v[132:135], v[20:23], v[252:255], v[132:135]
  global_load_lds_dwordx4 v223, s[56:57] offset:3072
  s_waitcnt lgkmcnt(8)
  v_mfma_f32_16x16x32_bf16 v[136:139], v[24:27], v[224:227], v[136:139]
  v_mfma_f32_16x16x32_bf16 v[136:139], v[28:31], v[240:243], v[136:139]
  s_waitcnt vmcnt(8) lgkmcnt(3)
  s_barrier
  v_mfma_f32_16x16x32_bf16 v[140:143], v[24:27], v[228:231], v[140:143]
  ds_read_b64_tr_b16 v[16:17], v7 offset:0
  s_add_u32 m0, s50, 49152
  v_mfma_f32_16x16x32_bf16 v[140:143], v[28:31], v[244:247], v[140:143]
  ds_read_b64_tr_b16 v[18:19], v7 offset:2048
  s_add_u32 s56, s78, s81
  v_mfma_f32_16x16x32_bf16 v[144:147], v[24:27], v[232:235], v[144:147]
  ds_read_b64_tr_b16 v[20:21], v7 offset:4096
  s_add_u32 s56, s54, s56
  v_mfma_f32_16x16x32_bf16 v[144:147], v[28:31], v[248:251], v[144:147]
  ds_read_b64_tr_b16 v[22:23], v7 offset:6144
  s_addc_u32 s57, s55, 0
  v_mfma_f32_16x16x32_bf16 v[148:151], v[24:27], v[236:239], v[148:151]
  v_mul_f32 v104, v176, v104
  v_mul_f32 v105, v176, v105
  v_mfma_f32_16x16x32_bf16 v[148:151], v[28:31], v[252:255], v[148:151]
  global_load_lds_dwordx4 v220, s[56:57] offset:0
  v_subrev_u32 v13, 81920, v13
  v_mfma_f32_16x16x32_bf16 v[152:155], v[32:35], v[224:227], v[152:155]
  ds_read_b64_tr_b16 v[24:25], v8 offset:0
  v_xor_b32 v214, 8, v13
  v_mfma_f32_16x16x32_bf16 v[152:155], v[36:39], v[240:243], v[152:155]
  ds_read_b64_tr_b16 v[26:27], v8 offset:2048
  v_mul_f32 v106, v176, v106
  v_mfma_f32_16x16x32_bf16 v[156:159], v[32:35], v[228:231], v[156:159]
  ds_read_b64_tr_b16 v[28:29], v8 offset:4096
  v_mul_f32 v107, v176, v107
  v_mfma_f32_16x16x32_bf16 v[156:159], v[36:39], v[244:247], v[156:159]
  ds_read_b64_tr_b16 v[30:31], v8 offset:6144
  v_exp_f32 v107, v107
  v_mfma_f32_16x16x32_bf16 v[160:163], v[32:35], v[232:235], v[160:163]
  v_exp_f32 v104, v104
  v_mfma_f32_16x16x32_bf16 v[160:163], v[36:39], v[248:251], v[160:163]
  v_exp_f32 v105, v105
  v_mfma_f32_16x16x32_bf16 v[164:167], v[32:35], v[236:239], v[164:167]
  v_exp_f32 v106, v106
  v_mul_f32 v120, v176, v120
  v_mfma_f32_16x16x32_bf16 v[164:167], v[36:39], v[252:255], v[164:167]
  global_load_lds_dwordx4 v221, s[56:57] offset:1024
  v_mul_f32 v122, v176, v122
  s_waitcnt lgkmcnt(4)
  v_mfma_f32_16x16x32_bf16 v[40:43], v[16:19], a[0:3], 0
  ds_read_b64_tr_b16 v[32:33], v7 offset:8192
  v_fma_f32 v104, v104, v180, v180
  v_mfma_f32_16x16x32_bf16 v[40:43], v[20:23], a[16:19], v[40:43]
  ds_read_b64_tr_b16 v[34:35], v7 offset:10240
  v_fma_f32 v105, v105, v180, v180
  v_mfma_f32_16x16x32_bf16 v[44:47], v[16:19], a[4:7], 0
  ds_read_b64_tr_b16 v[36:37], v7 offset:12288
  v_fma_f32 v106, v106, v180, v180
  v_exp_f32 v122, v122
  v_mfma_f32_16x16x32_bf16 v[44:47], v[20:23], a[20:23], v[44:47]
  ds_read_b64_tr_b16 v[38:39], v7 offset:14336
  v_fma_f32 v107, v107, v180, v180
  v_mfma_f32_16x16x32_bf16 v[48:51], v[16:19], a[8:11], 0
  v_rcp_f32 v104, v104
  v_rcp_f32 v107, v107
  v_mfma_f32_16x16x32_bf16 v[48:51], v[20:23], a[24:27], v[48:51]
  v_rcp_f32 v105, v105
  v_mul_f32 v107, v107, v139
  v_mfma_f32_16x16x32_bf16 v[52:55], v[16:19], a[12:15], 0
  v_rcp_f32 v106, v106
  v_mul_f32 v105, v105, v137
  v_mfma_f32_16x16x32_bf16 v[52:55], v[20:23], a[28:31], v[52:55]
  global_load_lds_dwordx4 v222, s[56:57] offset:2048
  v_fma_f32 v122, v122, v180, v180
  s_waitcnt lgkmcnt(4)
  v_mfma_f32_16x16x32_bf16 v[56:59], v[24:27], a[0:3], 0
  ds_read_b64_tr_b16 v[16:17], v8 offset:8192
  v_mul_f32 v104, v104, v136
  v_rcp_f32 v122, v122
  v_mfma_f32_16x16x32_bf16 v[56:59], v[28:31], a[16:19], v[56:59]
  ds_read_b64_tr_b16 v[18:19], v8 offset:10240
  v_mul_f32 v106, v106, v138
  v_mfma_f32_16x16x32_bf16 v[60:63], v[24:27], a[4:7], 0
  ds_read_b64_tr_b16 v[20:21], v8 offset:12288
  v_cvt_pk_bf16_f32 v168, v104, v105
  v_cvt_pk_bf16_f32 v169, v106, v107
  v_mfma_f32_16x16x32_bf16 v[60:63], v[28:31], a[20:23], v[60:63]
  ds_read_b64_tr_b16 v[22:23], v8 offset:14336
  ds_write_b32 v13, v168 offset:0
  v_mul_f32 v108, v177, v108
  v_mfma_f32_16x16x32_bf16 v[64:67], v[24:27], a[8:11], 0
  ds_write_b32 v13, v169 offset:4
  v_mul_f32 v121, v176, v121
  v_mul_f32 v109, v177, v109
  v_mfma_f32_16x16x32_bf16 v[64:67], v[28:31], a[24:27], v[64:67]
  v_mul_f32 v123, v176, v123
  v_exp_f32 v120, v120
  v_mfma_f32_16x16x32_bf16 v[68:71], v[24:27], a[12:15], 0
  v_exp_f32 v121, v121
  v_exp_f32 v123, v123
  v_mfma_f32_16x16x32_bf16 v[68:71], v[28:31], a[28:31], v[68:71]
  global_load_lds_dwordx4 v223, s[56:57] offset:3072
  v_fma_f32 v123, v123, v180, v180
  s_waitcnt lgkmcnt(6)
  v_mfma_f32_16x16x32_bf16 v[40:43], v[32:35], a[32:35], v[40:43]
  v_fma_f32 v120, v120, v180, v180
  v_fma_f32 v121, v121, v180, v180
  v_rcp_f32 v123, v123
  v_mfma_f32_16x16x32_bf16 v[40:43], v[36:39], a[48:51], v[40:43]
  s_waitcnt vmcnt(8) lgkmcnt(2)
  s_barrier
  v_rcp_f32 v120, v120
  v_mfma_f32_16x16x32_bf16 v[44:47], v[32:35], a[36:39], v[44:47]
  ds_read_b64_tr_b16 v[24:25], v7 offset:16384
  s_add_u32 m0, s50, 0
  v_rcp_f32 v121, v121
  v_mfma_f32_16x16x32_bf16 v[44:47], v[36:39], a[52:55], v[44:47]
  ds_read_b64_tr_b16 v[26:27], v7 offset:18432
  s_add_u32 s56, s79, s80
  v_mul_f32 v120, v120, v152
  v_mfma_f32_16x16x32_bf16 v[48:51], v[32:35], a[40:43], v[48:51]
  ds_read_b64_tr_b16 v[28:29], v7 offset:20480
  s_add_u32 s56, s54, s56
  v_mul_f32 v123, v123, v155
  v_mfma_f32_16x16x32_bf16 v[48:51], v[36:39], a[56:59], v[48:51]
  ds_read_b64_tr_b16 v[30:31], v7 offset:22528
  s_addc_u32 s57, s55, 0
  v_mul_f32 v110, v177, v110
  v_mfma_f32_16x16x32_bf16 v[52:55], v[32:35], a[44:47], v[52:55]
  v_mul_f32 v121, v121, v153
  v_mul_f32 v122, v122, v154
  v_exp_f32 v108, v108
  v_mfma_f32_16x16x32_bf16 v[52:55], v[36:39], a[60:63], v[52:55]
  global_load_lds_dwordx4 v220, s[56:57] offset:0
  v_cvt_pk_bf16_f32 v170, v120, v121
  v_cvt_pk_bf16_f32 v171, v122, v123
  v_mfma_f32_16x16x32_bf16 v[56:59], v[16:19], a[32:35], v[56:59]
  ds_read_b64_tr_b16 v[32:33], v8 offset:16384
  ds_write_b32 v214, v170 offset:0
  v_mfma_f32_16x16x32_bf16 v[56:59], v[20:23], a[48:51], v[56:59]
  ds_read_b64_tr_b16 v[34:35], v8 offset:18432
  ds_write_b32 v214, v171 offset:4
  v_mul_f32 v126, v177, v126
  v_mfma_f32_16x16x32_bf16 v[60:63], v[16:19], a[36:39], v[60:63]
  ds_read_b64_tr_b16 v[36:37], v8 offset:20480
  v_mul_f32 v111, v177, v111
  v_mul_f32 v127, v177, v127
  v_mfma_f32_16x16x32_bf16 v[60:63], v[20:23], a[52:55], v[60:63]
  ds_read_b64_tr_b16 v[38:39], v8 offset:22528
  v_exp_f32 v109, v109
  v_mfma_f32_16x16x32_bf16 v[64:67], v[16:19], a[40:43], v[64:67]
  v_exp_f32 v110, v110
  v_exp_f32 v111, v111
  v_mfma_f32_16x16x32_bf16 v[64:67], v[20:23], a[56:59], v[64:67]
  v_fma_f32 v108, v108, v181, v181
  v_fma_f32 v109, v109, v181, v181
  v_exp_f32 v127, v127
  v_mfma_f32_16x16x32_bf16 v[68:71], v[16:19], a[44:47], v[68:71]
  v_fma_f32 v110, v110, v181, v181
  v_fma_f32 v111, v111, v181, v181
  v_rcp_f32 v108, v108
  v_mfma_f32_16x16x32_bf16 v[68:71], v[20:23], a[60:63], v[68:71]
  global_load_lds_dwordx4 v221, s[56:57] offset:1024
  v_rcp_f32 v111, v111
  s_waitcnt lgkmcnt(6)
  v_mfma_f32_16x16x32_bf16 v[40:43], v[24:27], a[64:67], v[40:43]
  ds_read_b64_tr_b16 v[16:17], v7 offset:24576
  v_rcp_f32 v109, v109
  v_mfma_f32_16x16x32_bf16 v[40:43], v[28:31], a[80:83], v[40:43]
  ds_read_b64_tr_b16 v[18:19], v7 offset:26624
  v_rcp_f32 v110, v110
  v_mfma_f32_16x16x32_bf16 v[44:47], v[24:27], a[68:71], v[44:47]
  ds_read_b64_tr_b16 v[20:21], v7 offset:28672
  v_mul_f32 v108, v108, v140
  v_mul_f32 v110, v110, v142
  v_mfma_f32_16x16x32_bf16 v[44:47], v[28:31], a[84:87], v[44:47]
  ds_read_b64_tr_b16 v[22:23], v7 offset:30720
  v_mul_f32 v109, v109, v141
  v_mul_f32 v111, v111, v143
  v_mfma_f32_16x16x32_bf16 v[48:51], v[24:27], a[72:75], v[48:51]
  ds_read_b128 a[128:131], v215 offset:16384
  v_cvt_pk_bf16_f32 v172, v108, v109
  v_cvt_pk_bf16_f32 v173, v110, v111
  v_mfma_f32_16x16x32_bf16 v[48:51], v[28:31], a[88:91], v[48:51]
  ds_write_b32 v13, v172 offset:1024
  v_mul_f32 v124, v177, v124
  v_fma_f32 v127, v127, v181, v181
  v_mfma_f32_16x16x32_bf16 v[52:55], v[24:27], a[76:79], v[52:55]
  ds_write_b32 v13, v173 offset:1028
  v_mul_f32 v125, v177, v125
  v_exp_f32 v124, v124
  v_mfma_f32_16x16x32_bf16 v[52:55], v[28:31], a[92:95], v[52:55]
  global_load_lds_dwordx4 v222, s[56:57] offset:2048
  v_rcp_f32 v127, v127
  s_waitcnt lgkmcnt(7)
  v_mfma_f32_16x16x32_bf16 v[56:59], v[32:35], a[64:67], v[56:59]
  ds_read_b64_tr_b16 v[24:25], v8 offset:24576
  v_exp_f32 v125, v125
  v_mfma_f32_16x16x32_bf16 v[56:59], v[36:39], a[80:83], v[56:59]
  ds_read_b64_tr_b16 v[26:27], v8 offset:26624
  v_exp_f32 v126, v126
  v_mfma_f32_16x16x32_bf16 v[60:63], v[32:35], a[68:71], v[60:63]
  ds_read_b64_tr_b16 v[28:29], v8 offset:28672
  v_fma_f32 v124, v124, v181, v181
  v_fma_f32 v126, v126, v181, v181
  v_mfma_f32_16x16x32_bf16 v[60:63], v[36:39], a[84:87], v[60:63]
  ds_read_b64_tr_b16 v[30:31], v8 offset:30720
  v_fma_f32 v125, v125, v181, v181
  v_mul_f32 v127, v127, v159
  v_mfma_f32_16x16x32_bf16 v[64:67], v[32:35], a[72:75], v[64:67]
  ds_read_b128 a[132:135], v215 offset:17408
  v_rcp_f32 v124, v124
  v_mfma_f32_16x16x32_bf16 v[64:67], v[36:39], a[88:91], v[64:67]
  v_rcp_f32 v125, v125
  v_mul_f32 v124, v124, v156
  v_mfma_f32_16x16x32_bf16 v[68:71], v[32:35], a[76:79], v[68:71]
  v_rcp_f32 v126, v126
  v_mul_f32 v112, v178, v112
  v_mfma_f32_16x16x32_bf16 v[68:71], v[36:39], a[92:95], v[68:71]
  global_load_lds_dwordx4 v223, s[56:57] offset:3072
  v_mul_f32 v113, v178, v113
  v_exp_f32 v112, v112
  s_waitcnt lgkmcnt(8)
  v_mfma_f32_16x16x32_bf16 v[40:43], v[16:19], a[96:99], v[40:43]
  v_mul_f32 v125, v125, v157
  v_mul_f32 v126, v126, v158
  v_mul_f32 v114, v178, v114
  v_mfma_f32_16x16x32_bf16 v[40:43], v[20:23], a[112:115], v[40:43]
  s_waitcnt vmcnt(8) lgkmcnt(1)
  s_barrier
  v_cvt_pk_bf16_f32 v174, v124, v125
  v_cvt_pk_bf16_f32 v175, v126, v127
  v_mfma_f32_16x16x32_bf16 v[44:47], v[16:19], a[100:103], v[44:47]
  ds_read_b64_tr_b16 v[32:33], v7 offset:32768
  ds_write_b32 v214, v174 offset:1024
  s_add_u32 m0, s50, 16384
  v_mfma_f32_16x16x32_bf16 v[44:47], v[20:23], a[116:119], v[44:47]
  ds_read_b64_tr_b16 v[34:35], v7 offset:34816
  ds_write_b32 v214, v175 offset:1028
  s_add_u32 s56, s79, s81
  v_mfma_f32_16x16x32_bf16 v[48:51], v[16:19], a[104:107], v[48:51]
  ds_read_b64_tr_b16 v[36:37], v7 offset:36864
  s_add_u32 s56, s54, s56
  v_mul_f32 v115, v178, v115
  v_mfma_f32_16x16x32_bf16 v[48:51], v[20:23], a[120:123], v[48:51]
  ds_read_b64_tr_b16 v[38:39], v7 offset:38912
  s_addc_u32 s57, s55, 0
  v_exp_f32 v113, v113
  v_mfma_f32_16x16x32_bf16 v[52:55], v[16:19], a[108:111], v[52:55]
  ds_read_b128 a[136:139], v215 offset:18432
  v_exp_f32 v114, v114
  v_exp_f32 v115, v115
  v_mfma_f32_16x16x32_bf16 v[52:55], v[20:23], a[124:127], v[52:55]
  global_load_lds_dwordx4 v220, s[56:57] offset:0
  v_fma_f32 v112, v112, v182, v182
  v_fma_f32 v114, v114, v182, v182
  v_mfma_f32_16x16x32_bf16 v[56:59], v[24:27], a[96:99], v[56:59]
  ds_read_b64_tr_b16 v[16:17], v8 offset:32768
  v_fma_f32 v113, v113, v182, v182
  v_rcp_f32 v112, v112
  v_mfma_f32_16x16x32_bf16 v[56:59], v[28:31], a[112:115], v[56:59]
  ds_read_b64_tr_b16 v[18:19], v8 offset:34816
  v_fma_f32 v115, v115, v182, v182
  v_mul_f32 v128, v178, v128
  v_mfma_f32_16x16x32_bf16 v[60:63], v[24:27], a[100:103], v[60:63]
  ds_read_b64_tr_b16 v[20:21], v8 offset:36864
  v_rcp_f32 v113, v113
  v_rcp_f32 v115, v115
  v_mfma_f32_16x16x32_bf16 v[60:63], v[28:31], a[116:119], v[60:63]
  ds_read_b64_tr_b16 v[22:23], v8 offset:38912
  v_rcp_f32 v114, v114
  v_mfma_f32_16x16x32_bf16 v[64:67], v[24:27], a[104:107], v[64:67]
  ds_read_b128 a[140:143], v215 offset:19456
  v_mul_f32 v112, v112, v144
  v_mul_f32 v115, v115, v147
  v_mfma_f32_16x16x32_bf16 v[64:67], v[28:31], a[120:123], v[64:67]
  v_mul_f32 v113, v113, v145
  v_mul_f32 v114, v114, v146
  v_mul_f32 v129, v178, v129
  v_mfma_f32_16x16x32_bf16 v[68:71], v[24:27], a[108:111], v[68:71]
  v_cvt_pk_bf16_f32 v168, v112, v113
  v_cvt_pk_bf16_f32 v169, v114, v115
  v_mul_f32 v130, v178, v130
  v_mfma_f32_16x16x32_bf16 v[68:71], v[28:31], a[124:127], v[68:71]
  global_load_lds_dwordx4 v221, s[56:57] offset:1024
  ds_write_b32 v13, v168 offset:2048
  s_waitcnt lgkmcnt(7)
  v_mfma_f32_16x16x32_bf16 v[72:75], v[32:35], a[0:3], 0
  ds_read_b64_tr_b16 v[24:25], v7 offset:40960
  ds_write_b32 v13, v169 offset:2052
  v_exp_f32 v128, v128
  v_mfma_f32_16x16x32_bf16 v[72:75], v[36:39], a[16:19], v[72:75]
  ds_read_b64_tr_b16 v[26:27], v7 offset:43008
  v_mul_f32 v131, v178, v131
  v_fma_f32 v128, v128, v182, v182
  v_mfma_f32_16x16x32_bf16 v[76:79], v[32:35], a[4:7], 0
  ds_read_b64_tr_b16 v[28:29], v7 offset:45056
  v_exp_f32 v129, v129
  v_mfma_f32_16x16x32_bf16 v[76:79], v[36:39], a[20:23], v[76:79]
  ds_read_b64_tr_b16 v[30:31], v7 offset:47104
  v_exp_f32 v130, v130
  v_mfma_f32_16x16x32_bf16 v[80:83], v[32:35], a[8:11], 0
  ds_read_b128 a[144:147], v215 offset:24576
  v_exp_f32 v131, v131
  v_mfma_f32_16x16x32_bf16 v[80:83], v[36:39], a[24:27], v[80:83]
  v_fma_f32 v129, v129, v182, v182
  v_fma_f32 v130, v130, v182, v182
  v_mul_f32 v116, v179, v116
  v_mfma_f32_16x16x32_bf16 v[84:87], v[32:35], a[12:15], 0
  v_fma_f32 v131, v131, v182, v182
  v_rcp_f32 v128, v128
  v_mfma_f32_16x16x32_bf16 v[84:87], v[36:39], a[28:31], v[84:87]
  global_load_lds_dwordx4 v222, s[56:57] offset:2048
  v_rcp_f32 v129, v129
  v_rcp_f32 v131, v131
  s_waitcnt lgkmcnt(8)
  v_mfma_f32_16x16x32_bf16 v[88:91], v[16:19], a[0:3], 0
  ds_read_b64_tr_b16 v[32:33], v8 offset:40960
  s_xor_b32 s19, s19, 81920
  v_rcp_f32 v130, v130
  v_mfma_f32_16x16x32_bf16 v[88:91], v[20:23], a[16:19], v[88:91]
  ds_read_b64_tr_b16 v[34:35], v8 offset:43008
  s_add_u32 s69, s69, 128
  v_mul_f32 v128, v128, v160
  v_mul_f32 v130, v130, v162
  v_mfma_f32_16x16x32_bf16 v[92:95], v[16:19], a[4:7], 0
  ds_read_b64_tr_b16 v[36:37], v8 offset:45056
  s_cmp_eq_u32 s69, 1152
  v_mul_f32 v129, v129, v161
  v_mul_f32 v131, v131, v163
  v_mfma_f32_16x16x32_bf16 v[92:95], v[20:23], a[20:23], v[92:95]
  ds_read_b64_tr_b16 v[38:39], v8 offset:47104
  s_cselect_b32 s69, 0, s69
  v_cvt_pk_bf16_f32 v170, v128, v129
  v_cvt_pk_bf16_f32 v171, v130, v131
  v_mfma_f32_16x16x32_bf16 v[96:99], v[16:19], a[8:11], 0
  ds_read_b128 a[148:151], v215 offset:25600
  ds_write_b32 v214, v170 offset:2048
  v_mul_f32 v118, v179, v118
  v_mfma_f32_16x16x32_bf16 v[96:99], v[20:23], a[24:27], v[96:99]
  ds_write_b32 v214, v171 offset:2052
  v_mul_f32 v117, v179, v117
  v_mul_f32 v132, v179, v132
  v_mfma_f32_16x16x32_bf16 v[100:103], v[16:19], a[12:15], 0
  v_mul_f32 v119, v179, v119
  v_exp_f32 v116, v116
  v_mfma_f32_16x16x32_bf16 v[100:103], v[20:23], a[28:31], v[100:103]
  global_load_lds_dwordx4 v223, s[56:57] offset:3072
  v_exp_f32 v117, v117
  s_waitcnt lgkmcnt(8)
  v_mfma_f32_16x16x32_bf16 v[72:75], v[24:27], a[32:35], v[72:75]
  v_exp_f32 v118, v118
  v_exp_f32 v119, v119
  v_mfma_f32_16x16x32_bf16 v[72:75], v[28:31], a[48:51], v[72:75]
  s_waitcnt vmcnt(8) lgkmcnt(3)
  s_barrier
  v_fma_f32 v116, v116, v183, v183
  v_fma_f32 v118, v118, v183, v183
  v_mfma_f32_16x16x32_bf16 v[76:79], v[24:27], a[36:39], v[76:79]
  ds_read_b64_tr_b16 v[16:17], v7 offset:49152
  s_add_u32 m0, s19, 0
  v_fma_f32 v117, v117, v183, v183
  v_rcp_f32 v116, v116
  v_mfma_f32_16x16x32_bf16 v[76:79], v[28:31], a[52:55], v[76:79]
  ds_read_b64_tr_b16 v[18:19], v7 offset:51200
  s_add_u32 s56, s77, s69
  v_fma_f32 v119, v119, v183, v183
  v_mfma_f32_16x16x32_bf16 v[80:83], v[24:27], a[40:43], v[80:83]
  ds_read_b64_tr_b16 v[20:21], v7 offset:53248
  s_add_u32 s56, s54, s56
  v_rcp_f32 v117, v117
  v_rcp_f32 v119, v119
  v_mfma_f32_16x16x32_bf16 v[80:83], v[28:31], a[56:59], v[80:83]
  ds_read_b64_tr_b16 v[22:23], v7 offset:55296
  s_addc_u32 s57, s55, 0
  v_rcp_f32 v118, v118
  v_mfma_f32_16x16x32_bf16 v[84:87], v[24:27], a[44:47], v[84:87]
  ds_read_b128 a[152:155], v215 offset:26624
  v_mul_f32 v116, v116, v148
  v_mul_f32 v118, v118, v150
  v_mfma_f32_16x16x32_bf16 v[84:87], v[28:31], a[60:63], v[84:87]
  global_load_lds_dwordx4 v220, s[56:57] offset:0
  v_mul_f32 v117, v117, v149
  v_mul_f32 v119, v119, v151
  v_mfma_f32_16x16x32_bf16 v[88:91], v[32:35], a[32:35], v[88:91]
  ds_read_b64_tr_b16 v[24:25], v8 offset:49152
  v_cvt_pk_bf16_f32 v172, v116, v117
  v_cvt_pk_bf16_f32 v173, v118, v119
  v_mfma_f32_16x16x32_bf16 v[88:91], v[36:39], a[48:51], v[88:91]
  ds_read_b64_tr_b16 v[26:27], v8 offset:51200
  ds_write_b32 v13, v172 offset:3072
  v_mul_f32 v133, v179, v133
  v_mfma_f32_16x16x32_bf16 v[92:95], v[32:35], a[36:39], v[92:95]
  ds_read_b64_tr_b16 v[28:29], v8 offset:53248
  ds_write_b32 v13, v173 offset:3076
  v_mul_f32 v134, v179, v134
  v_mfma_f32_16x16x32_bf16 v[92:95], v[36:39], a[52:55], v[92:95]
  ds_read_b64_tr_b16 v[30:31], v8 offset:55296
  v_mul_f32 v135, v179, v135
  v_exp_f32 v132, v132
  v_mfma_f32_16x16x32_bf16 v[96:99], v[32:35], a[40:43], v[96:99]
  ds_read_b128 a[156:159], v215 offset:27648
  v_exp_f32 v133, v133
  v_mfma_f32_16x16x32_bf16 v[96:99], v[36:39], a[56:59], v[96:99]
  v_exp_f32 v134, v134
  v_fma_f32 v132, v132, v183, v183
  v_mfma_f32_16x16x32_bf16 v[100:103], v[32:35], a[44:47], v[100:103]
  v_exp_f32 v135, v135
  v_fma_f32 v133, v133, v183, v183
  v_mfma_f32_16x16x32_bf16 v[100:103], v[36:39], a[60:63], v[100:103]
  global_load_lds_dwordx4 v221, s[56:57] offset:1024
  v_fma_f32 v134, v134, v183, v183
  s_waitcnt lgkmcnt(8)
  v_mfma_f32_16x16x32_bf16 v[72:75], v[16:19], a[64:67], v[72:75]
  ds_read_b64_tr_b16 v[32:33], v7 offset:57344
  v_fma_f32 v135, v135, v183, v183
  v_rcp_f32 v132, v132
  v_mfma_f32_16x16x32_bf16 v[72:75], v[20:23], a[80:83], v[72:75]
  ds_read_b64_tr_b16 v[34:35], v7 offset:59392
  v_rcp_f32 v133, v133
  v_rcp_f32 v135, v135
  v_mfma_f32_16x16x32_bf16 v[76:79], v[16:19], a[68:71], v[76:79]
  ds_read_b64_tr_b16 v[36:37], v7 offset:61440
  v_rcp_f32 v134, v134
  v_mfma_f32_16x16x32_bf16 v[76:79], v[20:23], a[84:87], v[76:79]
  ds_read_b64_tr_b16 v[38:39], v7 offset:63488
  v_mul_f32 v132, v132, v164
  v_mul_f32 v135, v135, v167
  v_mfma_f32_16x16x32_bf16 v[80:83], v[16:19], a[72:75], v[80:83]
  v_mul_f32 v133, v133, v165
  v_mul_f32 v134, v134, v166
  v_mfma_f32_16x16x32_bf16 v[80:83], v[20:23], a[88:91], v[80:83]
  v_cvt_pk_bf16_f32 v174, v132, v133
  v_cvt_pk_bf16_f32 v175, v134, v135
  v_mfma_f32_16x16x32_bf16 v[84:87], v[16:19], a[76:79], v[84:87]
  ds_write_b32 v214, v174 offset:3072
  v_mfma_f32_16x16x32_bf16 v[84:87], v[20:23], a[92:95], v[84:87]
  global_load_lds_dwordx4 v222, s[56:57] offset:2048
  ds_write_b32 v214, v175 offset:3076
  s_waitcnt lgkmcnt(7)
  v_mfma_f32_16x16x32_bf16 v[88:91], v[24:27], a[64:67], v[88:91]
  ds_read_b64_tr_b16 v[16:17], v8 offset:57344
  v_mfma_f32_16x16x32_bf16 v[88:91], v[28:31], a[80:83], v[88:91]
  ds_read_b64_tr_b16 v[18:19], v8 offset:59392
  v_mfma_f32_16x16x32_bf16 v[92:95], v[24:27], a[68:71], v[92:95]
  ds_read_b64_tr_b16 v[20:21], v8 offset:61440
  v_mfma_f32_16x16x32_bf16 v[92:95], v[28:31], a[84:87], v[92:95]
  ds_read_b64_tr_b16 v[22:23], v8 offset:63488
  v_mfma_f32_16x16x32_bf16 v[96:99], v[24:27], a[72:75], v[96:99]
  v_mfma_f32_16x16x32_bf16 v[96:99], v[28:31], a[88:91], v[96:99]
  v_mfma_f32_16x16x32_bf16 v[100:103], v[24:27], a[76:79], v[100:103]
  v_mfma_f32_16x16x32_bf16 v[100:103], v[28:31], a[92:95], v[100:103]
  global_load_lds_dwordx4 v223, s[56:57] offset:3072
  s_waitcnt lgkmcnt(6)
  v_mfma_f32_16x16x32_bf16 v[72:75], v[32:35], a[96:99], v[72:75]
  v_mfma_f32_16x16x32_bf16 v[72:75], v[36:39], a[112:115], v[72:75]
  s_waitcnt vmcnt(8) lgkmcnt(0)
  s_barrier
  v_mfma_f32_16x16x32_bf16 v[76:79], v[32:35], a[100:103], v[76:79]
  ds_read_b64_tr_b16 v[24:25], v7 offset:0
  s_add_u32 m0, s19, 16384
  v_mfma_f32_16x16x32_bf16 v[76:79], v[36:39], a[116:119], v[76:79]
  ds_read_b64_tr_b16 v[26:27], v7 offset:2048
  s_add_u32 s56, s78, s69
  v_mfma_f32_16x16x32_bf16 v[80:83], v[32:35], a[104:107], v[80:83]
  ds_read_b64_tr_b16 v[28:29], v7 offset:4096
  s_add_u32 s56, s54, s56
  v_mfma_f32_16x16x32_bf16 v[80:83], v[36:39], a[120:123], v[80:83]
  ds_read_b64_tr_b16 v[30:31], v7 offset:6144
  s_addc_u32 s57, s55, 0
  v_mfma_f32_16x16x32_bf16 v[84:87], v[32:35], a[108:111], v[84:87]
  ds_read_b128 a[160:163], v14 offset:0
  v_mfma_f32_16x16x32_bf16 v[84:87], v[36:39], a[124:127], v[84:87]
  global_load_lds_dwordx4 v220, s[56:57] offset:0
  v_mfma_f32_16x16x32_bf16 v[88:91], v[16:19], a[96:99], v[88:91]
  ds_read_b64_tr_b16 v[32:33], v8 offset:0
  v_mfma_f32_16x16x32_bf16 v[88:91], v[20:23], a[112:115], v[88:91]
  ds_read_b64_tr_b16 v[34:35], v8 offset:2048
  v_mfma_f32_16x16x32_bf16 v[92:95], v[16:19], a[100:103], v[92:95]
  ds_read_b64_tr_b16 v[36:37], v8 offset:4096
  v_mfma_f32_16x16x32_bf16 v[92:95], v[20:23], a[116:119], v[92:95]
  ds_read_b64_tr_b16 v[38:39], v8 offset:6144
  v_mfma_f32_16x16x32_bf16 v[96:99], v[16:19], a[104:107], v[96:99]
  ds_read_b128 a[164:167], v14 offset:1024
  v_mfma_f32_16x16x32_bf16 v[96:99], v[20:23], a[120:123], v[96:99]
  ds_read_b128 a[168:171], v14 offset:2048
  v_mfma_f32_16x16x32_bf16 v[100:103], v[16:19], a[108:111], v[100:103]
  ds_read_b128 a[172:175], v14 offset:3072
  v_mfma_f32_16x16x32_bf16 v[100:103], v[20:23], a[124:127], v[100:103]
  global_load_lds_dwordx4 v221, s[56:57] offset:1024
  s_waitcnt lgkmcnt(8)
  v_mfma_f32_16x16x32_bf16 v[40:43], v[24:27], a[128:131], v[40:43]
  ds_read_b64_tr_b16 v[16:17], v7 offset:8192
  v_mfma_f32_16x16x32_bf16 v[40:43], v[28:31], a[144:147], v[40:43]
  ds_read_b64_tr_b16 v[18:19], v7 offset:10240
  v_mfma_f32_16x16x32_bf16 v[44:47], v[24:27], a[132:135], v[44:47]
  ds_read_b64_tr_b16 v[20:21], v7 offset:12288
  v_mfma_f32_16x16x32_bf16 v[44:47], v[28:31], a[148:151], v[44:47]
  ds_read_b64_tr_b16 v[22:23], v7 offset:14336
  v_mfma_f32_16x16x32_bf16 v[48:51], v[24:27], a[136:139], v[48:51]
  ds_read_b128 a[176:179], v14 offset:8192
  v_mfma_f32_16x16x32_bf16 v[48:51], v[28:31], a[152:155], v[48:51]
  ds_read_b128 a[180:183], v14 offset:9216
  v_mfma_f32_16x16x32_bf16 v[52:55], v[24:27], a[140:143], v[52:55]
  ds_read_b128 a[184:187], v14 offset:10240
  v_mfma_f32_16x16x32_bf16 v[52:55], v[28:31], a[156:159], v[52:55]
  global_load_lds_dwordx4 v222, s[56:57] offset:2048
  ds_read_b128 a[188:191], v14 offset:11264
  s_waitcnt lgkmcnt(11)
  v_mfma_f32_16x16x32_bf16 v[56:59], v[32:35], a[128:131], v[56:59]
  ds_read_b64_tr_b16 v[24:25], v8 offset:8192
  v_mfma_f32_16x16x32_bf16 v[56:59], v[36:39], a[144:147], v[56:59]
  ds_read_b64_tr_b16 v[26:27], v8 offset:10240
  v_mfma_f32_16x16x32_bf16 v[60:63], v[32:35], a[132:135], v[60:63]
  ds_read_b64_tr_b16 v[28:29], v8 offset:12288
  v_mfma_f32_16x16x32_bf16 v[60:63], v[36:39], a[148:151], v[60:63]
  ds_read_b64_tr_b16 v[30:31], v8 offset:14336
  v_mfma_f32_16x16x32_bf16 v[64:67], v[32:35], a[136:139], v[64:67]
  v_mfma_f32_16x16x32_bf16 v[64:67], v[36:39], a[152:155], v[64:67]
  v_mfma_f32_16x16x32_bf16 v[68:71], v[32:35], a[140:143], v[68:71]
  v_mfma_f32_16x16x32_bf16 v[68:71], v[36:39], a[156:159], v[68:71]
  global_load_lds_dwordx4 v223, s[56:57] offset:3072
  s_waitcnt lgkmcnt(8)
  s_waitcnt lgkmcnt(4)
  v_mfma_f32_16x16x32_bf16 v[40:43], v[16:19], a[160:163], v[40:43]
  v_mfma_f32_16x16x32_bf16 v[40:43], v[20:23], a[176:179], v[40:43]
  s_waitcnt vmcnt(8) lgkmcnt(0)
  s_barrier
  v_mfma_f32_16x16x32_bf16 v[44:47], v[16:19], a[164:167], v[44:47]
  ds_read_b64_tr_b16 v[32:33], v7 offset:16384
  s_add_u32 m0, s19, 32768
  v_mfma_f32_16x16x32_bf16 v[44:47], v[20:23], a[180:183], v[44:47]
  ds_read_b64_tr_b16 v[34:35], v7 offset:18432
  s_add_u32 s56, s79, s69
  v_mfma_f32_16x16x32_bf16 v[48:51], v[16:19], a[168:171], v[48:51]
  ds_read_b64_tr_b16 v[36:37], v7 offset:20480
  s_add_u32 s56, s54, s56
  v_mfma_f32_16x16x32_bf16 v[48:51], v[20:23], a[184:187], v[48:51]
  ds_read_b64_tr_b16 v[38:39], v7 offset:22528
  s_addc_u32 s57, s55, 0
  v_mfma_f32_16x16x32_bf16 v[52:55], v[16:19], a[172:175], v[52:55]
  global_load_lds_dwordx4 v220, s[56:57] offset:0
  v_add_u32 v5, 81920, v7
  v_mfma_f32_16x16x32_bf16 v[52:55], v[20:23], a[188:191], v[52:55]
  v_cvt_pk_bf16_f32 v120, v40, v41
  v_cvt_pk_bf16_f32 v121, v42, v43
  v_mfma_f32_16x16x32_bf16 v[56:59], v[24:27], a[160:163], v[56:59]
  ds_read_b64_tr_b16 v[16:17], v8 offset:16384
  v_add_u32 v6, 81920, v8
  v_cvt_pk_bf16_f32 v124, v44, v45
  v_mfma_f32_16x16x32_bf16 v[56:59], v[28:31], a[176:179], v[56:59]
  ds_read_b64_tr_b16 v[18:19], v8 offset:18432
  v_cvt_pk_bf16_f32 v125, v46, v47
  v_mfma_f32_16x16x32_bf16 v[60:63], v[24:27], a[164:167], v[60:63]
  ds_read_b64_tr_b16 v[20:21], v8 offset:20480
  v_cvt_pk_bf16_f32 v128, v48, v49
  v_mfma_f32_16x16x32_bf16 v[60:63], v[28:31], a[180:183], v[60:63]
  ds_read_b64_tr_b16 v[22:23], v8 offset:22528
  v_cvt_pk_bf16_f32 v129, v50, v51
  v_mfma_f32_16x16x32_bf16 v[64:67], v[24:27], a[168:171], v[64:67]
  v_cvt_pk_bf16_f32 v132, v52, v53
  v_cvt_pk_bf16_f32 v133, v54, v55
  v_mfma_f32_16x16x32_bf16 v[64:67], v[28:31], a[184:187], v[64:67]
  s_mul_i32 s61, s80, 256
  v_mfma_f32_16x16x32_bf16 v[68:71], v[24:27], a[172:175], v[68:71]
  global_load_lds_dwordx4 v221, s[56:57] offset:1024
  v_mfma_f32_16x16x32_bf16 v[68:71], v[28:31], a[188:191], v[68:71]
  s_waitcnt lgkmcnt(4)
  v_mfma_f32_16x16x32_bf16 v[72:75], v[32:35], a[128:131], v[72:75]
  ds_read_b64_tr_b16 v[24:25], v7 offset:24576
  v_cvt_pk_bf16_f32 v122, v56, v57
  v_mfma_f32_16x16x32_bf16 v[72:75], v[36:39], a[144:147], v[72:75]
  ds_read_b64_tr_b16 v[26:27], v7 offset:26624
  v_cvt_pk_bf16_f32 v123, v58, v59
  v_mfma_f32_16x16x32_bf16 v[76:79], v[32:35], a[132:135], v[76:79]
  ds_read_b64_tr_b16 v[28:29], v7 offset:28672
  v_cvt_pk_bf16_f32 v126, v60, v61
  v_mfma_f32_16x16x32_bf16 v[76:79], v[36:39], a[148:151], v[76:79]
  ds_read_b64_tr_b16 v[30:31], v7 offset:30720
  buffer_store_dwordx4 v[120:123], v184, s[40:43], s61 offen sc1
  v_cvt_pk_bf16_f32 v127, v62, v63
  v_mfma_f32_16x16x32_bf16 v[80:83], v[32:35], a[136:139], v[80:83]
  v_cvt_pk_bf16_f32 v130, v64, v65
  v_cvt_pk_bf16_f32 v131, v66, v67
  v_mfma_f32_16x16x32_bf16 v[80:83], v[36:39], a[152:155], v[80:83]
  v_cvt_pk_bf16_f32 v134, v68, v69
  v_cvt_pk_bf16_f32 v135, v70, v71
  v_mfma_f32_16x16x32_bf16 v[84:87], v[32:35], a[140:143], v[84:87]
  global_load_lds_dwordx4 v222, s[56:57] offset:2048
  v_mfma_f32_16x16x32_bf16 v[84:87], v[36:39], a[156:159], v[84:87]
  buffer_store_dwordx4 v[124:127], v185, s[40:43], s61 offen sc1
  s_waitcnt lgkmcnt(4)
  v_mfma_f32_16x16x32_bf16 v[88:91], v[16:19], a[128:131], v[88:91]
  ds_read_b64_tr_b16 v[32:33], v8 offset:24576
  s_xor_b32 s19, s19, 81920
  v_mfma_f32_16x16x32_bf16 v[88:91], v[20:23], a[144:147], v[88:91]
  ds_read_b64_tr_b16 v[34:35], v8 offset:26624
  s_add_u32 s69, s69, 128
  v_mfma_f32_16x16x32_bf16 v[92:95], v[16:19], a[132:135], v[92:95]
  ds_read_b64_tr_b16 v[36:37], v8 offset:28672
  s_cmp_eq_u32 s69, 1152
  v_mfma_f32_16x16x32_bf16 v[92:95], v[20:23], a[148:151], v[92:95]
  ds_read_b64_tr_b16 v[38:39], v8 offset:30720
  s_cselect_b32 s69, 0, s69
  v_mfma_f32_16x16x32_bf16 v[96:99], v[16:19], a[136:139], v[96:99]
  buffer_store_dwordx4 v[128:131], v186, s[40:43], s61 offen sc1
  v_mfma_f32_16x16x32_bf16 v[96:99], v[20:23], a[152:155], v[96:99]
  v_mfma_f32_16x16x32_bf16 v[100:103], v[16:19], a[140:143], v[100:103]
  global_load_lds_dwordx4 v223, s[56:57] offset:3072
  v_mfma_f32_16x16x32_bf16 v[100:103], v[20:23], a[156:159], v[100:103]
  s_waitcnt lgkmcnt(4)
  v_mfma_f32_16x16x32_bf16 v[72:75], v[24:27], a[160:163], v[72:75]
  buffer_store_dwordx4 v[132:135], v187, s[40:43], s61 offen sc1
L_loop2:
  v_mfma_f32_16x16x32_bf16 v[72:75], v[28:31], a[176:179], v[72:75]
  s_waitcnt vmcnt(12) lgkmcnt(0)
  s_barrier
  v_mfma_f32_16x16x32_bf16 v[76:79], v[24:27], a[164:167], v[76:79]
  ds_read_b64_tr_b16 v[16:17], v5 offset:0
  s_add_u32 m0, s19, 0
  v_mfma_f32_16x16x32_bf16 v[76:79], v[28:31], a[180:183], v[76:79]
  ds_read_b64_tr_b16 v[18:19], v5 offset:2048
  s_add_u32 s56, s77, s69
  v_mfma_f32_16x16x32_bf16 v[80:83], v[24:27], a[168:171], v[80:83]
  ds_read_b64_tr_b16 v[20:21], v5 offset:4096
  s_add_u32 s56, s54, s56
  v_mfma_f32_16x16x32_bf16 v[80:83], v[28:31], a[184:187], v[80:83]
  ds_read_b64_tr_b16 v[22:23], v5 offset:6144
  s_addc_u32 s57, s55, 0
  v_mfma_f32_16x16x32_bf16 v[84:87], v[24:27], a[172:175], v[84:87]
  global_load_lds_dwordx4 v220, s[56:57] offset:0
  v_mfma_f32_16x16x32_bf16 v[84:87], v[28:31], a[188:191], v[84:87]
  v_cvt_pk_bf16_f32 v104, v72, v73
  v_cvt_pk_bf16_f32 v105, v74, v75
  v_mfma_f32_16x16x32_bf16 v[88:91], v[32:35], a[160:163], v[88:91]
  ds_read_b64_tr_b16 v[24:25], v6 offset:0
  v_cvt_pk_bf16_f32 v108, v76, v77
  v_mfma_f32_16x16x32_bf16 v[88:91], v[36:39], a[176:179], v[88:91]
  ds_read_b64_tr_b16 v[26:27], v6 offset:2048
  v_cvt_pk_bf16_f32 v109, v78, v79
  v_mfma_f32_16x16x32_bf16 v[92:95], v[32:35], a[164:167], v[92:95]
  ds_read_b64_tr_b16 v[28:29], v6 offset:4096
  v_cvt_pk_bf16_f32 v112, v80, v81
  v_mfma_f32_16x16x32_bf16 v[92:95], v[36:39], a[180:183], v[92:95]
  ds_read_b64_tr_b16 v[30:31], v6 offset:6144
  v_cvt_pk_bf16_f32 v113, v82, v83
  v_mfma_f32_16x16x32_bf16 v[96:99], v[32:35], a[168:171], v[96:99]
  v_cvt_pk_bf16_f32 v116, v84, v85
  v_cvt_pk_bf16_f32 v117, v86, v87
  v_mfma_f32_16x16x32_bf16 v[96:99], v[36:39], a[184:187], v[96:99]
  v_mfma_f32_16x16x32_bf16 v[100:103], v[32:35], a[172:175], v[100:103]
  global_load_lds_dwordx4 v221, s[56:57] offset:1024
  v_mfma_f32_16x16x32_bf16 v[100:103], v[36:39], a[188:191], v[100:103]
  s_waitcnt lgkmcnt(4)
  v_mfma_f32_16x16x32_bf16 v[72:75], v[16:19], a[0:3], 0
  ds_read_b64_tr_b16 v[32:33], v5 offset:8192
  v_cvt_pk_bf16_f32 v106, v88, v89
  v_mfma_f32_16x16x32_bf16 v[72:75], v[20:23], a[16:19], v[72:75]
  ds_read_b64_tr_b16 v[34:35], v5 offset:10240
  v_cvt_pk_bf16_f32 v107, v90, v91
  v_mfma_f32_16x16x32_bf16 v[76:79], v[16:19], a[4:7], 0
  ds_read_b64_tr_b16 v[36:37], v5 offset:12288
  v_cvt_pk_bf16_f32 v110, v92, v93
  v_mfma_f32_16x16x32_bf16 v[76:79], v[20:23], a[20:23], v[76:79]
  ds_read_b64_tr_b16 v[38:39], v5 offset:14336
  v_cvt_pk_bf16_f32 v111, v94, v95
  v_mfma_f32_16x16x32_bf16 v[80:83], v[16:19], a[8:11], 0
  v_cvt_pk_bf16_f32 v114, v96, v97
  v_cvt_pk_bf16_f32 v115, v98, v99
  v_mfma_f32_16x16x32_bf16 v[80:83], v[20:23], a[24:27], v[80:83]
  v_cvt_pk_bf16_f32 v118, v100, v101
  v_cvt_pk_bf16_f32 v119, v102, v103
  v_mfma_f32_16x16x32_bf16 v[84:87], v[16:19], a[12:15], 0
  global_load_lds_dwordx4 v222, s[56:57] offset:2048
  v_mfma_f32_16x16x32_bf16 v[84:87], v[20:23], a[28:31], v[84:87]
  s_add_u32 s61, s61, 32768
  s_waitcnt lgkmcnt(4)
  v_mfma_f32_16x16x32_bf16 v[88:91], v[24:27], a[0:3], 0
  ds_read_b64_tr_b16 v[16:17], v6 offset:8192
  s_cmp_eq_u32 s61, 294912
  v_mfma_f32_16x16x32_bf16 v[88:91], v[28:31], a[16:19], v[88:91]
  ds_read_b64_tr_b16 v[18:19], v6 offset:10240
  s_cselect_b32 s61, 0, s61
  v_mfma_f32_16x16x32_bf16 v[92:95], v[24:27], a[4:7], 0
  ds_read_b64_tr_b16 v[20:21], v6 offset:12288
  v_mfma_f32_16x16x32_bf16 v[92:95], v[28:31], a[20:23], v[92:95]
  ds_read_b64_tr_b16 v[22:23], v6 offset:14336
  v_mfma_f32_16x16x32_bf16 v[96:99], v[24:27], a[8:11], 0
  v_mfma_f32_16x16x32_bf16 v[96:99], v[28:31], a[24:27], v[96:99]
  v_mfma_f32_16x16x32_bf16 v[100:103], v[24:27], a[12:15], 0
  global_load_lds_dwordx4 v223, s[56:57] offset:3072
  v_mfma_f32_16x16x32_bf16 v[100:103], v[28:31], a[28:31], v[100:103]
  s_waitcnt lgkmcnt(4)
  v_mfma_f32_16x16x32_bf16 v[72:75], v[32:35], a[32:35], v[72:75]
  v_mfma_f32_16x16x32_bf16 v[72:75], v[36:39], a[48:51], v[72:75]
  s_waitcnt vmcnt(9) lgkmcnt(0)
  s_barrier
  v_mfma_f32_16x16x32_bf16 v[76:79], v[32:35], a[36:39], v[76:79]
  ds_read_b64_tr_b16 v[24:25], v5 offset:16384
  s_add_u32 m0, s19, 16384
  v_mfma_f32_16x16x32_bf16 v[76:79], v[36:39], a[52:55], v[76:79]
  ds_read_b64_tr_b16 v[26:27], v5 offset:18432
  s_add_u32 s56, s78, s69
  v_mfma_f32_16x16x32_bf16 v[80:83], v[32:35], a[40:43], v[80:83]
  ds_read_b64_tr_b16 v[28:29], v5 offset:20480
  s_add_u32 s56, s54, s56
  v_mfma_f32_16x16x32_bf16 v[80:83], v[36:39], a[56:59], v[80:83]
  ds_read_b64_tr_b16 v[30:31], v5 offset:22528
  s_addc_u32 s57, s55, 0
  v_mfma_f32_16x16x32_bf16 v[84:87], v[32:35], a[44:47], v[84:87]
  global_load_lds_dwordx4 v220, s[56:57] offset:0
  v_mfma_f32_16x16x32_bf16 v[84:87], v[36:39], a[60:63], v[84:87]
  v_mfma_f32_16x16x32_bf16 v[88:91], v[16:19], a[32:35], v[88:91]
  ds_read_b64_tr_b16 v[32:33], v6 offset:16384
  v_mfma_f32_16x16x32_bf16 v[88:91], v[20:23], a[48:51], v[88:91]
  ds_read_b64_tr_b16 v[34:35], v6 offset:18432
  v_mfma_f32_16x16x32_bf16 v[92:95], v[16:19], a[36:39], v[92:95]
  ds_read_b64_tr_b16 v[36:37], v6 offset:20480
  buffer_store_dwordx4 v[104:107], v184, s[40:43], s61 offen sc1
  v_mfma_f32_16x16x32_bf16 v[92:95], v[20:23], a[52:55], v[92:95]
  ds_read_b64_tr_b16 v[38:39], v6 offset:22528
  v_mfma_f32_16x16x32_bf16 v[96:99], v[16:19], a[40:43], v[96:99]
  s_waitcnt vmcnt(10)
  buffer_atomic_add v4, v15, s[40:43], s17 offen offset:0 sc1
  v_mfma_f32_16x16x32_bf16 v[96:99], v[20:23], a[56:59], v[96:99]
  v_mfma_f32_16x16x32_bf16 v[100:103], v[16:19], a[44:47], v[100:103]
  global_load_lds_dwordx4 v221, s[56:57] offset:1024
  v_mfma_f32_16x16x32_bf16 v[100:103], v[20:23], a[60:63], v[100:103]
  s_waitcnt lgkmcnt(4)
  v_mfma_f32_16x16x32_bf16 v[72:75], v[24:27], a[64:67], v[72:75]
  ds_read_b64_tr_b16 v[16:17], v5 offset:24576
  v_mfma_f32_16x16x32_bf16 v[72:75], v[28:31], a[80:83], v[72:75]
  ds_read_b64_tr_b16 v[18:19], v5 offset:26624
  v_mfma_f32_16x16x32_bf16 v[76:79], v[24:27], a[68:71], v[76:79]
  ds_read_b64_tr_b16 v[20:21], v5 offset:28672
  buffer_store_dwordx4 v[108:111], v185, s[40:43], s61 offen sc1
  v_mfma_f32_16x16x32_bf16 v[76:79], v[28:31], a[84:87], v[76:79]
  ds_read_b64_tr_b16 v[22:23], v5 offset:30720
  v_mfma_f32_16x16x32_bf16 v[80:83], v[24:27], a[72:75], v[80:83]
  v_mfma_f32_16x16x32_bf16 v[80:83], v[28:31], a[88:91], v[80:83]
  v_mfma_f32_16x16x32_bf16 v[84:87], v[24:27], a[76:79], v[84:87]
  global_load_lds_dwordx4 v222, s[56:57] offset:2048
  v_mfma_f32_16x16x32_bf16 v[84:87], v[28:31], a[92:95], v[84:87]
  s_waitcnt lgkmcnt(4)
  v_mfma_f32_16x16x32_bf16 v[88:91], v[32:35], a[64:67], v[88:91]
  ds_read_b64_tr_b16 v[24:25], v6 offset:24576
  v_mfma_f32_16x16x32_bf16 v[88:91], v[36:39], a[80:83], v[88:91]
  ds_read_b64_tr_b16 v[26:27], v6 offset:26624
  v_mfma_f32_16x16x32_bf16 v[92:95], v[32:35], a[68:71], v[92:95]
  ds_read_b64_tr_b16 v[28:29], v6 offset:28672
  buffer_store_dwordx4 v[112:115], v186, s[40:43], s61 offen sc1
  v_mfma_f32_16x16x32_bf16 v[92:95], v[36:39], a[84:87], v[92:95]
  ds_read_b64_tr_b16 v[30:31], v6 offset:30720
  s_lshl2_add_u32 s17, s18, 4
  v_mfma_f32_16x16x32_bf16 v[96:99], v[32:35], a[72:75], v[96:99]
  v_mfma_f32_16x16x32_bf16 v[96:99], v[36:39], a[88:91], v[96:99]
  v_mfma_f32_16x16x32_bf16 v[100:103], v[32:35], a[76:79], v[100:103]
  global_load_lds_dwordx4 v223, s[56:57] offset:3072
  v_mfma_f32_16x16x32_bf16 v[100:103], v[36:39], a[92:95], v[100:103]
  s_waitcnt lgkmcnt(4)
  v_mfma_f32_16x16x32_bf16 v[72:75], v[16:19], a[96:99], v[72:75]
  buffer_store_dwordx4 v[116:119], v187, s[40:43], s61 offen sc1
  v_mfma_f32_16x16x32_bf16 v[72:75], v[20:23], a[112:115], v[72:75]
  s_waitcnt vmcnt(13) lgkmcnt(0)
  s_barrier
  v_mfma_f32_16x16x32_bf16 v[76:79], v[16:19], a[100:103], v[76:79]
  ds_read_b64_tr_b16 v[32:33], v5 offset:32768
  s_add_u32 m0, s19, 32768
  v_mfma_f32_16x16x32_bf16 v[76:79], v[20:23], a[116:119], v[76:79]
  ds_read_b64_tr_b16 v[34:35], v5 offset:34816
  s_add_u32 s56, s79, s69
  v_mfma_f32_16x16x32_bf16 v[80:83], v[16:19], a[104:107], v[80:83]
  ds_read_b64_tr_b16 v[36:37], v5 offset:36864
  s_add_u32 s56, s54, s56
  v_mfma_f32_16x16x32_bf16 v[80:83], v[20:23], a[120:123], v[80:83]
  ds_read_b64_tr_b16 v[38:39], v5 offset:38912
  s_addc_u32 s57, s55, 0
  v_mfma_f32_16x16x32_bf16 v[84:87], v[16:19], a[108:111], v[84:87]
  global_load_lds_dwordx4 v220, s[56:57] offset:0
  v_mfma_f32_16x16x32_bf16 v[84:87], v[20:23], a[124:127], v[84:87]
  v_mfma_f32_16x16x32_bf16 v[88:91], v[24:27], a[96:99], v[88:91]
  ds_read_b64_tr_b16 v[16:17], v6 offset:32768
  v_mfma_f32_16x16x32_bf16 v[88:91], v[28:31], a[112:115], v[88:91]
  ds_read_b64_tr_b16 v[18:19], v6 offset:34816
  v_mfma_f32_16x16x32_bf16 v[92:95], v[24:27], a[100:103], v[92:95]
  ds_read_b64_tr_b16 v[20:21], v6 offset:36864
  v_mfma_f32_16x16x32_bf16 v[92:95], v[28:31], a[116:119], v[92:95]
  ds_read_b64_tr_b16 v[22:23], v6 offset:38912
  v_mfma_f32_16x16x32_bf16 v[96:99], v[24:27], a[104:107], v[96:99]
  v_mfma_f32_16x16x32_bf16 v[96:99], v[28:31], a[120:123], v[96:99]
  v_mfma_f32_16x16x32_bf16 v[100:103], v[24:27], a[108:111], v[100:103]
  global_load_lds_dwordx4 v221, s[56:57] offset:1024
  v_mfma_f32_16x16x32_bf16 v[100:103], v[28:31], a[124:127], v[100:103]
  s_waitcnt lgkmcnt(4)
  v_mfma_f32_16x16x32_bf16 v[72:75], v[32:35], a[128:131], v[72:75]
  ds_read_b64_tr_b16 v[24:25], v5 offset:40960
  v_mfma_f32_16x16x32_bf16 v[72:75], v[36:39], a[144:147], v[72:75]
  ds_read_b64_tr_b16 v[26:27], v5 offset:43008
  v_mfma_f32_16x16x32_bf16 v[76:79], v[32:35], a[132:135], v[76:79]
  ds_read_b64_tr_b16 v[28:29], v5 offset:45056
  v_mfma_f32_16x16x32_bf16 v[76:79], v[36:39], a[148:151], v[76:79]
  ds_read_b64_tr_b16 v[30:31], v5 offset:47104
  v_mfma_f32_16x16x32_bf16 v[80:83], v[32:35], a[136:139], v[80:83]
  v_mfma_f32_16x16x32_bf16 v[80:83], v[36:39], a[152:155], v[80:83]
  v_mfma_f32_16x16x32_bf16 v[84:87], v[32:35], a[140:143], v[84:87]
  global_load_lds_dwordx4 v222, s[56:57] offset:2048
  v_mfma_f32_16x16x32_bf16 v[84:87], v[36:39], a[156:159], v[84:87]
  s_waitcnt lgkmcnt(4)
  v_mfma_f32_16x16x32_bf16 v[88:91], v[16:19], a[128:131], v[88:91]
  ds_read_b64_tr_b16 v[32:33], v6 offset:40960
  s_xor_b32 s19, s19, 81920
  v_mfma_f32_16x16x32_bf16 v[88:91], v[20:23], a[144:147], v[88:91]
  ds_read_b64_tr_b16 v[34:35], v6 offset:43008
  s_add_u32 s69, s69, 128
  v_mfma_f32_16x16x32_bf16 v[92:95], v[16:19], a[132:135], v[92:95]
  ds_read_b64_tr_b16 v[36:37], v6 offset:45056
  s_cmp_eq_u32 s69, 1152
  v_mfma_f32_16x16x32_bf16 v[92:95], v[20:23], a[148:151], v[92:95]
  ds_read_b64_tr_b16 v[38:39], v6 offset:47104
  s_cselect_b32 s69, 0, s69
  v_mfma_f32_16x16x32_bf16 v[96:99], v[16:19], a[136:139], v[96:99]
  v_xor_b32 v5, 81920, v5
  v_xor_b32 v6, 81920, v6
  v_mfma_f32_16x16x32_bf16 v[96:99], v[20:23], a[152:155], v[96:99]
  s_add_u32 s18, s18, 1
  v_mfma_f32_16x16x32_bf16 v[100:103], v[16:19], a[140:143], v[100:103]
  global_load_lds_dwordx4 v223, s[56:57] offset:3072
  v_mfma_f32_16x16x32_bf16 v[100:103], v[20:23], a[156:159], v[100:103]
  s_waitcnt lgkmcnt(4)
  v_mfma_f32_16x16x32_bf16 v[72:75], v[24:27], a[160:163], v[72:75]
  s_bitcmp1_b32 66, s18
  s_cbranch_scc0 L_loop2
  s_cmp_eq_u32 s18, 6
  s_cbranch_scc1 L_loop2_exit
  s_waitcnt vmcnt(17)
  buffer_atomic_add v4, v15, s[40:43], 0 offen offset:0 sc1
  s_branch L_loop2
L_loop2_exit:
  v_mfma_f32_16x16x32_bf16 v[72:75], v[28:31], a[176:179], v[72:75]
  s_waitcnt vmcnt(13) lgkmcnt(0)
  s_barrier
  v_mfma_f32_16x16x32_bf16 v[76:79], v[24:27], a[164:167], v[76:79]
  ds_read_b64_tr_b16 v[16:17], v5 offset:0
  v_mov_b32 v195, 0
  v_mfma_f32_16x16x32_bf16 v[76:79], v[28:31], a[180:183], v[76:79]
  ds_read_b64_tr_b16 v[18:19], v5 offset:2048
  v_mfma_f32_16x16x32_bf16 v[80:83], v[24:27], a[168:171], v[80:83]
  ds_read_b64_tr_b16 v[20:21], v5 offset:4096
  v_mfma_f32_16x16x32_bf16 v[80:83], v[28:31], a[184:187], v[80:83]
  ds_read_b64_tr_b16 v[22:23], v5 offset:6144
  v_mfma_f32_16x16x32_bf16 v[84:87], v[24:27], a[172:175], v[84:87]
  buffer_atomic_or v195, v193, s[40:43], 0 offen sc0 sc1
  v_mfma_f32_16x16x32_bf16 v[84:87], v[28:31], a[188:191], v[84:87]
  v_cvt_pk_bf16_f32 v104, v72, v73
  v_cvt_pk_bf16_f32 v105, v74, v75
  v_mfma_f32_16x16x32_bf16 v[88:91], v[32:35], a[160:163], v[88:91]
  ds_read_b64_tr_b16 v[24:25], v6 offset:0
  v_cvt_pk_bf16_f32 v108, v76, v77
  v_mfma_f32_16x16x32_bf16 v[88:91], v[36:39], a[176:179], v[88:91]
  ds_read_b64_tr_b16 v[26:27], v6 offset:2048
  v_cvt_pk_bf16_f32 v109, v78, v79
  v_mfma_f32_16x16x32_bf16 v[92:95], v[32:35], a[164:167], v[92:95]
  ds_read_b64_tr_b16 v[28:29], v6 offset:4096
  v_cvt_pk_bf16_f32 v112, v80, v81
  v_mfma_f32_16x16x32_bf16 v[92:95], v[36:39], a[180:183], v[92:95]
  ds_read_b64_tr_b16 v[30:31], v6 offset:6144
  v_cvt_pk_bf16_f32 v113, v82, v83
  v_mfma_f32_16x16x32_bf16 v[96:99], v[32:35], a[168:171], v[96:99]
  v_cvt_pk_bf16_f32 v116, v84, v85
  v_cvt_pk_bf16_f32 v117, v86, v87
  v_mfma_f32_16x16x32_bf16 v[96:99], v[36:39], a[184:187], v[96:99]
  v_mfma_f32_16x16x32_bf16 v[100:103], v[32:35], a[172:175], v[100:103]
  v_mfma_f32_16x16x32_bf16 v[100:103], v[36:39], a[188:191], v[100:103]
  s_waitcnt lgkmcnt(4)
  v_mfma_f32_16x16x32_bf16 v[72:75], v[16:19], a[0:3], 0
  ds_read_b64_tr_b16 v[32:33], v5 offset:8192
  v_cvt_pk_bf16_f32 v106, v88, v89
  v_mfma_f32_16x16x32_bf16 v[72:75], v[20:23], a[16:19], v[72:75]
  ds_read_b64_tr_b16 v[34:35], v5 offset:10240
  v_cvt_pk_bf16_f32 v107, v90, v91
  v_mfma_f32_16x16x32_bf16 v[76:79], v[16:19], a[4:7], 0
  ds_read_b64_tr_b16 v[36:37], v5 offset:12288
  v_cvt_pk_bf16_f32 v110, v92, v93
  v_mfma_f32_16x16x32_bf16 v[76:79], v[20:23], a[20:23], v[76:79]
  ds_read_b64_tr_b16 v[38:39], v5 offset:14336
  v_cvt_pk_bf16_f32 v111, v94, v95
  v_mfma_f32_16x16x32_bf16 v[80:83], v[16:19], a[8:11], 0
  v_cvt_pk_bf16_f32 v114, v96, v97
  v_cvt_pk_bf16_f32 v115, v98, v99
  v_mfma_f32_16x16x32_bf16 v[80:83], v[20:23], a[24:27], v[80:83]
  v_cvt_pk_bf16_f32 v118, v100, v101
  v_cvt_pk_bf16_f32 v119, v102, v103
  v_mfma_f32_16x16x32_bf16 v[84:87], v[16:19], a[12:15], 0
  v_mfma_f32_16x16x32_bf16 v[84:87], v[20:23], a[28:31], v[84:87]
  s_add_u32 s61, s61, 32768
  s_waitcnt lgkmcnt(4)
  v_mfma_f32_16x16x32_bf16 v[88:91], v[24:27], a[0:3], 0
  ds_read_b64_tr_b16 v[16:17], v6 offset:8192
  s_cmp_eq_u32 s61, 294912
  v_mfma_f32_16x16x32_bf16 v[88:91], v[28:31], a[16:19], v[88:91]
  ds_read_b64_tr_b16 v[18:19], v6 offset:10240
  s_cselect_b32 s61, 0, s61
  v_mfma_f32_16x16x32_bf16 v[92:95], v[24:27], a[4:7], 0
  ds_read_b64_tr_b16 v[20:21], v6 offset:12288
  v_mfma_f32_16x16x32_bf16 v[92:95], v[28:31], a[20:23], v[92:95]
  ds_read_b64_tr_b16 v[22:23], v6 offset:14336
  v_mfma_f32_16x16x32_bf16 v[96:99], v[24:27], a[8:11], 0
  v_mfma_f32_16x16x32_bf16 v[96:99], v[28:31], a[24:27], v[96:99]
  v_mfma_f32_16x16x32_bf16 v[100:103], v[24:27], a[12:15], 0
  v_mfma_f32_16x16x32_bf16 v[100:103], v[28:31], a[28:31], v[100:103]
  s_waitcnt lgkmcnt(4)
  v_mfma_f32_16x16x32_bf16 v[72:75], v[32:35], a[32:35], v[72:75]
  v_mfma_f32_16x16x32_bf16 v[72:75], v[36:39], a[48:51], v[72:75]
  s_waitcnt vmcnt(6) lgkmcnt(0)
  s_barrier
  v_mfma_f32_16x16x32_bf16 v[76:79], v[32:35], a[36:39], v[76:79]
  ds_read_b64_tr_b16 v[24:25], v5 offset:16384
  v_mfma_f32_16x16x32_bf16 v[76:79], v[36:39], a[52:55], v[76:79]
  ds_read_b64_tr_b16 v[26:27], v5 offset:18432
  v_mfma_f32_16x16x32_bf16 v[80:83], v[32:35], a[40:43], v[80:83]
  ds_read_b64_tr_b16 v[28:29], v5 offset:20480
  v_mfma_f32_16x16x32_bf16 v[80:83], v[36:39], a[56:59], v[80:83]
  ds_read_b64_tr_b16 v[30:31], v5 offset:22528
  v_mfma_f32_16x16x32_bf16 v[84:87], v[32:35], a[44:47], v[84:87]
  v_mfma_f32_16x16x32_bf16 v[84:87], v[36:39], a[60:63], v[84:87]
  v_mfma_f32_16x16x32_bf16 v[88:91], v[16:19], a[32:35], v[88:91]
  ds_read_b64_tr_b16 v[32:33], v6 offset:16384
  v_mfma_f32_16x16x32_bf16 v[88:91], v[20:23], a[48:51], v[88:91]
  ds_read_b64_tr_b16 v[34:35], v6 offset:18432
  v_mfma_f32_16x16x32_bf16 v[92:95], v[16:19], a[36:39], v[92:95]
  ds_read_b64_tr_b16 v[36:37], v6 offset:20480
  buffer_store_dwordx4 v[104:107], v184, s[40:43], s61 offen sc1
  v_mfma_f32_16x16x32_bf16 v[92:95], v[20:23], a[52:55], v[92:95]
  ds_read_b64_tr_b16 v[38:39], v6 offset:22528
  v_mfma_f32_16x16x32_bf16 v[96:99], v[16:19], a[40:43], v[96:99]
  s_waitcnt vmcnt(6)
  buffer_atomic_add v4, v15, s[40:43], s17 offen offset:0 sc1
  v_mfma_f32_16x16x32_bf16 v[96:99], v[20:23], a[56:59], v[96:99]
  v_mfma_f32_16x16x32_bf16 v[100:103], v[16:19], a[44:47], v[100:103]
  v_mfma_f32_16x16x32_bf16 v[100:103], v[20:23], a[60:63], v[100:103]
  s_waitcnt lgkmcnt(4)
  v_mfma_f32_16x16x32_bf16 v[72:75], v[24:27], a[64:67], v[72:75]
  ds_read_b64_tr_b16 v[16:17], v5 offset:24576
  v_mfma_f32_16x16x32_bf16 v[72:75], v[28:31], a[80:83], v[72:75]
  ds_read_b64_tr_b16 v[18:19], v5 offset:26624
  v_mfma_f32_16x16x32_bf16 v[76:79], v[24:27], a[68:71], v[76:79]
  ds_read_b64_tr_b16 v[20:21], v5 offset:28672
  buffer_store_dwordx4 v[108:111], v185, s[40:43], s61 offen sc1
  v_mfma_f32_16x16x32_bf16 v[76:79], v[28:31], a[84:87], v[76:79]
  ds_read_b64_tr_b16 v[22:23], v5 offset:30720
  v_mfma_f32_16x16x32_bf16 v[80:83], v[24:27], a[72:75], v[80:83]
  v_mfma_f32_16x16x32_bf16 v[80:83], v[28:31], a[88:91], v[80:83]
  v_mfma_f32_16x16x32_bf16 v[84:87], v[24:27], a[76:79], v[84:87]
  v_mfma_f32_16x16x32_bf16 v[84:87], v[28:31], a[92:95], v[84:87]
  s_waitcnt lgkmcnt(4)
  v_mfma_f32_16x16x32_bf16 v[88:91], v[32:35], a[64:67], v[88:91]
  ds_read_b64_tr_b16 v[24:25], v6 offset:24576
  v_mfma_f32_16x16x32_bf16 v[88:91], v[36:39], a[80:83], v[88:91]
  ds_read_b64_tr_b16 v[26:27], v6 offset:26624
  v_mfma_f32_16x16x32_bf16 v[92:95], v[32:35], a[68:71], v[92:95]
  ds_read_b64_tr_b16 v[28:29], v6 offset:28672
  buffer_store_dwordx4 v[112:115], v186, s[40:43], s61 offen sc1
  v_mfma_f32_16x16x32_bf16 v[92:95], v[36:39], a[84:87], v[92:95]
  ds_read_b64_tr_b16 v[30:31], v6 offset:30720
  s_lshl2_add_u32 s17, s18, 4
  v_mfma_f32_16x16x32_bf16 v[96:99], v[32:35], a[72:75], v[96:99]
  s_waitcnt vmcnt(4)
  v_cmp_lt_u32 vcc, v195, v194
  v_mfma_f32_16x16x32_bf16 v[96:99], v[36:39], a[88:91], v[96:99]
  v_mfma_f32_16x16x32_bf16 v[100:103], v[32:35], a[76:79], v[100:103]
  s_and_b32 s59, vcc_lo, 0x200
  s_cbranch_scc1 L_f_qs_slow
L_f_qs_ok:
  v_mfma_f32_16x16x32_bf16 v[100:103], v[36:39], a[92:95], v[100:103]
  buffer_load_dword v200, v192, s[40:43], s85 offen sc1
  s_waitcnt lgkmcnt(4)
  v_mfma_f32_16x16x32_bf16 v[72:75], v[16:19], a[96:99], v[72:75]
  buffer_store_dwordx4 v[116:119], v187, s[40:43], s61 offen sc1
  v_mfma_f32_16x16x32_bf16 v[72:75], v[20:23], a[112:115], v[72:75]
  s_waitcnt lgkmcnt(0)
  s_barrier
  v_mfma_f32_16x16x32_bf16 v[76:79], v[16:19], a[100:103], v[76:79]
  ds_read_b64_tr_b16 v[32:33], v5 offset:32768
  v_mfma_f32_16x16x32_bf16 v[76:79], v[20:23], a[116:119], v[76:79]
  ds_read_b64_tr_b16 v[34:35], v5 offset:34816
  v_mfma_f32_16x16x32_bf16 v[80:83], v[16:19], a[104:107], v[80:83]
  ds_read_b64_tr_b16 v[36:37], v5 offset:36864
  v_mfma_f32_16x16x32_bf16 v[80:83], v[20:23], a[120:123], v[80:83]
  ds_read_b64_tr_b16 v[38:39], v5 offset:38912
  v_mfma_f32_16x16x32_bf16 v[84:87], v[16:19], a[108:111], v[84:87]
  buffer_load_dword v201, v192, s[40:43], s86 offen sc1
  v_mfma_f32_16x16x32_bf16 v[84:87], v[20:23], a[124:127], v[84:87]
  v_mfma_f32_16x16x32_bf16 v[88:91], v[24:27], a[96:99], v[88:91]
  ds_read_b64_tr_b16 v[16:17], v6 offset:32768
  v_mfma_f32_16x16x32_bf16 v[88:91], v[28:31], a[112:115], v[88:91]
  ds_read_b64_tr_b16 v[18:19], v6 offset:34816
  v_mfma_f32_16x16x32_bf16 v[92:95], v[24:27], a[100:103], v[92:95]
  ds_read_b64_tr_b16 v[20:21], v6 offset:36864
  v_mfma_f32_16x16x32_bf16 v[92:95], v[28:31], a[116:119], v[92:95]
  ds_read_b64_tr_b16 v[22:23], v6 offset:38912
  v_mfma_f32_16x16x32_bf16 v[96:99], v[24:27], a[104:107], v[96:99]
  buffer_load_dword v202, v192, s[40:43], s87 offen sc1
  v_mfma_f32_16x16x32_bf16 v[96:99], v[28:31], a[120:123], v[96:99]
  v_mfma_f32_16x16x32_bf16 v[100:103], v[24:27], a[108:111], v[100:103]
  v_mfma_f32_16x16x32_bf16 v[100:103], v[28:31], a[124:127], v[100:103]
  buffer_load_dword v203, v192, s[40:43], s88 offen sc1
  s_waitcnt lgkmcnt(4)
  v_mfma_f32_16x16x32_bf16 v[72:75], v[32:35], a[128:131], v[72:75]
  ds_read_b64_tr_b16 v[24:25], v5 offset:40960
  v_mfma_f32_16x16x32_bf16 v[72:75], v[36:39], a[144:147], v[72:75]
  ds_read_b64_tr_b16 v[26:27], v5 offset:43008
  v_mfma_f32_16x16x32_bf16 v[76:79], v[32:35], a[132:135], v[76:79]
  ds_read_b64_tr_b16 v[28:29], v5 offset:45056
  v_writelane_b32 v193, -16, 9
  v_mfma_f32_16x16x32_bf16 v[76:79], v[36:39], a[148:151], v[76:79]
  ds_read_b64_tr_b16 v[30:31], v5 offset:47104
  v_mfma_f32_16x16x32_bf16 v[80:83], v[32:35], a[136:139], v[80:83]
  v_mfma_f32_16x16x32_bf16 v[80:83], v[36:39], a[152:155], v[80:83]
  v_mfma_f32_16x16x32_bf16 v[84:87], v[32:35], a[140:143], v[84:87]
  v_mfma_f32_16x16x32_bf16 v[84:87], v[36:39], a[156:159], v[84:87]
  s_waitcnt lgkmcnt(4)
  v_mfma_f32_16x16x32_bf16 v[88:91], v[16:19], a[128:131], v[88:91]
  ds_read_b64_tr_b16 v[32:33], v6 offset:40960
  v_mov_b32 v195, 0
  v_mfma_f32_16x16x32_bf16 v[88:91], v[20:23], a[144:147], v[88:91]
  ds_read_b64_tr_b16 v[34:35], v6 offset:43008
  v_mfma_f32_16x16x32_bf16 v[92:95], v[16:19], a[132:135], v[92:95]
  ds_read_b64_tr_b16 v[36:37], v6 offset:45056
  v_mfma_f32_16x16x32_bf16 v[92:95], v[20:23], a[148:151], v[92:95]
  ds_read_b64_tr_b16 v[38:39], v6 offset:47104
  v_mfma_f32_16x16x32_bf16 v[96:99], v[16:19], a[136:139], v[96:99]
  buffer_atomic_or v195, v193, s[40:43], 0 offen sc0 sc1
  v_mfma_f32_16x16x32_bf16 v[96:99], v[20:23], a[152:155], v[96:99]
  v_mfma_f32_16x16x32_bf16 v[100:103], v[16:19], a[140:143], v[100:103]
  v_mfma_f32_16x16x32_bf16 v[100:103], v[20:23], a[156:159], v[100:103]
  s_waitcnt lgkmcnt(4)
  v_mfma_f32_16x16x32_bf16 v[72:75], v[24:27], a[160:163], v[72:75]
  v_mfma_f32_16x16x32_bf16 v[72:75], v[28:31], a[176:179], v[72:75]
  s_waitcnt lgkmcnt(0)
  v_mfma_f32_16x16x32_bf16 v[88:91], v[32:35], a[160:163], v[88:91]
  s_add_u32 s61, s61, 32768
  v_mfma_f32_16x16x32_bf16 v[88:91], v[36:39], a[176:179], v[88:91]
  s_cmp_eq_u32 s61, 294912
  s_cselect_b32 s61, 0, s61
  v_mfma_f32_16x16x32_bf16 v[76:79], v[24:27], a[164:167], v[76:79]
  v_mfma_f32_16x16x32_bf16 v[76:79], v[28:31], a[180:183], v[76:79]
  v_mfma_f32_16x16x32_bf16 v[92:95], v[32:35], a[164:167], v[92:95]
  v_cvt_pk_bf16_f32 v104, v72, v73
  v_cvt_pk_bf16_f32 v105, v74, v75
  v_mfma_f32_16x16x32_bf16 v[92:95], v[36:39], a[180:183], v[92:95]
  v_mfma_f32_16x16x32_bf16 v[80:83], v[24:27], a[168:171], v[80:83]
  v_cvt_pk_bf16_f32 v106, v88, v89
  v_cvt_pk_bf16_f32 v107, v90, v91
  v_mfma_f32_16x16x32_bf16 v[80:83], v[28:31], a[184:187], v[80:83]
  buffer_store_dwordx4 v[104:107], v184, s[40:43], s61 offen sc1
  v_mfma_f32_16x16x32_bf16 v[96:99], v[32:35], a[168:171], v[96:99]
  v_cvt_pk_bf16_f32 v108, v76, v77
  v_cvt_pk_bf16_f32 v109, v78, v79
  v_mfma_f32_16x16x32_bf16 v[96:99], v[36:39], a[184:187], v[96:99]
  v_mfma_f32_16x16x32_bf16 v[84:87], v[24:27], a[172:175], v[84:87]
  v_cvt_pk_bf16_f32 v110, v92, v93
  v_cvt_pk_bf16_f32 v111, v94, v95
  v_mfma_f32_16x16x32_bf16 v[84:87], v[28:31], a[188:191], v[84:87]
  buffer_store_dwordx4 v[108:111], v185, s[40:43], s61 offen sc1
  v_mfma_f32_16x16x32_bf16 v[100:103], v[32:35], a[172:175], v[100:103]
  v_mfma_f32_16x16x32_bf16 v[100:103], v[36:39], a[188:191], v[100:103]
  v_cvt_pk_bf16_f32 v112, v80, v81
  v_cvt_pk_bf16_f32 v113, v82, v83
  v_cvt_pk_bf16_f32 v114, v96, v97
  v_cvt_pk_bf16_f32 v115, v98, v99
  buffer_store_dwordx4 v[112:115], v186, s[40:43], s61 offen sc1
  v_cvt_pk_bf16_f32 v116, v84, v85
  v_cvt_pk_bf16_f32 v117, v86, v87
  s_nop 0
  v_cvt_pk_bf16_f32 v118, v100, v101
  v_cvt_pk_bf16_f32 v119, v102, v103
  buffer_store_dwordx4 v[116:119], v187, s[40:43], s61 offen sc1
  s_waitcnt vmcnt(8)
  buffer_atomic_add v4, v15, s[40:43], 0 offen offset:28 sc1
  s_waitcnt vmcnt(5)
  v_cmp_lt_u32 vcc, v195, v194
  s_nop 1
  s_and_b32 s59, vcc_lo, 0x60
  s_cbranch_scc1 L_f_e_slow
  buffer_load_dwordx4 v[136:139], v188, s[40:43], s64 offen sc1
  buffer_load_dwordx4 v[140:143], v189, s[40:43], s64 offen sc1
  buffer_load_dwordx4 v[144:147], v190, s[40:43], s64 offen sc1
  buffer_load_dwordx4 v[148:151], v188, s[40:43], s65 offen sc1
  buffer_load_dwordx4 v[152:155], v189, s[40:43], s65 offen sc1
  buffer_load_dwordx4 v[156:159], v190, s[40:43], s65 offen sc1
  s_waitcnt vmcnt(7)
  buffer_atomic_add v4, v15, s[40:43], 0 offen offset:32 sc1
L_f_e_ok:
  v_mov_b32 v195, 0
  buffer_atomic_or v195, v193, s[40:43], 0 offen sc0 sc1
  s_waitcnt vmcnt(0)
  v_cmp_lt_u32 vcc, v195, v194
  s_nop 1
  s_and_b32 s59, vcc_lo, 0x180
  s_cbranch_scc1 L_f_wait
  buffer_load_dwordx4 v[40:43], v188, s[40:43], s66 offen sc1
  buffer_load_dwordx4 v[44:47], v189, s[40:43], s66 offen sc1
  buffer_load_dwordx4 v[48:51], v190, s[40:43], s66 offen sc1
  buffer_load_dwordx4 v[52:55], v188, s[40:43], s67 offen sc1
  buffer_load_dwordx4 v[56:59], v189, s[40:43], s67 offen sc1
  buffer_load_dwordx4 v[60:63], v190, s[40:43], s67 offen sc1
  s_nop 0
  v_lshlrev_b32 v16, 16, v136
  v_and_b32 v17, s3, v136
  v_lshlrev_b32 v18, 16, v137
  v_and_b32 v19, s3, v137
  v_lshlrev_b32 v20, 16, v138
  v_and_b32 v21, s3, v138
  v_lshlrev_b32 v22, 16, v139
  v_and_b32 v23, s3, v139
  s_nop 0
  v_dot2c_f32_bf16 v16, s48, v140
  v_dot2c_f32_bf16 v17, s49, v140
  v_dot2c_f32_bf16 v18, s48, v141
  v_dot2c_f32_bf16 v19, s49, v141
  v_dot2c_f32_bf16 v20, s48, v142
  v_dot2c_f32_bf16 v21, s49, v142
  v_dot2c_f32_bf16 v22, s48, v143
  v_dot2c_f32_bf16 v23, s49, v143
  s_nop 0
  v_dot2c_f32_bf16 v16, s48, v144
  v_dot2c_f32_bf16 v17, s49, v144
  v_dot2c_f32_bf16 v18, s48, v145
  v_dot2c_f32_bf16 v19, s49, v145
  v_dot2c_f32_bf16 v20, s48, v146
  v_dot2c_f32_bf16 v21, s49, v146
  v_dot2c_f32_bf16 v22, s48, v147
  v_dot2c_f32_bf16 v23, s49, v147
  s_nop 0
  v_lshlrev_b32 v24, 16, v148
  v_and_b32 v25, s3, v148
  v_lshlrev_b32 v26, 16, v149
  v_and_b32 v27, s3, v149
  v_lshlrev_b32 v28, 16, v150
  v_and_b32 v29, s3, v150
  v_lshlrev_b32 v30, 16, v151
  v_and_b32 v31, s3, v151
  s_nop 0
  v_dot2c_f32_bf16 v24, s48, v152
  v_dot2c_f32_bf16 v25, s49, v152
  v_dot2c_f32_bf16 v26, s48, v153
  v_dot2c_f32_bf16 v27, s49, v153
  v_dot2c_f32_bf16 v28, s48, v154
  v_dot2c_f32_bf16 v29, s49, v154
  v_dot2c_f32_bf16 v30, s48, v155
  v_dot2c_f32_bf16 v31, s49, v155
  s_nop 0
  v_dot2c_f32_bf16 v24, s48, v156
  v_dot2c_f32_bf16 v25, s49, v156
  v_dot2c_f32_bf16 v26, s48, v157
  v_dot2c_f32_bf16 v27, s49, v157
  v_dot2c_f32_bf16 v28, s48, v158
  v_dot2c_f32_bf16 v29, s49, v158
  v_dot2c_f32_bf16 v30, s48, v159
  v_dot2c_f32_bf16 v31, s49, v159
  v_permlane32_swap_b32 v16, v20
  v_permlane32_swap_b32 v17, v21
  v_permlane32_swap_b32 v18, v22
  v_permlane32_swap_b32 v19, v23
  v_add_f32 v16, v16, v20
  v_add_f32 v17, v17, v21
  v_add_f32 v18, v18, v22
  v_add_f32 v19, v19, v23
  v_permlane32_swap_b32 v24, v28
  v_permlane32_swap_b32 v25, v29
  v_permlane32_swap_b32 v26, v30
  v_permlane32_swap_b32 v27, v31
  v_add_f32 v24, v24, v28
  v_add_f32 v25, v25, v29
  v_add_f32 v26, v26, v30
  v_add_f32 v27, v27, v31
  v_permlane16_swap_b32 v16, v18
  v_permlane16_swap_b32 v17, v19
  v_add_f32 v16, v16, v18
  v_add_f32 v17, v17, v19
  v_permlane16_swap_b32 v24, v26
  v_permlane16_swap_b32 v25, v27
  v_add_f32 v24, v24, v26
  v_add_f32 v25, v25, v27
  v_mul_f32 v18, 0xbfb8aa3b, v16
  v_mul_f32 v19, 0xbfb8aa3b, v17
  v_exp_f32 v18, v18
  v_exp_f32 v19, v19
  v_lshlrev_b32 v20, 16, v200
  v_and_b32 v21, s3, v200
  v_add_f32 v18, 1.0, v18
  v_add_f32 v19, 1.0, v19
  v_rcp_f32 v18, v18
  v_rcp_f32 v19, v19
  v_mul_f32 v16, v16, v20
  v_mul_f32 v17, v17, v21
  v_lshlrev_b32 v22, 16, v196
  v_and_b32 v23, s3, v196
  v_fmac_f32 v22, v16, v18
  v_fmac_f32 v23, v17, v19
  v_cvt_pk_bf16_f32 v196, v22, v23
  buffer_store_dword v196, v191, s[32:35], s85 offen
  v_mul_f32 v26, 0xbfb8aa3b, v24
  v_mul_f32 v27, 0xbfb8aa3b, v25
  v_exp_f32 v26, v26
  v_exp_f32 v27, v27
  v_lshlrev_b32 v28, 16, v201
  v_and_b32 v29, s3, v201
  v_add_f32 v26, 1.0, v26
  v_add_f32 v27, 1.0, v27
  v_rcp_f32 v26, v26
  v_rcp_f32 v27, v27
  v_mul_f32 v24, v24, v28
  v_mul_f32 v25, v25, v29
  v_lshlrev_b32 v30, 16, v197
  v_and_b32 v31, s3, v197
  v_fmac_f32 v30, v24, v26
  v_fmac_f32 v31, v25, v27
  v_cvt_pk_bf16_f32 v197, v30, v31
  buffer_store_dword v197, v191, s[32:35], s86 offen
  s_waitcnt vmcnt(7)
  v_lshlrev_b32 v16, 16, v40
  v_and_b32 v17, s3, v40
  v_lshlrev_b32 v18, 16, v41
  v_and_b32 v19, s3, v41
  v_lshlrev_b32 v20, 16, v42
  v_and_b32 v21, s3, v42
  v_lshlrev_b32 v22, 16, v43
  v_and_b32 v23, s3, v43
  s_waitcnt vmcnt(6)
  v_dot2c_f32_bf16 v16, s48, v44
  v_dot2c_f32_bf16 v17, s49, v44
  v_dot2c_f32_bf16 v18, s48, v45
  v_dot2c_f32_bf16 v19, s49, v45
  v_dot2c_f32_bf16 v20, s48, v46
  v_dot2c_f32_bf16 v21, s49, v46
  v_dot2c_f32_bf16 v22, s48, v47
  v_dot2c_f32_bf16 v23, s49, v47
  s_waitcnt vmcnt(5)
  v_dot2c_f32_bf16 v16, s48, v48
  v_dot2c_f32_bf16 v17, s49, v48
  v_dot2c_f32_bf16 v18, s48, v49
  v_dot2c_f32_bf16 v19, s49, v49
  v_dot2c_f32_bf16 v20, s48, v50
  v_dot2c_f32_bf16 v21, s49, v50
  v_dot2c_f32_bf16 v22, s48, v51
  v_dot2c_f32_bf16 v23, s49, v51
  s_waitcnt vmcnt(4)
  v_lshlrev_b32 v24, 16, v52
  v_and_b32 v25, s3, v52
  v_lshlrev_b32 v26, 16, v53
  v_and_b32 v27, s3, v53
  v_lshlrev_b32 v28, 16, v54
  v_and_b32 v29, s3, v54
  v_lshlrev_b32 v30, 16, v55
  v_and_b32 v31, s3, v55
  s_waitcnt vmcnt(3)
  v_dot2c_f32_bf16 v24, s48, v56
  v_dot2c_f32_bf16 v25, s49, v56
  v_dot2c_f32_bf16 v26, s48, v57
  v_dot2c_f32_bf16 v27, s49, v57
  v_dot2c_f32_bf16 v28, s48, v58
  v_dot2c_f32_bf16 v29, s49, v58
  v_dot2c_f32_bf16 v30, s48, v59
  v_dot2c_f32_bf16 v31, s49, v59
  s_waitcnt vmcnt(2)
  v_dot2c_f32_bf16 v24, s48, v60
  v_dot2c_f32_bf16 v25, s49, v60
  v_dot2c_f32_bf16 v26, s48, v61
  v_dot2c_f32_bf16 v27, s49, v61
  v_dot2c_f32_bf16 v28, s48, v62
  v_dot2c_f32_bf16 v29, s49, v62
  v_dot2c_f32_bf16 v30, s48, v63
  v_dot2c_f32_bf16 v31, s49, v63
  v_permlane32_swap_b32 v16, v20
  v_permlane32_swap_b32 v17, v21
  v_permlane32_swap_b32 v18, v22
  v_permlane32_swap_b32 v19, v23
  v_add_f32 v16, v16, v20
  v_add_f32 v17, v17, v21
  v_add_f32 v18, v18, v22
  v_add_f32 v19, v19, v23
  v_permlane32_swap_b32 v24, v28
  v_permlane32_swap_b32 v25, v29
  v_permlane32_swap_b32 v26, v30
  v_permlane32_swap_b32 v27, v31
  v_add_f32 v24, v24, v28
  v_add_f32 v25, v25, v29
  v_add_f32 v26, v26, v30
  v_add_f32 v27, v27, v31
  v_permlane16_swap_b32 v16, v18
  v_permlane16_swap_b32 v17, v19
  v_add_f32 v16, v16, v18
  v_add_f32 v17, v17, v19
  v_permlane16_swap_b32 v24, v26
  v_permlane16_swap_b32 v25, v27
  v_add_f32 v24, v24, v26
  v_add_f32 v25, v25, v27
  v_mul_f32 v18, 0xbfb8aa3b, v16
  v_mul_f32 v19, 0xbfb8aa3b, v17
  v_exp_f32 v18, v18
  v_exp_f32 v19, v19
  v_lshlrev_b32 v20, 16, v202
  v_and_b32 v21, s3, v202
  v_add_f32 v18, 1.0, v18
  v_add_f32 v19, 1.0, v19
  v_rcp_f32 v18, v18
  v_rcp_f32 v19, v19
  v_mul_f32 v16, v16, v20
  v_mul_f32 v17, v17, v21
  v_lshlrev_b32 v22, 16, v198
  v_and_b32 v23, s3, v198
  v_fmac_f32 v22, v16, v18
  v_fmac_f32 v23, v17, v19
  v_cvt_pk_bf16_f32 v198, v22, v23
  buffer_store_dword v198, v191, s[32:35], s87 offen
  v_mul_f32 v26, 0xbfb8aa3b, v24
  v_mul_f32 v27, 0xbfb8aa3b, v25
  v_exp_f32 v26, v26
  v_exp_f32 v27, v27
  v_lshlrev_b32 v28, 16, v203
  v_and_b32 v29, s3, v203
  v_add_f32 v26, 1.0, v26
  v_add_f32 v27, 1.0, v27
  v_rcp_f32 v26, v26
  v_rcp_f32 v27, v27
  v_mul_f32 v24, v24, v28
  v_mul_f32 v25, v25, v29
  v_lshlrev_b32 v30, 16, v199
  v_and_b32 v31, s3, v199
  v_fmac_f32 v30, v24, v26
  v_fmac_f32 v31, v25, v27
  v_cvt_pk_bf16_f32 v199, v30, v31
  buffer_store_dword v199, v191, s[32:35], s88 offen
L_f_done:
  s_endpgm
L_f_wait:
  v_mov_b32 v195, 0
  buffer_atomic_or v195, v193, s[40:43], 0 offen sc0 sc1
  s_nop 0
  v_lshlrev_b32 v16, 16, v136
  v_and_b32 v17, s3, v136
  v_lshlrev_b32 v18, 16, v137
  v_and_b32 v19, s3, v137
  v_lshlrev_b32 v20, 16, v138
  v_and_b32 v21, s3, v138
  v_lshlrev_b32 v22, 16, v139
  v_and_b32 v23, s3, v139
  s_nop 0
  v_dot2c_f32_bf16 v16, s48, v140
  v_dot2c_f32_bf16 v17, s49, v140
  v_dot2c_f32_bf16 v18, s48, v141
  v_dot2c_f32_bf16 v19, s49, v141
  v_dot2c_f32_bf16 v20, s48, v142
  v_dot2c_f32_bf16 v21, s49, v142
  v_dot2c_f32_bf16 v22, s48, v143
  v_dot2c_f32_bf16 v23, s49, v143
  s_nop 0
  v_dot2c_f32_bf16 v16, s48, v144
  v_dot2c_f32_bf16 v17, s49, v144
  v_dot2c_f32_bf16 v18, s48, v145
  v_dot2c_f32_bf16 v19, s49, v145
  v_dot2c_f32_bf16 v20, s48, v146
  v_dot2c_f32_bf16 v21, s49, v146
  v_dot2c_f32_bf16 v22, s48, v147
  v_dot2c_f32_bf16 v23, s49, v147
  s_nop 0
  v_lshlrev_b32 v24, 16, v148
  v_and_b32 v25, s3, v148
  v_lshlrev_b32 v26, 16, v149
  v_and_b32 v27, s3, v149
  v_lshlrev_b32 v28, 16, v150
  v_and_b32 v29, s3, v150
  v_lshlrev_b32 v30, 16, v151
  v_and_b32 v31, s3, v151
  s_nop 0
  v_dot2c_f32_bf16 v24, s48, v152
  v_dot2c_f32_bf16 v25, s49, v152
  v_dot2c_f32_bf16 v26, s48, v153
  v_dot2c_f32_bf16 v27, s49, v153
  v_dot2c_f32_bf16 v28, s48, v154
  v_dot2c_f32_bf16 v29, s49, v154
  v_dot2c_f32_bf16 v30, s48, v155
  v_dot2c_f32_bf16 v31, s49, v155
  s_nop 0
  v_dot2c_f32_bf16 v24, s48, v156
  v_dot2c_f32_bf16 v25, s49, v156
  v_dot2c_f32_bf16 v26, s48, v157
  v_dot2c_f32_bf16 v27, s49, v157
  v_dot2c_f32_bf16 v28, s48, v158
  v_dot2c_f32_bf16 v29, s49, v158
  v_dot2c_f32_bf16 v30, s48, v159
  v_dot2c_f32_bf16 v31, s49, v159
  v_permlane32_swap_b32 v16, v20
  v_permlane32_swap_b32 v17, v21
  v_permlane32_swap_b32 v18, v22
  v_permlane32_swap_b32 v19, v23
  v_add_f32 v16, v16, v20
  v_add_f32 v17, v17, v21
  v_add_f32 v18, v18, v22
  v_add_f32 v19, v19, v23
  v_permlane32_swap_b32 v24, v28
  v_permlane32_swap_b32 v25, v29
  v_permlane32_swap_b32 v26, v30
  v_permlane32_swap_b32 v27, v31
  v_add_f32 v24, v24, v28
  v_add_f32 v25, v25, v29
  v_add_f32 v26, v26, v30
  v_add_f32 v27, v27, v31
  v_permlane16_swap_b32 v16, v18
  v_permlane16_swap_b32 v17, v19
  v_add_f32 v16, v16, v18
  v_add_f32 v17, v17, v19
  v_permlane16_swap_b32 v24, v26
  v_permlane16_swap_b32 v25, v27
  v_add_f32 v24, v24, v26
  v_add_f32 v25, v25, v27
  v_mul_f32 v18, 0xbfb8aa3b, v16
  v_mul_f32 v19, 0xbfb8aa3b, v17
  v_exp_f32 v18, v18
  v_exp_f32 v19, v19
  v_lshlrev_b32 v20, 16, v200
  v_and_b32 v21, s3, v200
  v_add_f32 v18, 1.0, v18
  v_add_f32 v19, 1.0, v19
  v_rcp_f32 v18, v18
  v_rcp_f32 v19, v19
  v_mul_f32 v16, v16, v20
  v_mul_f32 v17, v17, v21
  v_lshlrev_b32 v22, 16, v196
  v_and_b32 v23, s3, v196
  v_fmac_f32 v22, v16, v18
  v_fmac_f32 v23, v17, v19
  v_cvt_pk_bf16_f32 v196, v22, v23
  buffer_store_dword v196, v191, s[32:35], s85 offen
  v_mul_f32 v26, 0xbfb8aa3b, v24
  v_mul_f32 v27, 0xbfb8aa3b, v25
  v_exp_f32 v26, v26
  v_exp_f32 v27, v27
  v_lshlrev_b32 v28, 16, v201
  v_and_b32 v29, s3, v201
  v_add_f32 v26, 1.0, v26
  v_add_f32 v27, 1.0, v27
  v_rcp_f32 v26, v26
  v_rcp_f32 v27, v27
  v_mul_f32 v24, v24, v28
  v_mul_f32 v25, v25, v29
  v_lshlrev_b32 v30, 16, v197
  v_and_b32 v31, s3, v197
  v_fmac_f32 v30, v24, v26
  v_fmac_f32 v31, v25, v27
  v_cvt_pk_bf16_f32 v197, v30, v31
  buffer_store_dword v197, v191, s[32:35], s86 offen
  s_waitcnt vmcnt(2)
  s_mov_b32 s70, 0
L_f_waits:
  v_cmp_lt_u32 vcc, v195, v194
  s_add_u32 s70, s70, 1
  s_cmp_ge_u32 s70, 200000
  s_cbranch_scc1 L_f_waits_x
  s_and_b32 s59, vcc_lo, 384
  s_cbranch_scc0 L_f_waits_x
  v_mov_b32 v195, 0
  buffer_atomic_or v195, v193, s[40:43], 0 offen sc0 sc1
  s_waitcnt vmcnt(0)
  s_branch L_f_waits
L_f_waits_x:
  buffer_load_dwordx4 v[40:43], v188, s[40:43], s66 offen sc1
  buffer_load_dwordx4 v[44:47], v189, s[40:43], s66 offen sc1
  buffer_load_dwordx4 v[48:51], v190, s[40:43], s66 offen sc1
  buffer_load_dwordx4 v[52:55], v188, s[40:43], s67 offen sc1
  buffer_load_dwordx4 v[56:59], v189, s[40:43], s67 offen sc1
  buffer_load_dwordx4 v[60:63], v190, s[40:43], s67 offen sc1
  s_waitcnt vmcnt(5)
  v_lshlrev_b32 v16, 16, v40
  v_and_b32 v17, s3, v40
  v_lshlrev_b32 v18, 16, v41
  v_and_b32 v19, s3, v41
  v_lshlrev_b32 v20, 16, v42
  v_and_b32 v21, s3, v42
  v_lshlrev_b32 v22, 16, v43
  v_and_b32 v23, s3, v43
  s_waitcnt vmcnt(4)
  v_dot2c_f32_bf16 v16, s48, v44
  v_dot2c_f32_bf16 v17, s49, v44
  v_dot2c_f32_bf16 v18, s48, v45
  v_dot2c_f32_bf16 v19, s49, v45
  v_dot2c_f32_bf16 v20, s48, v46
  v_dot2c_f32_bf16 v21, s49, v46
  v_dot2c_f32_bf16 v22, s48, v47
  v_dot2c_f32_bf16 v23, s49, v47
  s_waitcnt vmcnt(3)
  v_dot2c_f32_bf16 v16, s48, v48
  v_dot2c_f32_bf16 v17, s49, v48
  v_dot2c_f32_bf16 v18, s48, v49
  v_dot2c_f32_bf16 v19, s49, v49
  v_dot2c_f32_bf16 v20, s48, v50
  v_dot2c_f32_bf16 v21, s49, v50
  v_dot2c_f32_bf16 v22, s48, v51
  v_dot2c_f32_bf16 v23, s49, v51
  s_waitcnt vmcnt(2)
  v_lshlrev_b32 v24, 16, v52
  v_and_b32 v25, s3, v52
  v_lshlrev_b32 v26, 16, v53
  v_and_b32 v27, s3, v53
  v_lshlrev_b32 v28, 16, v54
  v_and_b32 v29, s3, v54
  v_lshlrev_b32 v30, 16, v55
  v_and_b32 v31, s3, v55
  s_waitcnt vmcnt(1)
  v_dot2c_f32_bf16 v24, s48, v56
  v_dot2c_f32_bf16 v25, s49, v56
  v_dot2c_f32_bf16 v26, s48, v57
  v_dot2c_f32_bf16 v27, s49, v57
  v_dot2c_f32_bf16 v28, s48, v58
  v_dot2c_f32_bf16 v29, s49, v58
  v_dot2c_f32_bf16 v30, s48, v59
  v_dot2c_f32_bf16 v31, s49, v59
  s_waitcnt vmcnt(0)
  v_dot2c_f32_bf16 v24, s48, v60
  v_dot2c_f32_bf16 v25, s49, v60
  v_dot2c_f32_bf16 v26, s48, v61
  v_dot2c_f32_bf16 v27, s49, v61
  v_dot2c_f32_bf16 v28, s48, v62
  v_dot2c_f32_bf16 v29, s49, v62
  v_dot2c_f32_bf16 v30, s48, v63
  v_dot2c_f32_bf16 v31, s49, v63
  v_permlane32_swap_b32 v16, v20
  v_permlane32_swap_b32 v17, v21
  v_permlane32_swap_b32 v18, v22
  v_permlane32_swap_b32 v19, v23
  v_add_f32 v16, v16, v20
  v_add_f32 v17, v17, v21
  v_add_f32 v18, v18, v22
  v_add_f32 v19, v19, v23
  v_permlane32_swap_b32 v24, v28
  v_permlane32_swap_b32 v25, v29
  v_permlane32_swap_b32 v26, v30
  v_permlane32_swap_b32 v27, v31
  v_add_f32 v24, v24, v28
  v_add_f32 v25, v25, v29
  v_add_f32 v26, v26, v30
  v_add_f32 v27, v27, v31
  v_permlane16_swap_b32 v16, v18
  v_permlane16_swap_b32 v17, v19
  v_add_f32 v16, v16, v18
  v_add_f32 v17, v17, v19
  v_permlane16_swap_b32 v24, v26
  v_permlane16_swap_b32 v25, v27
  v_add_f32 v24, v24, v26
  v_add_f32 v25, v25, v27
  v_mul_f32 v18, 0xbfb8aa3b, v16
  v_mul_f32 v19, 0xbfb8aa3b, v17
  v_exp_f32 v18, v18
  v_exp_f32 v19, v19
  v_lshlrev_b32 v20, 16, v202
  v_and_b32 v21, s3, v202
  v_add_f32 v18, 1.0, v18
  v_add_f32 v19, 1.0, v19
  v_rcp_f32 v18, v18
  v_rcp_f32 v19, v19
  v_mul_f32 v16, v16, v20
  v_mul_f32 v17, v17, v21
  v_lshlrev_b32 v22, 16, v198
  v_and_b32 v23, s3, v198
  v_fmac_f32 v22, v16, v18
  v_fmac_f32 v23, v17, v19
  v_cvt_pk_bf16_f32 v198, v22, v23
  buffer_store_dword v198, v191, s[32:35], s87 offen
  v_mul_f32 v26, 0xbfb8aa3b, v24
  v_mul_f32 v27, 0xbfb8aa3b, v25
  v_exp_f32 v26, v26
  v_exp_f32 v27, v27
  v_lshlrev_b32 v28, 16, v203
  v_and_b32 v29, s3, v203
  v_add_f32 v26, 1.0, v26
  v_add_f32 v27, 1.0, v27
  v_rcp_f32 v26, v26
  v_rcp_f32 v27, v27
  v_mul_f32 v24, v24, v28
  v_mul_f32 v25, v25, v29
  v_lshlrev_b32 v30, 16, v199
  v_and_b32 v31, s3, v199
  v_fmac_f32 v30, v24, v26
  v_fmac_f32 v31, v25, v27
  v_cvt_pk_bf16_f32 v199, v30, v31
  buffer_store_dword v199, v191, s[32:35], s88 offen
  s_endpgm
L_f_dbg_slow:
  s_mov_b32 s70, 0
L_f_dbg:
  buffer_load_dword v218, v216, s[36:39], 0 offen sc1
  s_add_u32 s70, s70, 1
  s_waitcnt vmcnt(0)
  v_cmp_eq_u32 vcc, 0, v218
  s_cmp_ge_u32 s70, 200000
  s_cbranch_scc1 L_f_dbg_x
  s_cmp_lg_u64 vcc, 0
  s_cbranch_scc1 L_f_dbg
L_f_dbg_x:
  s_branch L_f_dbgok
L_f_qs_slow:
  s_mov_b32 s70, 0
L_f_qss:
  v_cmp_lt_u32 vcc, v195, v194
  s_add_u32 s70, s70, 1
  s_cmp_ge_u32 s70, 200000
  s_cbranch_scc1 L_f_qss_x
  s_and_b32 s59, vcc_lo, 512
  s_cbranch_scc0 L_f_qss_x
  s_sleep 2
  v_mov_b32 v195, 0
  buffer_atomic_or v195, v193, s[40:43], 0 offen sc0 sc1
  s_waitcnt vmcnt(0)
  s_branch L_f_qss
L_f_qss_x:
  s_branch L_f_qs_ok
L_f_e_slow:
  v_mov_b32 v195, 0
  buffer_atomic_or v195, v193, s[40:43], 0 offen sc0 sc1
  s_waitcnt vmcnt(2)
  buffer_atomic_add v4, v15, s[40:43], 0 offen offset:32 sc1
  s_waitcnt vmcnt(1)
  s_mov_b32 s70, 0
L_f_es:
  v_cmp_lt_u32 vcc, v195, v194
  s_add_u32 s70, s70, 1
  s_cmp_ge_u32 s70, 200000
  s_cbranch_scc1 L_f_es_x
  s_and_b32 s59, vcc_lo, 96
  s_cbranch_scc0 L_f_es_x
  v_mov_b32 v195, 0
  buffer_atomic_or v195, v193, s[40:43], 0 offen sc0 sc1
  s_waitcnt vmcnt(0)
  s_branch L_f_es
L_f_es_x:
  buffer_load_dwordx4 v[136:139], v188, s[40:43], s64 offen sc1
  buffer_load_dwordx4 v[140:143], v189, s[40:43], s64 offen sc1
  buffer_load_dwordx4 v[144:147], v190, s[40:43], s64 offen sc1
  buffer_load_dwordx4 v[148:151], v188, s[40:43], s65 offen sc1
  buffer_load_dwordx4 v[152:155], v189, s[40:43], s65 offen sc1
  buffer_load_dwordx4 v[156:159], v190, s[40:43], s65 offen sc1
  s_branch L_f_e_ok
L_apath:
  v_subrev_u32 v60, 9216, v2
  v_subrev_u32 v61, 18432, v2
  v_subrev_u32 v63, 27648, v2
  v_lshrrev_b32 v220, 4, v1
  v_bfe_u32 v221, v1, 2, 2
  v_cmp_eq_u32 vcc, v220, v221
  v_mov_b32 v220, 0x3f803f80
  v_and_b32 v221, 1, v1
  v_cndmask_b32 v70, 0, v220, vcc
  v_lshlrev_b32 v221, 4, v221
  v_mov_b32 v220, 0xffff
  v_lshlrev_b32 v220, v221, v220
  v_and_b32 v220, v220, v70
  v_and_b32 v221, 2, v1
  v_cmp_eq_u32 vcc, 0, v221
  v_mov_b32 v71, v70
  v_mov_b32 v72, v70
  v_cndmask_b32 v66, 0, v220, vcc
  v_mov_b32 v73, v70
  v_xor_b32 v67, v220, v66
  v_mov_b32 v64, 0
  v_mov_b32 v65, 0
  v_mov_b32 v68, 0
  v_mov_b32 v69, 0
  s_mul_i32 s60, s44, 18432
  s_add_u32 s60, s60, 49152
  v_lshrrev_b32 v220, 3, v1
  v_xor_b32 v220, v220, v1
  v_and_b32 v220, 7, v220
  v_and_b32 v221, 7, v1
  v_lshlrev_b32 v221, 8, v221
  v_lshl_add_u32 v220, v220, 4, v221
  v_add_u32 v3, s60, v220
  v_xor_b32 v4, 128, v3
  v_lshrrev_b32 v220, 4, v1
  v_xor_b32 v220, v220, v1
  v_lshl_add_u32 v5, v220, 4, s60
  v_xor_b32 v6, 64, v5
  s_waitcnt lgkmcnt(0)
  s_mov_b32 s40, s26
  s_and_b32 s41, s27, 0xffff
  s_mov_b32 s42, 0x10000000
  s_mov_b32 s43, 0x20000
  s_and_b32 s58, s45, 3
  s_sub_u32 s59, s46, 12
  s_or_b32 s58, s58, s59
  s_lshl_b32 s51, s58, 28
  s_add_u32 s58, s45, s44
  s_lshl_b32 s58, s58, 9
  s_add_u32 s58, s58, 41943040
  s_add_u32 s58, s58, s51
  v_lshrrev_b32 v220, 4, v1
  v_lshl_add_u32 v220, v220, 13, s58
  v_bfe_u32 v221, v1, 2, 2
  v_lshl_add_u32 v220, v221, 7, v220
  v_and_b32 v221, 3, v1
  v_lshl_add_u32 v220, v221, 4, v220
  buffer_store_dwordx2 v[64:65], v220, s[40:43], 0 offen offset:0 sc1
  buffer_store_dwordx2 v[64:65], v220, s[40:43], 0 offen offset:8 sc1
  s_sub_u32 s61, s46, 12
  s_and_b32 s58, s44, 1
  s_lshr_b32 s59, s44, 1
  s_lshl2_add_u32 s58, s58, s59
  s_mul_i32 s58, s58, 13824
  s_lshl_b32 s59, s61, 8
  s_add_u32 s58, s58, s59
  s_add_u32 s52, s10, s58
  s_addc_u32 s53, s11, 0
  s_sub_u32 s52, s52, 2944
  s_subb_u32 s53, s53, 0
  s_mul_i32 s50, s44, 6144
  v_lshrrev_b32 v220, 3, v1
  v_and_b32 v221, 6, v220
  v_xor_b32 v221, v221, v1
  v_and_b32 v221, 7, v221
  v_and_b32 v222, 4, v220
  v_add_u32 v220, v220, v222
  v_mul_u32_u24 v220, 3456, v220
  v_lshl_add_u32 v223, v221, 4, v220
  v_add_u32 v22, 4096, v223
  v_add_u32 v23, 113664, v223
  v_add_u32 v26, 2176, v223
  v_add_u32 v27, 114816, v223
  v_add_u32 v28, 3328, v223
  v_add_u32 v29, 112896, v223
  v_lshrrev_b32 v220, 3, v1
  s_mul_i32 s58, s44, 192
  s_add_u32 s58, s58, 147520
  v_lshl_add_u32 v25, v220, 2, s58
  v_bfe_u32 v220, v1, 3, 2
  v_xor_b32 v220, 0, v220
  v_lshlrev_b32 v220, 5, v220
  v_lshrrev_b32 v221, 2, v1
  v_lshl_add_u32 v220, v221, 7, v220
  v_and_b32 v221, 3, v1
  v_lshl_add_u32 v223, v221, 3, v220
  v_lshrrev_b32 v220, 5, v1
  v_mul_u32_u24 v220, 5120, v220
  s_add_u32 s58, s61, 0
  s_and_b32 s59, s58, 3
  s_lshr_b32 s58, s58, 2
  s_lshl_b32 s58, s58, 6
  s_or_b32 s58, s58, s59
  s_lshl_b32 s58, s58, 5
  v_xor_b32 v8, s58, v223
  v_add_u32 v8, v8, v220
  v_add_u32 v12, 49152, v8
  s_add_u32 s58, s61, 1
  s_and_b32 s59, s58, 3
  s_lshr_b32 s58, s58, 2
  s_lshl_b32 s58, s58, 6
  s_or_b32 s58, s58, s59
  s_lshl_b32 s58, s58, 5
  v_xor_b32 v9, s58, v223
  v_add_u32 v9, v9, v220
  v_add_u32 v13, 49152, v9
  s_add_u32 s58, s61, 2
  s_and_b32 s59, s58, 3
  s_lshr_b32 s58, s58, 2
  s_lshl_b32 s58, s58, 6
  s_or_b32 s58, s58, s59
  s_lshl_b32 s58, s58, 5
  v_xor_b32 v10, s58, v223
  v_add_u32 v10, v10, v220
  v_add_u32 v14, 49152, v10
  s_add_u32 s58, s61, 3
  s_and_b32 s59, s58, 3
  s_lshr_b32 s58, s58, 2
  s_lshl_b32 s58, s58, 6
  s_or_b32 s58, s58, s59
  s_lshl_b32 s58, s58, 5
  v_xor_b32 v11, s58, v223
  v_add_u32 v11, v11, v220
  v_add_u32 v15, 49152, v11
  s_mov_b32 s36, s24
  s_and_b32 s37, s25, 0xffff
  s_mov_b32 s38, 0x100
  s_mov_b32 s39, 0x20000
  v_mov_b32 v56, 0
  v_mov_b32 v62, 0
  s_mov_b32 s70, 0x3f803f80
  s_cmp_eq_u32 s89, 18432
  s_cselect_b32 s89, 0, s89
  v_add_u32 v224, s89, v4
  s_add_u32 s89, s89, 2048
  s_cmp_eq_u32 s89, 18432
  s_cselect_b32 s89, 0, s89
  v_add_u32 v225, s89, v4
  s_add_u32 s89, s89, 2048
  s_cmp_eq_u32 s89, 18432
  s_cselect_b32 s89, 0, s89
  v_add_u32 v226, s89, v4
  s_add_u32 s89, s89, 2048
  s_cmp_eq_u32 s89, 18432
  s_cselect_b32 s89, 0, s89
  v_add_u32 v227, s89, v4
  s_add_u32 s89, s89, 2048
  s_cmp_eq_u32 s89, 18432
  s_cselect_b32 s89, 0, s89
  v_add_u32 v228, s89, v4
  s_add_u32 s89, s89, 2048
  s_cmp_eq_u32 s89, 18432
  s_cselect_b32 s89, 0, s89
  v_add_u32 v229, s89, v4
  s_add_u32 s89, s89, 2048
  s_cmp_eq_u32 s89, 18432
  s_cselect_b32 s89, 0, s89
  v_add_u32 v230, s89, v4
  s_add_u32 s89, s89, 2048
  s_cmp_eq_u32 s89, 18432
  s_cselect_b32 s89, 0, s89
  v_add_u32 v231, s89, v4
  s_add_u32 s89, s89, 2048
  s_cmp_eq_u32 s89, 18432
  s_cselect_b32 s89, 0, s89
  v_add_u32 v232, s89, v4
  s_mov_b32 s72, 0xffff0000
  s_mov_b32 s73, -1
  s_mov_b32 s74, 0
  s_mov_b32 s75, -1
  s_mov_b32 s76, 0
  s_mov_b32 s77, 0xffff0000
  s_mov_b32 s78, 0xaaaaaaaa
  s_mov_b32 s79, 0xaaaaaaaa
  s_mov_b32 s14, 0xfff0ffff
  s_mov_b32 s15, 0xf000ff00
  s_mov_b32 s16, 0xffc0fffc
  s_mov_b32 s17, 0xc000fc00
  s_or_b32 s58, s45, s44
  s_cmp_eq_u32 s58, 0
  s_cselect_b64 s[18:19], s[14:15], -1
  s_cselect_b64 s[62:63], s[16:17], -1
  buffer_load_dwordx4 v[112:115], v60, s[28:31], s80 offen
  buffer_load_dwordx4 v[116:119], v60, s[28:31], s81 offen
  buffer_load_dwordx4 v[120:123], v60, s[28:31], s82 offen
  s_waitcnt vmcnt(13)
  buffer_load_dwordx4 v[124:127], v60, s[28:31], s83 offen
  v_dot2c_f32_bf16 v56, s70, v76
  v_dot2c_f32_bf16 v62, v76, v76
  v_dot2c_f32_bf16 v56, s70, v77
  v_dot2c_f32_bf16 v62, v77, v77
  v_dot2c_f32_bf16 v56, s70, v78
  v_dot2c_f32_bf16 v62, v78, v78
  v_dot2c_f32_bf16 v56, s70, v79
  v_dot2c_f32_bf16 v62, v79, v79
  s_waitcnt vmcnt(13)
  buffer_load_dwordx4 v[128:131], v60, s[28:31], s84 offen
  v_dot2c_f32_bf16 v56, s70, v80
  v_dot2c_f32_bf16 v62, v80, v80
  v_dot2c_f32_bf16 v56, s70, v81
  v_dot2c_f32_bf16 v62, v81, v81
  v_dot2c_f32_bf16 v56, s70, v82
  v_dot2c_f32_bf16 v62, v82, v82
  v_dot2c_f32_bf16 v56, s70, v83
  v_dot2c_f32_bf16 v62, v83, v83
  s_waitcnt vmcnt(13)
  buffer_load_dwordx4 v[132:135], v60, s[28:31], s85 offen
  v_dot2c_f32_bf16 v56, s70, v84
  v_dot2c_f32_bf16 v62, v84, v84
  v_dot2c_f32_bf16 v56, s70, v85
  v_dot2c_f32_bf16 v62, v85, v85
  v_dot2c_f32_bf16 v56, s70, v86
  v_dot2c_f32_bf16 v62, v86, v86
  v_dot2c_f32_bf16 v56, s70, v87
  v_dot2c_f32_bf16 v62, v87, v87
  s_waitcnt vmcnt(13)
  buffer_load_dwordx4 v[136:139], v60, s[28:31], s86 offen
  v_dot2c_f32_bf16 v56, s70, v88
  v_dot2c_f32_bf16 v62, v88, v88
  v_dot2c_f32_bf16 v56, s70, v89
  v_dot2c_f32_bf16 v62, v89, v89
  v_dot2c_f32_bf16 v56, s70, v90
  v_dot2c_f32_bf16 v62, v90, v90
  v_dot2c_f32_bf16 v56, s70, v91
  v_dot2c_f32_bf16 v62, v91, v91
  s_waitcnt vmcnt(13)
  buffer_load_dwordx4 v[140:143], v60, s[28:31], s87 offen
  v_dot2c_f32_bf16 v56, s70, v92
  v_dot2c_f32_bf16 v62, v92, v92
  v_dot2c_f32_bf16 v56, s70, v93
  v_dot2c_f32_bf16 v62, v93, v93
  v_dot2c_f32_bf16 v56, s70, v94
  v_dot2c_f32_bf16 v62, v94, v94
  v_dot2c_f32_bf16 v56, s70, v95
  v_dot2c_f32_bf16 v62, v95, v95
  s_waitcnt vmcnt(13)
  buffer_load_dwordx4 v[144:147], v60, s[28:31], s88 offen
  v_dot2c_f32_bf16 v56, s70, v96
  v_dot2c_f32_bf16 v62, v96, v96
  v_dot2c_f32_bf16 v56, s70, v97
  v_dot2c_f32_bf16 v62, v97, v97
  v_dot2c_f32_bf16 v56, s70, v98
  v_dot2c_f32_bf16 v62, v98, v98
  v_dot2c_f32_bf16 v56, s70, v99
  v_dot2c_f32_bf16 v62, v99, v99
  s_waitcnt vmcnt(13)
  buffer_load_dwordx4 v[148:151], v61, s[28:31], s80 offen
  v_dot2c_f32_bf16 v56, s70, v100
  v_dot2c_f32_bf16 v62, v100, v100
  v_dot2c_f32_bf16 v56, s70, v101
  v_dot2c_f32_bf16 v62, v101, v101
  v_dot2c_f32_bf16 v56, s70, v102
  v_dot2c_f32_bf16 v62, v102, v102
  v_dot2c_f32_bf16 v56, s70, v103
  v_dot2c_f32_bf16 v62, v103, v103
  s_waitcnt vmcnt(13)
  buffer_load_dwordx4 v[152:155], v61, s[28:31], s81 offen
  v_dot2c_f32_bf16 v56, s70, v104
  v_dot2c_f32_bf16 v62, v104, v104
  v_dot2c_f32_bf16 v56, s70, v105
  v_dot2c_f32_bf16 v62, v105, v105
  v_dot2c_f32_bf16 v56, s70, v106
  v_dot2c_f32_bf16 v62, v106, v106
  v_dot2c_f32_bf16 v56, s70, v107
  v_dot2c_f32_bf16 v62, v107, v107
  s_waitcnt vmcnt(13)
  buffer_load_dwordx4 v[156:159], v61, s[28:31], s82 offen
  v_dot2c_f32_bf16 v56, s70, v108
  v_dot2c_f32_bf16 v62, v108, v108
  v_dot2c_f32_bf16 v56, s70, v109
  v_dot2c_f32_bf16 v62, v109, v109
  v_dot2c_f32_bf16 v56, s70, v110
  v_dot2c_f32_bf16 v62, v110, v110
  v_dot2c_f32_bf16 v56, s70, v111
  v_dot2c_f32_bf16 v62, v111, v111
  s_nop 1
  v_add_f32_dpp v56, v56, v56 quad_perm:[1,0,3,2] row_mask:0xf bank_mask:0xf
  s_nop 1
  v_add_f32_dpp v56, v56, v56 quad_perm:[2,3,0,1] row_mask:0xf bank_mask:0xf
  s_nop 1
  v_add_f32_dpp v56, v56, v56 row_half_mirror row_mask:0xf bank_mask:0xf
  v_mul_f32 v56, 0xbae38e39, v56
  v_cvt_pk_bf16_f32 v57, v56, v56
  v_lshlrev_b32 v16, 16, v57
  v_lshlrev_b32 v17, 16, v57
  v_lshlrev_b32 v18, 16, v57
  v_lshlrev_b32 v19, 16, v57
  v_mul_f32 v75, v56, v56
  s_nop 0
  v_mfma_f32_16x16x32_bf16 v[32:35], v[66:69], v[76:79], v[16:19]
  s_nop 0
  s_nop 0
  v_mfma_f32_16x16x32_bf16 v[36:39], v[64:67], v[76:79], v[16:19]
  s_nop 0
  s_nop 0
  v_mfma_f32_16x16x32_bf16 v[40:43], v[66:69], v[80:83], v[16:19]
  s_nop 0
  s_nop 0
  v_mfma_f32_16x16x32_bf16 v[44:47], v[64:67], v[80:83], v[16:19]
  s_nop 0
  v_mfma_f32_16x16x32_bf16 v[48:51], v[66:69], v[84:87], v[16:19]
  v_cvt_pk_bf16_f32 v76, v32, v33
  v_cvt_pk_bf16_f32 v77, v34, v35
  v_mfma_f32_16x16x32_bf16 v[52:55], v[64:67], v[84:87], v[16:19]
  v_cvt_pk_bf16_f32 v78, v36, v37
  s_waitcnt vmcnt(11)
  v_mfma_f32_16x16x32_bf16 v[56:59], v[70:73], v[112:115], 0
  buffer_load_dwordx4 v[160:163], v61, s[28:31], s83 offen
  v_cvt_pk_bf16_f32 v79, v38, v39
  v_mfma_f32_16x16x32_bf16 v[32:35], v[66:69], v[88:91], v[16:19]
  ds_write_b128 v224, v[76:79]
  v_cvt_pk_bf16_f32 v80, v40, v41
  v_cvt_pk_bf16_f32 v81, v42, v43
  v_mfma_f32_16x16x32_bf16 v[36:39], v[64:67], v[88:91], v[16:19]
  v_cvt_pk_bf16_f32 v82, v44, v45
  s_waitcnt vmcnt(11)
  v_mfma_f32_16x16x32_bf16 v[56:59], v[70:73], v[116:119], v[56:59]
  buffer_load_dwordx4 v[164:167], v61, s[28:31], s84 offen
  v_cvt_pk_bf16_f32 v83, v46, v47
  v_mfma_f32_16x16x32_bf16 v[40:43], v[66:69], v[92:95], v[16:19]
  ds_write_b128 v225, v[80:83]
  v_cvt_pk_bf16_f32 v84, v48, v49
  v_cvt_pk_bf16_f32 v85, v50, v51
  v_mfma_f32_16x16x32_bf16 v[44:47], v[64:67], v[92:95], v[16:19]
  v_cvt_pk_bf16_f32 v86, v52, v53
  s_waitcnt vmcnt(11)
  v_mfma_f32_16x16x32_bf16 v[56:59], v[70:73], v[120:123], v[56:59]
  buffer_load_dwordx4 v[168:171], v61, s[28:31], s85 offen
  v_cvt_pk_bf16_f32 v87, v54, v55
  v_mfma_f32_16x16x32_bf16 v[48:51], v[66:69], v[96:99], v[16:19]
  ds_write_b128 v226, v[84:87]
  v_cvt_pk_bf16_f32 v88, v32, v33
  v_cvt_pk_bf16_f32 v89, v34, v35
  v_mfma_f32_16x16x32_bf16 v[52:55], v[64:67], v[96:99], v[16:19]
  v_cvt_pk_bf16_f32 v90, v36, v37
  s_waitcnt vmcnt(11)
  v_mfma_f32_16x16x32_bf16 v[56:59], v[70:73], v[124:127], v[56:59]
  buffer_load_dwordx4 v[172:175], v61, s[28:31], s86 offen
  v_cvt_pk_bf16_f32 v91, v38, v39
  v_mfma_f32_16x16x32_bf16 v[32:35], v[66:69], v[100:103], v[16:19]
  ds_write_b128 v227, v[88:91]
  v_cvt_pk_bf16_f32 v92, v40, v41
  v_cvt_pk_bf16_f32 v93, v42, v43
  v_mfma_f32_16x16x32_bf16 v[36:39], v[64:67], v[100:103], v[16:19]
  v_cvt_pk_bf16_f32 v94, v44, v45
  s_waitcnt vmcnt(11)
  v_mfma_f32_16x16x32_bf16 v[56:59], v[70:73], v[128:131], v[56:59]
  buffer_load_dwordx4 v[176:179], v61, s[28:31], s87 offen
  v_cvt_pk_bf16_f32 v95, v46, v47
  v_mfma_f32_16x16x32_bf16 v[40:43], v[66:69], v[104:107], v[16:19]
  ds_write_b128 v228, v[92:95]
  v_cvt_pk_bf16_f32 v96, v48, v49
  v_cvt_pk_bf16_f32 v97, v50, v51
  v_mfma_f32_16x16x32_bf16 v[44:47], v[64:67], v[104:107], v[16:19]
  v_cvt_pk_bf16_f32 v98, v52, v53
  s_waitcnt vmcnt(11)
  v_mfma_f32_16x16x32_bf16 v[56:59], v[70:73], v[132:135], v[56:59]
  buffer_load_dwordx4 v[180:183], v61, s[28:31], s88 offen
  v_cvt_pk_bf16_f32 v99, v54, v55
  v_mfma_f32_16x16x32_bf16 v[48:51], v[66:69], v[108:111], v[16:19]
  ds_write_b128 v229, v[96:99]
  v_cvt_pk_bf16_f32 v100, v32, v33
  v_cvt_pk_bf16_f32 v101, v34, v35
  v_mfma_f32_16x16x32_bf16 v[52:55], v[64:67], v[108:111], v[16:19]
  v_cvt_pk_bf16_f32 v102, v36, v37
  s_waitcnt vmcnt(11)
  v_mfma_f32_16x16x32_bf16 v[56:59], v[70:73], v[136:139], v[56:59]
  buffer_load_dwordx4 v[184:187], v63, s[28:31], s80 offen
  v_cvt_pk_bf16_f32 v103, v38, v39
  ds_write_b128 v230, v[100:103]
  v_cvt_pk_bf16_f32 v104, v40, v41
  v_cvt_pk_bf16_f32 v105, v42, v43
  v_cvt_pk_bf16_f32 v106, v44, v45
  s_waitcnt vmcnt(11)
  v_mfma_f32_16x16x32_bf16 v[56:59], v[70:73], v[140:143], v[56:59]
  buffer_load_dwordx4 v[188:191], v63, s[28:31], s81 offen
  v_cvt_pk_bf16_f32 v107, v46, v47
  ds_write_b128 v231, v[104:107]
  v_cvt_pk_bf16_f32 v108, v48, v49
  v_cvt_pk_bf16_f32 v109, v50, v51
  v_cvt_pk_bf16_f32 v110, v52, v53
  s_waitcnt vmcnt(11)
  v_mfma_f32_16x16x32_bf16 v[56:59], v[70:73], v[144:147], v[56:59]
  buffer_load_dwordx4 v[192:195], v63, s[28:31], s82 offen
  v_cvt_pk_bf16_f32 v111, v54, v55
  ds_write_b128 v232, v[108:111]
  s_nop 4
  v_add_f32_dpp v56, v56, v56 quad_perm:[1,0,3,2] row_mask:0xf bank_mask:0xf
  s_nop 1
  v_add_f32_dpp v62, v62, v62 quad_perm:[1,0,3,2] row_mask:0xf bank_mask:0xf
  s_nop 0
  v_add_f32_dpp v56, v56, v56 quad_perm:[2,3,0,1] row_mask:0xf bank_mask:0xf
  v_add_f32_dpp v62, v62, v62 quad_perm:[2,3,0,1] row_mask:0xf bank_mask:0xf
  s_nop 0
  v_add_f32_dpp v56, v56, v56 row_half_mirror row_mask:0xf bank_mask:0xf
  v_add_f32_dpp v62, v62, v62 row_half_mirror row_mask:0xf bank_mask:0xf
  v_mul_f32 v56, 0xbae38e39, v56
  v_mul_f32 v62, 0x3ae38e39, v62
  v_cvt_pk_bf16_f32 v57, v56, v56
  v_sub_f32 v62, v62, v75
  v_lshlrev_b32 v16, 16, v57
  v_lshlrev_b32 v17, 16, v57
  v_lshlrev_b32 v18, 16, v57
  v_lshlrev_b32 v19, 16, v57
  v_sub_f32 v75, v16, v56
  s_nop 0
  v_mfma_f32_16x16x32_bf16 v[32:35], v[66:69], v[112:115], v[16:19]
  v_max_f32 v74, 0, v62
  v_cvt_pk_bf16_f32 v74, v74, v74
  v_lshlrev_b32 v74, 16, v74
  v_mfma_f32_16x16x32_bf16 v[36:39], v[64:67], v[112:115], v[16:19]
  v_add_f32 v74, 0x3727c5ac, v74
  v_cvt_pk_bf16_f32 v74, v74, v74
  v_lshlrev_b32 v74, 16, v74
  v_mfma_f32_16x16x32_bf16 v[40:43], v[66:69], v[116:119], v[16:19]
  v_sqrt_f32 v74, v74
  s_nop 0
  v_cvt_pk_bf16_f32 v74, v74, v74
  v_mfma_f32_16x16x32_bf16 v[44:47], v[64:67], v[116:119], v[16:19]
  v_lshlrev_b32 v74, 16, v74
  v_rcp_f32 v74, v74
  s_nop 0
  v_mfma_f32_16x16x32_bf16 v[48:51], v[66:69], v[120:123], v[16:19]
  v_cvt_pk_bf16_f32 v112, v32, v33
  v_cvt_pk_bf16_f32 v113, v34, v35
  v_mfma_f32_16x16x32_bf16 v[52:55], v[64:67], v[120:123], v[16:19]
  v_cvt_pk_bf16_f32 v114, v36, v37
  s_waitcnt vmcnt(11)
  v_mfma_f32_16x16x32_bf16 v[56:59], v[70:73], v[148:151], 0
  buffer_load_dwordx4 v[196:199], v63, s[28:31], s83 offen
  v_cvt_pk_bf16_f32 v115, v38, v39
  v_mfma_f32_16x16x32_bf16 v[32:35], v[66:69], v[124:127], v[16:19]
  ds_write_b128 v3, v[112:115] offset:0
  v_cvt_pk_bf16_f32 v116, v40, v41
  v_cvt_pk_bf16_f32 v117, v42, v43
  v_mfma_f32_16x16x32_bf16 v[36:39], v[64:67], v[124:127], v[16:19]
  v_cvt_pk_bf16_f32 v118, v44, v45
  s_waitcnt vmcnt(11)
  v_mfma_f32_16x16x32_bf16 v[56:59], v[70:73], v[152:155], v[56:59]
  buffer_load_dwordx4 v[200:203], v63, s[28:31], s84 offen
  v_cvt_pk_bf16_f32 v119, v46, v47
  v_mfma_f32_16x16x32_bf16 v[40:43], v[66:69], v[128:131], v[16:19]
  ds_write_b128 v3, v[116:119] offset:2048
  v_cvt_pk_bf16_f32 v120, v48, v49
  v_cvt_pk_bf16_f32 v121, v50, v51
  v_mfma_f32_16x16x32_bf16 v[44:47], v[64:67], v[128:131], v[16:19]
  v_cvt_pk_bf16_f32 v122, v52, v53
  s_waitcnt vmcnt(11)
  v_mfma_f32_16x16x32_bf16 v[56:59], v[70:73], v[156:159], v[56:59]
  buffer_load_dwordx4 v[204:207], v63, s[28:31], s85 offen
  v_cvt_pk_bf16_f32 v123, v54, v55
  v_mfma_f32_16x16x32_bf16 v[48:51], v[66:69], v[132:135], v[16:19]
  ds_write_b128 v3, v[120:123] offset:4096
  v_cvt_pk_bf16_f32 v124, v32, v33
  v_cvt_pk_bf16_f32 v125, v34, v35
  v_mfma_f32_16x16x32_bf16 v[52:55], v[64:67], v[132:135], v[16:19]
  v_cvt_pk_bf16_f32 v126, v36, v37
  s_waitcnt vmcnt(11)
  v_mfma_f32_16x16x32_bf16 v[56:59], v[70:73], v[160:163], v[56:59]
  buffer_load_dwordx4 v[208:211], v63, s[28:31], s86 offen
  v_cvt_pk_bf16_f32 v127, v38, v39
  v_mfma_f32_16x16x32_bf16 v[32:35], v[66:69], v[136:139], v[16:19]
  ds_write_b128 v3, v[124:127] offset:6144
  v_cvt_pk_bf16_f32 v128, v40, v41
  v_cvt_pk_bf16_f32 v129, v42, v43
  v_mfma_f32_16x16x32_bf16 v[36:39], v[64:67], v[136:139], v[16:19]
  v_cvt_pk_bf16_f32 v130, v44, v45
  s_waitcnt vmcnt(11)
  v_mfma_f32_16x16x32_bf16 v[56:59], v[70:73], v[164:167], v[56:59]
  buffer_load_dwordx4 v[212:215], v63, s[28:31], s87 offen
  v_cvt_pk_bf16_f32 v131, v46, v47
  v_mfma_f32_16x16x32_bf16 v[40:43], v[66:69], v[140:143], v[16:19]
  ds_write_b128 v3, v[128:131] offset:8192
  v_cvt_pk_bf16_f32 v132, v48, v49
  v_cvt_pk_bf16_f32 v133, v50, v51
  v_mfma_f32_16x16x32_bf16 v[44:47], v[64:67], v[140:143], v[16:19]
  v_cvt_pk_bf16_f32 v134, v52, v53
  s_waitcnt vmcnt(11)
  v_mfma_f32_16x16x32_bf16 v[56:59], v[70:73], v[168:171], v[56:59]
  buffer_load_dwordx4 v[216:219], v63, s[28:31], s88 offen
  v_cvt_pk_bf16_f32 v135, v54, v55
  v_mfma_f32_16x16x32_bf16 v[48:51], v[66:69], v[144:147], v[16:19]
  ds_write_b128 v3, v[132:135] offset:10240
  v_cvt_pk_bf16_f32 v136, v32, v33
  v_cvt_pk_bf16_f32 v137, v34, v35
  v_mfma_f32_16x16x32_bf16 v[52:55], v[64:67], v[144:147], v[16:19]
  v_cvt_pk_bf16_f32 v138, v36, v37
  s_waitcnt vmcnt(11)
  v_mfma_f32_16x16x32_bf16 v[56:59], v[70:73], v[172:175], v[56:59]
  v_cvt_pk_bf16_f32 v139, v38, v39
  ds_write_b128 v3, v[136:139] offset:12288
  v_cvt_pk_bf16_f32 v140, v40, v41
  v_cvt_pk_bf16_f32 v141, v42, v43
  v_cvt_pk_bf16_f32 v142, v44, v45
  s_waitcnt vmcnt(10)
  v_mfma_f32_16x16x32_bf16 v[56:59], v[70:73], v[176:179], v[56:59]
  v_cvt_pk_bf16_f32 v143, v46, v47
  ds_write_b128 v3, v[140:143] offset:14336
  v_cvt_pk_bf16_f32 v144, v48, v49
  v_cvt_pk_bf16_f32 v145, v50, v51
  v_cvt_pk_bf16_f32 v146, v52, v53
  s_waitcnt vmcnt(9)
  v_mfma_f32_16x16x32_bf16 v[56:59], v[70:73], v[180:183], v[56:59]
  v_cvt_pk_bf16_f32 v147, v54, v55
  ds_write_b128 v3, v[144:147] offset:16384
  ds_write_b32 v25, v74 offset:96
  ds_read_b128 a[4:7], v5 offset:0
  v_mul_f32 v75, v75, v75
  v_mov_b32 v62, 0
  ds_read_b128 a[12:15], v6 offset:1024
  v_dot2c_f32_bf16 v62, v112, v112
  v_dot2c_f32_bf16 v62, v113, v113
  ds_read_b128 a[20:23], v5 offset:2048
  v_dot2c_f32_bf16 v62, v114, v114
  v_dot2c_f32_bf16 v62, v115, v115
  ds_read_b128 a[28:31], v6 offset:3072
  v_dot2c_f32_bf16 v62, v116, v116
  v_dot2c_f32_bf16 v62, v117, v117
  ds_read_b128 a[36:39], v5 offset:4096
  v_dot2c_f32_bf16 v62, v118, v118
  v_dot2c_f32_bf16 v62, v119, v119
  ds_read_b128 a[44:47], v6 offset:5120
  v_dot2c_f32_bf16 v62, v120, v120
  v_dot2c_f32_bf16 v62, v121, v121
  ds_read_b128 a[52:55], v5 offset:6144
  v_dot2c_f32_bf16 v62, v122, v122
  v_dot2c_f32_bf16 v62, v123, v123
  ds_read_b128 a[60:63], v6 offset:7168
  v_dot2c_f32_bf16 v62, v124, v124
  v_dot2c_f32_bf16 v62, v125, v125
  ds_read_b128 a[68:71], v5 offset:8192
  v_dot2c_f32_bf16 v62, v126, v126
  v_dot2c_f32_bf16 v62, v127, v127
  v_dot2c_f32_bf16 v62, v128, v128
  ds_read_b128 a[76:79], v6 offset:9216
  v_dot2c_f32_bf16 v62, v129, v129
  v_dot2c_f32_bf16 v62, v130, v130
  ds_read_b128 a[84:87], v5 offset:10240
  v_dot2c_f32_bf16 v62, v131, v131
  v_dot2c_f32_bf16 v62, v132, v132
  ds_read_b128 a[92:95], v6 offset:11264
  v_dot2c_f32_bf16 v62, v133, v133
  v_dot2c_f32_bf16 v62, v134, v134
  ds_read_b128 a[100:103], v5 offset:12288
  v_dot2c_f32_bf16 v62, v135, v135
  v_dot2c_f32_bf16 v62, v136, v136
  ds_read_b128 a[108:111], v6 offset:13312
  v_dot2c_f32_bf16 v62, v137, v137
  v_dot2c_f32_bf16 v62, v138, v138
  ds_read_b128 a[116:119], v5 offset:14336
  v_dot2c_f32_bf16 v62, v139, v139
  v_dot2c_f32_bf16 v62, v140, v140
  ds_read_b128 a[124:127], v6 offset:15360
  v_dot2c_f32_bf16 v62, v141, v141
  v_dot2c_f32_bf16 v62, v142, v142
  ds_read_b128 a[132:135], v5 offset:16384
  v_dot2c_f32_bf16 v62, v143, v143
  v_dot2c_f32_bf16 v62, v144, v144
  ds_read_b128 a[140:143], v6 offset:17408
  v_dot2c_f32_bf16 v62, v145, v145
  v_dot2c_f32_bf16 v62, v146, v146
  v_dot2c_f32_bf16 v62, v147, v147
  v_add_f32_dpp v56, v56, v56 quad_perm:[1,0,3,2] row_mask:0xf bank_mask:0xf
  s_nop 1
  v_add_f32_dpp v62, v62, v62 quad_perm:[1,0,3,2] row_mask:0xf bank_mask:0xf
  s_nop 0
  v_add_f32_dpp v56, v56, v56 quad_perm:[2,3,0,1] row_mask:0xf bank_mask:0xf
  v_add_f32_dpp v62, v62, v62 quad_perm:[2,3,0,1] row_mask:0xf bank_mask:0xf
  s_nop 0
  v_add_f32_dpp v56, v56, v56 row_half_mirror row_mask:0xf bank_mask:0xf
  v_add_f32_dpp v62, v62, v62 row_half_mirror row_mask:0xf bank_mask:0xf
  v_mul_f32 v56, 0xbae38e39, v56
  v_mul_f32 v62, 0x3ae38e39, v62
  v_cvt_pk_bf16_f32 v57, v56, v56
  v_sub_f32 v62, v62, v75
  v_lshlrev_b32 v16, 16, v57
  v_lshlrev_b32 v17, 16, v57
  v_lshlrev_b32 v18, 16, v57
  v_lshlrev_b32 v19, 16, v57
  v_sub_f32 v75, v16, v56
  s_nop 0
  v_mfma_f32_16x16x32_bf16 v[32:35], v[66:69], v[148:151], v[16:19]
  v_max_f32 v74, 0, v62
  v_cvt_pk_bf16_f32 v74, v74, v74
  v_lshlrev_b32 v74, 16, v74
  v_mfma_f32_16x16x32_bf16 v[36:39], v[64:67], v[148:151], v[16:19]
  v_add_f32 v74, 0x3727c5ac, v74
  v_cvt_pk_bf16_f32 v74, v74, v74
  v_lshlrev_b32 v74, 16, v74
  v_mfma_f32_16x16x32_bf16 v[40:43], v[66:69], v[152:155], v[16:19]
  v_sqrt_f32 v74, v74
  s_nop 0
  v_cvt_pk_bf16_f32 v74, v74, v74
  v_mfma_f32_16x16x32_bf16 v[44:47], v[64:67], v[152:155], v[16:19]
  v_lshlrev_b32 v74, 16, v74
  v_rcp_f32 v74, v74
  s_nop 0
  v_mfma_f32_16x16x32_bf16 v[48:51], v[66:69], v[156:159], v[16:19]
  v_cvt_pk_bf16_f32 v148, v32, v33
  v_cvt_pk_bf16_f32 v149, v34, v35
  v_mfma_f32_16x16x32_bf16 v[52:55], v[64:67], v[156:159], v[16:19]
  v_cvt_pk_bf16_f32 v150, v36, v37
  s_waitcnt vmcnt(8)
  v_mfma_f32_16x16x32_bf16 v[56:59], v[70:73], v[184:187], 0
  s_mul_i32 s56, s80, 1728
  s_add_u32 s56, s52, s56
  s_addc_u32 s57, s53, 0
  s_add_u32 m0, s50, 0
  s_nop 0
  global_load_lds_dwordx4 v22, s[56:57] offset:0
  v_cvt_pk_bf16_f32 v151, v38, v39
  v_mfma_f32_16x16x32_bf16 v[32:35], v[66:69], v[160:163], v[16:19]
  ds_write_b128 v4, v[148:151] offset:0
  v_cvt_pk_bf16_f32 v152, v40, v41
  v_cvt_pk_bf16_f32 v153, v42, v43
  v_mfma_f32_16x16x32_bf16 v[36:39], v[64:67], v[160:163], v[16:19]
  v_cvt_pk_bf16_f32 v154, v44, v45
  s_waitcnt vmcnt(8)
  v_mfma_f32_16x16x32_bf16 v[56:59], v[70:73], v[188:191], v[56:59]
  global_load_lds_dwordx4 v23, s[56:57] offset:1024
  v_cvt_pk_bf16_f32 v155, v46, v47
  v_mfma_f32_16x16x32_bf16 v[40:43], v[66:69], v[164:167], v[16:19]
  ds_write_b128 v4, v[152:155] offset:2048
  v_cvt_pk_bf16_f32 v156, v48, v49
  v_cvt_pk_bf16_f32 v157, v50, v51
  v_mfma_f32_16x16x32_bf16 v[44:47], v[64:67], v[164:167], v[16:19]
  v_cvt_pk_bf16_f32 v158, v52, v53
  s_waitcnt vmcnt(8)
  v_mfma_f32_16x16x32_bf16 v[56:59], v[70:73], v[192:195], v[56:59]
  global_load_lds_dwordx4 v26, s[56:57] offset:2048
  v_cvt_pk_bf16_f32 v159, v54, v55
  v_mfma_f32_16x16x32_bf16 v[48:51], v[66:69], v[168:171], v[16:19]
  ds_write_b128 v4, v[156:159] offset:4096
  v_cvt_pk_bf16_f32 v160, v32, v33
  v_cvt_pk_bf16_f32 v161, v34, v35
  v_mfma_f32_16x16x32_bf16 v[52:55], v[64:67], v[168:171], v[16:19]
  v_cvt_pk_bf16_f32 v162, v36, v37
  s_waitcnt vmcnt(8)
  v_mfma_f32_16x16x32_bf16 v[56:59], v[70:73], v[196:199], v[56:59]
  s_add_u32 m0, s50, 3072
  s_nop 0
  global_load_lds_dwordx4 v27, s[56:57] offset:0
  v_cvt_pk_bf16_f32 v163, v38, v39
  v_mfma_f32_16x16x32_bf16 v[32:35], v[66:69], v[172:175], v[16:19]
  ds_write_b128 v4, v[160:163] offset:6144
  v_cvt_pk_bf16_f32 v164, v40, v41
  v_cvt_pk_bf16_f32 v165, v42, v43
  v_mfma_f32_16x16x32_bf16 v[36:39], v[64:67], v[172:175], v[16:19]
  v_cvt_pk_bf16_f32 v166, v44, v45
  s_waitcnt vmcnt(8)
  v_mfma_f32_16x16x32_bf16 v[56:59], v[70:73], v[200:203], v[56:59]
  global_load_lds_dwordx4 v28, s[56:57] offset:1024
  v_cvt_pk_bf16_f32 v167, v46, v47
  v_mfma_f32_16x16x32_bf16 v[40:43], v[66:69], v[176:179], v[16:19]
  ds_write_b128 v4, v[164:167] offset:8192
  v_cvt_pk_bf16_f32 v168, v48, v49
  v_cvt_pk_bf16_f32 v169, v50, v51
  v_mfma_f32_16x16x32_bf16 v[44:47], v[64:67], v[176:179], v[16:19]
  v_cvt_pk_bf16_f32 v170, v52, v53
  s_waitcnt vmcnt(8)
  v_mfma_f32_16x16x32_bf16 v[56:59], v[70:73], v[204:207], v[56:59]
  global_load_lds_dwordx4 v29, s[56:57] offset:2048
  v_cvt_pk_bf16_f32 v171, v54, v55
  v_mfma_f32_16x16x32_bf16 v[48:51], v[66:69], v[180:183], v[16:19]
  ds_write_b128 v4, v[168:171] offset:10240
  v_cvt_pk_bf16_f32 v172, v32, v33
  v_cvt_pk_bf16_f32 v173, v34, v35
  v_mfma_f32_16x16x32_bf16 v[52:55], v[64:67], v[180:183], v[16:19]
  v_cvt_pk_bf16_f32 v174, v36, v37
  s_waitcnt vmcnt(8)
  v_mfma_f32_16x16x32_bf16 v[56:59], v[70:73], v[208:211], v[56:59]
  v_cvt_pk_bf16_f32 v175, v38, v39
  ds_write_b128 v4, v[172:175] offset:12288
  v_cvt_pk_bf16_f32 v176, v40, v41
  v_cvt_pk_bf16_f32 v177, v42, v43
  v_cvt_pk_bf16_f32 v178, v44, v45
  s_waitcnt vmcnt(7)
  v_mfma_f32_16x16x32_bf16 v[56:59], v[70:73], v[212:215], v[56:59]
  v_cvt_pk_bf16_f32 v179, v46, v47
  ds_write_b128 v4, v[176:179] offset:14336
  v_cvt_pk_bf16_f32 v180, v48, v49
  v_cvt_pk_bf16_f32 v181, v50, v51
  v_cvt_pk_bf16_f32 v182, v52, v53
  s_waitcnt vmcnt(6)
  v_mfma_f32_16x16x32_bf16 v[56:59], v[70:73], v[216:219], v[56:59]
  v_cvt_pk_bf16_f32 v183, v54, v55
  ds_write_b128 v4, v[180:183] offset:16384
  ds_write_b32 v25, v74 offset:64
  v_mul_f32 v75, v75, v75
  v_mov_b32 v62, 0
  v_dot2c_f32_bf16 v62, v148, v148
  v_dot2c_f32_bf16 v62, v149, v149
  v_dot2c_f32_bf16 v62, v150, v150
  v_dot2c_f32_bf16 v62, v151, v151
  v_dot2c_f32_bf16 v62, v152, v152
  v_dot2c_f32_bf16 v62, v153, v153
  v_dot2c_f32_bf16 v62, v154, v154
  v_dot2c_f32_bf16 v62, v155, v155
  v_dot2c_f32_bf16 v62, v156, v156
  v_dot2c_f32_bf16 v62, v157, v157
  v_dot2c_f32_bf16 v62, v158, v158
  v_dot2c_f32_bf16 v62, v159, v159
  v_dot2c_f32_bf16 v62, v160, v160
  v_dot2c_f32_bf16 v62, v161, v161
  v_dot2c_f32_bf16 v62, v162, v162
  v_dot2c_f32_bf16 v62, v163, v163
  v_dot2c_f32_bf16 v62, v164, v164
  v_dot2c_f32_bf16 v62, v165, v165
  v_dot2c_f32_bf16 v62, v166, v166
  v_dot2c_f32_bf16 v62, v167, v167
  v_dot2c_f32_bf16 v62, v168, v168
  v_dot2c_f32_bf16 v62, v169, v169
  v_dot2c_f32_bf16 v62, v170, v170
  v_dot2c_f32_bf16 v62, v171, v171
  v_dot2c_f32_bf16 v62, v172, v172
  v_dot2c_f32_bf16 v62, v173, v173
  v_dot2c_f32_bf16 v62, v174, v174
  v_dot2c_f32_bf16 v62, v175, v175
  v_dot2c_f32_bf16 v62, v176, v176
  v_dot2c_f32_bf16 v62, v177, v177
  v_dot2c_f32_bf16 v62, v178, v178
  v_dot2c_f32_bf16 v62, v179, v179
  v_dot2c_f32_bf16 v62, v180, v180
  v_dot2c_f32_bf16 v62, v181, v181
  v_dot2c_f32_bf16 v62, v182, v182
  v_dot2c_f32_bf16 v62, v183, v183
  v_add_f32_dpp v56, v56, v56 quad_perm:[1,0,3,2] row_mask:0xf bank_mask:0xf
  s_nop 1
  v_add_f32_dpp v62, v62, v62 quad_perm:[1,0,3,2] row_mask:0xf bank_mask:0xf
  s_nop 0
  v_add_f32_dpp v56, v56, v56 quad_perm:[2,3,0,1] row_mask:0xf bank_mask:0xf
  v_add_f32_dpp v62, v62, v62 quad_perm:[2,3,0,1] row_mask:0xf bank_mask:0xf
  s_nop 0
  v_add_f32_dpp v56, v56, v56 row_half_mirror row_mask:0xf bank_mask:0xf
  v_add_f32_dpp v62, v62, v62 row_half_mirror row_mask:0xf bank_mask:0xf
  v_mul_f32 v56, 0xbae38e39, v56
  v_mul_f32 v62, 0x3ae38e39, v62
  v_cvt_pk_bf16_f32 v57, v56, v56
  v_sub_f32 v62, v62, v75
  v_lshlrev_b32 v16, 16, v57
  v_lshlrev_b32 v17, 16, v57
  v_lshlrev_b32 v18, 16, v57
  v_lshlrev_b32 v19, 16, v57
  v_sub_f32 v75, v16, v56
  s_nop 0
  v_mfma_f32_16x16x32_bf16 v[32:35], v[66:69], v[184:187], v[16:19]
  v_max_f32 v74, 0, v62
  v_cvt_pk_bf16_f32 v74, v74, v74
  v_lshlrev_b32 v74, 16, v74
  v_mfma_f32_16x16x32_bf16 v[36:39], v[64:67], v[184:187], v[16:19]
  v_add_f32 v74, 0x3727c5ac, v74
  v_cvt_pk_bf16_f32 v74, v74, v74
  v_lshlrev_b32 v74, 16, v74
  v_mfma_f32_16x16x32_bf16 v[40:43], v[66:69], v[188:191], v[16:19]
  v_sqrt_f32 v74, v74
  s_nop 0
  v_cvt_pk_bf16_f32 v74, v74, v74
  v_mfma_f32_16x16x32_bf16 v[44:47], v[64:67], v[188:191], v[16:19]
  v_lshlrev_b32 v74, 16, v74
  v_rcp_f32 v74, v74
  s_nop 0
  v_mfma_f32_16x16x32_bf16 v[48:51], v[66:69], v[192:195], v[16:19]
  v_cvt_pk_bf16_f32 v184, v32, v33
  v_cvt_pk_bf16_f32 v185, v34, v35
  v_mfma_f32_16x16x32_bf16 v[52:55], v[64:67], v[192:195], v[16:19]
  v_cvt_pk_bf16_f32 v186, v36, v37
  s_mul_i32 s56, s81, 1728
  s_add_u32 s56, s52, s56
  s_addc_u32 s57, s53, 0
  s_add_u32 m0, s50, 24576
  s_nop 0
  global_load_lds_dwordx4 v22, s[56:57] offset:0
  v_cvt_pk_bf16_f32 v187, v38, v39
  v_mfma_f32_16x16x32_bf16 v[32:35], v[66:69], v[196:199], v[16:19]
  ds_write_b128 v3, v[184:187] offset:0
  v_cvt_pk_bf16_f32 v188, v40, v41
  v_cvt_pk_bf16_f32 v189, v42, v43
  v_mfma_f32_16x16x32_bf16 v[36:39], v[64:67], v[196:199], v[16:19]
  v_cvt_pk_bf16_f32 v190, v44, v45
  global_load_lds_dwordx4 v23, s[56:57] offset:1024
  v_cvt_pk_bf16_f32 v191, v46, v47
  v_mfma_f32_16x16x32_bf16 v[40:43], v[66:69], v[200:203], v[16:19]
  ds_write_b128 v3, v[188:191] offset:2048
  v_cvt_pk_bf16_f32 v192, v48, v49
  v_cvt_pk_bf16_f32 v193, v50, v51
  v_mfma_f32_16x16x32_bf16 v[44:47], v[64:67], v[200:203], v[16:19]
  v_cvt_pk_bf16_f32 v194, v52, v53
  global_load_lds_dwordx4 v26, s[56:57] offset:2048
  v_cvt_pk_bf16_f32 v195, v54, v55
  v_mfma_f32_16x16x32_bf16 v[48:51], v[66:69], v[204:207], v[16:19]
  ds_write_b128 v3, v[192:195] offset:4096
  v_cvt_pk_bf16_f32 v196, v32, v33
  v_cvt_pk_bf16_f32 v197, v34, v35
  v_mfma_f32_16x16x32_bf16 v[52:55], v[64:67], v[204:207], v[16:19]
  v_cvt_pk_bf16_f32 v198, v36, v37
  s_add_u32 m0, s50, 27648
  s_nop 0
  global_load_lds_dwordx4 v27, s[56:57] offset:0
  v_cvt_pk_bf16_f32 v199, v38, v39
  v_mfma_f32_16x16x32_bf16 v[32:35], v[66:69], v[208:211], v[16:19]
  ds_write_b128 v3, v[196:199] offset:6144
  v_cvt_pk_bf16_f32 v200, v40, v41
  v_cvt_pk_bf16_f32 v201, v42, v43
  v_mfma_f32_16x16x32_bf16 v[36:39], v[64:67], v[208:211], v[16:19]
  v_cvt_pk_bf16_f32 v202, v44, v45
  global_load_lds_dwordx4 v28, s[56:57] offset:1024
  v_cvt_pk_bf16_f32 v203, v46, v47
  v_mfma_f32_16x16x32_bf16 v[40:43], v[66:69], v[212:215], v[16:19]
  ds_write_b128 v3, v[200:203] offset:8192
  v_cvt_pk_bf16_f32 v204, v48, v49
  v_cvt_pk_bf16_f32 v205, v50, v51
  v_mfma_f32_16x16x32_bf16 v[44:47], v[64:67], v[212:215], v[16:19]
  v_cvt_pk_bf16_f32 v206, v52, v53
  global_load_lds_dwordx4 v29, s[56:57] offset:2048
  v_cvt_pk_bf16_f32 v207, v54, v55
  v_mfma_f32_16x16x32_bf16 v[48:51], v[66:69], v[216:219], v[16:19]
  ds_write_b128 v3, v[204:207] offset:10240
  v_cvt_pk_bf16_f32 v208, v32, v33
  v_cvt_pk_bf16_f32 v209, v34, v35
  v_mfma_f32_16x16x32_bf16 v[52:55], v[64:67], v[216:219], v[16:19]
  v_cvt_pk_bf16_f32 v210, v36, v37
  v_cvt_pk_bf16_f32 v211, v38, v39
  ds_write_b128 v3, v[208:211] offset:12288
  v_cvt_pk_bf16_f32 v212, v40, v41
  v_cvt_pk_bf16_f32 v213, v42, v43
  v_cvt_pk_bf16_f32 v214, v44, v45
  v_cvt_pk_bf16_f32 v215, v46, v47
  ds_write_b128 v3, v[212:215] offset:14336
  v_cvt_pk_bf16_f32 v216, v48, v49
  v_cvt_pk_bf16_f32 v217, v50, v51
  v_cvt_pk_bf16_f32 v218, v52, v53
  v_cvt_pk_bf16_f32 v219, v54, v55
  ds_write_b128 v3, v[216:219] offset:16384
  ds_write_b32 v25, v74 offset:32
  ds_read_b128 a[0:3], v5 offset:0
  v_mul_f32 v75, v75, v75
  v_mov_b32 v62, 0
  ds_read_b128 a[8:11], v6 offset:1024
  v_dot2c_f32_bf16 v62, v184, v184
  v_dot2c_f32_bf16 v62, v185, v185
  ds_read_b128 a[16:19], v5 offset:2048
  v_dot2c_f32_bf16 v62, v186, v186
  v_dot2c_f32_bf16 v62, v187, v187
  ds_read_b128 a[24:27], v6 offset:3072
  v_dot2c_f32_bf16 v62, v188, v188
  v_dot2c_f32_bf16 v62, v189, v189
  ds_read_b128 a[32:35], v5 offset:4096
  v_dot2c_f32_bf16 v62, v190, v190
  v_dot2c_f32_bf16 v62, v191, v191
  ds_read_b128 a[40:43], v6 offset:5120
  v_dot2c_f32_bf16 v62, v192, v192
  v_dot2c_f32_bf16 v62, v193, v193
  ds_read_b128 a[48:51], v5 offset:6144
  v_dot2c_f32_bf16 v62, v194, v194
  v_dot2c_f32_bf16 v62, v195, v195
  ds_read_b128 a[56:59], v6 offset:7168
  v_dot2c_f32_bf16 v62, v196, v196
  v_dot2c_f32_bf16 v62, v197, v197
  ds_read_b128 a[64:67], v5 offset:8192
  v_dot2c_f32_bf16 v62, v198, v198
  v_dot2c_f32_bf16 v62, v199, v199
  v_dot2c_f32_bf16 v62, v200, v200
  ds_read_b128 a[72:75], v6 offset:9216
  v_dot2c_f32_bf16 v62, v201, v201
  v_dot2c_f32_bf16 v62, v202, v202
  ds_read_b128 a[80:83], v5 offset:10240
  v_dot2c_f32_bf16 v62, v203, v203
  v_dot2c_f32_bf16 v62, v204, v204
  ds_read_b128 a[88:91], v6 offset:11264
  v_dot2c_f32_bf16 v62, v205, v205
  v_dot2c_f32_bf16 v62, v206, v206
  ds_read_b128 a[96:99], v5 offset:12288
  v_dot2c_f32_bf16 v62, v207, v207
  v_dot2c_f32_bf16 v62, v208, v208
  ds_read_b128 a[104:107], v6 offset:13312
  v_dot2c_f32_bf16 v62, v209, v209
  v_dot2c_f32_bf16 v62, v210, v210
  ds_read_b128 a[112:115], v5 offset:14336
  v_dot2c_f32_bf16 v62, v211, v211
  v_dot2c_f32_bf16 v62, v212, v212
  ds_read_b128 a[120:123], v6 offset:15360
  v_dot2c_f32_bf16 v62, v213, v213
  v_dot2c_f32_bf16 v62, v214, v214
  ds_read_b128 a[128:131], v5 offset:16384
  v_dot2c_f32_bf16 v62, v215, v215
  v_dot2c_f32_bf16 v62, v216, v216
  ds_read_b128 a[136:139], v6 offset:17408
  v_dot2c_f32_bf16 v62, v217, v217
  v_dot2c_f32_bf16 v62, v218, v218
  v_dot2c_f32_bf16 v62, v219, v219
  s_nop 2
  v_add_f32_dpp v62, v62, v62 quad_perm:[1,0,3,2] row_mask:0xf bank_mask:0xf
  s_nop 1
  v_add_f32_dpp v62, v62, v62 quad_perm:[2,3,0,1] row_mask:0xf bank_mask:0xf
  s_nop 1
  v_add_f32_dpp v62, v62, v62 row_half_mirror row_mask:0xf bank_mask:0xf
  v_mul_f32 v62, 0x3ae38e39, v62
  v_sub_f32 v62, v62, v75
  v_max_f32 v74, 0, v62
  v_cvt_pk_bf16_f32 v74, v74, v74
  v_lshlrev_b32 v74, 16, v74
  v_add_f32 v74, 0x3727c5ac, v74
  v_cvt_pk_bf16_f32 v74, v74, v74
  v_lshlrev_b32 v74, 16, v74
  v_sqrt_f32 v74, v74
  s_nop 0
  v_cvt_pk_bf16_f32 v74, v74, v74
  v_lshlrev_b32 v74, 16, v74
  v_rcp_f32 v74, v74
  s_nop 0
  ds_write_b32 v25, v74 offset:0
  s_waitcnt vmcnt(6) lgkmcnt(0)
  s_barrier
  ds_read_b64_tr_b16 v[32:33], v8 offset:0
  ds_read_b64_tr_b16 v[34:35], v8 offset:12288
  ds_read_b64_tr_b16 v[36:37], v8 offset:1024
  ds_read_b64_tr_b16 v[38:39], v8 offset:13312
  ds_read_b64_tr_b16 v[40:41], v9 offset:0
  ds_read_b64_tr_b16 v[42:43], v9 offset:12288
  ds_read_b64_tr_b16 v[44:45], v9 offset:1024
  ds_read_b64_tr_b16 v[46:47], v9 offset:13312
  ds_read_b64_tr_b16 v[48:49], v10 offset:0
  ds_read_b64_tr_b16 v[50:51], v10 offset:12288
  ds_read_b64_tr_b16 v[52:53], v10 offset:1024
  ds_read_b64_tr_b16 v[54:55], v10 offset:13312
  s_lshl_b32 s58, s44, 8
  s_lshl4_add_u32 s58, s45, s58
  s_add_u32 s58, s58, s51
  v_lshl_add_u32 v136, v1, 8, s58
  v_mov_b32 v137, 1
  buffer_store_dword v137, v136, s[36:39], 0 offen sc1
  v_add_u32 v16, 98304, v8
  v_add_u32 v17, 98304, v9
  v_add_u32 v18, 98304, v10
  v_add_u32 v19, 98304, v11
  s_waitcnt lgkmcnt(8)
  v_mfma_f32_16x16x32_bf16 v[64:67], v[32:35], a[0:3], 0
  ds_read_b64_tr_b16 v[56:57], v11 offset:0
  s_mul_i32 s56, s82, 1728
  v_mfma_f32_16x16x32_bf16 v[64:67], v[36:39], a[8:11], v[64:67]
  ds_read_b64_tr_b16 v[58:59], v11 offset:12288
  s_add_u32 s56, s52, s56
  v_mfma_f32_16x16x32_bf16 v[68:71], v[32:35], a[4:7], 0
  ds_read_b64_tr_b16 v[60:61], v11 offset:1024
  s_addc_u32 s57, s53, 0
  v_mfma_f32_16x16x32_bf16 v[68:71], v[36:39], a[12:15], v[68:71]
  ds_read_b64_tr_b16 v[62:63], v11 offset:13312
  s_waitcnt lgkmcnt(8)
  v_mfma_f32_16x16x32_bf16 v[72:75], v[40:43], a[0:3], 0
  ds_read_b64_tr_b16 v[32:33], v8 offset:2048
  s_add_u32 m0, s50, 122880
  v_mfma_f32_16x16x32_bf16 v[72:75], v[44:47], a[8:11], v[72:75]
  ds_read_b64_tr_b16 v[34:35], v8 offset:14336
  global_load_lds_dwordx4 v22, s[56:57] offset:0
  v_mfma_f32_16x16x32_bf16 v[76:79], v[40:43], a[4:7], 0
  ds_read_b64_tr_b16 v[36:37], v8 offset:3072
  v_mfma_f32_16x16x32_bf16 v[76:79], v[44:47], a[12:15], v[76:79]
  ds_read_b64_tr_b16 v[38:39], v8 offset:15360
  s_waitcnt lgkmcnt(8)
  v_mfma_f32_16x16x32_bf16 v[80:83], v[48:51], a[0:3], 0
  ds_read_b64_tr_b16 v[40:41], v9 offset:2048
  global_load_lds_dwordx4 v23, s[56:57] offset:1024
  v_mfma_f32_16x16x32_bf16 v[80:83], v[52:55], a[8:11], v[80:83]
  ds_read_b64_tr_b16 v[42:43], v9 offset:14336
  v_mfma_f32_16x16x32_bf16 v[84:87], v[48:51], a[4:7], 0
  ds_read_b64_tr_b16 v[44:45], v9 offset:3072
  v_mfma_f32_16x16x32_bf16 v[84:87], v[52:55], a[12:15], v[84:87]
  ds_read_b64_tr_b16 v[46:47], v9 offset:15360
  s_waitcnt lgkmcnt(8)
  v_mfma_f32_16x16x32_bf16 v[88:91], v[56:59], a[0:3], 0
  ds_read_b64_tr_b16 v[48:49], v10 offset:2048
  global_load_lds_dwordx4 v26, s[56:57] offset:2048
  v_mfma_f32_16x16x32_bf16 v[88:91], v[60:63], a[8:11], v[88:91]
  ds_read_b64_tr_b16 v[50:51], v10 offset:14336
  s_add_u32 m0, s50, 125952
  v_mfma_f32_16x16x32_bf16 v[92:95], v[56:59], a[4:7], 0
  ds_read_b64_tr_b16 v[52:53], v10 offset:3072
  global_load_lds_dwordx4 v27, s[56:57] offset:0
  v_mfma_f32_16x16x32_bf16 v[92:95], v[60:63], a[12:15], v[92:95]
  ds_read_b64_tr_b16 v[54:55], v10 offset:15360
  s_waitcnt lgkmcnt(8)
  v_mfma_f32_16x16x32_bf16 v[96:99], v[32:35], a[0:3], 0
  ds_read_b64_tr_b16 v[56:57], v11 offset:2048
  v_mfma_f32_16x16x32_bf16 v[96:99], v[36:39], a[8:11], v[96:99]
  ds_read_b64_tr_b16 v[58:59], v11 offset:14336
  global_load_lds_dwordx4 v28, s[56:57] offset:1024
  v_mfma_f32_16x16x32_bf16 v[100:103], v[32:35], a[4:7], 0
  ds_read_b64_tr_b16 v[60:61], v11 offset:3072
  v_mfma_f32_16x16x32_bf16 v[100:103], v[36:39], a[12:15], v[100:103]
  ds_read_b64_tr_b16 v[62:63], v11 offset:15360
  s_waitcnt lgkmcnt(8)
  v_mfma_f32_16x16x32_bf16 v[104:107], v[40:43], a[0:3], 0
  ds_read_b64_tr_b16 v[32:33], v8 offset:4096
  global_load_lds_dwordx4 v29, s[56:57] offset:2048
  v_mfma_f32_16x16x32_bf16 v[104:107], v[44:47], a[8:11], v[104:107]
  ds_read_b64_tr_b16 v[34:35], v8 offset:16384
  v_mfma_f32_16x16x32_bf16 v[108:111], v[40:43], a[4:7], 0
  ds_read_b64_tr_b16 v[36:37], v8 offset:5120
  s_waitcnt vmcnt(7) lgkmcnt(7)
  v_mfma_f32_16x16x32_bf16 v[108:111], v[44:47], a[12:15], v[108:111]
  ds_read_b64_tr_b16 v[38:39], v8 offset:17408
  s_barrier
  v_mfma_f32_16x16x32_bf16 v[112:115], v[48:51], a[0:3], 0
  ds_read_b64_tr_b16 v[40:41], v8 offset:24576
  s_mul_i32 s56, s83, 1728
  v_mfma_f32_16x16x32_bf16 v[112:115], v[52:55], a[8:11], v[112:115]
  ds_read_b64_tr_b16 v[42:43], v8 offset:36864
  s_add_u32 s56, s52, s56
  v_mfma_f32_16x16x32_bf16 v[116:119], v[48:51], a[4:7], 0
  ds_read_b64_tr_b16 v[44:45], v8 offset:25600
  s_addc_u32 s57, s53, 0
  v_mfma_f32_16x16x32_bf16 v[116:119], v[52:55], a[12:15], v[116:119]
  ds_read_b64_tr_b16 v[46:47], v8 offset:37888
  s_waitcnt lgkmcnt(8)
  v_mfma_f32_16x16x32_bf16 v[120:123], v[56:59], a[0:3], 0
  ds_read_b64_tr_b16 v[48:49], v9 offset:24576
  s_add_u32 m0, s50, 49152
  v_mfma_f32_16x16x32_bf16 v[120:123], v[60:63], a[8:11], v[120:123]
  ds_read_b64_tr_b16 v[50:51], v9 offset:36864
  global_load_lds_dwordx4 v22, s[56:57] offset:0
  v_mfma_f32_16x16x32_bf16 v[124:127], v[56:59], a[4:7], 0
  ds_read_b64_tr_b16 v[52:53], v9 offset:25600
  v_mfma_f32_16x16x32_bf16 v[124:127], v[60:63], a[12:15], v[124:127]
  ds_read_b64_tr_b16 v[54:55], v9 offset:37888
  s_waitcnt lgkmcnt(8)
  v_mfma_f32_16x16x32_bf16 v[128:131], v[32:35], a[0:3], 0
  ds_read_b64_tr_b16 v[56:57], v10 offset:24576
  v_mfma_f32_16x16x32_bf16 v[128:131], v[36:39], a[8:11], v[128:131]
  ds_read_b64_tr_b16 v[58:59], v10 offset:36864
  global_load_lds_dwordx4 v23, s[56:57] offset:1024
  v_mfma_f32_16x16x32_bf16 v[132:135], v[32:35], a[4:7], 0
  ds_read_b64_tr_b16 v[60:61], v10 offset:25600
  v_mfma_f32_16x16x32_bf16 v[132:135], v[36:39], a[12:15], v[132:135]
  ds_read_b64_tr_b16 v[62:63], v10 offset:37888
  s_waitcnt lgkmcnt(8)
  v_mfma_f32_16x16x32_bf16 v[64:67], v[40:43], a[16:19], v[64:67]
  ds_read_b64_tr_b16 v[32:33], v11 offset:24576
  v_mfma_f32_16x16x32_bf16 v[64:67], v[44:47], a[24:27], v[64:67]
  ds_read_b64_tr_b16 v[34:35], v11 offset:36864
  global_load_lds_dwordx4 v26, s[56:57] offset:2048
  v_mfma_f32_16x16x32_bf16 v[68:71], v[40:43], a[20:23], v[68:71]
  ds_read_b64_tr_b16 v[36:37], v11 offset:25600
  s_add_u32 m0, s50, 52224
  v_mfma_f32_16x16x32_bf16 v[68:71], v[44:47], a[28:31], v[68:71]
  ds_read_b64_tr_b16 v[38:39], v11 offset:37888
  s_waitcnt lgkmcnt(8)
  v_mfma_f32_16x16x32_bf16 v[72:75], v[48:51], a[16:19], v[72:75]
  ds_read_b64_tr_b16 v[40:41], v8 offset:26624
  s_mov_b32 s32, s22
  v_mfma_f32_16x16x32_bf16 v[72:75], v[52:55], a[24:27], v[72:75]
  ds_read_b64_tr_b16 v[42:43], v8 offset:38912
  global_load_lds_dwordx4 v27, s[56:57] offset:0
  v_mfma_f32_16x16x32_bf16 v[76:79], v[48:51], a[20:23], v[76:79]
  ds_read_b64_tr_b16 v[44:45], v8 offset:27648
  s_and_b32 s33, s23, 0xffff
  v_mfma_f32_16x16x32_bf16 v[76:79], v[52:55], a[28:31], v[76:79]
  ds_read_b64_tr_b16 v[46:47], v8 offset:39936
  s_waitcnt lgkmcnt(8)
  v_mfma_f32_16x16x32_bf16 v[80:83], v[56:59], a[16:19], v[80:83]
  ds_read_b64_tr_b16 v[48:49], v9 offset:26624
  s_mov_b32 s34, 0x240000
  v_mfma_f32_16x16x32_bf16 v[80:83], v[60:63], a[24:27], v[80:83]
  ds_read_b64_tr_b16 v[50:51], v9 offset:38912
  global_load_lds_dwordx4 v28, s[56:57] offset:1024
  v_mfma_f32_16x16x32_bf16 v[84:87], v[56:59], a[20:23], v[84:87]
  ds_read_b64_tr_b16 v[52:53], v9 offset:27648
  s_mov_b32 s35, 0x20000
  v_mfma_f32_16x16x32_bf16 v[84:87], v[60:63], a[28:31], v[84:87]
  ds_read_b64_tr_b16 v[54:55], v9 offset:39936
  s_waitcnt lgkmcnt(8)
  v_mfma_f32_16x16x32_bf16 v[88:91], v[32:35], a[16:19], v[88:91]
  ds_read_b64_tr_b16 v[56:57], v10 offset:26624
  s_lshl2_add_u32 s58, s45, s44
  v_mfma_f32_16x16x32_bf16 v[88:91], v[36:39], a[24:27], v[88:91]
  ds_read_b64_tr_b16 v[58:59], v10 offset:38912
  global_load_lds_dwordx4 v29, s[56:57] offset:2048
  v_mfma_f32_16x16x32_bf16 v[92:95], v[32:35], a[20:23], v[92:95]
  ds_read_b64_tr_b16 v[60:61], v10 offset:27648
  s_mul_i32 s56, s84, 1728
  v_mfma_f32_16x16x32_bf16 v[92:95], v[36:39], a[28:31], v[92:95]
  ds_read_b64_tr_b16 v[62:63], v10 offset:39936
  s_waitcnt lgkmcnt(8)
  v_mfma_f32_16x16x32_bf16 v[96:99], v[40:43], a[16:19], v[96:99]
  ds_read_b64_tr_b16 v[32:33], v11 offset:26624
  s_add_u32 s56, s52, s56
  v_mfma_f32_16x16x32_bf16 v[96:99], v[44:47], a[24:27], v[96:99]
  ds_read_b64_tr_b16 v[34:35], v11 offset:38912
  s_addc_u32 s57, s53, 0
  v_mfma_f32_16x16x32_bf16 v[100:103], v[40:43], a[20:23], v[100:103]
  ds_read_b64_tr_b16 v[36:37], v11 offset:27648
  s_add_u32 m0, s50, 73728
  v_mfma_f32_16x16x32_bf16 v[100:103], v[44:47], a[28:31], v[100:103]
  ds_read_b64_tr_b16 v[38:39], v11 offset:39936
  s_waitcnt lgkmcnt(8)
  v_mfma_f32_16x16x32_bf16 v[104:107], v[48:51], a[16:19], v[104:107]
  ds_read_b64_tr_b16 v[40:41], v8 offset:28672
  global_load_lds_dwordx4 v22, s[56:57] offset:0
  v_mfma_f32_16x16x32_bf16 v[104:107], v[52:55], a[24:27], v[104:107]
  ds_read_b64_tr_b16 v[42:43], v8 offset:40960
  s_lshl_b32 s58, s58, 7
  v_mfma_f32_16x16x32_bf16 v[108:111], v[48:51], a[20:23], v[108:111]
  ds_read_b64_tr_b16 v[44:45], v8 offset:29696
  s_waitcnt vmcnt(7) lgkmcnt(7)
  v_mfma_f32_16x16x32_bf16 v[108:111], v[52:55], a[28:31], v[108:111]
  ds_read_b64_tr_b16 v[46:47], v8 offset:41984
  s_barrier
  v_mfma_f32_16x16x32_bf16 v[112:115], v[56:59], a[16:19], v[112:115]
  ds_read_b64_tr_b16 v[48:49], v16 offset:24576
  s_add_u32 s58, s58, 41943040
  v_mfma_f32_16x16x32_bf16 v[112:115], v[60:63], a[24:27], v[112:115]
  ds_read_b64_tr_b16 v[50:51], v16 offset:36864
  v_lshrrev_b32 v24, 0, v1
  v_mfma_f32_16x16x32_bf16 v[116:119], v[56:59], a[20:23], v[116:119]
  ds_read_b64_tr_b16 v[52:53], v16 offset:25600
  global_load_lds_dwordx4 v23, s[56:57] offset:1024
  v_mfma_f32_16x16x32_bf16 v[116:119], v[60:63], a[28:31], v[116:119]
  ds_read_b64_tr_b16 v[54:55], v16 offset:37888
  s_waitcnt lgkmcnt(8)
  v_mfma_f32_16x16x32_bf16 v[120:123], v[32:35], a[16:19], v[120:123]
  ds_read_b64_tr_b16 v[56:57], v17 offset:24576
  v_min_u32 v24, 1, v24
  v_mfma_f32_16x16x32_bf16 v[120:123], v[36:39], a[24:27], v[120:123]
  ds_read_b64_tr_b16 v[58:59], v17 offset:36864
  v_lshl_add_u32 v24, v24, 15, v1
  v_mfma_f32_16x16x32_bf16 v[124:127], v[32:35], a[20:23], v[124:127]
  ds_read_b64_tr_b16 v[60:61], v17 offset:25600
  global_load_lds_dwordx4 v26, s[56:57] offset:2048
  v_mfma_f32_16x16x32_bf16 v[124:127], v[36:39], a[28:31], v[124:127]
  ds_read_b64_tr_b16 v[62:63], v17 offset:37888
  s_waitcnt lgkmcnt(8)
  v_mfma_f32_16x16x32_bf16 v[128:131], v[40:43], a[16:19], v[128:131]
  ds_read_b64_tr_b16 v[32:33], v18 offset:24576
  s_add_u32 m0, s50, 76800
  v_mfma_f32_16x16x32_bf16 v[128:131], v[44:47], a[24:27], v[128:131]
  ds_read_b64_tr_b16 v[34:35], v18 offset:36864
  v_lshl_add_u32 v24, v24, 13, s58
  v_mfma_f32_16x16x32_bf16 v[132:135], v[40:43], a[20:23], v[132:135]
  ds_read_b64_tr_b16 v[36:37], v18 offset:25600
  global_load_lds_dwordx4 v27, s[56:57] offset:0
  v_mfma_f32_16x16x32_bf16 v[132:135], v[44:47], a[28:31], v[132:135]
  ds_read_b64_tr_b16 v[38:39], v18 offset:37888
  s_waitcnt lgkmcnt(8)
  v_mfma_f32_16x16x32_bf16 v[64:67], v[48:51], a[32:35], v[64:67]
  ds_read_b64_tr_b16 v[40:41], v19 offset:24576
  s_lshl2_add_u32 s59, s45, s44
  v_mfma_f32_16x16x32_bf16 v[64:67], v[52:55], a[40:43], v[64:67]
  ds_read_b64_tr_b16 v[42:43], v19 offset:36864
  s_min_u32 s60, s59, 1
  v_mfma_f32_16x16x32_bf16 v[68:71], v[48:51], a[36:39], v[68:71]
  ds_read_b64_tr_b16 v[44:45], v19 offset:25600
  global_load_lds_dwordx4 v28, s[56:57] offset:1024
  v_mfma_f32_16x16x32_bf16 v[68:71], v[52:55], a[44:47], v[68:71]
  ds_read_b64_tr_b16 v[46:47], v19 offset:37888
  s_waitcnt lgkmcnt(8)
  v_mfma_f32_16x16x32_bf16 v[72:75], v[56:59], a[32:35], v[72:75]
  ds_read_b64_tr_b16 v[48:49], v16 offset:26624
  s_lshl_b32 s51, s60, 7
  v_mfma_f32_16x16x32_bf16 v[72:75], v[60:63], a[40:43], v[72:75]
  ds_read_b64_tr_b16 v[50:51], v16 offset:38912
  s_lshl_b32 s66, s61, 2
  v_mfma_f32_16x16x32_bf16 v[76:79], v[56:59], a[36:39], v[76:79]
  ds_read_b64_tr_b16 v[52:53], v16 offset:27648
  global_load_lds_dwordx4 v29, s[56:57] offset:2048
  v_mfma_f32_16x16x32_bf16 v[76:79], v[60:63], a[44:47], v[76:79]
  ds_read_b64_tr_b16 v[54:55], v16 offset:39936
  s_waitcnt lgkmcnt(8)
  v_mfma_f32_16x16x32_bf16 v[80:83], v[32:35], a[32:35], v[80:83]
  ds_read_b64_tr_b16 v[56:57], v17 offset:26624
  s_mul_i32 s56, s85, 1728
  v_mfma_f32_16x16x32_bf16 v[80:83], v[36:39], a[40:43], v[80:83]
  ds_read_b64_tr_b16 v[58:59], v17 offset:38912
  s_add_u32 s56, s52, s56
  v_mfma_f32_16x16x32_bf16 v[84:87], v[32:35], a[36:39], v[84:87]
  ds_read_b64_tr_b16 v[60:61], v17 offset:27648
  s_addc_u32 s57, s53, 0
  v_mfma_f32_16x16x32_bf16 v[84:87], v[36:39], a[44:47], v[84:87]
  ds_read_b64_tr_b16 v[62:63], v17 offset:39936
  s_waitcnt lgkmcnt(8)
  v_mfma_f32_16x16x32_bf16 v[88:91], v[40:43], a[32:35], v[88:91]
  ds_read_b64_tr_b16 v[32:33], v18 offset:26624
  s_add_u32 m0, s50, 98304
  v_mfma_f32_16x16x32_bf16 v[88:91], v[44:47], a[40:43], v[88:91]
  ds_read_b64_tr_b16 v[34:35], v18 offset:38912
  global_load_lds_dwordx4 v22, s[56:57] offset:0
  v_mfma_f32_16x16x32_bf16 v[92:95], v[40:43], a[36:39], v[92:95]
  ds_read_b64_tr_b16 v[36:37], v18 offset:27648
  global_load_lds_dwordx4 v23, s[56:57] offset:1024
  v_mfma_f32_16x16x32_bf16 v[92:95], v[44:47], a[44:47], v[92:95]
  ds_read_b64_tr_b16 v[38:39], v18 offset:39936
  s_waitcnt lgkmcnt(8)
  v_mfma_f32_16x16x32_bf16 v[96:99], v[48:51], a[32:35], v[96:99]
  ds_read_b64_tr_b16 v[40:41], v19 offset:26624
  s_sub_u32 s51, s66, s51
  v_mfma_f32_16x16x32_bf16 v[96:99], v[52:55], a[40:43], v[96:99]
  ds_read_b64_tr_b16 v[42:43], v19 offset:38912
  s_add_u32 s51, s51, 40
  v_mfma_f32_16x16x32_bf16 v[100:103], v[48:51], a[36:39], v[100:103]
  ds_read_b64_tr_b16 v[44:45], v19 offset:27648
  v_add_u32 v21, s51, v24
  v_mfma_f32_16x16x32_bf16 v[100:103], v[52:55], a[44:47], v[100:103]
  ds_read_b64_tr_b16 v[46:47], v19 offset:39936
  s_waitcnt lgkmcnt(8)
  v_mfma_f32_16x16x32_bf16 v[104:107], v[56:59], a[32:35], v[104:107]
  ds_read_b64_tr_b16 v[48:49], v16 offset:28672
  s_mul_i32 s58, s59, 589824
  v_mfma_f32_16x16x32_bf16 v[104:107], v[60:63], a[40:43], v[104:107]
  ds_read_b64_tr_b16 v[50:51], v16 offset:40960
  s_lshl_b32 s51, s46, 10
  v_mfma_f32_16x16x32_bf16 v[108:111], v[56:59], a[36:39], v[108:111]
  ds_read_b64_tr_b16 v[52:53], v16 offset:29696
  s_waitcnt vmcnt(8) lgkmcnt(7)
  v_mfma_f32_16x16x32_bf16 v[108:111], v[60:63], a[44:47], v[108:111]
  ds_read_b64_tr_b16 v[54:55], v16 offset:41984
  s_barrier
  v_mfma_f32_16x16x32_bf16 v[112:115], v[32:35], a[32:35], v[112:115]
  ds_read_b64_tr_b16 v[56:57], v12 offset:0
  s_add_u32 s67, s58, s51
  v_mfma_f32_16x16x32_bf16 v[112:115], v[36:39], a[40:43], v[112:115]
  ds_read_b64_tr_b16 v[58:59], v12 offset:12288
  s_lshl2_add_u32 s59, s59, s61
  v_mfma_f32_16x16x32_bf16 v[116:119], v[32:35], a[36:39], v[116:119]
  ds_read_b64_tr_b16 v[60:61], v12 offset:1024
  global_load_lds_dwordx4 v26, s[56:57] offset:2048
  v_mfma_f32_16x16x32_bf16 v[116:119], v[36:39], a[44:47], v[116:119]
  ds_read_b64_tr_b16 v[62:63], v12 offset:13312
  s_waitcnt lgkmcnt(8)
  v_mfma_f32_16x16x32_bf16 v[120:123], v[40:43], a[32:35], v[120:123]
  ds_read_b64_tr_b16 v[32:33], v13 offset:0
  s_add_u32 m0, s50, 101376
  v_mfma_f32_16x16x32_bf16 v[120:123], v[44:47], a[40:43], v[120:123]
  ds_read_b64_tr_b16 v[34:35], v13 offset:12288
  s_mul_i32 s59, s59, 10240
  v_mfma_f32_16x16x32_bf16 v[124:127], v[40:43], a[36:39], v[124:127]
  ds_read_b64_tr_b16 v[36:37], v13 offset:1024
  global_load_lds_dwordx4 v27, s[56:57] offset:0
  v_mfma_f32_16x16x32_bf16 v[124:127], v[44:47], a[44:47], v[124:127]
  ds_read_b64_tr_b16 v[38:39], v13 offset:13312
  s_waitcnt lgkmcnt(8)
  v_mfma_f32_16x16x32_bf16 v[128:131], v[48:51], a[32:35], v[128:131]
  ds_read_b64_tr_b16 v[40:41], v14 offset:0
  s_add_u32 s59, s59, 42991616
  v_mfma_f32_16x16x32_bf16 v[128:131], v[52:55], a[40:43], v[128:131]
  ds_read_b64_tr_b16 v[42:43], v14 offset:12288
  v_lshl_add_u32 v7, v1, 3, s59
  v_mfma_f32_16x16x32_bf16 v[132:135], v[48:51], a[36:39], v[132:135]
  ds_read_b64_tr_b16 v[44:45], v14 offset:1024
  global_load_lds_dwordx4 v28, s[56:57] offset:1024
  v_mfma_f32_16x16x32_bf16 v[132:135], v[52:55], a[44:47], v[132:135]
  ds_read_b64_tr_b16 v[46:47], v14 offset:13312
  s_waitcnt lgkmcnt(8)
  v_mfma_f32_16x16x32_bf16 v[64:67], v[56:59], a[48:51], v[64:67]
  ds_read_b64_tr_b16 v[48:49], v15 offset:0
  s_mul_i32 s60, s60, 40960
  v_mfma_f32_16x16x32_bf16 v[64:67], v[60:63], a[56:59], v[64:67]
  ds_read_b64_tr_b16 v[50:51], v15 offset:12288
  v_subrev_u32 v20, s60, v7
  v_mfma_f32_16x16x32_bf16 v[68:71], v[56:59], a[52:55], v[68:71]
  ds_read_b64_tr_b16 v[52:53], v15 offset:1024
  global_load_lds_dwordx4 v29, s[56:57] offset:2048
  v_mfma_f32_16x16x32_bf16 v[68:71], v[60:63], a[60:63], v[68:71]
  ds_read_b64_tr_b16 v[54:55], v15 offset:13312
  s_waitcnt lgkmcnt(8)
  v_mfma_f32_16x16x32_bf16 v[72:75], v[32:35], a[48:51], v[72:75]
  ds_read_b64_tr_b16 v[56:57], v12 offset:2048
  s_mul_i32 s56, s86, 1728
  v_mfma_f32_16x16x32_bf16 v[72:75], v[36:39], a[56:59], v[72:75]
  ds_read_b64_tr_b16 v[58:59], v12 offset:14336
  s_add_u32 s56, s52, s56
  v_mfma_f32_16x16x32_bf16 v[76:79], v[32:35], a[52:55], v[76:79]
  ds_read_b64_tr_b16 v[60:61], v12 offset:3072
  s_addc_u32 s57, s53, 0
  v_mfma_f32_16x16x32_bf16 v[76:79], v[36:39], a[60:63], v[76:79]
  ds_read_b64_tr_b16 v[62:63], v12 offset:15360
  s_waitcnt lgkmcnt(8)
  v_mfma_f32_16x16x32_bf16 v[80:83], v[40:43], a[48:51], v[80:83]
  ds_read_b64_tr_b16 v[32:33], v13 offset:2048
  s_add_u32 m0, s50, 0
  v_mfma_f32_16x16x32_bf16 v[80:83], v[44:47], a[56:59], v[80:83]
  ds_read_b64_tr_b16 v[34:35], v13 offset:14336
  global_load_lds_dwordx4 v22, s[56:57] offset:0
  v_mfma_f32_16x16x32_bf16 v[84:87], v[40:43], a[52:55], v[84:87]
  ds_read_b64_tr_b16 v[36:37], v13 offset:3072
  global_load_lds_dwordx4 v23, s[56:57] offset:1024
  v_mfma_f32_16x16x32_bf16 v[84:87], v[44:47], a[60:63], v[84:87]
  ds_read_b64_tr_b16 v[38:39], v13 offset:15360
  s_waitcnt lgkmcnt(8)
  v_mfma_f32_16x16x32_bf16 v[88:91], v[48:51], a[48:51], v[88:91]
  ds_read_b64_tr_b16 v[40:41], v14 offset:2048
  s_mov_b32 s64, 4096
  v_mfma_f32_16x16x32_bf16 v[88:91], v[52:55], a[56:59], v[88:91]
  ds_read_b64_tr_b16 v[42:43], v14 offset:14336
  s_mov_b32 s65, 8192
  v_mfma_f32_16x16x32_bf16 v[92:95], v[48:51], a[52:55], v[92:95]
  ds_read_b64_tr_b16 v[44:45], v14 offset:3072
  global_load_lds_dwordx4 v26, s[56:57] offset:2048
  v_mfma_f32_16x16x32_bf16 v[92:95], v[52:55], a[60:63], v[92:95]
  ds_read_b64_tr_b16 v[46:47], v14 offset:15360
  s_waitcnt lgkmcnt(8)
  v_mfma_f32_16x16x32_bf16 v[96:99], v[56:59], a[48:51], v[96:99]
  ds_read_b64_tr_b16 v[48:49], v15 offset:2048
  s_mul_i32 s58, s61, 144
  v_mfma_f32_16x16x32_bf16 v[96:99], v[60:63], a[56:59], v[96:99]
  ds_read_b64_tr_b16 v[50:51], v15 offset:14336
  s_mul_i32 s59, s44, 40
  v_mfma_f32_16x16x32_bf16 v[100:103], v[56:59], a[52:55], v[100:103]
  ds_read_b64_tr_b16 v[52:53], v15 offset:3072
  s_add_u32 s58, s58, s59
  v_mfma_f32_16x16x32_bf16 v[100:103], v[60:63], a[60:63], v[100:103]
  ds_read_b64_tr_b16 v[54:55], v15 offset:15360
  s_waitcnt lgkmcnt(8)
  v_mfma_f32_16x16x32_bf16 v[104:107], v[32:35], a[48:51], v[104:107]
  ds_read_b64_tr_b16 v[56:57], v12 offset:4096
  s_mul_i32 s68, s58, 1152
  v_mfma_f32_16x16x32_bf16 v[104:107], v[36:39], a[56:59], v[104:107]
  ds_read_b64_tr_b16 v[58:59], v12 offset:16384
  s_mul_i32 s51, s44, 5120
  v_mfma_f32_16x16x32_bf16 v[108:111], v[32:35], a[52:55], v[108:111]
  ds_read_b64_tr_b16 v[60:61], v12 offset:5120
  s_waitcnt vmcnt(9) lgkmcnt(7)
  v_mfma_f32_16x16x32_bf16 v[108:111], v[36:39], a[60:63], v[108:111]
  ds_read_b64_tr_b16 v[62:63], v12 offset:17408
  s_barrier
  v_mfma_f32_16x16x32_bf16 v[112:115], v[40:43], a[48:51], v[112:115]
  ds_read_b64_tr_b16 v[32:33], v12 offset:24576
  s_add_u32 m0, s50, 3072
  v_mfma_f32_16x16x32_bf16 v[112:115], v[44:47], a[56:59], v[112:115]
  ds_read_b64_tr_b16 v[34:35], v12 offset:36864
  v_lshrrev_b32 v136, 3, v1
  v_mfma_f32_16x16x32_bf16 v[116:119], v[40:43], a[52:55], v[116:119]
  ds_read_b64_tr_b16 v[36:37], v12 offset:25600
  v_and_b32 v137, 6, v136
  v_mfma_f32_16x16x32_bf16 v[116:119], v[44:47], a[60:63], v[116:119]
  ds_read_b64_tr_b16 v[38:39], v12 offset:37888
  s_waitcnt lgkmcnt(8)
  v_mfma_f32_16x16x32_bf16 v[120:123], v[48:51], a[48:51], v[120:123]
  ds_read_b64_tr_b16 v[40:41], v13 offset:24576
  v_xor_b32 v137, v137, v1
  v_mfma_f32_16x16x32_bf16 v[120:123], v[52:55], a[56:59], v[120:123]
  ds_read_b64_tr_b16 v[42:43], v13 offset:36864
  global_load_lds_dwordx4 v27, s[56:57] offset:0
  v_mfma_f32_16x16x32_bf16 v[124:127], v[48:51], a[52:55], v[124:127]
  ds_read_b64_tr_b16 v[44:45], v13 offset:25600
  v_and_b32 v137, 7, v137
  v_mfma_f32_16x16x32_bf16 v[124:127], v[52:55], a[60:63], v[124:127]
  ds_read_b64_tr_b16 v[46:47], v13 offset:37888
  s_waitcnt lgkmcnt(8)
  v_mfma_f32_16x16x32_bf16 v[128:131], v[56:59], a[48:51], v[128:131]
  ds_read_b64_tr_b16 v[48:49], v14 offset:24576
  v_mul_u32_u24 v136, 1152, v136
  v_mfma_f32_16x16x32_bf16 v[128:131], v[60:63], a[56:59], v[128:131]
  ds_read_b64_tr_b16 v[50:51], v14 offset:36864
  global_load_lds_dwordx4 v28, s[56:57] offset:1024
  v_mfma_f32_16x16x32_bf16 v[132:135], v[56:59], a[52:55], v[132:135]
  ds_read_b64_tr_b16 v[52:53], v14 offset:25600
  v_lshl_add_u32 v2, v137, 4, v136
  v_mfma_f32_16x16x32_bf16 v[132:135], v[60:63], a[60:63], v[132:135]
  ds_read_b64_tr_b16 v[54:55], v14 offset:37888
  s_waitcnt lgkmcnt(8)
  v_mfma_f32_16x16x32_bf16 v[64:67], v[32:35], a[64:67], v[64:67]
  ds_read_b64_tr_b16 v[56:57], v15 offset:24576
  s_add_u32 s58, s44, 1
  v_mfma_f32_16x16x32_bf16 v[64:67], v[36:39], a[72:75], v[64:67]
  ds_read_b64_tr_b16 v[58:59], v15 offset:36864
  global_load_lds_dwordx4 v29, s[56:57] offset:2048
  v_mfma_f32_16x16x32_bf16 v[68:71], v[32:35], a[68:71], v[68:71]
  ds_read_b64_tr_b16 v[60:61], v15 offset:25600
  s_mul_i32 s56, s87, 1728
  v_mfma_f32_16x16x32_bf16 v[68:71], v[36:39], a[76:79], v[68:71]
  ds_read_b64_tr_b16 v[62:63], v15 offset:37888
  s_waitcnt lgkmcnt(8)
  v_mfma_f32_16x16x32_bf16 v[72:75], v[40:43], a[64:67], v[72:75]
  ds_read_b64_tr_b16 v[32:33], v12 offset:26624
  s_add_u32 s56, s52, s56
  v_mfma_f32_16x16x32_bf16 v[72:75], v[44:47], a[72:75], v[72:75]
  ds_read_b64_tr_b16 v[34:35], v12 offset:38912
  s_addc_u32 s57, s53, 0
  v_mfma_f32_16x16x32_bf16 v[76:79], v[40:43], a[68:71], v[76:79]
  ds_read_b64_tr_b16 v[36:37], v12 offset:27648
  s_add_u32 m0, s50, 24576
  v_mfma_f32_16x16x32_bf16 v[76:79], v[44:47], a[76:79], v[76:79]
  ds_read_b64_tr_b16 v[38:39], v12 offset:39936
  s_waitcnt lgkmcnt(8)
  v_mfma_f32_16x16x32_bf16 v[80:83], v[48:51], a[64:67], v[80:83]
  ds_read_b64_tr_b16 v[40:41], v13 offset:26624
  global_load_lds_dwordx4 v22, s[56:57] offset:0
  v_mfma_f32_16x16x32_bf16 v[80:83], v[52:55], a[72:75], v[80:83]
  ds_read_b64_tr_b16 v[42:43], v13 offset:38912
  global_load_lds_dwordx4 v23, s[56:57] offset:1024
  v_mfma_f32_16x16x32_bf16 v[84:87], v[48:51], a[68:71], v[84:87]
  ds_read_b64_tr_b16 v[44:45], v13 offset:27648
  s_lshr_b32 s58, s58, 2
  v_mfma_f32_16x16x32_bf16 v[84:87], v[52:55], a[76:79], v[84:87]
  ds_read_b64_tr_b16 v[46:47], v13 offset:39936
  s_waitcnt lgkmcnt(8)
  v_mfma_f32_16x16x32_bf16 v[88:91], v[56:59], a[64:67], v[88:91]
  ds_read_b64_tr_b16 v[48:49], v14 offset:26624
  s_mul_i32 s58, s58, 18432
  v_mfma_f32_16x16x32_bf16 v[88:91], v[60:63], a[72:75], v[88:91]
  ds_read_b64_tr_b16 v[50:51], v14 offset:38912
  global_load_lds_dwordx4 v26, s[56:57] offset:2048
  v_mfma_f32_16x16x32_bf16 v[92:95], v[56:59], a[68:71], v[92:95]
  ds_read_b64_tr_b16 v[52:53], v14 offset:27648
  s_add_u32 m0, s50, 27648
  v_mfma_f32_16x16x32_bf16 v[92:95], v[60:63], a[76:79], v[92:95]
  ds_read_b64_tr_b16 v[54:55], v14 offset:39936
  s_waitcnt lgkmcnt(8)
  v_mfma_f32_16x16x32_bf16 v[96:99], v[32:35], a[64:67], v[96:99]
  ds_read_b64_tr_b16 v[56:57], v15 offset:26624
  v_add_u32 v3, 8192, v2
  v_mfma_f32_16x16x32_bf16 v[96:99], v[36:39], a[72:75], v[96:99]
  ds_read_b64_tr_b16 v[58:59], v15 offset:38912
  global_load_lds_dwordx4 v27, s[56:57] offset:0
  v_mfma_f32_16x16x32_bf16 v[100:103], v[32:35], a[68:71], v[100:103]
  ds_read_b64_tr_b16 v[60:61], v15 offset:27648
  v_add_u32 v4, 16384, v2
  v_mfma_f32_16x16x32_bf16 v[100:103], v[36:39], a[76:79], v[100:103]
  ds_read_b64_tr_b16 v[62:63], v15 offset:39936
  s_waitcnt lgkmcnt(8)
  v_mfma_f32_16x16x32_bf16 v[104:107], v[40:43], a[64:67], v[104:107]
  ds_read_b64_tr_b16 v[32:33], v12 offset:28672
  s_sub_u32 s59, 24576, s58
  v_mfma_f32_16x16x32_bf16 v[104:107], v[44:47], a[72:75], v[104:107]
  ds_read_b64_tr_b16 v[34:35], v12 offset:40960
  v_add_u32 v5, s59, v2
  v_mfma_f32_16x16x32_bf16 v[108:111], v[40:43], a[68:71], v[108:111]
  ds_read_b64_tr_b16 v[36:37], v12 offset:29696
  s_waitcnt vmcnt(10) lgkmcnt(7)
  v_mfma_f32_16x16x32_bf16 v[108:111], v[44:47], a[76:79], v[108:111]
  ds_read_b64_tr_b16 v[38:39], v12 offset:41984
  s_barrier
  v_mfma_f32_16x16x32_bf16 v[112:115], v[48:51], a[64:67], v[112:115]
  ds_read_b64_tr_b16 v[40:41], v16 offset:0
  s_sub_u32 s59, 36864, s58
  v_mfma_f32_16x16x32_bf16 v[112:115], v[52:55], a[72:75], v[112:115]
  ds_read_b64_tr_b16 v[42:43], v16 offset:12288
  v_add_u32 v6, s59, v2
  v_mfma_f32_16x16x32_bf16 v[116:119], v[48:51], a[68:71], v[116:119]
  ds_read_b64_tr_b16 v[44:45], v16 offset:1024
  global_load_lds_dwordx4 v28, s[56:57] offset:1024
  v_mfma_f32_16x16x32_bf16 v[116:119], v[52:55], a[76:79], v[116:119]
  ds_read_b64_tr_b16 v[46:47], v16 offset:13312
  s_waitcnt lgkmcnt(8)
  v_mfma_f32_16x16x32_bf16 v[120:123], v[56:59], a[64:67], v[120:123]
  ds_read_b64_tr_b16 v[48:49], v17 offset:0
  s_mul_i32 s58, s44, 192
  v_mfma_f32_16x16x32_bf16 v[120:123], v[60:63], a[72:75], v[120:123]
  ds_read_b64_tr_b16 v[50:51], v17 offset:12288
  s_add_u32 s58, s58, 147456
  v_mfma_f32_16x16x32_bf16 v[124:127], v[56:59], a[68:71], v[124:127]
  ds_read_b64_tr_b16 v[52:53], v17 offset:1024
  global_load_lds_dwordx4 v29, s[56:57] offset:2048
  v_mfma_f32_16x16x32_bf16 v[124:127], v[60:63], a[76:79], v[124:127]
  ds_read_b64_tr_b16 v[54:55], v17 offset:13312
  s_waitcnt lgkmcnt(8)
  v_mfma_f32_16x16x32_bf16 v[128:131], v[32:35], a[64:67], v[128:131]
  ds_read_b64_tr_b16 v[56:57], v18 offset:0
  s_mul_i32 s56, s88, 1728
  v_mfma_f32_16x16x32_bf16 v[128:131], v[36:39], a[72:75], v[128:131]
  ds_read_b64_tr_b16 v[58:59], v18 offset:12288
  s_add_u32 s56, s52, s56
  v_mfma_f32_16x16x32_bf16 v[132:135], v[32:35], a[68:71], v[132:135]
  ds_read_b64_tr_b16 v[60:61], v18 offset:1024
  s_addc_u32 s57, s53, 0
  v_mfma_f32_16x16x32_bf16 v[132:135], v[36:39], a[76:79], v[132:135]
  ds_read_b64_tr_b16 v[62:63], v18 offset:13312
  s_waitcnt lgkmcnt(8)
  v_mfma_f32_16x16x32_bf16 v[64:67], v[40:43], a[80:83], v[64:67]
  ds_read_b64_tr_b16 v[32:33], v19 offset:0
  s_add_u32 m0, s50, 122880
  v_mfma_f32_16x16x32_bf16 v[64:67], v[44:47], a[88:91], v[64:67]
  ds_read_b64_tr_b16 v[34:35], v19 offset:12288
  global_load_lds_dwordx4 v22, s[56:57] offset:0
  v_mfma_f32_16x16x32_bf16 v[68:71], v[40:43], a[84:87], v[68:71]
  ds_read_b64_tr_b16 v[36:37], v19 offset:1024
  global_load_lds_dwordx4 v23, s[56:57] offset:1024
  v_mfma_f32_16x16x32_bf16 v[68:71], v[44:47], a[92:95], v[68:71]
  ds_read_b64_tr_b16 v[38:39], v19 offset:13312
  s_waitcnt lgkmcnt(8)
  v_mfma_f32_16x16x32_bf16 v[72:75], v[48:51], a[80:83], v[72:75]
  ds_read_b64_tr_b16 v[40:41], v16 offset:2048
  v_and_b32 v25, 15, v1
  v_mfma_f32_16x16x32_bf16 v[72:75], v[52:55], a[88:91], v[72:75]
  ds_read_b64_tr_b16 v[42:43], v16 offset:14336
  v_lshl_add_u32 v25, v25, 2, s58
  v_mfma_f32_16x16x32_bf16 v[76:79], v[48:51], a[84:87], v[76:79]
  ds_read_b64_tr_b16 v[44:45], v16 offset:3072
  global_load_lds_dwordx4 v26, s[56:57] offset:2048
  v_mfma_f32_16x16x32_bf16 v[76:79], v[52:55], a[92:95], v[76:79]
  ds_read_b64_tr_b16 v[46:47], v16 offset:15360
  s_waitcnt lgkmcnt(8)
  v_mfma_f32_16x16x32_bf16 v[80:83], v[56:59], a[80:83], v[80:83]
  ds_read_b64_tr_b16 v[48:49], v17 offset:2048
  s_add_u32 m0, s50, 125952
  v_mfma_f32_16x16x32_bf16 v[80:83], v[60:63], a[88:91], v[80:83]
  ds_read_b64_tr_b16 v[50:51], v17 offset:14336
  v_and_b32 v136, 48, v1
  v_mfma_f32_16x16x32_bf16 v[84:87], v[56:59], a[84:87], v[84:87]
  ds_read_b64_tr_b16 v[52:53], v17 offset:3072
  global_load_lds_dwordx4 v27, s[56:57] offset:0
  v_mfma_f32_16x16x32_bf16 v[84:87], v[60:63], a[92:95], v[84:87]
  ds_read_b64_tr_b16 v[54:55], v17 offset:15360
  s_waitcnt lgkmcnt(8)
  v_mfma_f32_16x16x32_bf16 v[88:91], v[32:35], a[80:83], v[88:91]
  ds_read_b64_tr_b16 v[56:57], v18 offset:2048
  v_lshlrev_b32 v136, 2, v136
  v_mfma_f32_16x16x32_bf16 v[88:91], v[36:39], a[88:91], v[88:91]
  ds_read_b64_tr_b16 v[58:59], v18 offset:14336
  v_mov_b32 v139, 1
  v_mfma_f32_16x16x32_bf16 v[92:95], v[32:35], a[84:87], v[92:95]
  ds_read_b64_tr_b16 v[60:61], v18 offset:3072
  global_load_lds_dwordx4 v28, s[56:57] offset:1024
  v_mfma_f32_16x16x32_bf16 v[92:95], v[36:39], a[92:95], v[92:95]
  ds_read_b64_tr_b16 v[62:63], v18 offset:15360
  s_waitcnt lgkmcnt(8)
  v_mfma_f32_16x16x32_bf16 v[96:99], v[40:43], a[80:83], v[96:99]
  ds_read_b64_tr_b16 v[32:33], v19 offset:2048
  ds_read_b32 v138, v25 offset:128
  v_mfma_f32_16x16x32_bf16 v[96:99], v[44:47], a[88:91], v[96:99]
  ds_read_b64_tr_b16 v[34:35], v19 offset:14336
  buffer_load_dword v137, v136, s[36:39], 0 offen sc1
  v_mfma_f32_16x16x32_bf16 v[100:103], v[40:43], a[84:87], v[100:103]
  ds_read_b64_tr_b16 v[36:37], v19 offset:3072
  v_mfma_f32_16x16x32_bf16 v[100:103], v[44:47], a[92:95], v[100:103]
  ds_read_b64_tr_b16 v[38:39], v19 offset:15360
  s_waitcnt lgkmcnt(9)
  v_mfma_f32_16x16x32_bf16 v[104:107], v[48:51], a[80:83], v[104:107]
  ds_read_b64_tr_b16 v[40:41], v16 offset:4096
  v_mfma_f32_16x16x32_bf16 v[104:107], v[52:55], a[88:91], v[104:107]
  ds_read_b64_tr_b16 v[42:43], v16 offset:16384
  v_mfma_f32_16x16x32_bf16 v[108:111], v[48:51], a[84:87], v[108:111]
  ds_read_b64_tr_b16 v[44:45], v16 offset:5120
  s_waitcnt vmcnt(12) lgkmcnt(8)
  v_mfma_f32_16x16x32_bf16 v[108:111], v[52:55], a[92:95], v[108:111]
  ds_read_b64_tr_b16 v[46:47], v16 offset:17408
  s_barrier
  v_mfma_f32_16x16x32_bf16 v[112:115], v[56:59], a[80:83], v[112:115]
  ds_read_b64_tr_b16 v[48:49], v8 offset:0
  v_mfma_f32_16x16x32_bf16 v[112:115], v[60:63], a[88:91], v[112:115]
  ds_read_b64_tr_b16 v[50:51], v8 offset:12288
  v_mfma_f32_16x16x32_bf16 v[116:119], v[56:59], a[84:87], v[116:119]
  ds_read_b64_tr_b16 v[52:53], v8 offset:1024
  global_load_lds_dwordx4 v29, s[56:57] offset:2048
  v_mfma_f32_16x16x32_bf16 v[116:119], v[60:63], a[92:95], v[116:119]
  ds_read_b64_tr_b16 v[54:55], v8 offset:13312
  s_waitcnt lgkmcnt(8)
  v_mfma_f32_16x16x32_bf16 v[120:123], v[32:35], a[80:83], v[120:123]
  ds_read_b64_tr_b16 v[56:57], v9 offset:0
  s_mul_i32 s56, s80, 1728
  v_mfma_f32_16x16x32_bf16 v[120:123], v[36:39], a[88:91], v[120:123]
  ds_read_b64_tr_b16 v[58:59], v9 offset:12288
  s_add_u32 s52, s52, 1152
  v_mfma_f32_16x16x32_bf16 v[124:127], v[32:35], a[84:87], v[124:127]
  ds_read_b64_tr_b16 v[60:61], v9 offset:1024
  s_addc_u32 s53, s53, 0
  v_mfma_f32_16x16x32_bf16 v[124:127], v[36:39], a[92:95], v[124:127]
  ds_read_b64_tr_b16 v[62:63], v9 offset:13312
  s_waitcnt lgkmcnt(8)
  v_mfma_f32_16x16x32_bf16 v[128:131], v[40:43], a[80:83], v[128:131]
  ds_read_b64_tr_b16 v[32:33], v10 offset:0
  s_add_u32 s56, s52, s56
  v_mfma_f32_16x16x32_bf16 v[128:131], v[44:47], a[88:91], v[128:131]
  ds_read_b64_tr_b16 v[34:35], v10 offset:12288
  s_addc_u32 s57, s53, 0
  v_mfma_f32_16x16x32_bf16 v[132:135], v[40:43], a[84:87], v[132:135]
  ds_read_b64_tr_b16 v[36:37], v10 offset:1024
  s_add_u32 m0, s50, 49152
  v_mfma_f32_16x16x32_bf16 v[132:135], v[44:47], a[92:95], v[132:135]
  ds_read_b64_tr_b16 v[38:39], v10 offset:13312
  s_waitcnt lgkmcnt(8)
  v_mfma_f32_16x16x32_bf16 v[64:67], v[48:51], a[96:99], v[64:67]
  ds_read_b64_tr_b16 v[40:41], v11 offset:0
  global_load_lds_dwordx4 v22, s[56:57] offset:0
  v_mfma_f32_16x16x32_bf16 v[64:67], v[52:55], a[104:107], v[64:67]
  ds_read_b64_tr_b16 v[42:43], v11 offset:12288
  global_load_lds_dwordx4 v23, s[56:57] offset:1024
  v_mfma_f32_16x16x32_bf16 v[68:71], v[48:51], a[100:103], v[68:71]
  ds_read_b64_tr_b16 v[44:45], v11 offset:1024
  global_load_lds_dwordx4 v26, s[56:57] offset:2048
  v_mfma_f32_16x16x32_bf16 v[68:71], v[52:55], a[108:111], v[68:71]
  ds_read_b64_tr_b16 v[46:47], v11 offset:13312
  s_waitcnt lgkmcnt(8)
  v_mfma_f32_16x16x32_bf16 v[72:75], v[56:59], a[96:99], v[72:75]
  ds_read_b64_tr_b16 v[48:49], v8 offset:2048
  s_add_u32 m0, s50, 52224
  v_mfma_f32_16x16x32_bf16 v[72:75], v[60:63], a[104:107], v[72:75]
  ds_read_b64_tr_b16 v[50:51], v8 offset:14336
  v_mfma_f32_16x16x32_bf16 v[76:79], v[56:59], a[100:103], v[76:79]
  ds_read_b64_tr_b16 v[52:53], v8 offset:3072
  global_load_lds_dwordx4 v27, s[56:57] offset:0
  v_mfma_f32_16x16x32_bf16 v[76:79], v[60:63], a[108:111], v[76:79]
  ds_read_b64_tr_b16 v[54:55], v8 offset:15360
  s_waitcnt lgkmcnt(8)
  v_mfma_f32_16x16x32_bf16 v[80:83], v[32:35], a[96:99], v[80:83]
  ds_read_b64_tr_b16 v[56:57], v9 offset:2048
  v_mfma_f32_16x16x32_bf16 v[80:83], v[36:39], a[104:107], v[80:83]
  ds_read_b64_tr_b16 v[58:59], v9 offset:14336
  v_mfma_f32_16x16x32_bf16 v[84:87], v[32:35], a[100:103], v[84:87]
  ds_read_b64_tr_b16 v[60:61], v9 offset:3072
  global_load_lds_dwordx4 v28, s[56:57] offset:1024
  v_mfma_f32_16x16x32_bf16 v[84:87], v[36:39], a[108:111], v[84:87]
  ds_read_b64_tr_b16 v[62:63], v9 offset:15360
  s_waitcnt lgkmcnt(8)
  v_mfma_f32_16x16x32_bf16 v[88:91], v[40:43], a[96:99], v[88:91]
  ds_read_b64_tr_b16 v[32:33], v10 offset:2048
  v_mfma_f32_16x16x32_bf16 v[88:91], v[44:47], a[104:107], v[88:91]
  ds_read_b64_tr_b16 v[34:35], v10 offset:14336
  v_mfma_f32_16x16x32_bf16 v[92:95], v[40:43], a[100:103], v[92:95]
  ds_read_b64_tr_b16 v[36:37], v10 offset:3072
  global_load_lds_dwordx4 v29, s[56:57] offset:2048
  v_mfma_f32_16x16x32_bf16 v[92:95], v[44:47], a[108:111], v[92:95]
  ds_read_b64_tr_b16 v[38:39], v10 offset:15360
  s_waitcnt lgkmcnt(8)
  v_mfma_f32_16x16x32_bf16 v[96:99], v[48:51], a[96:99], v[96:99]
  ds_read_b64_tr_b16 v[40:41], v11 offset:2048
  v_mfma_f32_16x16x32_bf16 v[96:99], v[52:55], a[104:107], v[96:99]
  ds_read_b64_tr_b16 v[42:43], v11 offset:14336
  v_mfma_f32_16x16x32_bf16 v[100:103], v[48:51], a[100:103], v[100:103]
  ds_read_b64_tr_b16 v[44:45], v11 offset:3072
  v_mfma_f32_16x16x32_bf16 v[100:103], v[52:55], a[108:111], v[100:103]
  ds_read_b64_tr_b16 v[46:47], v11 offset:15360
  s_waitcnt lgkmcnt(8)
  v_mfma_f32_16x16x32_bf16 v[104:107], v[56:59], a[96:99], v[104:107]
  ds_read_b64_tr_b16 v[48:49], v8 offset:4096
  v_mfma_f32_16x16x32_bf16 v[104:107], v[60:63], a[104:107], v[104:107]
  ds_read_b64_tr_b16 v[50:51], v8 offset:16384
  v_mfma_f32_16x16x32_bf16 v[108:111], v[56:59], a[100:103], v[108:111]
  ds_read_b64_tr_b16 v[52:53], v8 offset:5120
  s_waitcnt vmcnt(13) lgkmcnt(7)
  v_mfma_f32_16x16x32_bf16 v[108:111], v[60:63], a[108:111], v[108:111]
  ds_read_b64_tr_b16 v[54:55], v8 offset:17408
  s_barrier
  v_mfma_f32_16x16x32_bf16 v[112:115], v[32:35], a[96:99], v[112:115]
  ds_read_b64_tr_b16 v[56:57], v8 offset:24576
  s_mul_i32 s56, s81, 1728
  v_mfma_f32_16x16x32_bf16 v[112:115], v[36:39], a[104:107], v[112:115]
  ds_read_b64_tr_b16 v[58:59], v8 offset:36864
  s_add_u32 s56, s52, s56
  v_mfma_f32_16x16x32_bf16 v[116:119], v[32:35], a[100:103], v[116:119]
  ds_read_b64_tr_b16 v[60:61], v8 offset:25600
  s_addc_u32 s57, s53, 0
  v_mfma_f32_16x16x32_bf16 v[116:119], v[36:39], a[108:111], v[116:119]
  ds_read_b64_tr_b16 v[62:63], v8 offset:37888
  s_waitcnt lgkmcnt(8)
  v_mfma_f32_16x16x32_bf16 v[120:123], v[40:43], a[96:99], v[120:123]
  ds_read_b64_tr_b16 v[32:33], v9 offset:24576
  s_add_u32 m0, s50, 73728
  v_mfma_f32_16x16x32_bf16 v[120:123], v[44:47], a[104:107], v[120:123]
  ds_read_b64_tr_b16 v[34:35], v9 offset:36864
  global_load_lds_dwordx4 v22, s[56:57] offset:0
  v_mfma_f32_16x16x32_bf16 v[124:127], v[40:43], a[100:103], v[124:127]
  ds_read_b64_tr_b16 v[36:37], v9 offset:25600
  v_mfma_f32_16x16x32_bf16 v[124:127], v[44:47], a[108:111], v[124:127]
  ds_read_b64_tr_b16 v[38:39], v9 offset:37888
  s_waitcnt lgkmcnt(8)
  v_mfma_f32_16x16x32_bf16 v[128:131], v[48:51], a[96:99], v[128:131]
  ds_read_b64_tr_b16 v[40:41], v10 offset:24576
  v_mfma_f32_16x16x32_bf16 v[128:131], v[52:55], a[104:107], v[128:131]
  ds_read_b64_tr_b16 v[42:43], v10 offset:36864
  v_mfma_f32_16x16x32_bf16 v[132:135], v[48:51], a[100:103], v[132:135]
  ds_read_b64_tr_b16 v[44:45], v10 offset:25600
  global_load_lds_dwordx4 v23, s[56:57] offset:1024
  v_mfma_f32_16x16x32_bf16 v[132:135], v[52:55], a[108:111], v[132:135]
  ds_read_b64_tr_b16 v[46:47], v10 offset:37888
  s_waitcnt lgkmcnt(8)
  v_mfma_f32_16x16x32_bf16 v[64:67], v[56:59], a[112:115], v[64:67]
  ds_read_b64_tr_b16 v[48:49], v11 offset:24576
  v_mfma_f32_16x16x32_bf16 v[64:67], v[60:63], a[120:123], v[64:67]
  ds_read_b64_tr_b16 v[50:51], v11 offset:36864
  v_mfma_f32_16x16x32_bf16 v[68:71], v[56:59], a[116:119], v[68:71]
  ds_read_b64_tr_b16 v[52:53], v11 offset:25600
  v_mfma_f32_16x16x32_bf16 v[68:71], v[60:63], a[124:127], v[68:71]
  ds_read_b64_tr_b16 v[54:55], v11 offset:37888
  s_waitcnt lgkmcnt(8)
  v_mfma_f32_16x16x32_bf16 v[72:75], v[32:35], a[112:115], v[72:75]
  ds_read_b64_tr_b16 v[56:57], v8 offset:26624
  global_load_lds_dwordx4 v26, s[56:57] offset:2048
  v_mfma_f32_16x16x32_bf16 v[72:75], v[36:39], a[120:123], v[72:75]
  ds_read_b64_tr_b16 v[58:59], v8 offset:38912
  s_add_u32 m0, s50, 76800
  v_mfma_f32_16x16x32_bf16 v[76:79], v[32:35], a[116:119], v[76:79]
  ds_read_b64_tr_b16 v[60:61], v8 offset:27648
  v_mfma_f32_16x16x32_bf16 v[76:79], v[36:39], a[124:127], v[76:79]
  ds_read_b64_tr_b16 v[62:63], v8 offset:39936
  s_waitcnt lgkmcnt(8)
  v_mfma_f32_16x16x32_bf16 v[80:83], v[40:43], a[112:115], v[80:83]
  ds_read_b64_tr_b16 v[32:33], v9 offset:26624
  global_load_lds_dwordx4 v27, s[56:57] offset:0
  v_mfma_f32_16x16x32_bf16 v[80:83], v[44:47], a[120:123], v[80:83]
  ds_read_b64_tr_b16 v[34:35], v9 offset:38912
  v_mfma_f32_16x16x32_bf16 v[84:87], v[40:43], a[116:119], v[84:87]
  ds_read_b64_tr_b16 v[36:37], v9 offset:27648
  v_mfma_f32_16x16x32_bf16 v[84:87], v[44:47], a[124:127], v[84:87]
  ds_read_b64_tr_b16 v[38:39], v9 offset:39936
  s_waitcnt lgkmcnt(8)
  v_mfma_f32_16x16x32_bf16 v[88:91], v[48:51], a[112:115], v[88:91]
  ds_read_b64_tr_b16 v[40:41], v10 offset:26624
  v_mfma_f32_16x16x32_bf16 v[88:91], v[52:55], a[120:123], v[88:91]
  ds_read_b64_tr_b16 v[42:43], v10 offset:38912
  global_load_lds_dwordx4 v28, s[56:57] offset:1024
  v_mfma_f32_16x16x32_bf16 v[92:95], v[48:51], a[116:119], v[92:95]
  ds_read_b64_tr_b16 v[44:45], v10 offset:27648
  v_mfma_f32_16x16x32_bf16 v[92:95], v[52:55], a[124:127], v[92:95]
  ds_read_b64_tr_b16 v[46:47], v10 offset:39936
  s_waitcnt lgkmcnt(8)
  v_mfma_f32_16x16x32_bf16 v[96:99], v[56:59], a[112:115], v[96:99]
  ds_read_b64_tr_b16 v[48:49], v11 offset:26624
  v_mfma_f32_16x16x32_bf16 v[96:99], v[60:63], a[120:123], v[96:99]
  ds_read_b64_tr_b16 v[50:51], v11 offset:38912
  v_mfma_f32_16x16x32_bf16 v[100:103], v[56:59], a[116:119], v[100:103]
  ds_read_b64_tr_b16 v[52:53], v11 offset:27648
  global_load_lds_dwordx4 v29, s[56:57] offset:2048
  v_mfma_f32_16x16x32_bf16 v[100:103], v[60:63], a[124:127], v[100:103]
  ds_read_b64_tr_b16 v[54:55], v11 offset:39936
  s_waitcnt lgkmcnt(8)
  v_mfma_f32_16x16x32_bf16 v[104:107], v[32:35], a[112:115], v[104:107]
  ds_read_b64_tr_b16 v[56:57], v8 offset:28672
  v_mfma_f32_16x16x32_bf16 v[104:107], v[36:39], a[120:123], v[104:107]
  ds_read_b64_tr_b16 v[58:59], v8 offset:40960
  v_mfma_f32_16x16x32_bf16 v[108:111], v[32:35], a[116:119], v[108:111]
  ds_read_b64_tr_b16 v[60:61], v8 offset:29696
  s_waitcnt vmcnt(12) lgkmcnt(7)
  v_mfma_f32_16x16x32_bf16 v[108:111], v[36:39], a[124:127], v[108:111]
  ds_read_b64_tr_b16 v[62:63], v8 offset:41984
  s_barrier
  v_mfma_f32_16x16x32_bf16 v[112:115], v[40:43], a[112:115], v[112:115]
  ds_read_b64_tr_b16 v[32:33], v16 offset:24576
  s_mul_i32 s56, s82, 1728
  v_mfma_f32_16x16x32_bf16 v[112:115], v[44:47], a[120:123], v[112:115]
  ds_read_b64_tr_b16 v[34:35], v16 offset:36864
  s_add_u32 s56, s52, s56
  v_mfma_f32_16x16x32_bf16 v[116:119], v[40:43], a[116:119], v[116:119]
  ds_read_b64_tr_b16 v[36:37], v16 offset:25600
  s_addc_u32 s57, s53, 0
  v_mfma_f32_16x16x32_bf16 v[116:119], v[44:47], a[124:127], v[116:119]
  ds_read_b64_tr_b16 v[38:39], v16 offset:37888
  s_waitcnt lgkmcnt(8)
  v_mfma_f32_16x16x32_bf16 v[120:123], v[48:51], a[112:115], v[120:123]
  ds_read_b64_tr_b16 v[40:41], v17 offset:24576
  s_add_u32 m0, s50, 98304
  v_mfma_f32_16x16x32_bf16 v[120:123], v[52:55], a[120:123], v[120:123]
  ds_read_b64_tr_b16 v[42:43], v17 offset:36864
  global_load_lds_dwordx4 v22, s[56:57] offset:0
  v_mfma_f32_16x16x32_bf16 v[124:127], v[48:51], a[116:119], v[124:127]
  ds_read_b64_tr_b16 v[44:45], v17 offset:25600
  v_mfma_f32_16x16x32_bf16 v[124:127], v[52:55], a[124:127], v[124:127]
  ds_read_b64_tr_b16 v[46:47], v17 offset:37888
  s_waitcnt lgkmcnt(8)
  v_mfma_f32_16x16x32_bf16 v[128:131], v[56:59], a[112:115], v[128:131]
  ds_read_b64_tr_b16 v[48:49], v18 offset:24576
  v_mfma_f32_16x16x32_bf16 v[128:131], v[60:63], a[120:123], v[128:131]
  ds_read_b64_tr_b16 v[50:51], v18 offset:36864
  v_mfma_f32_16x16x32_bf16 v[132:135], v[56:59], a[116:119], v[132:135]
  ds_read_b64_tr_b16 v[52:53], v18 offset:25600
  global_load_lds_dwordx4 v23, s[56:57] offset:1024
  v_mfma_f32_16x16x32_bf16 v[132:135], v[60:63], a[124:127], v[132:135]
  ds_read_b64_tr_b16 v[54:55], v18 offset:37888
  s_waitcnt lgkmcnt(8)
  v_mfma_f32_16x16x32_bf16 v[64:67], v[32:35], a[128:131], v[64:67]
  ds_read_b64_tr_b16 v[56:57], v19 offset:24576
  v_mfma_f32_16x16x32_bf16 v[64:67], v[36:39], a[136:139], v[64:67]
  ds_read_b64_tr_b16 v[58:59], v19 offset:36864
  v_mfma_f32_16x16x32_bf16 v[68:71], v[32:35], a[132:135], v[68:71]
  ds_read_b64_tr_b16 v[60:61], v19 offset:25600
  v_mfma_f32_16x16x32_bf16 v[68:71], v[36:39], a[140:143], v[68:71]
  ds_read_b64_tr_b16 v[62:63], v19 offset:37888
  s_waitcnt lgkmcnt(8)
  v_mfma_f32_16x16x32_bf16 v[72:75], v[40:43], a[128:131], v[72:75]
  ds_read_b64_tr_b16 v[32:33], v16 offset:26624
  global_load_lds_dwordx4 v26, s[56:57] offset:2048
  v_mfma_f32_16x16x32_bf16 v[72:75], v[44:47], a[136:139], v[72:75]
  ds_read_b64_tr_b16 v[34:35], v16 offset:38912
  s_add_u32 m0, s50, 101376
  v_mfma_f32_16x16x32_bf16 v[76:79], v[40:43], a[132:135], v[76:79]
  ds_read_b64_tr_b16 v[36:37], v16 offset:27648
  v_cvt_pk_bf16_f32 v148, v64, v65
  v_mfma_f32_16x16x32_bf16 v[76:79], v[44:47], a[140:143], v[76:79]
  ds_read_b64_tr_b16 v[38:39], v16 offset:39936
  s_waitcnt lgkmcnt(8)
  v_mfma_f32_16x16x32_bf16 v[80:83], v[48:51], a[128:131], v[80:83]
  ds_read_b64_tr_b16 v[40:41], v17 offset:26624
  global_load_lds_dwordx4 v27, s[56:57] offset:0
  v_mfma_f32_16x16x32_bf16 v[80:83], v[52:55], a[136:139], v[80:83]
  ds_read_b64_tr_b16 v[42:43], v17 offset:38912
  v_cvt_pk_bf16_f32 v149, v66, v67
  v_mfma_f32_16x16x32_bf16 v[84:87], v[48:51], a[132:135], v[84:87]
  ds_read_b64_tr_b16 v[44:45], v17 offset:27648
  v_cvt_pk_bf16_f32 v166, v68, v69
  v_mfma_f32_16x16x32_bf16 v[84:87], v[52:55], a[140:143], v[84:87]
  ds_read_b64_tr_b16 v[46:47], v17 offset:39936
  s_waitcnt lgkmcnt(8)
  v_mfma_f32_16x16x32_bf16 v[88:91], v[56:59], a[128:131], v[88:91]
  ds_read_b64_tr_b16 v[48:49], v18 offset:26624
  v_cvt_pk_bf16_f32 v167, v70, v71
  v_mfma_f32_16x16x32_bf16 v[88:91], v[60:63], a[136:139], v[88:91]
  ds_read_b64_tr_b16 v[50:51], v18 offset:38912
  global_load_lds_dwordx4 v28, s[56:57] offset:1024
  v_mfma_f32_16x16x32_bf16 v[92:95], v[56:59], a[132:135], v[92:95]
  ds_read_b64_tr_b16 v[52:53], v18 offset:27648
  v_cvt_pk_bf16_f32 v150, v72, v73
  v_mfma_f32_16x16x32_bf16 v[92:95], v[60:63], a[140:143], v[92:95]
  ds_read_b64_tr_b16 v[54:55], v18 offset:39936
  s_waitcnt lgkmcnt(8)
  v_mfma_f32_16x16x32_bf16 v[96:99], v[32:35], a[128:131], v[96:99]
  ds_read_b64_tr_b16 v[56:57], v19 offset:26624
  v_cvt_pk_bf16_f32 v151, v74, v75
  v_mfma_f32_16x16x32_bf16 v[96:99], v[36:39], a[136:139], v[96:99]
  ds_read_b64_tr_b16 v[58:59], v19 offset:38912
  v_cvt_pk_bf16_f32 v168, v76, v77
  v_mfma_f32_16x16x32_bf16 v[100:103], v[32:35], a[132:135], v[100:103]
  ds_read_b64_tr_b16 v[60:61], v19 offset:27648
  global_load_lds_dwordx4 v29, s[56:57] offset:2048
  v_mfma_f32_16x16x32_bf16 v[100:103], v[36:39], a[140:143], v[100:103]
  ds_read_b64_tr_b16 v[62:63], v19 offset:39936
  s_waitcnt lgkmcnt(8)
  v_mfma_f32_16x16x32_bf16 v[104:107], v[40:43], a[128:131], v[104:107]
  ds_read_b64_tr_b16 v[32:33], v16 offset:28672
  v_cvt_pk_bf16_f32 v169, v78, v79
  v_mfma_f32_16x16x32_bf16 v[104:107], v[44:47], a[136:139], v[104:107]
  ds_read_b64_tr_b16 v[34:35], v16 offset:40960
  v_cvt_pk_bf16_f32 v152, v80, v81
  v_mfma_f32_16x16x32_bf16 v[108:111], v[40:43], a[132:135], v[108:111]
  ds_read_b64_tr_b16 v[36:37], v16 offset:29696
  s_waitcnt vmcnt(12) lgkmcnt(7)
  v_mfma_f32_16x16x32_bf16 v[108:111], v[44:47], a[140:143], v[108:111]
  ds_read_b64_tr_b16 v[38:39], v16 offset:41984
  s_barrier
  v_mfma_f32_16x16x32_bf16 v[112:115], v[48:51], a[128:131], v[112:115]
  ds_read_b64_tr_b16 v[40:41], v12 offset:0
  s_mul_i32 s56, s83, 1728
  v_mfma_f32_16x16x32_bf16 v[112:115], v[52:55], a[136:139], v[112:115]
  ds_read_b64_tr_b16 v[42:43], v12 offset:12288
  s_add_u32 s56, s52, s56
  v_mfma_f32_16x16x32_bf16 v[116:119], v[48:51], a[132:135], v[116:119]
  ds_read_b64_tr_b16 v[44:45], v12 offset:1024
  s_addc_u32 s57, s53, 0
  v_mfma_f32_16x16x32_bf16 v[116:119], v[52:55], a[140:143], v[116:119]
  ds_read_b64_tr_b16 v[46:47], v12 offset:13312
  s_waitcnt lgkmcnt(8)
  v_mfma_f32_16x16x32_bf16 v[120:123], v[56:59], a[128:131], v[120:123]
  ds_read_b64_tr_b16 v[48:49], v13 offset:0
  s_add_u32 m0, s50, 0
  v_mfma_f32_16x16x32_bf16 v[120:123], v[60:63], a[136:139], v[120:123]
  ds_read_b64_tr_b16 v[50:51], v13 offset:12288
  global_load_lds_dwordx4 v22, s[56:57] offset:0
  v_mfma_f32_16x16x32_bf16 v[124:127], v[56:59], a[132:135], v[124:127]
  ds_read_b64_tr_b16 v[52:53], v13 offset:1024
  v_cvt_pk_bf16_f32 v153, v82, v83
  v_mfma_f32_16x16x32_bf16 v[124:127], v[60:63], a[140:143], v[124:127]
  ds_read_b64_tr_b16 v[54:55], v13 offset:13312
  s_waitcnt lgkmcnt(8)
  v_mfma_f32_16x16x32_bf16 v[128:131], v[32:35], a[128:131], v[128:131]
  ds_read_b64_tr_b16 v[56:57], v14 offset:0
  v_cvt_pk_bf16_f32 v170, v84, v85
  v_mfma_f32_16x16x32_bf16 v[128:131], v[36:39], a[136:139], v[128:131]
  ds_read_b64_tr_b16 v[58:59], v14 offset:12288
  v_cvt_pk_bf16_f32 v171, v86, v87
  v_mfma_f32_16x16x32_bf16 v[132:135], v[32:35], a[132:135], v[132:135]
  ds_read_b64_tr_b16 v[60:61], v14 offset:1024
  global_load_lds_dwordx4 v23, s[56:57] offset:1024
  v_mfma_f32_16x16x32_bf16 v[132:135], v[36:39], a[140:143], v[132:135]
  ds_read_b64_tr_b16 v[62:63], v14 offset:13312
  s_waitcnt lgkmcnt(8)
  v_mfma_f32_16x16x32_bf16 v[64:67], a[0:3], v[40:43], 0
  ds_read_b64_tr_b16 v[32:33], v15 offset:0
  v_cvt_pk_bf16_f32 v154, v88, v89
  v_mfma_f32_16x16x32_bf16 v[64:67], a[8:11], v[44:47], v[64:67]
  ds_read_b64_tr_b16 v[34:35], v15 offset:12288
  v_cvt_pk_bf16_f32 v155, v90, v91
  v_mfma_f32_16x16x32_bf16 v[68:71], a[4:7], v[40:43], 0
  ds_read_b64_tr_b16 v[36:37], v15 offset:1024
  v_cvt_pk_bf16_f32 v172, v92, v93
  v_mfma_f32_16x16x32_bf16 v[68:71], a[12:15], v[44:47], v[68:71]
  ds_read_b64_tr_b16 v[38:39], v15 offset:13312
  s_waitcnt lgkmcnt(8)
  v_mfma_f32_16x16x32_bf16 v[72:75], a[0:3], v[48:51], 0
  ds_read_b64_tr_b16 v[40:41], v12 offset:2048
  global_load_lds_dwordx4 v26, s[56:57] offset:2048
  v_mfma_f32_16x16x32_bf16 v[72:75], a[8:11], v[52:55], v[72:75]
  ds_read_b64_tr_b16 v[42:43], v12 offset:14336
  s_add_u32 m0, s50, 3072
  v_mfma_f32_16x16x32_bf16 v[76:79], a[4:7], v[48:51], 0
  ds_read_b64_tr_b16 v[44:45], v12 offset:3072
  v_cvt_pk_bf16_f32 v173, v94, v95
  v_mfma_f32_16x16x32_bf16 v[76:79], a[12:15], v[52:55], v[76:79]
  ds_read_b64_tr_b16 v[46:47], v12 offset:15360
  s_waitcnt lgkmcnt(8)
  v_mfma_f32_16x16x32_bf16 v[80:83], a[0:3], v[56:59], 0
  ds_read_b64_tr_b16 v[48:49], v13 offset:2048
  global_load_lds_dwordx4 v27, s[56:57] offset:0
  v_mfma_f32_16x16x32_bf16 v[80:83], a[8:11], v[60:63], v[80:83]
  ds_read_b64_tr_b16 v[50:51], v13 offset:14336
  v_cvt_pk_bf16_f32 v156, v96, v97
  v_mfma_f32_16x16x32_bf16 v[84:87], a[4:7], v[56:59], 0
  ds_read_b64_tr_b16 v[52:53], v13 offset:3072
  v_cvt_pk_bf16_f32 v157, v98, v99
  v_mfma_f32_16x16x32_bf16 v[84:87], a[12:15], v[60:63], v[84:87]
  ds_read_b64_tr_b16 v[54:55], v13 offset:15360
  s_waitcnt lgkmcnt(8)
  v_mfma_f32_16x16x32_bf16 v[88:91], a[0:3], v[32:35], 0
  ds_read_b64_tr_b16 v[56:57], v14 offset:2048
  v_cvt_pk_bf16_f32 v174, v100, v101
  v_mfma_f32_16x16x32_bf16 v[88:91], a[8:11], v[36:39], v[88:91]
  ds_read_b64_tr_b16 v[58:59], v14 offset:14336
  global_load_lds_dwordx4 v28, s[56:57] offset:1024
  v_mfma_f32_16x16x32_bf16 v[92:95], a[4:7], v[32:35], 0
  ds_read_b64_tr_b16 v[60:61], v14 offset:3072
  v_cvt_pk_bf16_f32 v175, v102, v103
  v_mfma_f32_16x16x32_bf16 v[92:95], a[12:15], v[36:39], v[92:95]
  ds_read_b64_tr_b16 v[62:63], v14 offset:15360
  s_waitcnt lgkmcnt(8)
  v_mfma_f32_16x16x32_bf16 v[96:99], a[0:3], v[40:43], 0
  ds_read_b64_tr_b16 v[32:33], v15 offset:2048
  v_cvt_pk_bf16_f32 v158, v104, v105
  v_mfma_f32_16x16x32_bf16 v[96:99], a[8:11], v[44:47], v[96:99]
  ds_read_b64_tr_b16 v[34:35], v15 offset:14336
  v_cvt_pk_bf16_f32 v159, v106, v107
  v_mfma_f32_16x16x32_bf16 v[100:103], a[4:7], v[40:43], 0
  ds_read_b64_tr_b16 v[36:37], v15 offset:3072
  global_load_lds_dwordx4 v29, s[56:57] offset:2048
  v_mfma_f32_16x16x32_bf16 v[100:103], a[12:15], v[44:47], v[100:103]
  ds_read_b64_tr_b16 v[38:39], v15 offset:15360
  s_waitcnt lgkmcnt(8)
  v_mfma_f32_16x16x32_bf16 v[104:107], a[0:3], v[48:51], 0
  ds_read_b64_tr_b16 v[40:41], v12 offset:4096
  v_cvt_pk_bf16_f32 v176, v108, v109
  v_mfma_f32_16x16x32_bf16 v[104:107], a[8:11], v[52:55], v[104:107]
  ds_read_b64_tr_b16 v[42:43], v12 offset:16384
  v_cvt_pk_bf16_f32 v177, v110, v111
  v_mfma_f32_16x16x32_bf16 v[108:111], a[4:7], v[48:51], 0
  ds_read_b64_tr_b16 v[44:45], v12 offset:5120
  s_waitcnt vmcnt(12) lgkmcnt(7)
  v_mfma_f32_16x16x32_bf16 v[108:111], a[12:15], v[52:55], v[108:111]
  ds_read_b64_tr_b16 v[46:47], v12 offset:17408
  v_cvt_pk_bf16_f32 v160, v112, v113
  v_cvt_pk_bf16_f32 v161, v114, v115
  s_barrier
  v_mfma_f32_16x16x32_bf16 v[112:115], a[0:3], v[56:59], 0
  ds_read_b64_tr_b16 v[48:49], v12 offset:24576
  s_mul_i32 s56, s84, 1728
  v_mfma_f32_16x16x32_bf16 v[112:115], a[8:11], v[60:63], v[112:115]
  ds_read_b64_tr_b16 v[50:51], v12 offset:36864
  s_add_u32 s56, s52, s56
  v_cvt_pk_bf16_f32 v178, v116, v117
  v_cvt_pk_bf16_f32 v179, v118, v119
  v_mfma_f32_16x16x32_bf16 v[116:119], a[4:7], v[56:59], 0
  ds_read_b64_tr_b16 v[52:53], v12 offset:25600
  s_addc_u32 s57, s53, 0
  v_mfma_f32_16x16x32_bf16 v[116:119], a[12:15], v[60:63], v[116:119]
  ds_read_b64_tr_b16 v[54:55], v12 offset:37888
  v_cvt_pk_bf16_f32 v162, v120, v121
  v_cvt_pk_bf16_f32 v163, v122, v123
  s_waitcnt lgkmcnt(8)
  v_mfma_f32_16x16x32_bf16 v[120:123], a[0:3], v[32:35], 0
  ds_read_b64_tr_b16 v[56:57], v13 offset:24576
  s_add_u32 m0, s50, 24576
  v_mfma_f32_16x16x32_bf16 v[120:123], a[8:11], v[36:39], v[120:123]
  ds_read_b64_tr_b16 v[58:59], v13 offset:36864
  global_load_lds_dwordx4 v22, s[56:57] offset:0
  v_cvt_pk_bf16_f32 v180, v124, v125
  v_cvt_pk_bf16_f32 v181, v126, v127
  v_mfma_f32_16x16x32_bf16 v[124:127], a[4:7], v[32:35], 0
  ds_read_b64_tr_b16 v[60:61], v13 offset:25600
  v_cvt_pk_bf16_f32 v164, v128, v129
  v_mfma_f32_16x16x32_bf16 v[124:127], a[12:15], v[36:39], v[124:127]
  ds_read_b64_tr_b16 v[62:63], v13 offset:37888
  v_cvt_pk_bf16_f32 v165, v130, v131
  s_waitcnt lgkmcnt(8)
  v_mfma_f32_16x16x32_bf16 v[128:131], a[0:3], v[40:43], 0
  ds_read_b64_tr_b16 v[32:33], v14 offset:24576
  v_cvt_pk_bf16_f32 v182, v132, v133
  v_mfma_f32_16x16x32_bf16 v[128:131], a[8:11], v[44:47], v[128:131]
  ds_read_b64_tr_b16 v[34:35], v14 offset:36864
  v_cvt_pk_bf16_f32 v183, v134, v135
  v_mfma_f32_16x16x32_bf16 v[132:135], a[4:7], v[40:43], 0
  ds_read_b64_tr_b16 v[36:37], v14 offset:25600
  global_load_lds_dwordx4 v23, s[56:57] offset:1024
  v_mfma_f32_16x16x32_bf16 v[132:135], a[12:15], v[44:47], v[132:135]
  ds_read_b64_tr_b16 v[38:39], v14 offset:37888
  s_waitcnt lgkmcnt(8)
  v_mfma_f32_16x16x32_bf16 v[64:67], a[16:19], v[48:51], v[64:67]
  ds_read_b64_tr_b16 v[40:41], v15 offset:24576
  v_mfma_f32_16x16x32_bf16 v[64:67], a[24:27], v[52:55], v[64:67]
  ds_read_b64_tr_b16 v[42:43], v15 offset:36864
  v_mfma_f32_16x16x32_bf16 v[68:71], a[20:23], v[48:51], v[68:71]
  ds_read_b64_tr_b16 v[44:45], v15 offset:25600
  v_mfma_f32_16x16x32_bf16 v[68:71], a[28:31], v[52:55], v[68:71]
  ds_read_b64_tr_b16 v[46:47], v15 offset:37888
  s_waitcnt lgkmcnt(8)
  v_mfma_f32_16x16x32_bf16 v[72:75], a[16:19], v[56:59], v[72:75]
  ds_read_b64_tr_b16 v[48:49], v12 offset:26624
  global_load_lds_dwordx4 v26, s[56:57] offset:2048
  v_mfma_f32_16x16x32_bf16 v[72:75], a[24:27], v[60:63], v[72:75]
  ds_read_b64_tr_b16 v[50:51], v12 offset:38912
  s_add_u32 m0, s50, 27648
  v_mfma_f32_16x16x32_bf16 v[76:79], a[20:23], v[56:59], v[76:79]
  ds_read_b64_tr_b16 v[52:53], v12 offset:27648
  v_mfma_f32_16x16x32_bf16 v[76:79], a[28:31], v[60:63], v[76:79]
  ds_read_b64_tr_b16 v[54:55], v12 offset:39936
  s_waitcnt lgkmcnt(8)
  v_mfma_f32_16x16x32_bf16 v[80:83], a[16:19], v[32:35], v[80:83]
  ds_read_b64_tr_b16 v[56:57], v13 offset:26624
  global_load_lds_dwordx4 v27, s[56:57] offset:0
  v_mfma_f32_16x16x32_bf16 v[80:83], a[24:27], v[36:39], v[80:83]
  ds_read_b64_tr_b16 v[58:59], v13 offset:38912
  v_mfma_f32_16x16x32_bf16 v[84:87], a[20:23], v[32:35], v[84:87]
  ds_read_b64_tr_b16 v[60:61], v13 offset:27648
  v_mfma_f32_16x16x32_bf16 v[84:87], a[28:31], v[36:39], v[84:87]
  ds_read_b64_tr_b16 v[62:63], v13 offset:39936
  s_waitcnt lgkmcnt(8)
  v_mfma_f32_16x16x32_bf16 v[88:91], a[16:19], v[40:43], v[88:91]
  ds_read_b64_tr_b16 v[32:33], v14 offset:26624
  v_mfma_f32_16x16x32_bf16 v[88:91], a[24:27], v[44:47], v[88:91]
  ds_read_b64_tr_b16 v[34:35], v14 offset:38912
  global_load_lds_dwordx4 v28, s[56:57] offset:1024
  v_mfma_f32_16x16x32_bf16 v[92:95], a[20:23], v[40:43], v[92:95]
  ds_read_b64_tr_b16 v[36:37], v14 offset:27648
  v_mfma_f32_16x16x32_bf16 v[92:95], a[28:31], v[44:47], v[92:95]
  ds_read_b64_tr_b16 v[38:39], v14 offset:39936
  s_waitcnt lgkmcnt(8)
  v_mfma_f32_16x16x32_bf16 v[96:99], a[16:19], v[48:51], v[96:99]
  ds_read_b64_tr_b16 v[40:41], v15 offset:26624
  v_mfma_f32_16x16x32_bf16 v[96:99], a[24:27], v[52:55], v[96:99]
  ds_read_b64_tr_b16 v[42:43], v15 offset:38912
  v_mfma_f32_16x16x32_bf16 v[100:103], a[20:23], v[48:51], v[100:103]
  ds_read_b64_tr_b16 v[44:45], v15 offset:27648
  global_load_lds_dwordx4 v29, s[56:57] offset:2048
  v_mfma_f32_16x16x32_bf16 v[100:103], a[28:31], v[52:55], v[100:103]
  ds_read_b64_tr_b16 v[46:47], v15 offset:39936
  s_waitcnt lgkmcnt(8)
  v_mfma_f32_16x16x32_bf16 v[104:107], a[16:19], v[56:59], v[104:107]
  ds_read_b64_tr_b16 v[48:49], v12 offset:28672
  v_mfma_f32_16x16x32_bf16 v[104:107], a[24:27], v[60:63], v[104:107]
  ds_read_b64_tr_b16 v[50:51], v12 offset:40960
  v_mfma_f32_16x16x32_bf16 v[108:111], a[20:23], v[56:59], v[108:111]
  ds_read_b64_tr_b16 v[52:53], v12 offset:29696
  s_waitcnt vmcnt(12) lgkmcnt(7)
  v_mfma_f32_16x16x32_bf16 v[108:111], a[28:31], v[60:63], v[108:111]
  ds_read_b64_tr_b16 v[54:55], v12 offset:41984
  s_barrier
  v_mfma_f32_16x16x32_bf16 v[112:115], a[16:19], v[32:35], v[112:115]
  ds_read_b64_tr_b16 v[56:57], v16 offset:0
  s_mul_i32 s56, s85, 1728
  v_mfma_f32_16x16x32_bf16 v[112:115], a[24:27], v[36:39], v[112:115]
  ds_read_b64_tr_b16 v[58:59], v16 offset:12288
  s_add_u32 s56, s52, s56
  v_mfma_f32_16x16x32_bf16 v[116:119], a[20:23], v[32:35], v[116:119]
  ds_read_b64_tr_b16 v[60:61], v16 offset:1024
  s_addc_u32 s57, s53, 0
  v_mfma_f32_16x16x32_bf16 v[116:119], a[28:31], v[36:39], v[116:119]
  ds_read_b64_tr_b16 v[62:63], v16 offset:13312
  s_waitcnt lgkmcnt(8)
  v_mfma_f32_16x16x32_bf16 v[120:123], a[16:19], v[40:43], v[120:123]
  ds_read_b64_tr_b16 v[32:33], v17 offset:0
  s_add_u32 m0, s50, 122880
  v_mfma_f32_16x16x32_bf16 v[120:123], a[24:27], v[44:47], v[120:123]
  ds_read_b64_tr_b16 v[34:35], v17 offset:12288
  global_load_lds_dwordx4 v22, s[56:57] offset:0
  v_mfma_f32_16x16x32_bf16 v[124:127], a[20:23], v[40:43], v[124:127]
  ds_read_b64_tr_b16 v[36:37], v17 offset:1024
  v_mfma_f32_16x16x32_bf16 v[124:127], a[28:31], v[44:47], v[124:127]
  ds_read_b64_tr_b16 v[38:39], v17 offset:13312
  s_waitcnt lgkmcnt(8)
  v_mfma_f32_16x16x32_bf16 v[128:131], a[16:19], v[48:51], v[128:131]
  ds_read_b64_tr_b16 v[40:41], v18 offset:0
  v_mfma_f32_16x16x32_bf16 v[128:131], a[24:27], v[52:55], v[128:131]
  ds_read_b64_tr_b16 v[42:43], v18 offset:12288
  v_mfma_f32_16x16x32_bf16 v[132:135], a[20:23], v[48:51], v[132:135]
  ds_read_b64_tr_b16 v[44:45], v18 offset:1024
  global_load_lds_dwordx4 v23, s[56:57] offset:1024
  v_mfma_f32_16x16x32_bf16 v[132:135], a[28:31], v[52:55], v[132:135]
  ds_read_b64_tr_b16 v[46:47], v18 offset:13312
  s_waitcnt lgkmcnt(8)
  v_mfma_f32_16x16x32_bf16 v[64:67], a[32:35], v[56:59], v[64:67]
  ds_read_b64_tr_b16 v[48:49], v19 offset:0
  s_add_u32 s54, s12, s68
  s_addc_u32 s55, s13, 0
  v_mfma_f32_16x16x32_bf16 v[64:67], a[40:43], v[60:63], v[64:67]
  ds_read_b64_tr_b16 v[50:51], v19 offset:12288
  global_load_dword a255, v0, s[6:7]
  v_mfma_f32_16x16x32_bf16 v[68:71], a[36:39], v[56:59], v[68:71]
  ds_read_b64_tr_b16 v[52:53], v19 offset:1024
  v_mfma_f32_16x16x32_bf16 v[68:71], a[44:47], v[60:63], v[68:71]
  ds_read_b64_tr_b16 v[54:55], v19 offset:13312
  s_waitcnt lgkmcnt(8)
  v_mfma_f32_16x16x32_bf16 v[72:75], a[32:35], v[32:35], v[72:75]
  ds_read_b64_tr_b16 v[56:57], v16 offset:2048
  global_load_lds_dwordx4 v26, s[56:57] offset:2048
  v_mfma_f32_16x16x32_bf16 v[72:75], a[40:43], v[36:39], v[72:75]
  ds_read_b64_tr_b16 v[58:59], v16 offset:14336
  s_add_u32 m0, s50, 125952
  v_mfma_f32_16x16x32_bf16 v[76:79], a[36:39], v[32:35], v[76:79]
  ds_read_b64_tr_b16 v[60:61], v16 offset:3072
  v_mfma_f32_16x16x32_bf16 v[76:79], a[44:47], v[36:39], v[76:79]
  ds_read_b64_tr_b16 v[62:63], v16 offset:15360
  s_waitcnt lgkmcnt(8)
  v_mfma_f32_16x16x32_bf16 v[80:83], a[32:35], v[40:43], v[80:83]
  ds_read_b64_tr_b16 v[32:33], v17 offset:2048
  global_load_lds_dwordx4 v27, s[56:57] offset:0
  v_mfma_f32_16x16x32_bf16 v[80:83], a[40:43], v[44:47], v[80:83]
  ds_read_b64_tr_b16 v[34:35], v17 offset:14336
  v_mfma_f32_16x16x32_bf16 v[84:87], a[36:39], v[40:43], v[84:87]
  ds_read_b64_tr_b16 v[36:37], v17 offset:3072
  v_mfma_f32_16x16x32_bf16 v[84:87], a[44:47], v[44:47], v[84:87]
  ds_read_b64_tr_b16 v[38:39], v17 offset:15360
  s_waitcnt lgkmcnt(8)
  v_mfma_f32_16x16x32_bf16 v[88:91], a[32:35], v[48:51], v[88:91]
  ds_read_b64_tr_b16 v[40:41], v18 offset:2048
  v_mfma_f32_16x16x32_bf16 v[88:91], a[40:43], v[52:55], v[88:91]
  ds_read_b64_tr_b16 v[42:43], v18 offset:14336
  global_load_lds_dwordx4 v28, s[56:57] offset:1024
  v_mfma_f32_16x16x32_bf16 v[92:95], a[36:39], v[48:51], v[92:95]
  ds_read_b64_tr_b16 v[44:45], v18 offset:3072
  v_mfma_f32_16x16x32_bf16 v[92:95], a[44:47], v[52:55], v[92:95]
  ds_read_b64_tr_b16 v[46:47], v18 offset:15360
  s_waitcnt lgkmcnt(8)
  v_mfma_f32_16x16x32_bf16 v[96:99], a[32:35], v[56:59], v[96:99]
  ds_read_b64_tr_b16 v[48:49], v19 offset:2048
  v_mfma_f32_16x16x32_bf16 v[96:99], a[40:43], v[60:63], v[96:99]
  ds_read_b64_tr_b16 v[50:51], v19 offset:14336
  v_mfma_f32_16x16x32_bf16 v[100:103], a[36:39], v[56:59], v[100:103]
  ds_read_b64_tr_b16 v[52:53], v19 offset:3072
  global_load_lds_dwordx4 v29, s[56:57] offset:2048
  v_mfma_f32_16x16x32_bf16 v[100:103], a[44:47], v[60:63], v[100:103]
  ds_read_b64_tr_b16 v[54:55], v19 offset:15360
  s_waitcnt lgkmcnt(8)
  v_mfma_f32_16x16x32_bf16 v[104:107], a[32:35], v[32:35], v[104:107]
  ds_read_b64_tr_b16 v[56:57], v16 offset:4096
  v_mfma_f32_16x16x32_bf16 v[104:107], a[40:43], v[36:39], v[104:107]
  ds_read_b64_tr_b16 v[58:59], v16 offset:16384
  v_mfma_f32_16x16x32_bf16 v[108:111], a[36:39], v[32:35], v[108:111]
  ds_read_b64_tr_b16 v[60:61], v16 offset:5120
  s_waitcnt vmcnt(13) lgkmcnt(7)
  v_mfma_f32_16x16x32_bf16 v[108:111], a[44:47], v[36:39], v[108:111]
  ds_read_b64_tr_b16 v[62:63], v16 offset:17408
  s_barrier
  v_mfma_f32_16x16x32_bf16 v[112:115], a[32:35], v[40:43], v[112:115]
  ds_read_b64_tr_b16 v[32:33], v8 offset:0
  s_mul_i32 s56, s86, 1728
  v_mfma_f32_16x16x32_bf16 v[112:115], a[40:43], v[44:47], v[112:115]
  ds_read_b64_tr_b16 v[34:35], v8 offset:12288
  s_add_u32 s56, s52, s56
  v_mfma_f32_16x16x32_bf16 v[116:119], a[36:39], v[40:43], v[116:119]
  ds_read_b64_tr_b16 v[36:37], v8 offset:1024
  s_addc_u32 s57, s53, 0
  v_mfma_f32_16x16x32_bf16 v[116:119], a[44:47], v[44:47], v[116:119]
  ds_read_b64_tr_b16 v[38:39], v8 offset:13312
  s_waitcnt lgkmcnt(8)
  v_mfma_f32_16x16x32_bf16 v[120:123], a[32:35], v[48:51], v[120:123]
  ds_read_b64_tr_b16 v[40:41], v9 offset:0
  s_add_u32 m0, s50, 49152
  v_mfma_f32_16x16x32_bf16 v[120:123], a[40:43], v[52:55], v[120:123]
  ds_read_b64_tr_b16 v[42:43], v9 offset:12288
  global_load_lds_dwordx4 v22, s[56:57] offset:0
  v_mfma_f32_16x16x32_bf16 v[124:127], a[36:39], v[48:51], v[124:127]
  ds_read_b64_tr_b16 v[44:45], v9 offset:1024
  v_mfma_f32_16x16x32_bf16 v[124:127], a[44:47], v[52:55], v[124:127]
  ds_read_b64_tr_b16 v[46:47], v9 offset:13312
  s_waitcnt lgkmcnt(8)
  v_mfma_f32_16x16x32_bf16 v[128:131], a[32:35], v[56:59], v[128:131]
  ds_read_b64_tr_b16 v[48:49], v10 offset:0
  v_mfma_f32_16x16x32_bf16 v[128:131], a[40:43], v[60:63], v[128:131]
  ds_read_b64_tr_b16 v[50:51], v10 offset:12288
  v_mfma_f32_16x16x32_bf16 v[132:135], a[36:39], v[56:59], v[132:135]
  ds_read_b64_tr_b16 v[52:53], v10 offset:1024
  global_load_lds_dwordx4 v23, s[56:57] offset:1024
  v_mfma_f32_16x16x32_bf16 v[132:135], a[44:47], v[60:63], v[132:135]
  ds_read_b64_tr_b16 v[54:55], v10 offset:13312
  s_waitcnt lgkmcnt(8)
  v_mfma_f32_16x16x32_bf16 v[64:67], a[48:51], v[32:35], v[64:67]
  ds_read_b64_tr_b16 v[56:57], v11 offset:0
  v_cmp_eq_u32 vcc, 0, v137
  v_mfma_f32_16x16x32_bf16 v[64:67], a[56:59], v[36:39], v[64:67]
  ds_read_b64_tr_b16 v[58:59], v11 offset:12288
  s_cmp_lg_u64 vcc, 0
  v_mfma_f32_16x16x32_bf16 v[68:71], a[52:55], v[32:35], v[68:71]
  ds_read_b64_tr_b16 v[60:61], v11 offset:1024
  s_cbranch_scc1 L_a_dbg_slow
L_a_dbgok:
  v_mfma_f32_16x16x32_bf16 v[68:71], a[60:63], v[36:39], v[68:71]
  ds_read_b64_tr_b16 v[62:63], v11 offset:13312
  s_waitcnt lgkmcnt(8)
  v_mfma_f32_16x16x32_bf16 v[72:75], a[48:51], v[40:43], v[72:75]
  ds_read_b64_tr_b16 v[32:33], v8 offset:2048
  global_load_lds_dwordx4 v26, s[56:57] offset:2048
  v_mfma_f32_16x16x32_bf16 v[72:75], a[56:59], v[44:47], v[72:75]
  ds_read_b64_tr_b16 v[34:35], v8 offset:14336
  s_add_u32 m0, s50, 52224
  v_mfma_f32_16x16x32_bf16 v[76:79], a[52:55], v[40:43], v[76:79]
  ds_read_b64_tr_b16 v[36:37], v8 offset:3072
  v_mfma_f32_16x16x32_bf16 v[76:79], a[60:63], v[44:47], v[76:79]
  ds_read_b64_tr_b16 v[38:39], v8 offset:15360
  s_waitcnt lgkmcnt(8)
  v_mfma_f32_16x16x32_bf16 v[80:83], a[48:51], v[48:51], v[80:83]
  ds_read_b64_tr_b16 v[40:41], v9 offset:2048
  global_load_lds_dwordx4 v27, s[56:57] offset:0
  v_mfma_f32_16x16x32_bf16 v[80:83], a[56:59], v[52:55], v[80:83]
  ds_read_b64_tr_b16 v[42:43], v9 offset:14336
  v_mfma_f32_16x16x32_bf16 v[84:87], a[52:55], v[48:51], v[84:87]
  ds_read_b64_tr_b16 v[44:45], v9 offset:3072
  v_mfma_f32_16x16x32_bf16 v[84:87], a[60:63], v[52:55], v[84:87]
  ds_read_b64_tr_b16 v[46:47], v9 offset:15360
  s_waitcnt lgkmcnt(8)
  v_mfma_f32_16x16x32_bf16 v[88:91], a[48:51], v[56:59], v[88:91]
  ds_read_b64_tr_b16 v[48:49], v10 offset:2048
  v_mfma_f32_16x16x32_bf16 v[88:91], a[56:59], v[60:63], v[88:91]
  ds_read_b64_tr_b16 v[50:51], v10 offset:14336
  global_load_lds_dwordx4 v28, s[56:57] offset:1024
  v_mfma_f32_16x16x32_bf16 v[92:95], a[52:55], v[56:59], v[92:95]
  ds_read_b64_tr_b16 v[52:53], v10 offset:3072
  v_mfma_f32_16x16x32_bf16 v[92:95], a[60:63], v[60:63], v[92:95]
  ds_read_b64_tr_b16 v[54:55], v10 offset:15360
  s_waitcnt lgkmcnt(8)
  v_mfma_f32_16x16x32_bf16 v[96:99], a[48:51], v[32:35], v[96:99]
  ds_read_b64_tr_b16 v[56:57], v11 offset:2048
  v_mfma_f32_16x16x32_bf16 v[96:99], a[56:59], v[36:39], v[96:99]
  ds_read_b64_tr_b16 v[58:59], v11 offset:14336
  v_mfma_f32_16x16x32_bf16 v[100:103], a[52:55], v[32:35], v[100:103]
  ds_read_b64_tr_b16 v[60:61], v11 offset:3072
  global_load_lds_dwordx4 v29, s[56:57] offset:2048
  v_mfma_f32_16x16x32_bf16 v[100:103], a[60:63], v[36:39], v[100:103]
  ds_read_b64_tr_b16 v[62:63], v11 offset:15360
  s_waitcnt lgkmcnt(8)
  v_mfma_f32_16x16x32_bf16 v[104:107], a[48:51], v[40:43], v[104:107]
  ds_read_b64_tr_b16 v[32:33], v8 offset:4096
  v_mfma_f32_16x16x32_bf16 v[104:107], a[56:59], v[44:47], v[104:107]
  ds_read_b64_tr_b16 v[34:35], v8 offset:16384
  v_mfma_f32_16x16x32_bf16 v[108:111], a[52:55], v[40:43], v[108:111]
  ds_read_b64_tr_b16 v[36:37], v8 offset:5120
  s_waitcnt vmcnt(13) lgkmcnt(7)
  v_mfma_f32_16x16x32_bf16 v[108:111], a[60:63], v[44:47], v[108:111]
  ds_read_b64_tr_b16 v[38:39], v8 offset:17408
  s_barrier
  v_mfma_f32_16x16x32_bf16 v[112:115], a[48:51], v[48:51], v[112:115]
  ds_read_b64_tr_b16 v[40:41], v8 offset:24576
  s_mul_i32 s56, s87, 1728
  v_mfma_f32_16x16x32_bf16 v[112:115], a[56:59], v[52:55], v[112:115]
  ds_read_b64_tr_b16 v[42:43], v8 offset:36864
  s_add_u32 s56, s52, s56
  v_mfma_f32_16x16x32_bf16 v[116:119], a[52:55], v[48:51], v[116:119]
  ds_read_b64_tr_b16 v[44:45], v8 offset:25600
  s_addc_u32 s57, s53, 0
  v_mfma_f32_16x16x32_bf16 v[116:119], a[60:63], v[52:55], v[116:119]
  ds_read_b64_tr_b16 v[46:47], v8 offset:37888
  s_waitcnt lgkmcnt(8)
  v_mfma_f32_16x16x32_bf16 v[120:123], a[48:51], v[56:59], v[120:123]
  ds_read_b64_tr_b16 v[48:49], v9 offset:24576
  s_add_u32 m0, s50, 73728
  v_mfma_f32_16x16x32_bf16 v[120:123], a[56:59], v[60:63], v[120:123]
  ds_read_b64_tr_b16 v[50:51], v9 offset:36864
  global_load_lds_dwordx4 v22, s[56:57] offset:0
  v_mfma_f32_16x16x32_bf16 v[124:127], a[52:55], v[56:59], v[124:127]
  ds_read_b64_tr_b16 v[52:53], v9 offset:25600
  v_mfma_f32_16x16x32_bf16 v[124:127], a[60:63], v[60:63], v[124:127]
  ds_read_b64_tr_b16 v[54:55], v9 offset:37888
  s_waitcnt lgkmcnt(8)
  v_mfma_f32_16x16x32_bf16 v[128:131], a[48:51], v[32:35], v[128:131]
  ds_read_b64_tr_b16 v[56:57], v10 offset:24576
  v_mfma_f32_16x16x32_bf16 v[128:131], a[56:59], v[36:39], v[128:131]
  ds_read_b64_tr_b16 v[58:59], v10 offset:36864
  v_mfma_f32_16x16x32_bf16 v[132:135], a[52:55], v[32:35], v[132:135]
  ds_read_b64_tr_b16 v[60:61], v10 offset:25600
  global_load_lds_dwordx4 v23, s[56:57] offset:1024
  v_mfma_f32_16x16x32_bf16 v[132:135], a[60:63], v[36:39], v[132:135]
  ds_read_b64_tr_b16 v[62:63], v10 offset:37888
  s_waitcnt lgkmcnt(8)
  v_mfma_f32_16x16x32_bf16 v[64:67], a[64:67], v[40:43], v[64:67]
  ds_read_b64_tr_b16 v[32:33], v11 offset:24576
  buffer_store_dwordx2 v[166:167], v7, s[40:43], 0 offen offset:0 sc1
  v_mfma_f32_16x16x32_bf16 v[64:67], a[72:75], v[44:47], v[64:67]
  ds_read_b64_tr_b16 v[34:35], v11 offset:36864
  v_mfma_f32_16x16x32_bf16 v[68:71], a[68:71], v[40:43], v[68:71]
  ds_read_b64_tr_b16 v[36:37], v11 offset:25600
  v_mfma_f32_16x16x32_bf16 v[68:71], a[76:79], v[44:47], v[68:71]
  ds_read_b64_tr_b16 v[38:39], v11 offset:37888
  s_waitcnt lgkmcnt(8)
  v_mfma_f32_16x16x32_bf16 v[72:75], a[64:67], v[48:51], v[72:75]
  ds_read_b64_tr_b16 v[40:41], v8 offset:26624
  global_load_lds_dwordx4 v26, s[56:57] offset:2048
  v_mfma_f32_16x16x32_bf16 v[72:75], a[72:75], v[52:55], v[72:75]
  ds_read_b64_tr_b16 v[42:43], v8 offset:38912
  s_add_u32 m0, s50, 76800
  v_mfma_f32_16x16x32_bf16 v[76:79], a[68:71], v[48:51], v[76:79]
  ds_read_b64_tr_b16 v[44:45], v8 offset:27648
  buffer_store_dwordx2 v[168:169], v7, s[40:43], 0 offen offset:512 sc1
  v_mfma_f32_16x16x32_bf16 v[76:79], a[76:79], v[52:55], v[76:79]
  ds_read_b64_tr_b16 v[46:47], v8 offset:39936
  s_waitcnt lgkmcnt(8)
  v_mfma_f32_16x16x32_bf16 v[80:83], a[64:67], v[56:59], v[80:83]
  ds_read_b64_tr_b16 v[48:49], v9 offset:26624
  global_load_lds_dwordx4 v27, s[56:57] offset:0
  v_mfma_f32_16x16x32_bf16 v[80:83], a[72:75], v[60:63], v[80:83]
  ds_read_b64_tr_b16 v[50:51], v9 offset:38912
  v_mfma_f32_16x16x32_bf16 v[84:87], a[68:71], v[56:59], v[84:87]
  ds_read_b64_tr_b16 v[52:53], v9 offset:27648
  v_mfma_f32_16x16x32_bf16 v[84:87], a[76:79], v[60:63], v[84:87]
  ds_read_b64_tr_b16 v[54:55], v9 offset:39936
  s_waitcnt lgkmcnt(8)
  v_mfma_f32_16x16x32_bf16 v[88:91], a[64:67], v[32:35], v[88:91]
  ds_read_b64_tr_b16 v[56:57], v10 offset:26624
  buffer_store_dwordx2 v[170:171], v7, s[40:43], 0 offen offset:1024 sc1
  v_mfma_f32_16x16x32_bf16 v[88:91], a[72:75], v[36:39], v[88:91]
  ds_read_b64_tr_b16 v[58:59], v10 offset:38912
  global_load_lds_dwordx4 v28, s[56:57] offset:1024
  v_mfma_f32_16x16x32_bf16 v[92:95], a[68:71], v[32:35], v[92:95]
  ds_read_b64_tr_b16 v[60:61], v10 offset:27648
  v_mfma_f32_16x16x32_bf16 v[92:95], a[76:79], v[36:39], v[92:95]
  ds_read_b64_tr_b16 v[62:63], v10 offset:39936
  s_waitcnt lgkmcnt(8)
  v_mfma_f32_16x16x32_bf16 v[96:99], a[64:67], v[40:43], v[96:99]
  ds_read_b64_tr_b16 v[32:33], v11 offset:26624
  v_mfma_f32_16x16x32_bf16 v[96:99], a[72:75], v[44:47], v[96:99]
  ds_read_b64_tr_b16 v[34:35], v11 offset:38912
  buffer_store_dwordx2 v[172:173], v7, s[40:43], 0 offen offset:1536 sc1
  v_mfma_f32_16x16x32_bf16 v[100:103], a[68:71], v[40:43], v[100:103]
  ds_read_b64_tr_b16 v[36:37], v11 offset:27648
  global_load_lds_dwordx4 v29, s[56:57] offset:2048
  v_mfma_f32_16x16x32_bf16 v[100:103], a[76:79], v[44:47], v[100:103]
  ds_read_b64_tr_b16 v[38:39], v11 offset:39936
  s_waitcnt lgkmcnt(8)
  v_mfma_f32_16x16x32_bf16 v[104:107], a[64:67], v[48:51], v[104:107]
  ds_read_b64_tr_b16 v[40:41], v8 offset:28672
  v_mfma_f32_16x16x32_bf16 v[104:107], a[72:75], v[52:55], v[104:107]
  ds_read_b64_tr_b16 v[42:43], v8 offset:40960
  v_mfma_f32_16x16x32_bf16 v[108:111], a[68:71], v[48:51], v[108:111]
  ds_read_b64_tr_b16 v[44:45], v8 offset:29696
  s_waitcnt vmcnt(16) lgkmcnt(7)
  v_mfma_f32_16x16x32_bf16 v[108:111], a[76:79], v[52:55], v[108:111]
  ds_read_b64_tr_b16 v[46:47], v8 offset:41984
  s_barrier
  v_mfma_f32_16x16x32_bf16 v[112:115], a[64:67], v[56:59], v[112:115]
  ds_read_b64_tr_b16 v[48:49], v16 offset:24576
  s_mul_i32 s56, s88, 1728
  v_mfma_f32_16x16x32_bf16 v[112:115], a[72:75], v[60:63], v[112:115]
  ds_read_b64_tr_b16 v[50:51], v16 offset:36864
  s_add_u32 s56, s52, s56
  v_mfma_f32_16x16x32_bf16 v[116:119], a[68:71], v[56:59], v[116:119]
  ds_read_b64_tr_b16 v[52:53], v16 offset:25600
  s_addc_u32 s57, s53, 0
  v_mfma_f32_16x16x32_bf16 v[116:119], a[76:79], v[60:63], v[116:119]
  ds_read_b64_tr_b16 v[54:55], v16 offset:37888
  s_waitcnt lgkmcnt(8)
  v_mfma_f32_16x16x32_bf16 v[120:123], a[64:67], v[32:35], v[120:123]
  ds_read_b64_tr_b16 v[56:57], v17 offset:24576
  s_add_u32 m0, s50, 98304
  v_mfma_f32_16x16x32_bf16 v[120:123], a[72:75], v[36:39], v[120:123]
  ds_read_b64_tr_b16 v[58:59], v17 offset:36864
  global_load_lds_dwordx4 v22, s[56:57] offset:0
  v_mfma_f32_16x16x32_bf16 v[124:127], a[68:71], v[32:35], v[124:127]
  ds_read_b64_tr_b16 v[60:61], v17 offset:25600
  buffer_store_dwordx2 v[174:175], v7, s[40:43], 0 offen offset:2048 sc1
  v_mfma_f32_16x16x32_bf16 v[124:127], a[76:79], v[36:39], v[124:127]
  ds_read_b64_tr_b16 v[62:63], v17 offset:37888
  s_waitcnt lgkmcnt(8)
  v_mfma_f32_16x16x32_bf16 v[128:131], a[64:67], v[40:43], v[128:131]
  ds_read_b64_tr_b16 v[32:33], v18 offset:24576
  v_mfma_f32_16x16x32_bf16 v[128:131], a[72:75], v[44:47], v[128:131]
  ds_read_b64_tr_b16 v[34:35], v18 offset:36864
  v_mfma_f32_16x16x32_bf16 v[132:135], a[68:71], v[40:43], v[132:135]
  ds_read_b64_tr_b16 v[36:37], v18 offset:25600
  global_load_lds_dwordx4 v23, s[56:57] offset:1024
  v_mfma_f32_16x16x32_bf16 v[132:135], a[76:79], v[44:47], v[132:135]
  ds_read_b64_tr_b16 v[38:39], v18 offset:37888
  s_waitcnt lgkmcnt(8)
  v_mfma_f32_16x16x32_bf16 v[64:67], a[80:83], v[48:51], v[64:67]
  ds_read_b64_tr_b16 v[40:41], v19 offset:24576
  buffer_store_dwordx2 v[176:177], v7, s[40:43], 0 offen offset:2560 sc1
  v_mfma_f32_16x16x32_bf16 v[64:67], a[88:91], v[52:55], v[64:67]
  ds_read_b64_tr_b16 v[42:43], v19 offset:36864
  v_mfma_f32_16x16x32_bf16 v[68:71], a[84:87], v[48:51], v[68:71]
  ds_read_b64_tr_b16 v[44:45], v19 offset:25600
  v_mfma_f32_16x16x32_bf16 v[68:71], a[92:95], v[52:55], v[68:71]
  ds_read_b64_tr_b16 v[46:47], v19 offset:37888
  s_waitcnt lgkmcnt(8)
  v_mfma_f32_16x16x32_bf16 v[72:75], a[80:83], v[56:59], v[72:75]
  ds_read_b64_tr_b16 v[48:49], v16 offset:26624
  global_load_lds_dwordx4 v26, s[56:57] offset:2048
  v_mfma_f32_16x16x32_bf16 v[72:75], a[88:91], v[60:63], v[72:75]
  ds_read_b64_tr_b16 v[50:51], v16 offset:38912
  s_add_u32 m0, s50, 101376
  v_mfma_f32_16x16x32_bf16 v[76:79], a[84:87], v[56:59], v[76:79]
  ds_read_b64_tr_b16 v[52:53], v16 offset:27648
  buffer_store_dwordx2 v[178:179], v7, s[40:43], 0 offen offset:3072 sc1
  v_mfma_f32_16x16x32_bf16 v[76:79], a[92:95], v[60:63], v[76:79]
  ds_read_b64_tr_b16 v[54:55], v16 offset:39936
  s_waitcnt lgkmcnt(8)
  v_mfma_f32_16x16x32_bf16 v[80:83], a[80:83], v[32:35], v[80:83]
  ds_read_b64_tr_b16 v[56:57], v17 offset:26624
  global_load_lds_dwordx4 v27, s[56:57] offset:0
  v_mfma_f32_16x16x32_bf16 v[80:83], a[88:91], v[36:39], v[80:83]
  ds_read_b64_tr_b16 v[58:59], v17 offset:38912
  v_mfma_f32_16x16x32_bf16 v[84:87], a[84:87], v[32:35], v[84:87]
  ds_read_b64_tr_b16 v[60:61], v17 offset:27648
  v_mfma_f32_16x16x32_bf16 v[84:87], a[92:95], v[36:39], v[84:87]
  ds_read_b64_tr_b16 v[62:63], v17 offset:39936
  s_waitcnt lgkmcnt(8)
  v_mfma_f32_16x16x32_bf16 v[88:91], a[80:83], v[40:43], v[88:91]
  ds_read_b64_tr_b16 v[32:33], v18 offset:26624
  buffer_store_dwordx2 v[180:181], v7, s[40:43], 0 offen offset:3584 sc1
  v_mfma_f32_16x16x32_bf16 v[88:91], a[88:91], v[44:47], v[88:91]
  ds_read_b64_tr_b16 v[34:35], v18 offset:38912
  global_load_lds_dwordx4 v28, s[56:57] offset:1024
  v_mfma_f32_16x16x32_bf16 v[92:95], a[84:87], v[40:43], v[92:95]
  ds_read_b64_tr_b16 v[36:37], v18 offset:27648
  v_mfma_f32_16x16x32_bf16 v[92:95], a[92:95], v[44:47], v[92:95]
  ds_read_b64_tr_b16 v[38:39], v18 offset:39936
  s_waitcnt lgkmcnt(8)
  v_mfma_f32_16x16x32_bf16 v[96:99], a[80:83], v[48:51], v[96:99]
  ds_read_b64_tr_b16 v[40:41], v19 offset:26624
  v_mfma_f32_16x16x32_bf16 v[96:99], a[88:91], v[52:55], v[96:99]
  ds_read_b64_tr_b16 v[42:43], v19 offset:38912
  buffer_store_dwordx2 v[182:183], v7, s[40:43], s64 offen offset:0 sc1
  v_mfma_f32_16x16x32_bf16 v[100:103], a[84:87], v[48:51], v[100:103]
  ds_read_b64_tr_b16 v[44:45], v19 offset:27648
  global_load_lds_dwordx4 v29, s[56:57] offset:2048
  v_mfma_f32_16x16x32_bf16 v[100:103], a[92:95], v[52:55], v[100:103]
  ds_read_b64_tr_b16 v[46:47], v19 offset:39936
  s_waitcnt lgkmcnt(8)
  v_mfma_f32_16x16x32_bf16 v[104:107], a[80:83], v[56:59], v[104:107]
  ds_read_b64_tr_b16 v[48:49], v16 offset:28672
  v_mfma_f32_16x16x32_bf16 v[104:107], a[88:91], v[60:63], v[104:107]
  ds_read_b64_tr_b16 v[50:51], v16 offset:40960
  v_mfma_f32_16x16x32_bf16 v[108:111], a[84:87], v[56:59], v[108:111]
  ds_read_b64_tr_b16 v[52:53], v16 offset:29696
  s_waitcnt vmcnt(21) lgkmcnt(7)
  v_mfma_f32_16x16x32_bf16 v[108:111], a[92:95], v[60:63], v[108:111]
  ds_read_b64_tr_b16 v[54:55], v16 offset:41984
  s_barrier
  v_mfma_f32_16x16x32_bf16 v[112:115], a[80:83], v[32:35], v[112:115]
  ds_read_b64_tr_b16 v[56:57], v12 offset:0
  s_mul_i32 s56, s80, 1728
  v_mfma_f32_16x16x32_bf16 v[112:115], a[88:91], v[36:39], v[112:115]
  ds_read_b64_tr_b16 v[58:59], v12 offset:12288
  s_sub_u32 s52, s52, 2304
  v_mfma_f32_16x16x32_bf16 v[116:119], a[84:87], v[32:35], v[116:119]
  ds_read_b64_tr_b16 v[60:61], v12 offset:1024
  s_subb_u32 s53, s53, 0
  v_mfma_f32_16x16x32_bf16 v[116:119], a[92:95], v[36:39], v[116:119]
  ds_read_b64_tr_b16 v[62:63], v12 offset:13312
  s_waitcnt lgkmcnt(8)
  v_mfma_f32_16x16x32_bf16 v[120:123], a[80:83], v[40:43], v[120:123]
  ds_read_b64_tr_b16 v[32:33], v13 offset:0
  s_add_u32 s56, s52, s56
  v_mfma_f32_16x16x32_bf16 v[120:123], a[88:91], v[44:47], v[120:123]
  ds_read_b64_tr_b16 v[34:35], v13 offset:12288
  s_addc_u32 s57, s53, 0
  v_mfma_f32_16x16x32_bf16 v[124:127], a[84:87], v[40:43], v[124:127]
  ds_read_b64_tr_b16 v[36:37], v13 offset:1024
  s_add_u32 m0, s50, 0
  v_mfma_f32_16x16x32_bf16 v[124:127], a[92:95], v[44:47], v[124:127]
  ds_read_b64_tr_b16 v[38:39], v13 offset:13312
  s_waitcnt lgkmcnt(8)
  v_mfma_f32_16x16x32_bf16 v[128:131], a[80:83], v[48:51], v[128:131]
  ds_read_b64_tr_b16 v[40:41], v14 offset:0
  global_load_lds_dwordx4 v22, s[56:57] offset:0
  v_mfma_f32_16x16x32_bf16 v[128:131], a[88:91], v[52:55], v[128:131]
  ds_read_b64_tr_b16 v[42:43], v14 offset:12288
  buffer_store_dword v138, v7, s[40:43], s65 offen offset:1024 sc1
  v_mfma_f32_16x16x32_bf16 v[132:135], a[84:87], v[48:51], v[132:135]
  ds_read_b64_tr_b16 v[44:45], v14 offset:1024
  global_load_lds_dwordx4 v23, s[56:57] offset:1024
  v_mfma_f32_16x16x32_bf16 v[132:135], a[92:95], v[52:55], v[132:135]
  ds_read_b64_tr_b16 v[46:47], v14 offset:13312
  s_waitcnt lgkmcnt(8)
  v_mfma_f32_16x16x32_bf16 v[64:67], a[96:99], v[56:59], v[64:67]
  ds_read_b64_tr_b16 v[48:49], v15 offset:0
  v_mfma_f32_16x16x32_bf16 v[64:67], a[104:107], v[60:63], v[64:67]
  ds_read_b64_tr_b16 v[50:51], v15 offset:12288
  v_mfma_f32_16x16x32_bf16 v[68:71], a[100:103], v[56:59], v[68:71]
  ds_read_b64_tr_b16 v[52:53], v15 offset:1024
  v_mfma_f32_16x16x32_bf16 v[68:71], a[108:111], v[60:63], v[68:71]
  ds_read_b64_tr_b16 v[54:55], v15 offset:13312
  s_waitcnt lgkmcnt(8)
  v_mfma_f32_16x16x32_bf16 v[72:75], a[96:99], v[32:35], v[72:75]
  ds_read_b64_tr_b16 v[56:57], v12 offset:2048
  global_load_lds_dwordx4 v26, s[56:57] offset:2048
  v_mfma_f32_16x16x32_bf16 v[72:75], a[104:107], v[36:39], v[72:75]
  ds_read_b64_tr_b16 v[58:59], v12 offset:14336
  s_add_u32 m0, s50, 3072
  v_mfma_f32_16x16x32_bf16 v[76:79], a[100:103], v[32:35], v[76:79]
  ds_read_b64_tr_b16 v[60:61], v12 offset:3072
  v_mfma_f32_16x16x32_bf16 v[76:79], a[108:111], v[36:39], v[76:79]
  ds_read_b64_tr_b16 v[62:63], v12 offset:15360
  s_waitcnt lgkmcnt(8)
  v_mfma_f32_16x16x32_bf16 v[80:83], a[96:99], v[40:43], v[80:83]
  ds_read_b64_tr_b16 v[32:33], v13 offset:2048
  global_load_lds_dwordx4 v27, s[56:57] offset:0
  v_mfma_f32_16x16x32_bf16 v[80:83], a[104:107], v[44:47], v[80:83]
  ds_read_b64_tr_b16 v[34:35], v13 offset:14336
  v_mfma_f32_16x16x32_bf16 v[84:87], a[100:103], v[40:43], v[84:87]
  ds_read_b64_tr_b16 v[36:37], v13 offset:3072
  v_mfma_f32_16x16x32_bf16 v[84:87], a[108:111], v[44:47], v[84:87]
  ds_read_b64_tr_b16 v[38:39], v13 offset:15360
  s_waitcnt lgkmcnt(8)
  v_mfma_f32_16x16x32_bf16 v[88:91], a[96:99], v[48:51], v[88:91]
  ds_read_b64_tr_b16 v[40:41], v14 offset:2048
  v_mfma_f32_16x16x32_bf16 v[88:91], a[104:107], v[52:55], v[88:91]
  ds_read_b64_tr_b16 v[42:43], v14 offset:14336
  global_load_lds_dwordx4 v28, s[56:57] offset:1024
  v_mfma_f32_16x16x32_bf16 v[92:95], a[100:103], v[48:51], v[92:95]
  ds_read_b64_tr_b16 v[44:45], v14 offset:3072
  v_mfma_f32_16x16x32_bf16 v[92:95], a[108:111], v[52:55], v[92:95]
  ds_read_b64_tr_b16 v[46:47], v14 offset:15360
  s_waitcnt lgkmcnt(8)
  v_mfma_f32_16x16x32_bf16 v[96:99], a[96:99], v[56:59], v[96:99]
  ds_read_b64_tr_b16 v[48:49], v15 offset:2048
  v_mfma_f32_16x16x32_bf16 v[96:99], a[104:107], v[60:63], v[96:99]
  ds_read_b64_tr_b16 v[50:51], v15 offset:14336
  v_mfma_f32_16x16x32_bf16 v[100:103], a[100:103], v[56:59], v[100:103]
  ds_read_b64_tr_b16 v[52:53], v15 offset:3072
  global_load_lds_dwordx4 v29, s[56:57] offset:2048
  v_mfma_f32_16x16x32_bf16 v[100:103], a[108:111], v[60:63], v[100:103]
  ds_read_b64_tr_b16 v[54:55], v15 offset:15360
  s_waitcnt lgkmcnt(8)
  v_mfma_f32_16x16x32_bf16 v[104:107], a[96:99], v[32:35], v[104:107]
  ds_read_b64_tr_b16 v[56:57], v12 offset:4096
  v_mfma_f32_16x16x32_bf16 v[104:107], a[104:107], v[36:39], v[104:107]
  ds_read_b64_tr_b16 v[58:59], v12 offset:16384
  v_mfma_f32_16x16x32_bf16 v[108:111], a[100:103], v[32:35], v[108:111]
  ds_read_b64_tr_b16 v[60:61], v12 offset:5120
  s_waitcnt vmcnt(18) lgkmcnt(7)
  v_mfma_f32_16x16x32_bf16 v[108:111], a[108:111], v[36:39], v[108:111]
  ds_read_b64_tr_b16 v[62:63], v12 offset:17408
  s_barrier
  v_mfma_f32_16x16x32_bf16 v[112:115], a[96:99], v[40:43], v[112:115]
  ds_read_b64_tr_b16 v[32:33], v12 offset:24576
  s_mul_i32 s56, s81, 1728
  v_mfma_f32_16x16x32_bf16 v[112:115], a[104:107], v[44:47], v[112:115]
  ds_read_b64_tr_b16 v[34:35], v12 offset:36864
  s_add_u32 s56, s52, s56
  v_mfma_f32_16x16x32_bf16 v[116:119], a[100:103], v[40:43], v[116:119]
  ds_read_b64_tr_b16 v[36:37], v12 offset:25600
  s_addc_u32 s57, s53, 0
  v_mfma_f32_16x16x32_bf16 v[116:119], a[108:111], v[44:47], v[116:119]
  ds_read_b64_tr_b16 v[38:39], v12 offset:37888
  s_waitcnt lgkmcnt(8)
  v_mfma_f32_16x16x32_bf16 v[120:123], a[96:99], v[48:51], v[120:123]
  ds_read_b64_tr_b16 v[40:41], v13 offset:24576
  s_add_u32 m0, s50, 24576
  v_mfma_f32_16x16x32_bf16 v[120:123], a[104:107], v[52:55], v[120:123]
  ds_read_b64_tr_b16 v[42:43], v13 offset:36864
  global_load_lds_dwordx4 v22, s[56:57] offset:0
  v_mfma_f32_16x16x32_bf16 v[124:127], a[100:103], v[48:51], v[124:127]
  ds_read_b64_tr_b16 v[44:45], v13 offset:25600
  v_mfma_f32_16x16x32_bf16 v[124:127], a[108:111], v[52:55], v[124:127]
  ds_read_b64_tr_b16 v[46:47], v13 offset:37888
  s_waitcnt lgkmcnt(8)
  v_mfma_f32_16x16x32_bf16 v[128:131], a[96:99], v[56:59], v[128:131]
  ds_read_b64_tr_b16 v[48:49], v14 offset:24576
  v_mfma_f32_16x16x32_bf16 v[128:131], a[104:107], v[60:63], v[128:131]
  ds_read_b64_tr_b16 v[50:51], v14 offset:36864
  v_mfma_f32_16x16x32_bf16 v[132:135], a[100:103], v[56:59], v[132:135]
  ds_read_b64_tr_b16 v[52:53], v14 offset:25600
  global_load_lds_dwordx4 v23, s[56:57] offset:1024
  v_mfma_f32_16x16x32_bf16 v[132:135], a[108:111], v[60:63], v[132:135]
  ds_read_b64_tr_b16 v[54:55], v14 offset:37888
  s_waitcnt lgkmcnt(8)
  v_mfma_f32_16x16x32_bf16 v[64:67], a[112:115], v[32:35], v[64:67]
  ds_read_b64_tr_b16 v[56:57], v15 offset:24576
  v_mfma_f32_16x16x32_bf16 v[64:67], a[120:123], v[36:39], v[64:67]
  ds_read_b64_tr_b16 v[58:59], v15 offset:36864
  v_mfma_f32_16x16x32_bf16 v[68:71], a[116:119], v[32:35], v[68:71]
  ds_read_b64_tr_b16 v[60:61], v15 offset:25600
  v_mfma_f32_16x16x32_bf16 v[68:71], a[124:127], v[36:39], v[68:71]
  ds_read_b64_tr_b16 v[62:63], v15 offset:37888
  s_waitcnt lgkmcnt(8)
  v_mfma_f32_16x16x32_bf16 v[72:75], a[112:115], v[40:43], v[72:75]
  ds_read_b64_tr_b16 v[32:33], v12 offset:26624
  global_load_lds_dwordx4 v26, s[56:57] offset:2048
  v_mfma_f32_16x16x32_bf16 v[72:75], a[120:123], v[44:47], v[72:75]
  ds_read_b64_tr_b16 v[34:35], v12 offset:38912
  s_add_u32 m0, s50, 27648
  v_mfma_f32_16x16x32_bf16 v[76:79], a[116:119], v[40:43], v[76:79]
  ds_read_b64_tr_b16 v[36:37], v12 offset:27648
  v_mfma_f32_16x16x32_bf16 v[76:79], a[124:127], v[44:47], v[76:79]
  ds_read_b64_tr_b16 v[38:39], v12 offset:39936
  s_waitcnt lgkmcnt(8)
  v_mfma_f32_16x16x32_bf16 v[80:83], a[112:115], v[48:51], v[80:83]
  ds_read_b64_tr_b16 v[40:41], v13 offset:26624
  global_load_lds_dwordx4 v27, s[56:57] offset:0
  v_mfma_f32_16x16x32_bf16 v[80:83], a[120:123], v[52:55], v[80:83]
  ds_read_b64_tr_b16 v[42:43], v13 offset:38912
  v_mfma_f32_16x16x32_bf16 v[84:87], a[116:119], v[48:51], v[84:87]
  ds_read_b64_tr_b16 v[44:45], v13 offset:27648
  v_mfma_f32_16x16x32_bf16 v[84:87], a[124:127], v[52:55], v[84:87]
  ds_read_b64_tr_b16 v[46:47], v13 offset:39936
  s_waitcnt lgkmcnt(8)
  v_mfma_f32_16x16x32_bf16 v[88:91], a[112:115], v[56:59], v[88:91]
  ds_read_b64_tr_b16 v[48:49], v14 offset:26624
  v_mfma_f32_16x16x32_bf16 v[88:91], a[120:123], v[60:63], v[88:91]
  ds_read_b64_tr_b16 v[50:51], v14 offset:38912
  global_load_lds_dwordx4 v28, s[56:57] offset:1024
  v_mfma_f32_16x16x32_bf16 v[92:95], a[116:119], v[56:59], v[92:95]
  ds_read_b64_tr_b16 v[52:53], v14 offset:27648
  v_mfma_f32_16x16x32_bf16 v[92:95], a[124:127], v[60:63], v[92:95]
  ds_read_b64_tr_b16 v[54:55], v14 offset:39936
  s_waitcnt lgkmcnt(8)
  v_mfma_f32_16x16x32_bf16 v[96:99], a[112:115], v[32:35], v[96:99]
  ds_read_b64_tr_b16 v[56:57], v15 offset:26624
  v_mfma_f32_16x16x32_bf16 v[96:99], a[120:123], v[36:39], v[96:99]
  ds_read_b64_tr_b16 v[58:59], v15 offset:38912
  v_mfma_f32_16x16x32_bf16 v[100:103], a[116:119], v[32:35], v[100:103]
  ds_read_b64_tr_b16 v[60:61], v15 offset:27648
  global_load_lds_dwordx4 v29, s[56:57] offset:2048
  v_mfma_f32_16x16x32_bf16 v[100:103], a[124:127], v[36:39], v[100:103]
  ds_read_b64_tr_b16 v[62:63], v15 offset:39936
  s_waitcnt lgkmcnt(8)
  v_mfma_f32_16x16x32_bf16 v[104:107], a[112:115], v[40:43], v[104:107]
  ds_read_b64_tr_b16 v[32:33], v12 offset:28672
  v_mfma_f32_16x16x32_bf16 v[104:107], a[120:123], v[44:47], v[104:107]
  ds_read_b64_tr_b16 v[34:35], v12 offset:40960
  v_mfma_f32_16x16x32_bf16 v[108:111], a[116:119], v[40:43], v[108:111]
  ds_read_b64_tr_b16 v[36:37], v12 offset:29696
  s_waitcnt vmcnt(13) lgkmcnt(7)
  v_mfma_f32_16x16x32_bf16 v[108:111], a[124:127], v[44:47], v[108:111]
  ds_read_b64_tr_b16 v[38:39], v12 offset:41984
  s_barrier
  v_mfma_f32_16x16x32_bf16 v[112:115], a[112:115], v[48:51], v[112:115]
  ds_read_b64_tr_b16 v[40:41], v16 offset:0
  s_mul_i32 s56, s82, 1728
  v_mfma_f32_16x16x32_bf16 v[112:115], a[120:123], v[52:55], v[112:115]
  ds_read_b64_tr_b16 v[42:43], v16 offset:12288
  s_add_u32 s56, s52, s56
  v_mfma_f32_16x16x32_bf16 v[116:119], a[116:119], v[48:51], v[116:119]
  ds_read_b64_tr_b16 v[44:45], v16 offset:1024
  s_addc_u32 s57, s53, 0
  v_mfma_f32_16x16x32_bf16 v[116:119], a[124:127], v[52:55], v[116:119]
  ds_read_b64_tr_b16 v[46:47], v16 offset:13312
  s_waitcnt lgkmcnt(8)
  v_mfma_f32_16x16x32_bf16 v[120:123], a[112:115], v[56:59], v[120:123]
  ds_read_b64_tr_b16 v[48:49], v17 offset:0
  s_add_u32 m0, s50, 122880
  v_mfma_f32_16x16x32_bf16 v[120:123], a[120:123], v[60:63], v[120:123]
  ds_read_b64_tr_b16 v[50:51], v17 offset:12288
  global_load_lds_dwordx4 v22, s[56:57] offset:0
  v_mfma_f32_16x16x32_bf16 v[124:127], a[116:119], v[56:59], v[124:127]
  ds_read_b64_tr_b16 v[52:53], v17 offset:1024
  v_mfma_f32_16x16x32_bf16 v[124:127], a[124:127], v[60:63], v[124:127]
  ds_read_b64_tr_b16 v[54:55], v17 offset:13312
  s_waitcnt lgkmcnt(8)
  v_mfma_f32_16x16x32_bf16 v[128:131], a[112:115], v[32:35], v[128:131]
  ds_read_b64_tr_b16 v[56:57], v18 offset:0
  v_mfma_f32_16x16x32_bf16 v[128:131], a[120:123], v[36:39], v[128:131]
  ds_read_b64_tr_b16 v[58:59], v18 offset:12288
  v_mfma_f32_16x16x32_bf16 v[132:135], a[116:119], v[32:35], v[132:135]
  ds_read_b64_tr_b16 v[60:61], v18 offset:1024
  global_load_lds_dwordx4 v23, s[56:57] offset:1024
  v_mfma_f32_16x16x32_bf16 v[132:135], a[124:127], v[36:39], v[132:135]
  ds_read_b64_tr_b16 v[62:63], v18 offset:13312
  s_waitcnt lgkmcnt(8)
  v_mfma_f32_16x16x32_bf16 v[64:67], a[128:131], v[40:43], v[64:67]
  ds_read_b64_tr_b16 v[32:33], v19 offset:0
  v_mfma_f32_16x16x32_bf16 v[64:67], a[136:139], v[44:47], v[64:67]
  ds_read_b64_tr_b16 v[34:35], v19 offset:12288
  v_mfma_f32_16x16x32_bf16 v[68:71], a[132:135], v[40:43], v[68:71]
  ds_read_b64_tr_b16 v[36:37], v19 offset:1024
  v_mfma_f32_16x16x32_bf16 v[68:71], a[140:143], v[44:47], v[68:71]
  ds_read_b64_tr_b16 v[38:39], v19 offset:13312
  s_waitcnt lgkmcnt(8)
  v_mfma_f32_16x16x32_bf16 v[72:75], a[128:131], v[48:51], v[72:75]
  ds_read_b64_tr_b16 v[40:41], v16 offset:2048
  global_load_lds_dwordx4 v26, s[56:57] offset:2048
  v_mfma_f32_16x16x32_bf16 v[72:75], a[136:139], v[52:55], v[72:75]
  ds_read_b64_tr_b16 v[42:43], v16 offset:14336
  s_add_u32 m0, s50, 125952
  v_mfma_f32_16x16x32_bf16 v[76:79], a[132:135], v[48:51], v[76:79]
  ds_read_b64_tr_b16 v[44:45], v16 offset:3072
  v_cvt_pk_bf16_f32 v186, v64, v65
  v_mfma_f32_16x16x32_bf16 v[76:79], a[140:143], v[52:55], v[76:79]
  ds_read_b64_tr_b16 v[46:47], v16 offset:15360
  s_waitcnt lgkmcnt(8)
  v_mfma_f32_16x16x32_bf16 v[80:83], a[128:131], v[56:59], v[80:83]
  ds_read_b64_tr_b16 v[48:49], v17 offset:2048
  global_load_lds_dwordx4 v27, s[56:57] offset:0
  v_mfma_f32_16x16x32_bf16 v[80:83], a[136:139], v[60:63], v[80:83]
  ds_read_b64_tr_b16 v[50:51], v17 offset:14336
  v_cvt_pk_bf16_f32 v187, v66, v67
  v_mfma_f32_16x16x32_bf16 v[84:87], a[132:135], v[56:59], v[84:87]
  ds_read_b64_tr_b16 v[52:53], v17 offset:3072
  v_cvt_pk_bf16_f32 v188, v68, v69
  v_mfma_f32_16x16x32_bf16 v[84:87], a[140:143], v[60:63], v[84:87]
  ds_read_b64_tr_b16 v[54:55], v17 offset:15360
  s_waitcnt lgkmcnt(8)
  v_mfma_f32_16x16x32_bf16 v[88:91], a[128:131], v[32:35], v[88:91]
  ds_read_b64_tr_b16 v[56:57], v18 offset:2048
  v_cvt_pk_bf16_f32 v189, v70, v71
  v_mfma_f32_16x16x32_bf16 v[88:91], a[136:139], v[36:39], v[88:91]
  ds_read_b64_tr_b16 v[58:59], v18 offset:14336
  global_load_lds_dwordx4 v28, s[56:57] offset:1024
  v_mfma_f32_16x16x32_bf16 v[92:95], a[132:135], v[32:35], v[92:95]
  ds_read_b64_tr_b16 v[60:61], v18 offset:3072
  v_cvt_pk_bf16_f32 v192, v72, v73
  v_mfma_f32_16x16x32_bf16 v[92:95], a[140:143], v[36:39], v[92:95]
  ds_read_b64_tr_b16 v[62:63], v18 offset:15360
  s_waitcnt lgkmcnt(8)
  v_mfma_f32_16x16x32_bf16 v[96:99], a[128:131], v[40:43], v[96:99]
  ds_read_b64_tr_b16 v[32:33], v19 offset:2048
  v_cvt_pk_bf16_f32 v193, v74, v75
  v_mfma_f32_16x16x32_bf16 v[96:99], a[136:139], v[44:47], v[96:99]
  ds_read_b64_tr_b16 v[34:35], v19 offset:14336
  v_cvt_pk_bf16_f32 v194, v76, v77
  v_mfma_f32_16x16x32_bf16 v[100:103], a[132:135], v[40:43], v[100:103]
  ds_read_b64_tr_b16 v[36:37], v19 offset:3072
  global_load_lds_dwordx4 v29, s[56:57] offset:2048
  v_mfma_f32_16x16x32_bf16 v[100:103], a[140:143], v[44:47], v[100:103]
  ds_read_b64_tr_b16 v[38:39], v19 offset:15360
  s_waitcnt lgkmcnt(8)
  v_mfma_f32_16x16x32_bf16 v[104:107], a[128:131], v[48:51], v[104:107]
  ds_read_b64_tr_b16 v[40:41], v16 offset:4096
  v_cvt_pk_bf16_f32 v195, v78, v79
  v_mfma_f32_16x16x32_bf16 v[104:107], a[136:139], v[52:55], v[104:107]
  ds_read_b64_tr_b16 v[42:43], v16 offset:16384
  v_cvt_pk_bf16_f32 v198, v80, v81
  v_mfma_f32_16x16x32_bf16 v[108:111], a[132:135], v[48:51], v[108:111]
  ds_read_b64_tr_b16 v[44:45], v16 offset:5120
  s_waitcnt vmcnt(12) lgkmcnt(7)
  v_mfma_f32_16x16x32_bf16 v[108:111], a[140:143], v[52:55], v[108:111]
  ds_read_b64_tr_b16 v[46:47], v16 offset:17408
  s_barrier
  v_mfma_f32_16x16x32_bf16 v[112:115], a[128:131], v[56:59], v[112:115]
  ds_read_b64_tr_b16 v[48:49], v8 offset:0
  s_mul_i32 s56, s83, 1728
  v_mfma_f32_16x16x32_bf16 v[112:115], a[136:139], v[60:63], v[112:115]
  ds_read_b64_tr_b16 v[50:51], v8 offset:12288
  s_add_u32 s56, s52, s56
  v_mfma_f32_16x16x32_bf16 v[116:119], a[132:135], v[56:59], v[116:119]
  ds_read_b64_tr_b16 v[52:53], v8 offset:1024
  s_addc_u32 s57, s53, 0
  v_mfma_f32_16x16x32_bf16 v[116:119], a[140:143], v[60:63], v[116:119]
  ds_read_b64_tr_b16 v[54:55], v8 offset:13312
  s_waitcnt lgkmcnt(8)
  v_mfma_f32_16x16x32_bf16 v[120:123], a[128:131], v[32:35], v[120:123]
  ds_read_b64_tr_b16 v[56:57], v9 offset:0
  s_add_u32 m0, s50, 49152
  v_mfma_f32_16x16x32_bf16 v[120:123], a[136:139], v[36:39], v[120:123]
  ds_read_b64_tr_b16 v[58:59], v9 offset:12288
  global_load_lds_dwordx4 v22, s[56:57] offset:0
  v_mfma_f32_16x16x32_bf16 v[124:127], a[132:135], v[32:35], v[124:127]
  ds_read_b64_tr_b16 v[60:61], v9 offset:1024
  v_cvt_pk_bf16_f32 v199, v82, v83
  v_mfma_f32_16x16x32_bf16 v[124:127], a[140:143], v[36:39], v[124:127]
  ds_read_b64_tr_b16 v[62:63], v9 offset:13312
  s_waitcnt lgkmcnt(8)
  v_mfma_f32_16x16x32_bf16 v[128:131], a[128:131], v[40:43], v[128:131]
  ds_read_b64_tr_b16 v[32:33], v10 offset:0
  v_cvt_pk_bf16_f32 v200, v84, v85
  v_mfma_f32_16x16x32_bf16 v[128:131], a[136:139], v[44:47], v[128:131]
  ds_read_b64_tr_b16 v[34:35], v10 offset:12288
  v_cvt_pk_bf16_f32 v201, v86, v87
  v_mfma_f32_16x16x32_bf16 v[132:135], a[132:135], v[40:43], v[132:135]
  ds_read_b64_tr_b16 v[36:37], v10 offset:1024
  global_load_lds_dwordx4 v23, s[56:57] offset:1024
  v_mfma_f32_16x16x32_bf16 v[132:135], a[140:143], v[44:47], v[132:135]
  ds_read_b64_tr_b16 v[38:39], v10 offset:13312
  s_waitcnt lgkmcnt(8)
  v_mfma_f32_16x16x32_bf16 v[64:67], v[48:51], a[0:3], 0
  ds_read_b64_tr_b16 v[40:41], v11 offset:0
  v_cvt_pk_bf16_f32 v204, v88, v89
  v_mfma_f32_16x16x32_bf16 v[64:67], v[52:55], a[8:11], v[64:67]
  ds_read_b64_tr_b16 v[42:43], v11 offset:12288
  v_cvt_pk_bf16_f32 v205, v90, v91
  v_mfma_f32_16x16x32_bf16 v[68:71], v[48:51], a[4:7], 0
  ds_read_b64_tr_b16 v[44:45], v11 offset:1024
  v_cvt_pk_bf16_f32 v206, v92, v93
  v_mfma_f32_16x16x32_bf16 v[68:71], v[52:55], a[12:15], v[68:71]
  ds_read_b64_tr_b16 v[46:47], v11 offset:13312
  s_waitcnt lgkmcnt(8)
  v_mfma_f32_16x16x32_bf16 v[72:75], v[56:59], a[0:3], 0
  ds_read_b64_tr_b16 v[48:49], v8 offset:2048
  global_load_lds_dwordx4 v26, s[56:57] offset:2048
  v_mfma_f32_16x16x32_bf16 v[72:75], v[60:63], a[8:11], v[72:75]
  ds_read_b64_tr_b16 v[50:51], v8 offset:14336
  s_add_u32 m0, s50, 52224
  v_mfma_f32_16x16x32_bf16 v[76:79], v[56:59], a[4:7], 0
  ds_read_b64_tr_b16 v[52:53], v8 offset:3072
  v_cvt_pk_bf16_f32 v207, v94, v95
  v_mfma_f32_16x16x32_bf16 v[76:79], v[60:63], a[12:15], v[76:79]
  ds_read_b64_tr_b16 v[54:55], v8 offset:15360
  s_waitcnt lgkmcnt(8)
  v_mfma_f32_16x16x32_bf16 v[80:83], v[32:35], a[0:3], 0
  ds_read_b64_tr_b16 v[56:57], v9 offset:2048
  global_load_lds_dwordx4 v27, s[56:57] offset:0
  v_mfma_f32_16x16x32_bf16 v[80:83], v[36:39], a[8:11], v[80:83]
  ds_read_b64_tr_b16 v[58:59], v9 offset:14336
  v_cvt_pk_bf16_f32 v210, v96, v97
  v_mfma_f32_16x16x32_bf16 v[84:87], v[32:35], a[4:7], 0
  ds_read_b64_tr_b16 v[60:61], v9 offset:3072
  v_cvt_pk_bf16_f32 v211, v98, v99
  v_mfma_f32_16x16x32_bf16 v[84:87], v[36:39], a[12:15], v[84:87]
  ds_read_b64_tr_b16 v[62:63], v9 offset:15360
  s_waitcnt lgkmcnt(8)
  v_mfma_f32_16x16x32_bf16 v[88:91], v[40:43], a[0:3], 0
  ds_read_b64_tr_b16 v[32:33], v10 offset:2048
  v_cvt_pk_bf16_f32 v212, v100, v101
  v_mfma_f32_16x16x32_bf16 v[88:91], v[44:47], a[8:11], v[88:91]
  ds_read_b64_tr_b16 v[34:35], v10 offset:14336
  global_load_lds_dwordx4 v28, s[56:57] offset:1024
  v_mfma_f32_16x16x32_bf16 v[92:95], v[40:43], a[4:7], 0
  ds_read_b64_tr_b16 v[36:37], v10 offset:3072
  v_cvt_pk_bf16_f32 v213, v102, v103
  v_mfma_f32_16x16x32_bf16 v[92:95], v[44:47], a[12:15], v[92:95]
  ds_read_b64_tr_b16 v[38:39], v10 offset:15360
  s_waitcnt lgkmcnt(8)
  v_mfma_f32_16x16x32_bf16 v[96:99], v[48:51], a[0:3], 0
  ds_read_b64_tr_b16 v[40:41], v11 offset:2048
  v_cvt_pk_bf16_f32 v216, v104, v105
  v_mfma_f32_16x16x32_bf16 v[96:99], v[52:55], a[8:11], v[96:99]
  ds_read_b64_tr_b16 v[42:43], v11 offset:14336
  v_cvt_pk_bf16_f32 v217, v106, v107
  v_mfma_f32_16x16x32_bf16 v[100:103], v[48:51], a[4:7], 0
  ds_read_b64_tr_b16 v[44:45], v11 offset:3072
  global_load_lds_dwordx4 v29, s[56:57] offset:2048
  v_mfma_f32_16x16x32_bf16 v[100:103], v[52:55], a[12:15], v[100:103]
  ds_read_b64_tr_b16 v[46:47], v11 offset:15360
  s_waitcnt lgkmcnt(8)
  v_mfma_f32_16x16x32_bf16 v[104:107], v[56:59], a[0:3], 0
  ds_read_b64_tr_b16 v[48:49], v8 offset:4096
  v_cvt_pk_bf16_f32 v218, v108, v109
  v_mfma_f32_16x16x32_bf16 v[104:107], v[60:63], a[8:11], v[104:107]
  ds_read_b64_tr_b16 v[50:51], v8 offset:16384
  v_cvt_pk_bf16_f32 v219, v110, v111
  v_mfma_f32_16x16x32_bf16 v[108:111], v[56:59], a[4:7], 0
  ds_read_b64_tr_b16 v[52:53], v8 offset:5120
  s_waitcnt vmcnt(12) lgkmcnt(7)
  v_mfma_f32_16x16x32_bf16 v[108:111], v[60:63], a[12:15], v[108:111]
  ds_read_b64_tr_b16 v[54:55], v8 offset:17408
  v_cvt_pk_bf16_f32 v222, v112, v113
  v_cvt_pk_bf16_f32 v223, v114, v115
  s_barrier
  v_mfma_f32_16x16x32_bf16 v[112:115], v[32:35], a[0:3], 0
  ds_read_b64_tr_b16 v[56:57], v8 offset:24576
  s_mul_i32 s56, s84, 1728
  v_mfma_f32_16x16x32_bf16 v[112:115], v[36:39], a[8:11], v[112:115]
  ds_read_b64_tr_b16 v[58:59], v8 offset:36864
  s_add_u32 s56, s52, s56
  v_cvt_pk_bf16_f32 v224, v116, v117
  v_cvt_pk_bf16_f32 v225, v118, v119
  v_mfma_f32_16x16x32_bf16 v[116:119], v[32:35], a[4:7], 0
  ds_read_b64_tr_b16 v[60:61], v8 offset:25600
  s_addc_u32 s57, s53, 0
  v_mfma_f32_16x16x32_bf16 v[116:119], v[36:39], a[12:15], v[116:119]
  ds_read_b64_tr_b16 v[62:63], v8 offset:37888
  v_cvt_pk_bf16_f32 v228, v120, v121
  v_cvt_pk_bf16_f32 v229, v122, v123
  s_waitcnt lgkmcnt(8)
  v_mfma_f32_16x16x32_bf16 v[120:123], v[40:43], a[0:3], 0
  ds_read_b64_tr_b16 v[32:33], v9 offset:24576
  s_add_u32 m0, s50, 73728
  v_mfma_f32_16x16x32_bf16 v[120:123], v[44:47], a[8:11], v[120:123]
  ds_read_b64_tr_b16 v[34:35], v9 offset:36864
  global_load_lds_dwordx4 v22, s[56:57] offset:0
  v_cvt_pk_bf16_f32 v230, v124, v125
  v_cvt_pk_bf16_f32 v231, v126, v127
  v_mfma_f32_16x16x32_bf16 v[124:127], v[40:43], a[4:7], 0
  ds_read_b64_tr_b16 v[36:37], v9 offset:25600
  v_cvt_pk_bf16_f32 v234, v128, v129
  v_mfma_f32_16x16x32_bf16 v[124:127], v[44:47], a[12:15], v[124:127]
  ds_read_b64_tr_b16 v[38:39], v9 offset:37888
  v_cvt_pk_bf16_f32 v235, v130, v131
  s_waitcnt lgkmcnt(8)
  v_mfma_f32_16x16x32_bf16 v[128:131], v[48:51], a[0:3], 0
  ds_read_b64_tr_b16 v[40:41], v10 offset:24576
  v_cvt_pk_bf16_f32 v236, v132, v133
  v_mfma_f32_16x16x32_bf16 v[128:131], v[52:55], a[8:11], v[128:131]
  ds_read_b64_tr_b16 v[42:43], v10 offset:36864
  v_cvt_pk_bf16_f32 v237, v134, v135
  v_mfma_f32_16x16x32_bf16 v[132:135], v[48:51], a[4:7], 0
  ds_read_b64_tr_b16 v[44:45], v10 offset:25600
  global_load_lds_dwordx4 v23, s[56:57] offset:1024
  v_mfma_f32_16x16x32_bf16 v[132:135], v[52:55], a[12:15], v[132:135]
  ds_read_b64_tr_b16 v[46:47], v10 offset:37888
  s_waitcnt lgkmcnt(8)
  v_mfma_f32_16x16x32_bf16 v[64:67], v[56:59], a[16:19], v[64:67]
  ds_read_b64_tr_b16 v[48:49], v11 offset:24576
  buffer_store_dwordx2 v[188:189], v7, s[40:43], s64 offen offset:512 sc1
  v_mfma_f32_16x16x32_bf16 v[64:67], v[60:63], a[24:27], v[64:67]
  ds_read_b64_tr_b16 v[50:51], v11 offset:36864
  v_mfma_f32_16x16x32_bf16 v[68:71], v[56:59], a[20:23], v[68:71]
  ds_read_b64_tr_b16 v[52:53], v11 offset:25600
  v_mfma_f32_16x16x32_bf16 v[68:71], v[60:63], a[28:31], v[68:71]
  ds_read_b64_tr_b16 v[54:55], v11 offset:37888
  s_waitcnt lgkmcnt(8)
  v_mfma_f32_16x16x32_bf16 v[72:75], v[32:35], a[16:19], v[72:75]
  ds_read_b64_tr_b16 v[56:57], v8 offset:26624
  global_load_lds_dwordx4 v26, s[56:57] offset:2048
  v_mfma_f32_16x16x32_bf16 v[72:75], v[36:39], a[24:27], v[72:75]
  ds_read_b64_tr_b16 v[58:59], v8 offset:38912
  s_add_u32 m0, s50, 76800
  v_mfma_f32_16x16x32_bf16 v[76:79], v[32:35], a[20:23], v[76:79]
  ds_read_b64_tr_b16 v[60:61], v8 offset:27648
  buffer_store_dwordx2 v[194:195], v7, s[40:43], s64 offen offset:1024 sc1
  v_mfma_f32_16x16x32_bf16 v[76:79], v[36:39], a[28:31], v[76:79]
  ds_read_b64_tr_b16 v[62:63], v8 offset:39936
  s_waitcnt lgkmcnt(8)
  v_mfma_f32_16x16x32_bf16 v[80:83], v[40:43], a[16:19], v[80:83]
  ds_read_b64_tr_b16 v[32:33], v9 offset:26624
  global_load_lds_dwordx4 v27, s[56:57] offset:0
  v_mfma_f32_16x16x32_bf16 v[80:83], v[44:47], a[24:27], v[80:83]
  ds_read_b64_tr_b16 v[34:35], v9 offset:38912
  v_mfma_f32_16x16x32_bf16 v[84:87], v[40:43], a[20:23], v[84:87]
  ds_read_b64_tr_b16 v[36:37], v9 offset:27648
  v_mfma_f32_16x16x32_bf16 v[84:87], v[44:47], a[28:31], v[84:87]
  ds_read_b64_tr_b16 v[38:39], v9 offset:39936
  s_waitcnt lgkmcnt(8)
  v_mfma_f32_16x16x32_bf16 v[88:91], v[48:51], a[16:19], v[88:91]
  ds_read_b64_tr_b16 v[40:41], v10 offset:26624
  buffer_store_dwordx2 v[200:201], v7, s[40:43], s64 offen offset:1536 sc1
  v_mfma_f32_16x16x32_bf16 v[88:91], v[52:55], a[24:27], v[88:91]
  ds_read_b64_tr_b16 v[42:43], v10 offset:38912
  global_load_lds_dwordx4 v28, s[56:57] offset:1024
  v_mfma_f32_16x16x32_bf16 v[92:95], v[48:51], a[20:23], v[92:95]
  ds_read_b64_tr_b16 v[44:45], v10 offset:27648
  v_mfma_f32_16x16x32_bf16 v[92:95], v[52:55], a[28:31], v[92:95]
  ds_read_b64_tr_b16 v[46:47], v10 offset:39936
  s_waitcnt lgkmcnt(8)
  v_mfma_f32_16x16x32_bf16 v[96:99], v[56:59], a[16:19], v[96:99]
  ds_read_b64_tr_b16 v[48:49], v11 offset:26624
  v_mfma_f32_16x16x32_bf16 v[96:99], v[60:63], a[24:27], v[96:99]
  ds_read_b64_tr_b16 v[50:51], v11 offset:38912
  buffer_store_dwordx2 v[206:207], v7, s[40:43], s64 offen offset:2048 sc1
  v_mfma_f32_16x16x32_bf16 v[100:103], v[56:59], a[20:23], v[100:103]
  ds_read_b64_tr_b16 v[52:53], v11 offset:27648
  global_load_lds_dwordx4 v29, s[56:57] offset:2048
  v_mfma_f32_16x16x32_bf16 v[100:103], v[60:63], a[28:31], v[100:103]
  ds_read_b64_tr_b16 v[54:55], v11 offset:39936
  s_waitcnt lgkmcnt(8)
  v_mfma_f32_16x16x32_bf16 v[104:107], v[32:35], a[16:19], v[104:107]
  ds_read_b64_tr_b16 v[56:57], v8 offset:28672
  v_mfma_f32_16x16x32_bf16 v[104:107], v[36:39], a[24:27], v[104:107]
  ds_read_b64_tr_b16 v[58:59], v8 offset:40960
  v_mfma_f32_16x16x32_bf16 v[108:111], v[32:35], a[20:23], v[108:111]
  ds_read_b64_tr_b16 v[60:61], v8 offset:29696
  s_waitcnt vmcnt(16) lgkmcnt(7)
  v_mfma_f32_16x16x32_bf16 v[108:111], v[36:39], a[28:31], v[108:111]
  ds_read_b64_tr_b16 v[62:63], v8 offset:41984
  s_barrier
  v_mfma_f32_16x16x32_bf16 v[112:115], v[40:43], a[16:19], v[112:115]
  ds_read_b64_tr_b16 v[32:33], v16 offset:24576
  s_mul_i32 s56, s85, 1728
  v_mfma_f32_16x16x32_bf16 v[112:115], v[44:47], a[24:27], v[112:115]
  ds_read_b64_tr_b16 v[34:35], v16 offset:36864
  s_add_u32 s56, s52, s56
  v_mfma_f32_16x16x32_bf16 v[116:119], v[40:43], a[20:23], v[116:119]
  ds_read_b64_tr_b16 v[36:37], v16 offset:25600
  s_addc_u32 s57, s53, 0
  v_mfma_f32_16x16x32_bf16 v[116:119], v[44:47], a[28:31], v[116:119]
  ds_read_b64_tr_b16 v[38:39], v16 offset:37888
  s_waitcnt lgkmcnt(8)
  v_mfma_f32_16x16x32_bf16 v[120:123], v[48:51], a[16:19], v[120:123]
  ds_read_b64_tr_b16 v[40:41], v17 offset:24576
  s_add_u32 m0, s50, 98304
  v_mfma_f32_16x16x32_bf16 v[120:123], v[52:55], a[24:27], v[120:123]
  ds_read_b64_tr_b16 v[42:43], v17 offset:36864
  global_load_lds_dwordx4 v22, s[56:57] offset:0
  v_mfma_f32_16x16x32_bf16 v[124:127], v[48:51], a[20:23], v[124:127]
  ds_read_b64_tr_b16 v[44:45], v17 offset:25600
  buffer_store_dwordx2 v[212:213], v7, s[40:43], s64 offen offset:2560 sc1
  v_mfma_f32_16x16x32_bf16 v[124:127], v[52:55], a[28:31], v[124:127]
  ds_read_b64_tr_b16 v[46:47], v17 offset:37888
  s_waitcnt lgkmcnt(8)
  v_mfma_f32_16x16x32_bf16 v[128:131], v[56:59], a[16:19], v[128:131]
  ds_read_b64_tr_b16 v[48:49], v18 offset:24576
  v_mfma_f32_16x16x32_bf16 v[128:131], v[60:63], a[24:27], v[128:131]
  ds_read_b64_tr_b16 v[50:51], v18 offset:36864
  v_mfma_f32_16x16x32_bf16 v[132:135], v[56:59], a[20:23], v[132:135]
  ds_read_b64_tr_b16 v[52:53], v18 offset:25600
  global_load_lds_dwordx4 v23, s[56:57] offset:1024
  v_mfma_f32_16x16x32_bf16 v[132:135], v[60:63], a[28:31], v[132:135]
  ds_read_b64_tr_b16 v[54:55], v18 offset:37888
  s_waitcnt lgkmcnt(8)
  v_mfma_f32_16x16x32_bf16 v[64:67], v[32:35], a[32:35], v[64:67]
  ds_read_b64_tr_b16 v[56:57], v19 offset:24576
  buffer_store_dwordx2 v[218:219], v7, s[40:43], s64 offen offset:3072 sc1
  v_mfma_f32_16x16x32_bf16 v[64:67], v[36:39], a[40:43], v[64:67]
  ds_read_b64_tr_b16 v[58:59], v19 offset:36864
  v_mfma_f32_16x16x32_bf16 v[68:71], v[32:35], a[36:39], v[68:71]
  ds_read_b64_tr_b16 v[60:61], v19 offset:25600
  v_mfma_f32_16x16x32_bf16 v[68:71], v[36:39], a[44:47], v[68:71]
  ds_read_b64_tr_b16 v[62:63], v19 offset:37888
  s_waitcnt lgkmcnt(8)
  v_mfma_f32_16x16x32_bf16 v[72:75], v[40:43], a[32:35], v[72:75]
  ds_read_b64_tr_b16 v[32:33], v16 offset:26624
  global_load_lds_dwordx4 v26, s[56:57] offset:2048
  v_mfma_f32_16x16x32_bf16 v[72:75], v[44:47], a[40:43], v[72:75]
  ds_read_b64_tr_b16 v[34:35], v16 offset:38912
  s_add_u32 m0, s50, 101376
  v_mfma_f32_16x16x32_bf16 v[76:79], v[40:43], a[36:39], v[76:79]
  ds_read_b64_tr_b16 v[36:37], v16 offset:27648
  buffer_store_dwordx2 v[224:225], v7, s[40:43], s64 offen offset:3584 sc1
  v_mfma_f32_16x16x32_bf16 v[76:79], v[44:47], a[44:47], v[76:79]
  ds_read_b64_tr_b16 v[38:39], v16 offset:39936
  s_waitcnt lgkmcnt(8)
  v_mfma_f32_16x16x32_bf16 v[80:83], v[48:51], a[32:35], v[80:83]
  ds_read_b64_tr_b16 v[40:41], v17 offset:26624
  global_load_lds_dwordx4 v27, s[56:57] offset:0
  v_mfma_f32_16x16x32_bf16 v[80:83], v[52:55], a[40:43], v[80:83]
  ds_read_b64_tr_b16 v[42:43], v17 offset:38912
  v_mfma_f32_16x16x32_bf16 v[84:87], v[48:51], a[36:39], v[84:87]
  ds_read_b64_tr_b16 v[44:45], v17 offset:27648
  v_mfma_f32_16x16x32_bf16 v[84:87], v[52:55], a[44:47], v[84:87]
  ds_read_b64_tr_b16 v[46:47], v17 offset:39936
  s_waitcnt lgkmcnt(8)
  v_mfma_f32_16x16x32_bf16 v[88:91], v[56:59], a[32:35], v[88:91]
  ds_read_b64_tr_b16 v[48:49], v18 offset:26624
  buffer_store_dwordx2 v[230:231], v7, s[40:43], s65 offen offset:0 sc1
  v_mfma_f32_16x16x32_bf16 v[88:91], v[60:63], a[40:43], v[88:91]
  ds_read_b64_tr_b16 v[50:51], v18 offset:38912
  global_load_lds_dwordx4 v28, s[56:57] offset:1024
  v_mfma_f32_16x16x32_bf16 v[92:95], v[56:59], a[36:39], v[92:95]
  ds_read_b64_tr_b16 v[52:53], v18 offset:27648
  v_mfma_f32_16x16x32_bf16 v[92:95], v[60:63], a[44:47], v[92:95]
  ds_read_b64_tr_b16 v[54:55], v18 offset:39936
  s_waitcnt lgkmcnt(8)
  v_mfma_f32_16x16x32_bf16 v[96:99], v[32:35], a[32:35], v[96:99]
  ds_read_b64_tr_b16 v[56:57], v19 offset:26624
  v_mfma_f32_16x16x32_bf16 v[96:99], v[36:39], a[40:43], v[96:99]
  ds_read_b64_tr_b16 v[58:59], v19 offset:38912
  buffer_store_dwordx2 v[236:237], v7, s[40:43], s65 offen offset:512 sc1
  v_mfma_f32_16x16x32_bf16 v[100:103], v[32:35], a[36:39], v[100:103]
  ds_read_b64_tr_b16 v[60:61], v19 offset:27648
  global_load_lds_dwordx4 v29, s[56:57] offset:2048
  v_mfma_f32_16x16x32_bf16 v[100:103], v[36:39], a[44:47], v[100:103]
  ds_read_b64_tr_b16 v[62:63], v19 offset:39936
  s_waitcnt lgkmcnt(8)
  v_mfma_f32_16x16x32_bf16 v[104:107], v[40:43], a[32:35], v[104:107]
  ds_read_b64_tr_b16 v[32:33], v16 offset:28672
  v_mfma_f32_16x16x32_bf16 v[104:107], v[44:47], a[40:43], v[104:107]
  ds_read_b64_tr_b16 v[34:35], v16 offset:40960
  v_mfma_f32_16x16x32_bf16 v[108:111], v[40:43], a[36:39], v[108:111]
  ds_read_b64_tr_b16 v[36:37], v16 offset:29696
  s_waitcnt vmcnt(21) lgkmcnt(7)
  v_mfma_f32_16x16x32_bf16 v[108:111], v[44:47], a[44:47], v[108:111]
  ds_read_b64_tr_b16 v[38:39], v16 offset:41984
  s_barrier
  v_mfma_f32_16x16x32_bf16 v[112:115], v[48:51], a[32:35], v[112:115]
  ds_read_b64_tr_b16 v[40:41], v12 offset:0
  s_mul_i32 s56, s86, 1728
  v_mfma_f32_16x16x32_bf16 v[112:115], v[52:55], a[40:43], v[112:115]
  ds_read_b64_tr_b16 v[42:43], v12 offset:12288
  s_add_u32 s56, s52, s56
  v_mfma_f32_16x16x32_bf16 v[116:119], v[48:51], a[36:39], v[116:119]
  ds_read_b64_tr_b16 v[44:45], v12 offset:1024
  s_addc_u32 s57, s53, 0
  v_mfma_f32_16x16x32_bf16 v[116:119], v[52:55], a[44:47], v[116:119]
  ds_read_b64_tr_b16 v[46:47], v12 offset:13312
  s_waitcnt lgkmcnt(8)
  v_mfma_f32_16x16x32_bf16 v[120:123], v[56:59], a[32:35], v[120:123]
  ds_read_b64_tr_b16 v[48:49], v13 offset:0
  s_add_u32 m0, s50, 0
  v_mfma_f32_16x16x32_bf16 v[120:123], v[60:63], a[40:43], v[120:123]
  ds_read_b64_tr_b16 v[50:51], v13 offset:12288
  global_load_lds_dwordx4 v22, s[56:57] offset:0
  v_mfma_f32_16x16x32_bf16 v[124:127], v[56:59], a[36:39], v[124:127]
  ds_read_b64_tr_b16 v[52:53], v13 offset:1024
  v_mfma_f32_16x16x32_bf16 v[124:127], v[60:63], a[44:47], v[124:127]
  ds_read_b64_tr_b16 v[54:55], v13 offset:13312
  s_waitcnt lgkmcnt(8)
  v_mfma_f32_16x16x32_bf16 v[128:131], v[32:35], a[32:35], v[128:131]
  ds_read_b64_tr_b16 v[56:57], v14 offset:0
  v_mfma_f32_16x16x32_bf16 v[128:131], v[36:39], a[40:43], v[128:131]
  ds_read_b64_tr_b16 v[58:59], v14 offset:12288
  v_mfma_f32_16x16x32_bf16 v[132:135], v[32:35], a[36:39], v[132:135]
  ds_read_b64_tr_b16 v[60:61], v14 offset:1024
  global_load_lds_dwordx4 v23, s[56:57] offset:1024
  v_mfma_f32_16x16x32_bf16 v[132:135], v[36:39], a[44:47], v[132:135]
  ds_read_b64_tr_b16 v[62:63], v14 offset:13312
  s_waitcnt lgkmcnt(8)
  v_mfma_f32_16x16x32_bf16 v[64:67], v[40:43], a[48:51], v[64:67]
  ds_read_b64_tr_b16 v[32:33], v15 offset:0
  v_mov_b32 v240, 0x0c0c0504
  v_mfma_f32_16x16x32_bf16 v[64:67], v[44:47], a[56:59], v[64:67]
  ds_read_b64_tr_b16 v[34:35], v15 offset:12288
  v_mov_b32 v241, 0x05040c0c
  v_mfma_f32_16x16x32_bf16 v[68:71], v[40:43], a[52:55], v[68:71]
  ds_read_b64_tr_b16 v[36:37], v15 offset:1024
  v_cndmask_b32 v240, v240, v241, s[78:79]
  v_mfma_f32_16x16x32_bf16 v[68:71], v[44:47], a[60:63], v[68:71]
  ds_read_b64_tr_b16 v[38:39], v15 offset:13312
  s_waitcnt lgkmcnt(8)
  v_mfma_f32_16x16x32_bf16 v[72:75], v[48:51], a[48:51], v[72:75]
  ds_read_b64_tr_b16 v[40:41], v12 offset:2048
  global_load_lds_dwordx4 v26, s[56:57] offset:2048
  v_mfma_f32_16x16x32_bf16 v[72:75], v[52:55], a[56:59], v[72:75]
  ds_read_b64_tr_b16 v[42:43], v12 offset:14336
  s_add_u32 m0, s50, 3072
  v_mfma_f32_16x16x32_bf16 v[76:79], v[48:51], a[52:55], v[76:79]
  ds_read_b64_tr_b16 v[44:45], v12 offset:3072
  v_add_u32 v241, 0x02020202, v240
  v_mfma_f32_16x16x32_bf16 v[76:79], v[52:55], a[60:63], v[76:79]
  ds_read_b64_tr_b16 v[46:47], v12 offset:15360
  s_waitcnt lgkmcnt(8)
  v_mfma_f32_16x16x32_bf16 v[80:83], v[56:59], a[48:51], v[80:83]
  ds_read_b64_tr_b16 v[48:49], v13 offset:2048
  global_load_lds_dwordx4 v27, s[56:57] offset:0
  v_mfma_f32_16x16x32_bf16 v[80:83], v[60:63], a[56:59], v[80:83]
  ds_read_b64_tr_b16 v[50:51], v13 offset:14336
  v_mov_b32 v242, 0x0c0c0c0c
  v_mfma_f32_16x16x32_bf16 v[84:87], v[56:59], a[52:55], v[84:87]
  ds_read_b64_tr_b16 v[52:53], v13 offset:3072
  v_perm_b32 v243, -1, -1, v240
  v_mfma_f32_16x16x32_bf16 v[84:87], v[60:63], a[60:63], v[84:87]
  ds_read_b64_tr_b16 v[54:55], v13 offset:15360
  s_waitcnt lgkmcnt(8)
  v_mfma_f32_16x16x32_bf16 v[88:91], v[32:35], a[48:51], v[88:91]
  ds_read_b64_tr_b16 v[56:57], v14 offset:2048
  v_bfi_b32 v241, v243, v241, v242
  v_mfma_f32_16x16x32_bf16 v[88:91], v[36:39], a[56:59], v[88:91]
  ds_read_b64_tr_b16 v[58:59], v14 offset:14336
  global_load_lds_dwordx4 v28, s[56:57] offset:1024
  v_mfma_f32_16x16x32_bf16 v[92:95], v[32:35], a[52:55], v[92:95]
  ds_read_b64_tr_b16 v[60:61], v14 offset:3072
  v_cndmask_b32 v140, v240, v242, s[14:15]
  v_mfma_f32_16x16x32_bf16 v[92:95], v[36:39], a[60:63], v[92:95]
  ds_read_b64_tr_b16 v[62:63], v14 offset:15360
  s_waitcnt lgkmcnt(8)
  v_mfma_f32_16x16x32_bf16 v[96:99], v[40:43], a[48:51], v[96:99]
  ds_read_b64_tr_b16 v[32:33], v15 offset:2048
  v_cndmask_b32 v141, v241, v242, s[16:17]
  v_mfma_f32_16x16x32_bf16 v[96:99], v[44:47], a[56:59], v[96:99]
  ds_read_b64_tr_b16 v[34:35], v15 offset:14336
  v_cndmask_b32 v142, v242, v240, s[14:15]
  v_mfma_f32_16x16x32_bf16 v[100:103], v[40:43], a[52:55], v[100:103]
  ds_read_b64_tr_b16 v[36:37], v15 offset:3072
  global_load_lds_dwordx4 v29, s[56:57] offset:2048
  v_mfma_f32_16x16x32_bf16 v[100:103], v[44:47], a[60:63], v[100:103]
  ds_read_b64_tr_b16 v[38:39], v15 offset:15360
  s_waitcnt lgkmcnt(8)
  v_mfma_f32_16x16x32_bf16 v[104:107], v[48:51], a[48:51], v[104:107]
  ds_read_b64_tr_b16 v[40:41], v12 offset:4096
  v_cndmask_b32 v143, v242, v241, s[16:17]
  v_mfma_f32_16x16x32_bf16 v[104:107], v[52:55], a[56:59], v[104:107]
  ds_read_b64_tr_b16 v[42:43], v12 offset:16384
  s_mul_i32 s58, s44, 192
  v_mfma_f32_16x16x32_bf16 v[108:111], v[48:51], a[52:55], v[108:111]
  ds_read_b64_tr_b16 v[44:45], v12 offset:5120
  s_waitcnt vmcnt(17) lgkmcnt(7)
  v_mfma_f32_16x16x32_bf16 v[108:111], v[52:55], a[60:63], v[108:111]
  ds_read_b64_tr_b16 v[46:47], v12 offset:17408
  s_barrier
  v_mfma_f32_16x16x32_bf16 v[112:115], v[56:59], a[48:51], v[112:115]
  ds_read_b64_tr_b16 v[48:49], v12 offset:24576
  s_mul_i32 s56, s87, 1728
  v_mfma_f32_16x16x32_bf16 v[112:115], v[60:63], a[56:59], v[112:115]
  ds_read_b64_tr_b16 v[50:51], v12 offset:36864
  s_add_u32 s56, s52, s56
  v_mfma_f32_16x16x32_bf16 v[116:119], v[56:59], a[52:55], v[116:119]
  ds_read_b64_tr_b16 v[52:53], v12 offset:25600
  s_addc_u32 s57, s53, 0
  v_mfma_f32_16x16x32_bf16 v[116:119], v[60:63], a[60:63], v[116:119]
  ds_read_b64_tr_b16 v[54:55], v12 offset:37888
  s_waitcnt lgkmcnt(8)
  v_mfma_f32_16x16x32_bf16 v[120:123], v[32:35], a[48:51], v[120:123]
  ds_read_b64_tr_b16 v[56:57], v13 offset:24576
  s_add_u32 m0, s50, 24576
  v_mfma_f32_16x16x32_bf16 v[120:123], v[36:39], a[56:59], v[120:123]
  ds_read_b64_tr_b16 v[58:59], v13 offset:36864
  global_load_lds_dwordx4 v22, s[56:57] offset:0
  v_mfma_f32_16x16x32_bf16 v[124:127], v[32:35], a[52:55], v[124:127]
  ds_read_b64_tr_b16 v[60:61], v13 offset:25600
  v_lshrrev_b32 v241, 4, v1
  v_mfma_f32_16x16x32_bf16 v[124:127], v[36:39], a[60:63], v[124:127]
  ds_read_b64_tr_b16 v[62:63], v13 offset:37888
  s_waitcnt lgkmcnt(8)
  v_mfma_f32_16x16x32_bf16 v[128:131], v[40:43], a[48:51], v[128:131]
  ds_read_b64_tr_b16 v[32:33], v14 offset:24576
  v_and_b32 v242, 1, v1
  v_mfma_f32_16x16x32_bf16 v[128:131], v[44:47], a[56:59], v[128:131]
  ds_read_b64_tr_b16 v[34:35], v14 offset:36864
  v_lshl_add_u32 v241, v241, 2, v242
  v_mfma_f32_16x16x32_bf16 v[132:135], v[40:43], a[52:55], v[132:135]
  ds_read_b64_tr_b16 v[36:37], v14 offset:25600
  global_load_lds_dwordx4 v23, s[56:57] offset:1024
  v_mfma_f32_16x16x32_bf16 v[132:135], v[44:47], a[60:63], v[132:135]
  ds_read_b64_tr_b16 v[38:39], v14 offset:37888
  s_waitcnt lgkmcnt(8)
  v_mfma_f32_16x16x32_bf16 v[64:67], v[48:51], a[64:67], v[64:67]
  ds_read_b64_tr_b16 v[40:41], v15 offset:24576
  v_lshl_add_u32 v241, v241, 2, s58
  v_mfma_f32_16x16x32_bf16 v[64:67], v[52:55], a[72:75], v[64:67]
  ds_read_b64_tr_b16 v[42:43], v15 offset:36864
  v_add_u32 v241, 147456, v241
  v_mfma_f32_16x16x32_bf16 v[68:71], v[48:51], a[68:71], v[68:71]
  ds_read_b64_tr_b16 v[44:45], v15 offset:25600
  v_cndmask_b32 v242, 0, 64, s[14:15]
  v_mfma_f32_16x16x32_bf16 v[68:71], v[52:55], a[76:79], v[68:71]
  ds_read_b64_tr_b16 v[46:47], v15 offset:37888
  s_waitcnt lgkmcnt(8)
  v_mfma_f32_16x16x32_bf16 v[72:75], v[56:59], a[64:67], v[72:75]
  ds_read_b64_tr_b16 v[48:49], v12 offset:26624
  global_load_lds_dwordx4 v26, s[56:57] offset:2048
  v_mfma_f32_16x16x32_bf16 v[72:75], v[60:63], a[72:75], v[72:75]
  ds_read_b64_tr_b16 v[50:51], v12 offset:38912
  s_add_u32 m0, s50, 27648
  v_mfma_f32_16x16x32_bf16 v[76:79], v[56:59], a[68:71], v[76:79]
  ds_read_b64_tr_b16 v[52:53], v12 offset:27648
  v_cndmask_b32 v243, 0, 64, s[16:17]
  v_mfma_f32_16x16x32_bf16 v[76:79], v[60:63], a[76:79], v[76:79]
  ds_read_b64_tr_b16 v[54:55], v12 offset:39936
  s_waitcnt lgkmcnt(8)
  v_mfma_f32_16x16x32_bf16 v[80:83], v[32:35], a[64:67], v[80:83]
  ds_read_b64_tr_b16 v[56:57], v13 offset:26624
  global_load_lds_dwordx4 v27, s[56:57] offset:0
  v_mfma_f32_16x16x32_bf16 v[80:83], v[36:39], a[72:75], v[80:83]
  ds_read_b64_tr_b16 v[58:59], v13 offset:38912
  v_add_u32 v242, v242, v241
  v_mfma_f32_16x16x32_bf16 v[84:87], v[32:35], a[68:71], v[84:87]
  ds_read_b64_tr_b16 v[60:61], v13 offset:27648
  v_add_u32 v243, v243, v241
  v_mfma_f32_16x16x32_bf16 v[84:87], v[36:39], a[76:79], v[84:87]
  ds_read_b64_tr_b16 v[62:63], v13 offset:39936
  s_waitcnt lgkmcnt(8)
  v_mfma_f32_16x16x32_bf16 v[88:91], v[40:43], a[64:67], v[88:91]
  ds_read_b64_tr_b16 v[32:33], v14 offset:26624
  v_mfma_f32_16x16x32_bf16 v[88:91], v[44:47], a[72:75], v[88:91]
  ds_read_b64_tr_b16 v[34:35], v14 offset:38912
  global_load_lds_dwordx4 v28, s[56:57] offset:1024
  v_mfma_f32_16x16x32_bf16 v[92:95], v[40:43], a[68:71], v[92:95]
  ds_read_b64_tr_b16 v[36:37], v14 offset:27648
  ds_read_b32 v30, v25 offset:64
  v_mfma_f32_16x16x32_bf16 v[92:95], v[44:47], a[76:79], v[92:95]
  ds_read_b64_tr_b16 v[38:39], v14 offset:39936
  s_waitcnt lgkmcnt(9)
  v_mfma_f32_16x16x32_bf16 v[96:99], v[48:51], a[64:67], v[96:99]
  ds_read_b64_tr_b16 v[40:41], v15 offset:26624
  v_mfma_f32_16x16x32_bf16 v[96:99], v[52:55], a[72:75], v[96:99]
  ds_read_b64_tr_b16 v[42:43], v15 offset:38912
  ds_read_b32 v144, v242 offset:0
  v_mfma_f32_16x16x32_bf16 v[100:103], v[48:51], a[68:71], v[100:103]
  ds_read_b64_tr_b16 v[44:45], v15 offset:27648
  global_load_lds_dwordx4 v29, s[56:57] offset:2048
  v_mfma_f32_16x16x32_bf16 v[100:103], v[52:55], a[76:79], v[100:103]
  ds_read_b64_tr_b16 v[46:47], v15 offset:39936
  s_waitcnt lgkmcnt(10)
  v_mfma_f32_16x16x32_bf16 v[104:107], v[56:59], a[64:67], v[104:107]
  ds_read_b64_tr_b16 v[48:49], v12 offset:28672
  ds_read_b32 v145, v243 offset:8
  v_mfma_f32_16x16x32_bf16 v[104:107], v[60:63], a[72:75], v[104:107]
  ds_read_b64_tr_b16 v[50:51], v12 offset:40960
  v_mfma_f32_16x16x32_bf16 v[108:111], v[56:59], a[68:71], v[108:111]
  ds_read_b64_tr_b16 v[52:53], v12 offset:29696
  s_waitcnt vmcnt(12) lgkmcnt(9)
  v_mfma_f32_16x16x32_bf16 v[108:111], v[60:63], a[76:79], v[108:111]
  ds_read_b64_tr_b16 v[54:55], v12 offset:41984
  s_barrier
  v_mfma_f32_16x16x32_bf16 v[112:115], v[32:35], a[64:67], v[112:115]
  ds_read_b64_tr_b16 v[56:57], v16 offset:0
  s_mul_i32 s56, s88, 1728
  v_mfma_f32_16x16x32_bf16 v[112:115], v[36:39], a[72:75], v[112:115]
  ds_read_b64_tr_b16 v[58:59], v16 offset:12288
  s_add_u32 s56, s52, s56
  v_mfma_f32_16x16x32_bf16 v[116:119], v[32:35], a[68:71], v[116:119]
  ds_read_b64_tr_b16 v[60:61], v16 offset:1024
  s_addc_u32 s57, s53, 0
  v_mfma_f32_16x16x32_bf16 v[116:119], v[36:39], a[76:79], v[116:119]
  ds_read_b64_tr_b16 v[62:63], v16 offset:13312
  s_waitcnt lgkmcnt(9)
  v_mfma_f32_16x16x32_bf16 v[120:123], v[40:43], a[64:67], v[120:123]
  ds_read_b64_tr_b16 v[32:33], v17 offset:0
  s_add_u32 m0, s50, 122880
  v_mfma_f32_16x16x32_bf16 v[120:123], v[44:47], a[72:75], v[120:123]
  ds_read_b64_tr_b16 v[34:35], v17 offset:12288
  global_load_lds_dwordx4 v22, s[56:57] offset:0
  v_mfma_f32_16x16x32_bf16 v[124:127], v[40:43], a[68:71], v[124:127]
  ds_read_b64_tr_b16 v[36:37], v17 offset:1024
  ds_read_b32 v31, v25 offset:128
  v_mfma_f32_16x16x32_bf16 v[124:127], v[44:47], a[76:79], v[124:127]
  ds_read_b64_tr_b16 v[38:39], v17 offset:13312
  s_waitcnt lgkmcnt(9)
  v_mfma_f32_16x16x32_bf16 v[128:131], v[48:51], a[64:67], v[128:131]
  ds_read_b64_tr_b16 v[40:41], v18 offset:0
  buffer_atomic_add v139, v24, s[40:43], s66 offen offset:40 sc1
  v_mfma_f32_16x16x32_bf16 v[128:131], v[52:55], a[72:75], v[128:131]
  ds_read_b64_tr_b16 v[42:43], v18 offset:12288
  ds_read_b32 v146, v242 offset:64
  v_mfma_f32_16x16x32_bf16 v[132:135], v[48:51], a[68:71], v[132:135]
  ds_read_b64_tr_b16 v[44:45], v18 offset:1024
  global_load_lds_dwordx4 v23, s[56:57] offset:1024
  v_mfma_f32_16x16x32_bf16 v[132:135], v[52:55], a[76:79], v[132:135]
  ds_read_b64_tr_b16 v[46:47], v18 offset:13312
  s_waitcnt lgkmcnt(10)
  v_mfma_f32_16x16x32_bf16 v[64:67], v[56:59], a[80:83], v[64:67]
  ds_read_b64_tr_b16 v[48:49], v19 offset:0
  ds_read_b32 v147, v243 offset:72
  v_mfma_f32_16x16x32_bf16 v[64:67], v[60:63], a[88:91], v[64:67]
  ds_read_b64_tr_b16 v[50:51], v19 offset:12288
  v_mfma_f32_16x16x32_bf16 v[68:71], v[56:59], a[84:87], v[68:71]
  ds_read_b64_tr_b16 v[52:53], v19 offset:1024
  v_mfma_f32_16x16x32_bf16 v[68:71], v[60:63], a[92:95], v[68:71]
  ds_read_b64_tr_b16 v[54:55], v19 offset:13312
  s_waitcnt lgkmcnt(10)
  v_mfma_f32_16x16x32_bf16 v[72:75], v[32:35], a[80:83], v[72:75]
  ds_read_b64_tr_b16 v[56:57], v16 offset:2048
  global_load_lds_dwordx4 v26, s[56:57] offset:2048
  v_mfma_f32_16x16x32_bf16 v[72:75], v[36:39], a[88:91], v[72:75]
  ds_read_b64_tr_b16 v[58:59], v16 offset:14336
  s_add_u32 m0, s50, 125952
  v_mfma_f32_16x16x32_bf16 v[76:79], v[32:35], a[84:87], v[76:79]
  ds_read_b64_tr_b16 v[60:61], v16 offset:3072
  v_mfma_f32_16x16x32_bf16 v[76:79], v[36:39], a[92:95], v[76:79]
  ds_read_b64_tr_b16 v[62:63], v16 offset:15360
  s_waitcnt lgkmcnt(9)
  v_mfma_f32_16x16x32_bf16 v[80:83], v[40:43], a[80:83], v[80:83]
  ds_read_b64_tr_b16 v[32:33], v17 offset:2048
  global_load_lds_dwordx4 v27, s[56:57] offset:0
  v_mfma_f32_16x16x32_bf16 v[80:83], v[44:47], a[88:91], v[80:83]
  ds_read_b64_tr_b16 v[34:35], v17 offset:14336
  v_mfma_f32_16x16x32_bf16 v[84:87], v[40:43], a[84:87], v[84:87]
  ds_read_b64_tr_b16 v[36:37], v17 offset:3072
  v_mfma_f32_16x16x32_bf16 v[84:87], v[44:47], a[92:95], v[84:87]
  ds_read_b64_tr_b16 v[38:39], v17 offset:15360
  s_waitcnt lgkmcnt(8)
  v_mfma_f32_16x16x32_bf16 v[88:91], v[48:51], a[80:83], v[88:91]
  ds_read_b64_tr_b16 v[40:41], v18 offset:2048
  v_mfma_f32_16x16x32_bf16 v[88:91], v[52:55], a[88:91], v[88:91]
  ds_read_b64_tr_b16 v[42:43], v18 offset:14336
  global_load_lds_dwordx4 v28, s[56:57] offset:1024
  v_mfma_f32_16x16x32_bf16 v[92:95], v[48:51], a[84:87], v[92:95]
  ds_read_b64_tr_b16 v[44:45], v18 offset:3072
  v_mfma_f32_16x16x32_bf16 v[92:95], v[52:55], a[92:95], v[92:95]
  ds_read_b64_tr_b16 v[46:47], v18 offset:15360
  s_waitcnt lgkmcnt(8)
  v_mfma_f32_16x16x32_bf16 v[96:99], v[56:59], a[80:83], v[96:99]
  ds_read_b64_tr_b16 v[48:49], v19 offset:2048
  v_mfma_f32_16x16x32_bf16 v[96:99], v[60:63], a[88:91], v[96:99]
  ds_read_b64_tr_b16 v[50:51], v19 offset:14336
  v_mfma_f32_16x16x32_bf16 v[100:103], v[56:59], a[84:87], v[100:103]
  ds_read_b64_tr_b16 v[52:53], v19 offset:3072
  global_load_lds_dwordx4 v29, s[56:57] offset:2048
  v_mfma_f32_16x16x32_bf16 v[100:103], v[60:63], a[92:95], v[100:103]
  ds_read_b64_tr_b16 v[54:55], v19 offset:15360
  s_waitcnt lgkmcnt(8)
  v_mfma_f32_16x16x32_bf16 v[104:107], v[32:35], a[80:83], v[104:107]
  ds_read_b64_tr_b16 v[56:57], v16 offset:4096
  v_mfma_f32_16x16x32_bf16 v[104:107], v[36:39], a[88:91], v[104:107]
  ds_read_b64_tr_b16 v[58:59], v16 offset:16384
  v_mfma_f32_16x16x32_bf16 v[108:111], v[32:35], a[84:87], v[108:111]
  ds_read_b64_tr_b16 v[60:61], v16 offset:5120
  s_waitcnt vmcnt(13) lgkmcnt(7)
  v_mfma_f32_16x16x32_bf16 v[108:111], v[36:39], a[92:95], v[108:111]
  ds_read_b64_tr_b16 v[62:63], v16 offset:17408
  s_barrier
  v_mfma_f32_16x16x32_bf16 v[112:115], v[40:43], a[80:83], v[112:115]
  ds_read_b64_tr_b16 v[32:33], v8 offset:0
  s_add_u32 s56, s54, s80
  v_mfma_f32_16x16x32_bf16 v[112:115], v[44:47], a[88:91], v[112:115]
  ds_read_b64_tr_b16 v[34:35], v8 offset:12288
  s_addc_u32 s57, s55, 0
  v_mfma_f32_16x16x32_bf16 v[116:119], v[40:43], a[84:87], v[116:119]
  ds_read_b64_tr_b16 v[36:37], v8 offset:1024
  s_add_u32 m0, s51, 49152
  v_mfma_f32_16x16x32_bf16 v[116:119], v[44:47], a[92:95], v[116:119]
  ds_read_b64_tr_b16 v[38:39], v8 offset:13312
  s_waitcnt lgkmcnt(8)
  v_mfma_f32_16x16x32_bf16 v[120:123], v[48:51], a[80:83], v[120:123]
  ds_read_b64_tr_b16 v[40:41], v9 offset:0
  v_mfma_f32_16x16x32_bf16 v[120:123], v[52:55], a[88:91], v[120:123]
  ds_read_b64_tr_b16 v[42:43], v9 offset:12288
  global_load_lds_dwordx4 v2, s[56:57] offset:0
  v_mfma_f32_16x16x32_bf16 v[124:127], v[48:51], a[84:87], v[124:127]
  ds_read_b64_tr_b16 v[44:45], v9 offset:1024
  v_mfma_f32_16x16x32_bf16 v[124:127], v[52:55], a[92:95], v[124:127]
  ds_read_b64_tr_b16 v[46:47], v9 offset:13312
  s_waitcnt lgkmcnt(8)
  v_mfma_f32_16x16x32_bf16 v[128:131], v[56:59], a[80:83], v[128:131]
  ds_read_b64_tr_b16 v[48:49], v10 offset:0
  v_mfma_f32_16x16x32_bf16 v[128:131], v[60:63], a[88:91], v[128:131]
  ds_read_b64_tr_b16 v[50:51], v10 offset:12288
  v_mfma_f32_16x16x32_bf16 v[132:135], v[56:59], a[84:87], v[132:135]
  ds_read_b64_tr_b16 v[52:53], v10 offset:1024
  global_load_lds_dwordx4 v3, s[56:57] offset:1024
  v_mfma_f32_16x16x32_bf16 v[132:135], v[60:63], a[92:95], v[132:135]
  ds_read_b64_tr_b16 v[54:55], v10 offset:13312
  s_waitcnt lgkmcnt(8)
  v_mfma_f32_16x16x32_bf16 v[64:67], v[32:35], a[96:99], v[64:67]
  ds_read_b64_tr_b16 v[56:57], v11 offset:0
  v_mfma_f32_16x16x32_bf16 v[64:67], v[36:39], a[104:107], v[64:67]
  ds_read_b64_tr_b16 v[58:59], v11 offset:12288
  v_mfma_f32_16x16x32_bf16 v[68:71], v[32:35], a[100:103], v[68:71]
  ds_read_b64_tr_b16 v[60:61], v11 offset:1024
  v_mfma_f32_16x16x32_bf16 v[68:71], v[36:39], a[108:111], v[68:71]
  ds_read_b64_tr_b16 v[62:63], v11 offset:13312
  s_waitcnt lgkmcnt(8)
  v_mfma_f32_16x16x32_bf16 v[72:75], v[40:43], a[96:99], v[72:75]
  ds_read_b64_tr_b16 v[32:33], v8 offset:2048
  global_load_lds_dwordx4 v4, s[56:57] offset:2048
  v_mfma_f32_16x16x32_bf16 v[72:75], v[44:47], a[104:107], v[72:75]
  ds_read_b64_tr_b16 v[34:35], v8 offset:14336
  v_mfma_f32_16x16x32_bf16 v[76:79], v[40:43], a[100:103], v[76:79]
  ds_read_b64_tr_b16 v[36:37], v8 offset:3072
  v_mfma_f32_16x16x32_bf16 v[76:79], v[44:47], a[108:111], v[76:79]
  ds_read_b64_tr_b16 v[38:39], v8 offset:15360
  s_waitcnt lgkmcnt(8)
  v_mfma_f32_16x16x32_bf16 v[80:83], v[48:51], a[96:99], v[80:83]
  ds_read_b64_tr_b16 v[40:41], v9 offset:2048
  global_load_lds_dwordx4 v5, s[56:57] offset:3072
  v_mfma_f32_16x16x32_bf16 v[80:83], v[52:55], a[104:107], v[80:83]
  ds_read_b64_tr_b16 v[42:43], v9 offset:14336
  s_add_u32 m0, s51, 53248
  v_mfma_f32_16x16x32_bf16 v[84:87], v[48:51], a[100:103], v[84:87]
  ds_read_b64_tr_b16 v[44:45], v9 offset:3072
  v_mfma_f32_16x16x32_bf16 v[84:87], v[52:55], a[108:111], v[84:87]
  ds_read_b64_tr_b16 v[46:47], v9 offset:15360
  s_waitcnt lgkmcnt(8)
  v_mfma_f32_16x16x32_bf16 v[88:91], v[56:59], a[96:99], v[88:91]
  ds_read_b64_tr_b16 v[48:49], v10 offset:2048
  v_mfma_f32_16x16x32_bf16 v[88:91], v[60:63], a[104:107], v[88:91]
  ds_read_b64_tr_b16 v[50:51], v10 offset:14336
  global_load_lds_dwordx4 v6, s[56:57] offset:0
  v_mfma_f32_16x16x32_bf16 v[92:95], v[56:59], a[100:103], v[92:95]
  ds_read_b64_tr_b16 v[52:53], v10 offset:3072
  v_mfma_f32_16x16x32_bf16 v[92:95], v[60:63], a[108:111], v[92:95]
  ds_read_b64_tr_b16 v[54:55], v10 offset:15360
  s_waitcnt lgkmcnt(8)
  v_mfma_f32_16x16x32_bf16 v[96:99], v[32:35], a[96:99], v[96:99]
  ds_read_b64_tr_b16 v[56:57], v11 offset:2048
  v_mfma_f32_16x16x32_bf16 v[96:99], v[36:39], a[104:107], v[96:99]
  ds_read_b64_tr_b16 v[58:59], v11 offset:14336
  v_mfma_f32_16x16x32_bf16 v[100:103], v[32:35], a[100:103], v[100:103]
  ds_read_b64_tr_b16 v[60:61], v11 offset:3072
  v_mfma_f32_16x16x32_bf16 v[100:103], v[36:39], a[108:111], v[100:103]
  ds_read_b64_tr_b16 v[62:63], v11 offset:15360
  s_waitcnt lgkmcnt(8)
  v_mfma_f32_16x16x32_bf16 v[104:107], v[40:43], a[96:99], v[104:107]
  ds_read_b64_tr_b16 v[32:33], v8 offset:4096
  v_mfma_f32_16x16x32_bf16 v[104:107], v[44:47], a[104:107], v[104:107]
  ds_read_b64_tr_b16 v[34:35], v8 offset:16384
  v_mfma_f32_16x16x32_bf16 v[108:111], v[40:43], a[100:103], v[108:111]
  ds_read_b64_tr_b16 v[36:37], v8 offset:5120
  s_waitcnt vmcnt(12) lgkmcnt(7)
  v_mfma_f32_16x16x32_bf16 v[108:111], v[44:47], a[108:111], v[108:111]
  ds_read_b64_tr_b16 v[38:39], v8 offset:17408
  s_barrier
  v_mfma_f32_16x16x32_bf16 v[112:115], v[48:51], a[96:99], v[112:115]
  ds_read_b64_tr_b16 v[40:41], v8 offset:24576
  s_add_u32 s56, s54, s81
  v_mfma_f32_16x16x32_bf16 v[112:115], v[52:55], a[104:107], v[112:115]
  ds_read_b64_tr_b16 v[42:43], v8 offset:36864
  s_addc_u32 s57, s55, 0
  v_mfma_f32_16x16x32_bf16 v[116:119], v[48:51], a[100:103], v[116:119]
  ds_read_b64_tr_b16 v[44:45], v8 offset:25600
  s_add_u32 m0, s51, 73728
  v_mfma_f32_16x16x32_bf16 v[116:119], v[52:55], a[108:111], v[116:119]
  ds_read_b64_tr_b16 v[46:47], v8 offset:37888
  s_waitcnt lgkmcnt(8)
  v_mfma_f32_16x16x32_bf16 v[120:123], v[56:59], a[96:99], v[120:123]
  ds_read_b64_tr_b16 v[48:49], v9 offset:24576
  v_mfma_f32_16x16x32_bf16 v[120:123], v[60:63], a[104:107], v[120:123]
  ds_read_b64_tr_b16 v[50:51], v9 offset:36864
  global_load_lds_dwordx4 v2, s[56:57] offset:0
  v_mfma_f32_16x16x32_bf16 v[124:127], v[56:59], a[100:103], v[124:127]
  ds_read_b64_tr_b16 v[52:53], v9 offset:25600
  v_mfma_f32_16x16x32_bf16 v[124:127], v[60:63], a[108:111], v[124:127]
  ds_read_b64_tr_b16 v[54:55], v9 offset:37888
  s_waitcnt lgkmcnt(8)
  v_mfma_f32_16x16x32_bf16 v[128:131], v[32:35], a[96:99], v[128:131]
  ds_read_b64_tr_b16 v[56:57], v10 offset:24576
  v_mfma_f32_16x16x32_bf16 v[128:131], v[36:39], a[104:107], v[128:131]
  ds_read_b64_tr_b16 v[58:59], v10 offset:36864
  v_mfma_f32_16x16x32_bf16 v[132:135], v[32:35], a[100:103], v[132:135]
  ds_read_b64_tr_b16 v[60:61], v10 offset:25600
  global_load_lds_dwordx4 v3, s[56:57] offset:1024
  v_mfma_f32_16x16x32_bf16 v[132:135], v[36:39], a[108:111], v[132:135]
  ds_read_b64_tr_b16 v[62:63], v10 offset:37888
  s_waitcnt lgkmcnt(8)
  v_mfma_f32_16x16x32_bf16 v[64:67], v[40:43], a[112:115], v[64:67]
  ds_read_b64_tr_b16 v[32:33], v11 offset:24576
  v_mfma_f32_16x16x32_bf16 v[64:67], v[44:47], a[120:123], v[64:67]
  ds_read_b64_tr_b16 v[34:35], v11 offset:36864
  v_mfma_f32_16x16x32_bf16 v[68:71], v[40:43], a[116:119], v[68:71]
  ds_read_b64_tr_b16 v[36:37], v11 offset:25600
  v_mfma_f32_16x16x32_bf16 v[68:71], v[44:47], a[124:127], v[68:71]
  ds_read_b64_tr_b16 v[38:39], v11 offset:37888
  s_waitcnt lgkmcnt(8)
  v_mfma_f32_16x16x32_bf16 v[72:75], v[48:51], a[112:115], v[72:75]
  ds_read_b64_tr_b16 v[40:41], v8 offset:26624
  global_load_lds_dwordx4 v4, s[56:57] offset:2048
  v_mfma_f32_16x16x32_bf16 v[72:75], v[52:55], a[120:123], v[72:75]
  ds_read_b64_tr_b16 v[42:43], v8 offset:38912
  v_mfma_f32_16x16x32_bf16 v[76:79], v[48:51], a[116:119], v[76:79]
  ds_read_b64_tr_b16 v[44:45], v8 offset:27648
  v_mfma_f32_16x16x32_bf16 v[76:79], v[52:55], a[124:127], v[76:79]
  ds_read_b64_tr_b16 v[46:47], v8 offset:39936
  s_waitcnt lgkmcnt(8)
  v_mfma_f32_16x16x32_bf16 v[80:83], v[56:59], a[112:115], v[80:83]
  ds_read_b64_tr_b16 v[48:49], v9 offset:26624
  global_load_lds_dwordx4 v5, s[56:57] offset:3072
  v_mfma_f32_16x16x32_bf16 v[80:83], v[60:63], a[120:123], v[80:83]
  ds_read_b64_tr_b16 v[50:51], v9 offset:38912
  s_add_u32 m0, s51, 77824
  v_mfma_f32_16x16x32_bf16 v[84:87], v[56:59], a[116:119], v[84:87]
  ds_read_b64_tr_b16 v[52:53], v9 offset:27648
  v_mfma_f32_16x16x32_bf16 v[84:87], v[60:63], a[124:127], v[84:87]
  ds_read_b64_tr_b16 v[54:55], v9 offset:39936
  s_waitcnt lgkmcnt(8)
  v_mfma_f32_16x16x32_bf16 v[88:91], v[32:35], a[112:115], v[88:91]
  ds_read_b64_tr_b16 v[56:57], v10 offset:26624
  v_mfma_f32_16x16x32_bf16 v[88:91], v[36:39], a[120:123], v[88:91]
  ds_read_b64_tr_b16 v[58:59], v10 offset:38912
  global_load_lds_dwordx4 v6, s[56:57] offset:0
  v_mfma_f32_16x16x32_bf16 v[92:95], v[32:35], a[116:119], v[92:95]
  ds_read_b64_tr_b16 v[60:61], v10 offset:27648
  v_mfma_f32_16x16x32_bf16 v[92:95], v[36:39], a[124:127], v[92:95]
  ds_read_b64_tr_b16 v[62:63], v10 offset:39936
  s_waitcnt lgkmcnt(8)
  v_mfma_f32_16x16x32_bf16 v[96:99], v[40:43], a[112:115], v[96:99]
  ds_read_b64_tr_b16 v[32:33], v11 offset:26624
  v_mfma_f32_16x16x32_bf16 v[96:99], v[44:47], a[120:123], v[96:99]
  ds_read_b64_tr_b16 v[34:35], v11 offset:38912
  v_mfma_f32_16x16x32_bf16 v[100:103], v[40:43], a[116:119], v[100:103]
  ds_read_b64_tr_b16 v[36:37], v11 offset:27648
  v_mfma_f32_16x16x32_bf16 v[100:103], v[44:47], a[124:127], v[100:103]
  ds_read_b64_tr_b16 v[38:39], v11 offset:39936
  s_waitcnt lgkmcnt(8)
  v_mfma_f32_16x16x32_bf16 v[104:107], v[48:51], a[112:115], v[104:107]
  ds_read_b64_tr_b16 v[40:41], v8 offset:28672
  v_mfma_f32_16x16x32_bf16 v[104:107], v[52:55], a[120:123], v[104:107]
  ds_read_b64_tr_b16 v[42:43], v8 offset:40960
  v_mfma_f32_16x16x32_bf16 v[108:111], v[48:51], a[116:119], v[108:111]
  ds_read_b64_tr_b16 v[44:45], v8 offset:29696
  s_waitcnt vmcnt(10) lgkmcnt(7)
  v_mfma_f32_16x16x32_bf16 v[108:111], v[52:55], a[124:127], v[108:111]
  ds_read_b64_tr_b16 v[46:47], v8 offset:41984
  s_barrier
  v_mfma_f32_16x16x32_bf16 v[112:115], v[56:59], a[112:115], v[112:115]
  ds_read_b64_tr_b16 v[48:49], v16 offset:24576
  s_add_u32 s56, s54, s82
  v_mfma_f32_16x16x32_bf16 v[112:115], v[60:63], a[120:123], v[112:115]
  ds_read_b64_tr_b16 v[50:51], v16 offset:36864
  s_addc_u32 s57, s55, 0
  v_mfma_f32_16x16x32_bf16 v[116:119], v[56:59], a[116:119], v[116:119]
  ds_read_b64_tr_b16 v[52:53], v16 offset:25600
  s_add_u32 m0, s51, 98304
  v_mfma_f32_16x16x32_bf16 v[116:119], v[60:63], a[124:127], v[116:119]
  ds_read_b64_tr_b16 v[54:55], v16 offset:37888
  s_waitcnt lgkmcnt(8)
  v_mfma_f32_16x16x32_bf16 v[120:123], v[32:35], a[112:115], v[120:123]
  ds_read_b64_tr_b16 v[56:57], v17 offset:24576
  v_mfma_f32_16x16x32_bf16 v[120:123], v[36:39], a[120:123], v[120:123]
  ds_read_b64_tr_b16 v[58:59], v17 offset:36864
  global_load_lds_dwordx4 v2, s[56:57] offset:0
  v_mfma_f32_16x16x32_bf16 v[124:127], v[32:35], a[116:119], v[124:127]
  ds_read_b64_tr_b16 v[60:61], v17 offset:25600
  v_mfma_f32_16x16x32_bf16 v[124:127], v[36:39], a[124:127], v[124:127]
  ds_read_b64_tr_b16 v[62:63], v17 offset:37888
  s_waitcnt lgkmcnt(8)
  v_mfma_f32_16x16x32_bf16 v[128:131], v[40:43], a[112:115], v[128:131]
  ds_read_b64_tr_b16 v[32:33], v18 offset:24576
  v_mfma_f32_16x16x32_bf16 v[128:131], v[44:47], a[120:123], v[128:131]
  ds_read_b64_tr_b16 v[34:35], v18 offset:36864
  v_mfma_f32_16x16x32_bf16 v[132:135], v[40:43], a[116:119], v[132:135]
  ds_read_b64_tr_b16 v[36:37], v18 offset:25600
  global_load_lds_dwordx4 v3, s[56:57] offset:1024
  v_mfma_f32_16x16x32_bf16 v[132:135], v[44:47], a[124:127], v[132:135]
  ds_read_b64_tr_b16 v[38:39], v18 offset:37888
  s_waitcnt lgkmcnt(8)
  v_mfma_f32_16x16x32_bf16 v[64:67], v[48:51], a[128:131], v[64:67]
  ds_read_b64_tr_b16 v[40:41], v19 offset:24576
  v_mov_b32 v137, 0
  v_mfma_f32_16x16x32_bf16 v[64:67], v[52:55], a[136:139], v[64:67]
  ds_read_b64_tr_b16 v[42:43], v19 offset:36864
  buffer_atomic_or v137, v21, s[40:43], 0 offen sc0 sc1
  v_mfma_f32_16x16x32_bf16 v[68:71], v[48:51], a[132:135], v[68:71]
  ds_read_b64_tr_b16 v[44:45], v19 offset:25600
  v_mfma_f32_16x16x32_bf16 v[68:71], v[52:55], a[140:143], v[68:71]
  ds_read_b64_tr_b16 v[46:47], v19 offset:37888
  s_waitcnt lgkmcnt(8)
  v_mfma_f32_16x16x32_bf16 v[72:75], v[56:59], a[128:131], v[72:75]
  ds_read_b64_tr_b16 v[48:49], v16 offset:26624
  global_load_lds_dwordx4 v4, s[56:57] offset:2048
  v_mfma_f32_16x16x32_bf16 v[72:75], v[60:63], a[136:139], v[72:75]
  ds_read_b64_tr_b16 v[50:51], v16 offset:38912
  v_cvt_pk_bf16_f32 v238, v64, v65
  v_mfma_f32_16x16x32_bf16 v[76:79], v[56:59], a[132:135], v[76:79]
  ds_read_b64_tr_b16 v[52:53], v16 offset:27648
  v_cvt_pk_bf16_f32 v239, v66, v67
  v_mfma_f32_16x16x32_bf16 v[76:79], v[60:63], a[140:143], v[76:79]
  ds_read_b64_tr_b16 v[54:55], v16 offset:39936
  s_waitcnt lgkmcnt(8)
  v_mfma_f32_16x16x32_bf16 v[80:83], v[32:35], a[128:131], v[80:83]
  ds_read_b64_tr_b16 v[56:57], v17 offset:26624
  global_load_lds_dwordx4 v5, s[56:57] offset:3072
  v_mfma_f32_16x16x32_bf16 v[80:83], v[36:39], a[136:139], v[80:83]
  ds_read_b64_tr_b16 v[58:59], v17 offset:38912
  s_add_u32 m0, s51, 102400
  v_mfma_f32_16x16x32_bf16 v[84:87], v[32:35], a[132:135], v[84:87]
  ds_read_b64_tr_b16 v[60:61], v17 offset:27648
  v_cvt_pk_bf16_f32 v64, v68, v69
  v_mfma_f32_16x16x32_bf16 v[84:87], v[36:39], a[140:143], v[84:87]
  ds_read_b64_tr_b16 v[62:63], v17 offset:39936
  s_waitcnt lgkmcnt(8)
  v_mfma_f32_16x16x32_bf16 v[88:91], v[40:43], a[128:131], v[88:91]
  ds_read_b64_tr_b16 v[32:33], v18 offset:26624
  v_cvt_pk_bf16_f32 v65, v70, v71
  v_mfma_f32_16x16x32_bf16 v[88:91], v[44:47], a[136:139], v[88:91]
  ds_read_b64_tr_b16 v[34:35], v18 offset:38912
  global_load_lds_dwordx4 v6, s[56:57] offset:0
  v_mfma_f32_16x16x32_bf16 v[92:95], v[40:43], a[132:135], v[92:95]
  ds_read_b64_tr_b16 v[36:37], v18 offset:27648
  v_cvt_pk_bf16_f32 v240, v72, v73
  v_mfma_f32_16x16x32_bf16 v[92:95], v[44:47], a[140:143], v[92:95]
  ds_read_b64_tr_b16 v[38:39], v18 offset:39936
  s_waitcnt lgkmcnt(8)
  v_mfma_f32_16x16x32_bf16 v[96:99], v[48:51], a[128:131], v[96:99]
  ds_read_b64_tr_b16 v[40:41], v19 offset:26624
  v_cvt_pk_bf16_f32 v241, v74, v75
  v_mfma_f32_16x16x32_bf16 v[96:99], v[52:55], a[136:139], v[96:99]
  ds_read_b64_tr_b16 v[42:43], v19 offset:38912
  v_cvt_pk_bf16_f32 v66, v76, v77
  v_mfma_f32_16x16x32_bf16 v[100:103], v[48:51], a[132:135], v[100:103]
  ds_read_b64_tr_b16 v[44:45], v19 offset:27648
  v_cvt_pk_bf16_f32 v67, v78, v79
  v_mfma_f32_16x16x32_bf16 v[100:103], v[52:55], a[140:143], v[100:103]
  ds_read_b64_tr_b16 v[46:47], v19 offset:39936
  s_waitcnt lgkmcnt(8)
  v_mfma_f32_16x16x32_bf16 v[104:107], v[56:59], a[128:131], v[104:107]
  ds_read_b64_tr_b16 v[48:49], v16 offset:28672
  v_cvt_pk_bf16_f32 v242, v80, v81
  v_mfma_f32_16x16x32_bf16 v[104:107], v[60:63], a[136:139], v[104:107]
  ds_read_b64_tr_b16 v[50:51], v16 offset:40960
  v_cvt_pk_bf16_f32 v243, v82, v83
  v_mfma_f32_16x16x32_bf16 v[108:111], v[56:59], a[132:135], v[108:111]
  ds_read_b64_tr_b16 v[52:53], v16 offset:29696
  v_cvt_pk_bf16_f32 v68, v84, v85
  v_mfma_f32_16x16x32_bf16 v[108:111], v[60:63], a[140:143], v[108:111]
  ds_read_b64_tr_b16 v[54:55], v16 offset:41984
  s_waitcnt lgkmcnt(8)
  v_mfma_f32_16x16x32_bf16 v[112:115], v[32:35], a[128:131], v[112:115]
  v_cvt_pk_bf16_f32 v69, v86, v87
  v_cvt_pk_bf16_f32 v244, v88, v89
  v_mfma_f32_16x16x32_bf16 v[112:115], v[36:39], a[136:139], v[112:115]
  v_cvt_pk_bf16_f32 v245, v90, v91
  v_cvt_pk_bf16_f32 v70, v92, v93
  v_mfma_f32_16x16x32_bf16 v[116:119], v[32:35], a[132:135], v[116:119]
  v_cvt_pk_bf16_f32 v71, v94, v95
  v_cvt_pk_bf16_f32 v246, v96, v97
  v_mfma_f32_16x16x32_bf16 v[116:119], v[36:39], a[140:143], v[116:119]
  v_cvt_pk_bf16_f32 v247, v98, v99
  s_waitcnt lgkmcnt(4)
  v_mfma_f32_16x16x32_bf16 v[120:123], v[40:43], a[128:131], v[120:123]
  v_cvt_pk_bf16_f32 v72, v100, v101
  v_cvt_pk_bf16_f32 v73, v102, v103
  v_mfma_f32_16x16x32_bf16 v[120:123], v[44:47], a[136:139], v[120:123]
  v_cvt_pk_bf16_f32 v248, v104, v105
  v_cvt_pk_bf16_f32 v249, v106, v107
  v_mfma_f32_16x16x32_bf16 v[124:127], v[40:43], a[132:135], v[124:127]
  v_cvt_pk_bf16_f32 v74, v108, v109
  v_cvt_pk_bf16_f32 v75, v110, v111
  v_mfma_f32_16x16x32_bf16 v[124:127], v[44:47], a[140:143], v[124:127]
  v_cvt_pk_bf16_f32 v250, v112, v113
  s_waitcnt lgkmcnt(0)
  v_mfma_f32_16x16x32_bf16 v[128:131], v[48:51], a[128:131], v[128:131]
  v_cvt_pk_bf16_f32 v251, v114, v115
  v_cvt_pk_bf16_f32 v76, v116, v117
  v_mfma_f32_16x16x32_bf16 v[128:131], v[52:55], a[136:139], v[128:131]
  v_cvt_pk_bf16_f32 v77, v118, v119
  v_cvt_pk_bf16_f32 v252, v120, v121
  v_mfma_f32_16x16x32_bf16 v[132:135], v[48:51], a[132:135], v[132:135]
  v_cvt_pk_bf16_f32 v253, v122, v123
  v_mfma_f32_16x16x32_bf16 v[132:135], v[52:55], a[140:143], v[132:135]
  s_nop 6
  v_cvt_pk_bf16_f32 v78, v124, v125
  v_cvt_pk_bf16_f32 v79, v126, v127
  v_cvt_pk_bf16_f32 v254, v128, v129
  v_cvt_pk_bf16_f32 v255, v130, v131
  v_cvt_pk_bf16_f32 v80, v132, v133
  v_cvt_pk_bf16_f32 v81, v134, v135
  s_waitcnt vmcnt(3)
  s_mov_b32 s70, 0
L_a_kv:
  v_cmp_lt_u32 vcc, v137, v139
  s_add_u32 s70, s70, 1
  s_cmp_ge_u32 s70, 200000
  s_cbranch_scc1 L_a_kv_x
  s_and_b32 s59, vcc_lo, 1
  s_cbranch_scc0 L_a_kv_x
  v_mov_b32 v137, 0
  buffer_atomic_or v137, v21, s[40:43], 0 offen sc0 sc1
  s_waitcnt vmcnt(0)
  s_branch L_a_kv
L_a_kv_x:
  buffer_load_dword v62, v20, s[40:43], s65 offen offset:1024 sc1
  v_mov_b32 v82, 0xf149f2ca
  v_lshrrev_b32 v63, 4, v1
  v_and_b32 v100, 1, v1
  v_lshl_add_u32 v63, v63, 2, v100
  v_lshlrev_b32 v63, 2, v63
  s_barrier
  v_mul_f32 v31, 0x3eae1a93, v31
  v_mul_f32 v60, v31, v146
  v_mul_f32 v61, v31, v147
  s_sub_u32 s60, s46, 12
  s_lshl2_add_u32 s58, s45, s44
  s_mul_i32 s69, s58, 3
  s_mul_i32 s60, s60, 221184
  v_min_u32 v7, 53, v1
  v_lshl_add_u32 v7, v7, 7, s60
  buffer_load_dwordx2 a[216:217], v20, s[40:43], 0 offen offset:0 sc1
  v_mov_b32 v84, v64
  v_cndmask_b32 v86, v66, 0, s[72:73]
  v_mov_b32 v85, v65
  v_mov_b32 v87, 0
  v_cndmask_b32 v88, 0, v66, s[72:73]
  v_cndmask_b32 v90, v68, 0, s[72:73]
  v_mfma_f32_16x16x32_bf16 v[100:103], v[148:151], v[84:87], 0
  buffer_load_dwordx2 v[184:185], v20, s[40:43], s64 offen offset:512 sc1
  v_mov_b32 v89, v67
  v_cndmask_b32 v91, v69, 0, s[72:73]
  v_mfma_f32_16x16x32_bf16 v[104:107], v[166:169], v[84:87], 0
  v_cndmask_b32 v92, 0, v68, s[72:73]
  v_cndmask_b32 v94, v70, 0, s[74:75]
  v_mfma_f32_16x16x32_bf16 v[108:111], v[150:153], v[88:91], 0
  v_cndmask_b32 v93, 0, v69, s[72:73]
  v_cndmask_b32 v95, v71, 0, s[72:73]
  buffer_load_dwordx2 a[218:219], v20, s[40:43], 0 offen offset:512 sc1
  v_mfma_f32_16x16x32_bf16 v[112:115], v[168:171], v[88:91], 0
  v_cndmask_b32 v96, 0, v70, s[74:75]
  v_cndmask_b32 v98, v72, 0, s[74:75]
  v_mfma_f32_16x16x32_bf16 v[116:119], v[152:155], v[92:95], 0
  v_cndmask_b32 v97, 0, v71, s[72:73]
  v_cndmask_b32 v99, v73, 0, s[74:75]
  v_mfma_f32_16x16x32_bf16 v[120:123], v[170:173], v[92:95], 0
  v_cndmask_b32 v100, v100, v101, s[78:79]
  buffer_load_dwordx2 v[190:191], v20, s[40:43], s64 offen offset:1024 sc1
  v_cndmask_b32 v104, v104, v105, s[78:79]
  v_mfma_f32_16x16x32_bf16 v[124:127], v[154:157], v[96:99], 0
  v_cndmask_b32 v132, v100, v104, s[14:15]
  v_mul_f32 v132, v132, v60
  v_mfma_f32_16x16x32_bf16 v[128:131], v[172:175], v[96:99], 0
  v_cndmask_b32 v102, v102, v103, s[78:79]
  v_cndmask_b32 v106, v106, v107, s[78:79]
  v_cndmask_b32 v133, v102, v106, s[16:17]
  buffer_load_dwordx2 a[220:221], v20, s[40:43], 0 offen offset:1024 sc1
  v_mul_f32 v133, v133, v61
  v_max_f32 v54, v132, v133
  v_cndmask_b32 v108, v108, v109, s[78:79]
  v_cndmask_b32 v112, v112, v113, s[78:79]
  v_cndmask_b32 v134, v108, v112, s[14:15]
  v_mul_f32 v134, v134, v60
  v_cndmask_b32 v110, v110, v111, s[78:79]
  v_cndmask_b32 v114, v114, v115, s[78:79]
  buffer_load_dwordx2 v[196:197], v20, s[40:43], s64 offen offset:1536 sc1
  v_cndmask_b32 v135, v110, v114, s[16:17]
  v_mul_f32 v135, v135, v61
  v_max_f32 v55, v134, v135
  v_cndmask_b32 v116, v116, v117, s[78:79]
  v_cndmask_b32 v120, v120, v121, s[78:79]
  v_cndmask_b32 v136, v116, v120, s[14:15]
  v_mul_f32 v136, v136, v60
  v_cndmask_b32 v118, v118, v119, s[78:79]
  buffer_load_dwordx2 a[222:223], v20, s[40:43], 0 offen offset:1536 sc1
  v_cndmask_b32 v122, v122, v123, s[78:79]
  v_cndmask_b32 v137, v118, v122, s[16:17]
  v_mul_f32 v137, v137, v61
  v_max_f32 v56, v136, v137
  v_cndmask_b32 v124, v124, v125, s[78:79]
  v_cndmask_b32 v128, v128, v129, s[78:79]
  v_cndmask_b32 v138, v124, v128, s[14:15]
  buffer_load_dwordx2 v[202:203], v20, s[40:43], s64 offen offset:2048 sc1
  v_mul_f32 v138, v138, v60
  v_cndmask_b32 v126, v126, v127, s[78:79]
  v_cndmask_b32 v130, v130, v131, s[78:79]
  v_cndmask_b32 v139, v126, v130, s[16:17]
  v_mul_f32 v139, v139, v61
  v_max_f32 v57, v138, v139
  s_nop 0
  v_permlane16_swap_b32 v54, v55
  buffer_load_dwordx2 a[224:225], v20, s[40:43], 0 offen offset:2048 sc1
  v_permlane16_swap_b32 v56, v57
  v_max_f32 v54, v54, v55
  v_max_f32 v56, v56, v57
  s_nop 1
  v_permlane32_swap_b32 v54, v56
  v_max_f32 v54, v54, v56
  v_mov_b32 v56, v54
  s_nop 1
  buffer_load_dwordx2 v[208:209], v20, s[40:43], s64 offen offset:2560 sc1
  v_permlane32_swap_b32 v54, v56
  v_mov_b32 v55, v54
  v_mov_b32 v57, v56
  s_nop 0
  v_permlane16_swap_b32 v54, v55
  v_permlane16_swap_b32 v56, v57
  v_sub_f32 v132, v132, v54
  v_sub_f32 v133, v133, v54
  buffer_load_dwordx2 a[226:227], v20, s[40:43], 0 offen offset:2560 sc1
  v_sub_f32 v134, v134, v55
  v_sub_f32 v135, v135, v55
  v_sub_f32 v136, v136, v56
  v_sub_f32 v137, v137, v56
  v_sub_f32 v138, v138, v57
  v_sub_f32 v139, v139, v57
  v_exp_f32 v132, v132
  v_exp_f32 v133, v133
  buffer_load_dwordx2 v[214:215], v20, s[40:43], s64 offen offset:3072 sc1
  v_exp_f32 v134, v134
  v_exp_f32 v135, v135
  v_exp_f32 v136, v136
  v_exp_f32 v137, v137
  v_exp_f32 v138, v138
  v_exp_f32 v139, v139
  v_add_f32 v54, v132, v133
  v_add_f32 v55, v134, v135
  buffer_load_dwordx2 a[228:229], v20, s[40:43], 0 offen offset:3072 sc1
  v_add_f32 v56, v136, v137
  v_add_f32 v57, v138, v139
  v_mul_f32 v132, v132, v146
  v_permlane16_swap_b32 v54, v55
  v_permlane16_swap_b32 v56, v57
  v_add_f32 v54, v54, v55
  v_add_f32 v56, v56, v57
  buffer_load_dwordx2 v[220:221], v20, s[40:43], s64 offen offset:3584 sc1
  v_mul_f32 v133, v133, v147
  v_mul_f32 v134, v134, v146
  v_permlane32_swap_b32 v54, v56
  v_add_f32 v54, v54, v56
  v_rcp_f32 v54, v54
  v_mul_f32 v135, v135, v147
  v_mov_b32 v56, v54
  v_mul_f32 v136, v136, v146
  buffer_load_dwordx2 a[230:231], v20, s[40:43], 0 offen offset:3584 sc1
  v_mul_f32 v137, v137, v147
  v_permlane32_swap_b32 v54, v56
  v_mov_b32 v55, v54
  v_mov_b32 v57, v56
  v_mul_f32 v138, v138, v146
  v_permlane16_swap_b32 v54, v55
  v_permlane16_swap_b32 v56, v57
  v_mul_f32 v139, v139, v147
  buffer_load_dwordx2 v[226:227], v20, s[40:43], s65 offen offset:0 sc1
  v_mul_f32 v132, v132, v54
  v_mul_f32 v133, v133, v54
  v_cvt_pk_bf16_f32 v132, v132, v133
  v_perm_b32 v84, v132, v132, v140
  v_perm_b32 v85, v132, v132, v141
  v_perm_b32 v86, v132, v132, v142
  v_perm_b32 v87, v132, v132, v143
  v_mul_f32 v134, v134, v55
  buffer_load_dwordx2 a[232:233], v20, s[40:43], s64 offen offset:0 sc1
  v_mul_f32 v135, v135, v55
  v_mfma_f32_16x16x32_bf16 v[100:103], v[186:189], v[84:87], 0
  v_cvt_pk_bf16_f32 v134, v134, v135
  v_perm_b32 v88, v134, v134, v140
  v_mfma_f32_16x16x32_bf16 v[104:107], v[192:195], v[84:87], 0
  v_perm_b32 v89, v134, v134, v141
  v_perm_b32 v90, v134, v134, v142
  v_perm_b32 v91, v134, v134, v143
  buffer_load_dwordx2 v[232:233], v20, s[40:43], s65 offen offset:512 sc1
  v_mul_f32 v136, v136, v56
  v_mul_f32 v137, v137, v56
  v_mfma_f32_16x16x32_bf16 v[108:111], v[192:195], v[88:91], 0
  v_cvt_pk_bf16_f32 v136, v136, v137
  v_perm_b32 v92, v136, v136, v140
  v_mfma_f32_16x16x32_bf16 v[112:115], v[198:201], v[88:91], 0
  v_perm_b32 v93, v136, v136, v141
  v_perm_b32 v94, v136, v136, v142
  s_add_u32 s56, s54, s83
  s_addc_u32 s57, s55, 0
  s_add_u32 m0, s51, 0
  s_nop 0
  global_load_lds_dwordx4 v2, s[56:57] offset:0
  v_perm_b32 v95, v136, v136, v143
  v_mul_f32 v138, v138, v57
  v_mul_f32 v139, v139, v57
  v_mfma_f32_16x16x32_bf16 v[116:119], v[198:201], v[92:95], 0
  v_cvt_pk_bf16_f32 v138, v138, v139
  v_perm_b32 v96, v138, v138, v140
  v_mfma_f32_16x16x32_bf16 v[120:123], v[204:207], v[92:95], 0
  global_load_lds_dwordx4 v3, s[56:57] offset:1024
  v_perm_b32 v97, v138, v138, v141
  v_perm_b32 v98, v138, v138, v142
  v_perm_b32 v99, v138, v138, v143
  v_cvt_pk_bf16_f32 v64, v100, v101
  v_cvt_pk_bf16_f32 v65, v102, v103
  v_mfma_f32_16x16x32_bf16 v[124:127], v[204:207], v[96:99], 0
  v_cvt_pk_bf16_f32 v50, v104, v105
  v_cvt_pk_bf16_f32 v51, v106, v107
  global_load_lds_dwordx4 v4, s[56:57] offset:2048
  v_mfma_f32_16x16x32_bf16 v[128:131], v[210:213], v[96:99], 0
  v_cvt_pk_bf16_f32 v108, v108, v109
  v_cndmask_b32 v66, v50, v108, s[72:73]
  v_cvt_pk_bf16_f32 v67, v110, v111
  v_cvt_pk_bf16_f32 v50, v112, v113
  v_cvt_pk_bf16_f32 v51, v114, v115
  v_cvt_pk_bf16_f32 v116, v116, v117
  v_cndmask_b32 v68, v50, v116, s[72:73]
  global_load_lds_dwordx4 v5, s[56:57] offset:3072
  v_cvt_pk_bf16_f32 v118, v118, v119
  v_cndmask_b32 v69, v51, v118, s[72:73]
  v_cvt_pk_bf16_f32 v50, v120, v121
  v_cvt_pk_bf16_f32 v51, v122, v123
  v_cvt_pk_bf16_f32 v124, v124, v125
  v_cndmask_b32 v70, v50, v124, s[74:75]
  v_cvt_pk_bf16_f32 v126, v126, v127
  v_cndmask_b32 v71, v51, v126, s[72:73]
  s_add_u32 m0, s51, 4096
  s_nop 0
  global_load_lds_dwordx4 v6, s[56:57] offset:0
  v_cvt_pk_bf16_f32 v50, v128, v129
  v_cvt_pk_bf16_f32 v51, v130, v131
  v_cndmask_b32 v84, 0, v72, s[74:75]
  v_cndmask_b32 v86, v74, 0, s[76:77]
  v_cndmask_b32 v85, 0, v73, s[74:75]
  v_cndmask_b32 v87, v75, 0, s[74:75]
  v_cndmask_b32 v88, 0, v74, s[76:77]
  v_cndmask_b32 v90, v76, 0, s[76:77]
  global_load_dword a255, v0, s[6:7]
  v_mfma_f32_16x16x32_bf16 v[100:103], v[156:159], v[84:87], 0
  v_cndmask_b32 v89, 0, v75, s[74:75]
  v_cndmask_b32 v91, v77, 0, s[76:77]
  v_mfma_f32_16x16x32_bf16 v[104:107], v[174:177], v[84:87], 0
  v_cndmask_b32 v92, 0, v76, s[76:77]
  v_mov_b32 v94, v78
  v_mfma_f32_16x16x32_bf16 v[108:111], v[158:161], v[88:91], 0
  v_cndmask_b32 v93, 0, v77, s[76:77]
  s_add_u32 s56, s54, s84
  s_addc_u32 s57, s55, 0
  s_add_u32 m0, s51, 24576
  s_nop 0
  global_load_lds_dwordx4 v2, s[56:57] offset:0
  v_cndmask_b32 v95, v79, 0, s[76:77]
  v_mfma_f32_16x16x32_bf16 v[112:115], v[176:179], v[88:91], 0
  v_mov_b32 v96, 0
  v_mov_b32 v98, v80
  v_mfma_f32_16x16x32_bf16 v[116:119], v[160:163], v[92:95], 0
  v_cndmask_b32 v97, 0, v79, s[76:77]
  v_mov_b32 v99, v81
  global_load_lds_dwordx4 v3, s[56:57] offset:1024
  v_mfma_f32_16x16x32_bf16 v[120:123], v[178:181], v[92:95], 0
  v_cndmask_b32 v100, v100, v101, s[78:79]
  v_cndmask_b32 v104, v104, v105, s[78:79]
  v_mfma_f32_16x16x32_bf16 v[124:127], v[162:165], v[96:99], 0
  v_cndmask_b32 v132, v100, v104, s[14:15]
  v_mul_f32 v132, v132, v60
  v_mfma_f32_16x16x32_bf16 v[128:131], v[180:183], v[96:99], 0
  v_cndmask_b32 v102, v102, v103, s[78:79]
  global_load_lds_dwordx4 v4, s[56:57] offset:2048
  v_cndmask_b32 v106, v106, v107, s[78:79]
  v_cndmask_b32 v133, v102, v106, s[16:17]
  v_mul_f32 v133, v133, v61
  v_max_f32 v54, v132, v133
  v_cndmask_b32 v108, v108, v109, s[78:79]
  v_cndmask_b32 v112, v112, v113, s[78:79]
  v_cndmask_b32 v134, v108, v112, s[14:15]
  v_mul_f32 v134, v134, v60
  global_load_lds_dwordx4 v5, s[56:57] offset:3072
  v_cndmask_b32 v110, v110, v111, s[78:79]
  v_cndmask_b32 v114, v114, v115, s[78:79]
  v_cndmask_b32 v135, v110, v114, s[16:17]
  v_mul_f32 v135, v135, v61
  v_max_f32 v55, v134, v135
  v_cndmask_b32 v116, v116, v117, s[78:79]
  v_cndmask_b32 v120, v120, v121, s[78:79]
  v_cndmask_b32 v136, v116, v120, s[14:15]
  s_add_u32 m0, s51, 28672
  s_nop 0
  global_load_lds_dwordx4 v6, s[56:57] offset:0
  v_mul_f32 v136, v136, v60
  v_cndmask_b32 v118, v118, v119, s[78:79]
  v_cndmask_b32 v122, v122, v123, s[78:79]
  v_cndmask_b32 v137, v118, v122, s[16:17]
  v_mul_f32 v137, v137, v61
  v_max_f32 v56, v136, v137
  v_cndmask_b32 v124, v124, v125, s[78:79]
  v_cndmask_b32 v128, v128, v129, s[78:79]
  s_add_u32 s56, s54, s85
  s_addc_u32 s57, s55, 0
  s_add_u32 m0, s51, 122880
  s_nop 0
  global_load_lds_dwordx4 v2, s[56:57] offset:0
  v_cndmask_b32 v138, v124, v128, s[14:15]
  v_mul_f32 v138, v138, v60
  v_cndmask_b32 v126, v126, v127, s[78:79]
  v_cndmask_b32 v130, v130, v131, s[78:79]
  v_cndmask_b32 v139, v126, v130, s[16:17]
  v_mul_f32 v139, v139, v61
  v_max_f32 v57, v138, v139
  s_nop 0
  global_load_lds_dwordx4 v3, s[56:57] offset:1024
  v_permlane16_swap_b32 v54, v55
  v_permlane16_swap_b32 v56, v57
  v_max_f32 v54, v54, v55
  v_max_f32 v56, v56, v57
  s_nop 1
  v_permlane32_swap_b32 v54, v56
  v_max_f32 v54, v54, v56
  global_load_lds_dwordx4 v4, s[56:57] offset:2048
  v_mov_b32 v56, v54
  s_nop 1
  v_permlane32_swap_b32 v54, v56
  v_mov_b32 v55, v54
  v_mov_b32 v57, v56
  s_nop 0
  v_permlane16_swap_b32 v54, v55
  v_permlane16_swap_b32 v56, v57
  global_load_lds_dwordx4 v5, s[56:57] offset:3072
  v_sub_f32 v132, v132, v54
  v_sub_f32 v133, v133, v54
  v_sub_f32 v134, v134, v55
  v_sub_f32 v135, v135, v55
  v_sub_f32 v136, v136, v56
  v_sub_f32 v137, v137, v56
  v_sub_f32 v138, v138, v57
  v_sub_f32 v139, v139, v57
  s_add_u32 m0, s51, 126976
  s_nop 0
  global_load_lds_dwordx4 v6, s[56:57] offset:0
  v_exp_f32 v132, v132
  v_exp_f32 v133, v133
  v_exp_f32 v134, v134
  v_exp_f32 v135, v135
  v_exp_f32 v136, v136
  v_exp_f32 v137, v137
  v_exp_f32 v138, v138
  v_exp_f32 v139, v139
  s_add_u32 s58, s69, 0
  s_lshr_b32 s59, s58, 5
  s_cmp_ge_u32 s59, 6
  s_cselect_b32 s60, 6, 0
  s_sub_u32 s59, s59, s60
  s_mul_i32 s59, s59, 128
  s_and_b32 s58, s58, 31
  s_add_u32 s58, s58, s59
  s_mul_i32 s58, s58, 6912
  v_add_u32 v20, s58, v7
  global_load_dword a255, v20, s[20:21]
  v_add_f32 v54, v132, v133
  v_add_f32 v55, v134, v135
  v_add_f32 v56, v136, v137
  v_add_f32 v57, v138, v139
  v_mul_f32 v132, v132, v146
  v_permlane16_swap_b32 v54, v55
  v_permlane16_swap_b32 v56, v57
  v_add_f32 v54, v54, v55
  s_add_u32 s58, s69, 1
  s_lshr_b32 s59, s58, 5
  s_cmp_ge_u32 s59, 6
  s_cselect_b32 s60, 6, 0
  s_sub_u32 s59, s59, s60
  s_mul_i32 s59, s59, 128
  s_and_b32 s58, s58, 31
  s_add_u32 s58, s58, s59
  s_mul_i32 s58, s58, 6912
  v_add_u32 v20, s58, v7
  global_load_dword a255, v20, s[20:21]
  v_add_f32 v56, v56, v57
  v_mul_f32 v133, v133, v147
  v_mul_f32 v134, v134, v146
  v_permlane32_swap_b32 v54, v56
  v_add_f32 v54, v54, v56
  v_rcp_f32 v54, v54
  v_mul_f32 v135, v135, v147
  v_mov_b32 v56, v54
  s_add_u32 s58, s69, 2
  s_lshr_b32 s59, s58, 5
  s_cmp_ge_u32 s59, 6
  s_cselect_b32 s60, 6, 0
  s_sub_u32 s59, s59, s60
  s_mul_i32 s59, s59, 128
  s_and_b32 s58, s58, 31
  s_add_u32 s58, s58, s59
  s_mul_i32 s58, s58, 6912
  v_add_u32 v20, s58, v7
  global_load_dword a255, v20, s[20:21]
  v_mul_f32 v136, v136, v146
  v_mul_f32 v137, v137, v147
  v_permlane32_swap_b32 v54, v56
  v_mov_b32 v55, v54
  v_mov_b32 v57, v56
  v_mul_f32 v138, v138, v146
  v_permlane16_swap_b32 v54, v55
  v_permlane16_swap_b32 v56, v57
  v_mul_f32 v139, v139, v147
  v_mul_f32 v132, v132, v54
  v_mul_f32 v133, v133, v54
  v_cvt_pk_bf16_f32 v132, v132, v133
  v_perm_b32 v84, v132, v132, v140
  v_perm_b32 v85, v132, v132, v141
  v_perm_b32 v86, v132, v132, v142
  v_perm_b32 v87, v132, v132, v143
  v_mul_f32 v134, v134, v55
  v_mul_f32 v135, v135, v55
  v_mfma_f32_16x16x32_bf16 v[100:103], v[210:213], v[84:87], 0
  v_cvt_pk_bf16_f32 v134, v134, v135
  v_perm_b32 v88, v134, v134, v140
  v_mfma_f32_16x16x32_bf16 v[104:107], v[216:219], v[84:87], 0
  v_perm_b32 v89, v134, v134, v141
  v_perm_b32 v90, v134, v134, v142
  v_perm_b32 v91, v134, v134, v143
  v_mul_f32 v136, v136, v56
  v_mul_f32 v137, v137, v56
  v_mfma_f32_16x16x32_bf16 v[108:111], v[216:219], v[88:91], 0
  v_cvt_pk_bf16_f32 v136, v136, v137
  v_perm_b32 v92, v136, v136, v140
  v_mfma_f32_16x16x32_bf16 v[112:115], v[222:225], v[88:91], 0
  v_perm_b32 v93, v136, v136, v141
  v_perm_b32 v94, v136, v136, v142
  v_perm_b32 v95, v136, v136, v143
  v_mul_f32 v138, v138, v57
  v_mul_f32 v139, v139, v57
  v_mfma_f32_16x16x32_bf16 v[116:119], v[222:225], v[92:95], 0
  v_cvt_pk_bf16_f32 v138, v138, v139
  v_perm_b32 v96, v138, v138, v140
  v_mfma_f32_16x16x32_bf16 v[120:123], v[228:231], v[92:95], 0
  v_perm_b32 v97, v138, v138, v141
  v_perm_b32 v98, v138, v138, v142
  v_perm_b32 v99, v138, v138, v143
  v_cvt_pk_bf16_f32 v100, v100, v101
  v_cndmask_b32 v72, v50, v100, s[74:75]
  v_mfma_f32_16x16x32_bf16 v[124:127], v[228:231], v[96:99], 0
  v_cvt_pk_bf16_f32 v102, v102, v103
  v_cndmask_b32 v73, v51, v102, s[74:75]
  v_mfma_f32_16x16x32_bf16 v[128:131], v[234:237], v[96:99], 0
  v_cvt_pk_bf16_f32 v50, v104, v105
  v_cvt_pk_bf16_f32 v51, v106, v107
  v_cvt_pk_bf16_f32 v108, v108, v109
  v_cndmask_b32 v74, v50, v108, s[76:77]
  v_cvt_pk_bf16_f32 v110, v110, v111
  v_cndmask_b32 v75, v51, v110, s[74:75]
  v_cvt_pk_bf16_f32 v50, v112, v113
  v_cvt_pk_bf16_f32 v51, v114, v115
  v_cvt_pk_bf16_f32 v116, v116, v117
  v_cndmask_b32 v76, v50, v116, s[76:77]
  v_cvt_pk_bf16_f32 v118, v118, v119
  v_cndmask_b32 v77, v51, v118, s[76:77]
  v_cvt_pk_bf16_f32 v50, v120, v121
  v_cvt_pk_bf16_f32 v51, v122, v123
  v_cvt_pk_bf16_f32 v124, v124, v125
  v_mov_b32 v78, v50
  v_cvt_pk_bf16_f32 v126, v126, v127
  v_cndmask_b32 v79, v51, v126, s[76:77]
  v_cvt_pk_bf16_f32 v80, v128, v129
  v_cvt_pk_bf16_f32 v81, v130, v131
  s_waitcnt vmcnt(19)
  ds_bpermute_b32 v100, v63, v62
  ds_bpermute_b32 v101, v63, v62 offset:8
  s_waitcnt lgkmcnt(0)
  v_cndmask_b32 v144, v100, v144, s[14:15]
  v_cndmask_b32 v145, v101, v145, s[16:17]
  v_mul_f32 v30, 0x3eae1a93, v30
  v_mul_f32 v58, v30, v144
  v_mul_f32 v59, v30, v145
  v_mov_b32 v84, v238
  v_cndmask_b32 v86, v240, 0, s[72:73]
  v_mov_b32 v85, v239
  v_mov_b32 v87, 0
  v_cndmask_b32 v88, 0, v240, s[72:73]
  v_cndmask_b32 v90, v242, 0, s[72:73]
  v_mfma_f32_16x16x32_bf16 v[100:103], a[216:219], v[84:87], 0
  v_mov_b32 v89, v241
  v_cndmask_b32 v91, v243, 0, s[72:73]
  v_mfma_f32_16x16x32_bf16 v[104:107], v[148:151], v[84:87], 0
  v_cndmask_b32 v92, 0, v242, s[72:73]
  v_cndmask_b32 v94, v244, 0, s[74:75]
  v_mfma_f32_16x16x32_bf16 v[108:111], a[218:221], v[88:91], 0
  v_cndmask_b32 v93, 0, v243, s[72:73]
  v_cndmask_b32 v95, v245, 0, s[72:73]
  v_mfma_f32_16x16x32_bf16 v[112:115], v[150:153], v[88:91], 0
  v_cndmask_b32 v96, 0, v244, s[74:75]
  v_cndmask_b32 v98, v246, 0, s[74:75]
  v_mfma_f32_16x16x32_bf16 v[116:119], a[220:223], v[92:95], 0
  v_cndmask_b32 v97, 0, v245, s[72:73]
  v_cndmask_b32 v99, v247, 0, s[74:75]
  v_mfma_f32_16x16x32_bf16 v[120:123], v[152:155], v[92:95], 0
  v_cndmask_b32 v100, v100, v101, s[78:79]
  v_cndmask_b32 v104, v104, v105, s[78:79]
  v_mfma_f32_16x16x32_bf16 v[124:127], a[222:225], v[96:99], 0
  v_cndmask_b32 v132, v100, v104, s[14:15]
  v_mul_f32 v132, v132, v58
  v_mfma_f32_16x16x32_bf16 v[128:131], v[154:157], v[96:99], 0
  v_cndmask_b32 v132, v82, v132, s[18:19]
  v_cndmask_b32 v102, v102, v103, s[78:79]
  v_cndmask_b32 v106, v106, v107, s[78:79]
  v_cndmask_b32 v133, v102, v106, s[16:17]
  v_mul_f32 v133, v133, v59
  v_cndmask_b32 v133, v82, v133, s[62:63]
  v_max_f32 v54, v132, v133
  v_cndmask_b32 v108, v108, v109, s[78:79]
  v_cndmask_b32 v112, v112, v113, s[78:79]
  v_cndmask_b32 v134, v108, v112, s[14:15]
  v_mul_f32 v134, v134, v58
  v_cndmask_b32 v134, v82, v134, s[18:19]
  v_cndmask_b32 v110, v110, v111, s[78:79]
  v_cndmask_b32 v114, v114, v115, s[78:79]
  v_cndmask_b32 v135, v110, v114, s[16:17]
  v_mul_f32 v135, v135, v59
  v_cndmask_b32 v135, v82, v135, s[62:63]
  v_max_f32 v55, v134, v135
  v_cndmask_b32 v116, v116, v117, s[78:79]
  v_cndmask_b32 v120, v120, v121, s[78:79]
  v_cndmask_b32 v136, v116, v120, s[14:15]
  v_mul_f32 v136, v136, v58
  v_cndmask_b32 v136, v82, v136, s[18:19]
  v_cndmask_b32 v118, v118, v119, s[78:79]
  v_cndmask_b32 v122, v122, v123, s[78:79]
  v_cndmask_b32 v137, v118, v122, s[16:17]
  v_mul_f32 v137, v137, v59
  v_cndmask_b32 v137, v82, v137, s[62:63]
  v_max_f32 v56, v136, v137
  v_cndmask_b32 v124, v124, v125, s[78:79]
  v_cndmask_b32 v128, v128, v129, s[78:79]
  v_cndmask_b32 v138, v124, v128, s[14:15]
  v_mul_f32 v138, v138, v58
  v_cndmask_b32 v138, v82, v138, s[18:19]
  v_cndmask_b32 v126, v126, v127, s[78:79]
  v_cndmask_b32 v130, v130, v131, s[78:79]
  v_cndmask_b32 v139, v126, v130, s[16:17]
  v_mul_f32 v139, v139, v59
  v_cndmask_b32 v139, v82, v139, s[62:63]
  v_max_f32 v57, v138, v139
  s_nop 0
  v_permlane16_swap_b32 v54, v55
  v_permlane16_swap_b32 v56, v57
  v_max_f32 v54, v54, v55
  v_max_f32 v56, v56, v57
  s_nop 1
  v_permlane32_swap_b32 v54, v56
  v_max_f32 v54, v54, v56
  v_mov_b32 v56, v54
  s_nop 1
  v_permlane32_swap_b32 v54, v56
  v_mov_b32 v55, v54
  v_mov_b32 v57, v56
  s_nop 0
  v_permlane16_swap_b32 v54, v55
  v_permlane16_swap_b32 v56, v57
  v_sub_f32 v132, v132, v54
  v_sub_f32 v133, v133, v54
  v_sub_f32 v134, v134, v55
  v_sub_f32 v135, v135, v55
  v_sub_f32 v136, v136, v56
  v_sub_f32 v137, v137, v56
  v_sub_f32 v138, v138, v57
  v_sub_f32 v139, v139, v57
  v_exp_f32 v132, v132
  v_exp_f32 v133, v133
  v_exp_f32 v134, v134
  v_exp_f32 v135, v135
  v_exp_f32 v136, v136
  v_exp_f32 v137, v137
  v_exp_f32 v138, v138
  v_exp_f32 v139, v139
  v_add_f32 v54, v132, v133
  v_add_f32 v55, v134, v135
  v_add_f32 v56, v136, v137
  v_add_f32 v57, v138, v139
  v_mul_f32 v132, v132, v144
  v_permlane16_swap_b32 v54, v55
  v_permlane16_swap_b32 v56, v57
  v_add_f32 v54, v54, v55
  v_add_f32 v56, v56, v57
  v_mul_f32 v133, v133, v145
  v_mul_f32 v134, v134, v144
  v_permlane32_swap_b32 v54, v56
  v_add_f32 v54, v54, v56
  v_rcp_f32 v54, v54
  v_mul_f32 v135, v135, v145
  v_mov_b32 v56, v54
  v_mul_f32 v136, v136, v144
  v_mul_f32 v137, v137, v145
  v_permlane32_swap_b32 v54, v56
  v_mov_b32 v55, v54
  v_mov_b32 v57, v56
  v_mul_f32 v138, v138, v144
  v_permlane16_swap_b32 v54, v55
  v_permlane16_swap_b32 v56, v57
  v_mul_f32 v139, v139, v145
  v_mul_f32 v132, v132, v54
  v_mul_f32 v133, v133, v54
  v_cvt_pk_bf16_f32 v132, v132, v133
  v_perm_b32 v84, v132, v132, v140
  v_perm_b32 v85, v132, v132, v141
  v_perm_b32 v86, v132, v132, v142
  v_perm_b32 v87, v132, v132, v143
  v_mul_f32 v134, v134, v55
  v_mul_f32 v135, v135, v55
  v_mfma_f32_16x16x32_bf16 v[100:103], v[184:187], v[84:87], 0
  v_cvt_pk_bf16_f32 v134, v134, v135
  v_perm_b32 v88, v134, v134, v140
  v_mfma_f32_16x16x32_bf16 v[104:107], v[190:193], v[84:87], 0
  v_perm_b32 v89, v134, v134, v141
  v_perm_b32 v90, v134, v134, v142
  v_perm_b32 v91, v134, v134, v143
  v_mul_f32 v136, v136, v56
  v_mul_f32 v137, v137, v56
  v_mfma_f32_16x16x32_bf16 v[108:111], v[190:193], v[88:91], 0
  v_cvt_pk_bf16_f32 v136, v136, v137
  v_perm_b32 v92, v136, v136, v140
  v_mfma_f32_16x16x32_bf16 v[112:115], v[196:199], v[88:91], 0
  v_perm_b32 v93, v136, v136, v141
  v_perm_b32 v94, v136, v136, v142
  v_perm_b32 v95, v136, v136, v143
  v_mul_f32 v138, v138, v57
  v_mul_f32 v139, v139, v57
  v_mfma_f32_16x16x32_bf16 v[116:119], v[196:199], v[92:95], 0
  v_cvt_pk_bf16_f32 v138, v138, v139
  v_perm_b32 v96, v138, v138, v140
  v_mfma_f32_16x16x32_bf16 v[120:123], v[202:205], v[92:95], 0
  v_perm_b32 v97, v138, v138, v141
  v_perm_b32 v98, v138, v138, v142
  v_perm_b32 v99, v138, v138, v143
  v_cvt_pk_bf16_f32 v238, v100, v101
  v_cvt_pk_bf16_f32 v239, v102, v103
  v_mfma_f32_16x16x32_bf16 v[124:127], v[202:205], v[96:99], 0
  v_cvt_pk_bf16_f32 v50, v104, v105
  v_cvt_pk_bf16_f32 v51, v106, v107
  v_mfma_f32_16x16x32_bf16 v[128:131], v[208:211], v[96:99], 0
  v_cvt_pk_bf16_f32 v108, v108, v109
  v_cndmask_b32 v240, v50, v108, s[72:73]
  v_cvt_pk_bf16_f32 v241, v110, v111
  v_cvt_pk_bf16_f32 v50, v112, v113
  v_cvt_pk_bf16_f32 v51, v114, v115
  v_cvt_pk_bf16_f32 v116, v116, v117
  v_cndmask_b32 v242, v50, v116, s[72:73]
  v_cvt_pk_bf16_f32 v118, v118, v119
  v_cndmask_b32 v243, v51, v118, s[72:73]
  v_cvt_pk_bf16_f32 v50, v120, v121
  v_cvt_pk_bf16_f32 v51, v122, v123
  v_cvt_pk_bf16_f32 v124, v124, v125
  v_cndmask_b32 v244, v50, v124, s[74:75]
  v_cvt_pk_bf16_f32 v126, v126, v127
  v_cndmask_b32 v245, v51, v126, s[72:73]
  v_cvt_pk_bf16_f32 v50, v128, v129
  v_cvt_pk_bf16_f32 v51, v130, v131
  v_cndmask_b32 v84, 0, v246, s[74:75]
  v_cndmask_b32 v86, v248, 0, s[76:77]
  v_cndmask_b32 v85, 0, v247, s[74:75]
  v_cndmask_b32 v87, v249, 0, s[74:75]
  v_cndmask_b32 v88, 0, v248, s[76:77]
  v_cndmask_b32 v90, v250, 0, s[76:77]
  v_mfma_f32_16x16x32_bf16 v[100:103], a[224:227], v[84:87], 0
  v_cndmask_b32 v89, 0, v249, s[74:75]
  v_cndmask_b32 v91, v251, 0, s[76:77]
  v_mfma_f32_16x16x32_bf16 v[104:107], v[156:159], v[84:87], 0
  v_cndmask_b32 v92, 0, v250, s[76:77]
  v_mov_b32 v94, v252
  v_mfma_f32_16x16x32_bf16 v[108:111], a[226:229], v[88:91], 0
  v_cndmask_b32 v93, 0, v251, s[76:77]
  v_cndmask_b32 v95, v253, 0, s[76:77]
  v_mfma_f32_16x16x32_bf16 v[112:115], v[158:161], v[88:91], 0
  v_mov_b32 v96, 0
  v_mov_b32 v98, v254
  v_mfma_f32_16x16x32_bf16 v[116:119], a[228:231], v[92:95], 0
  v_cndmask_b32 v97, 0, v253, s[76:77]
  v_mov_b32 v99, v255
  v_mfma_f32_16x16x32_bf16 v[120:123], v[160:163], v[92:95], 0
  v_cndmask_b32 v100, v100, v101, s[78:79]
  v_cndmask_b32 v104, v104, v105, s[78:79]
  v_mfma_f32_16x16x32_bf16 v[124:127], a[230:233], v[96:99], 0
  v_cndmask_b32 v132, v100, v104, s[14:15]
  v_mul_f32 v132, v132, v58
  v_mfma_f32_16x16x32_bf16 v[128:131], v[162:165], v[96:99], 0
  v_cndmask_b32 v132, v82, v132, s[18:19]
  v_cndmask_b32 v102, v102, v103, s[78:79]
  v_cndmask_b32 v106, v106, v107, s[78:79]
  v_cndmask_b32 v133, v102, v106, s[16:17]
  v_mul_f32 v133, v133, v59
  v_cndmask_b32 v133, v82, v133, s[62:63]
  v_max_f32 v54, v132, v133
  v_cndmask_b32 v108, v108, v109, s[78:79]
  v_cndmask_b32 v112, v112, v113, s[78:79]
  v_cndmask_b32 v134, v108, v112, s[14:15]
  v_mul_f32 v134, v134, v58
  v_cndmask_b32 v134, v82, v134, s[18:19]
  v_cndmask_b32 v110, v110, v111, s[78:79]
  v_cndmask_b32 v114, v114, v115, s[78:79]
  v_cndmask_b32 v135, v110, v114, s[16:17]
  v_mul_f32 v135, v135, v59
  v_cndmask_b32 v135, v82, v135, s[62:63]
  v_max_f32 v55, v134, v135
  v_cndmask_b32 v116, v116, v117, s[78:79]
  v_cndmask_b32 v120, v120, v121, s[78:79]
  v_cndmask_b32 v136, v116, v120, s[14:15]
  v_mul_f32 v136, v136, v58
  v_cndmask_b32 v136, v82, v136, s[18:19]
  v_cndmask_b32 v118, v118, v119, s[78:79]
  v_cndmask_b32 v122, v122, v123, s[78:79]
  v_cndmask_b32 v137, v118, v122, s[16:17]
  v_mul_f32 v137, v137, v59
  v_cndmask_b32 v137, v82, v137, s[62:63]
  v_max_f32 v56, v136, v137
  v_cndmask_b32 v124, v124, v125, s[78:79]
  v_cndmask_b32 v128, v128, v129, s[78:79]
  v_cndmask_b32 v138, v124, v128, s[14:15]
  v_mul_f32 v138, v138, v58
  v_cndmask_b32 v138, v82, v138, s[18:19]
  v_cndmask_b32 v126, v126, v127, s[78:79]
  v_cndmask_b32 v130, v130, v131, s[78:79]
  v_cndmask_b32 v139, v126, v130, s[16:17]
  v_mul_f32 v139, v139, v59
  v_cndmask_b32 v139, v82, v139, s[62:63]
  v_max_f32 v57, v138, v139
  s_nop 0
  v_permlane16_swap_b32 v54, v55
  v_permlane16_swap_b32 v56, v57
  v_max_f32 v54, v54, v55
  v_max_f32 v56, v56, v57
  s_nop 1
  v_permlane32_swap_b32 v54, v56
  v_max_f32 v54, v54, v56
  v_mov_b32 v56, v54
  s_nop 1
  v_permlane32_swap_b32 v54, v56
  v_mov_b32 v55, v54
  v_mov_b32 v57, v56
  s_nop 0
  v_permlane16_swap_b32 v54, v55
  v_permlane16_swap_b32 v56, v57
  v_sub_f32 v132, v132, v54
  v_sub_f32 v133, v133, v54
  v_sub_f32 v134, v134, v55
  v_sub_f32 v135, v135, v55
  v_sub_f32 v136, v136, v56
  v_sub_f32 v137, v137, v56
  v_sub_f32 v138, v138, v57
  v_sub_f32 v139, v139, v57
  v_exp_f32 v132, v132
  v_exp_f32 v133, v133
  v_exp_f32 v134, v134
  v_exp_f32 v135, v135
  v_exp_f32 v136, v136
  v_exp_f32 v137, v137
  v_exp_f32 v138, v138
  v_exp_f32 v139, v139
  v_add_f32 v54, v132, v133
  v_add_f32 v55, v134, v135
  v_add_f32 v56, v136, v137
  v_add_f32 v57, v138, v139
  v_mul_f32 v132, v132, v144
  v_permlane16_swap_b32 v54, v55
  v_permlane16_swap_b32 v56, v57
  v_add_f32 v54, v54, v55
  v_add_f32 v56, v56, v57
  v_mul_f32 v133, v133, v145
  v_mul_f32 v134, v134, v144
  v_permlane32_swap_b32 v54, v56
  v_add_f32 v54, v54, v56
  v_rcp_f32 v54, v54
  v_mul_f32 v135, v135, v145
  v_mov_b32 v56, v54
  v_mul_f32 v136, v136, v144
  v_mul_f32 v137, v137, v145
  v_permlane32_swap_b32 v54, v56
  v_mov_b32 v55, v54
  v_mov_b32 v57, v56
  v_mul_f32 v138, v138, v144
  v_permlane16_swap_b32 v54, v55
  v_permlane16_swap_b32 v56, v57
  v_mul_f32 v139, v139, v145
  v_mul_f32 v132, v132, v54
  v_mul_f32 v133, v133, v54
  v_cvt_pk_bf16_f32 v132, v132, v133
  v_perm_b32 v84, v132, v132, v140
  v_perm_b32 v85, v132, v132, v141
  v_perm_b32 v86, v132, v132, v142
  v_perm_b32 v87, v132, v132, v143
  v_mul_f32 v134, v134, v55
  v_mul_f32 v135, v135, v55
  v_mfma_f32_16x16x32_bf16 v[100:103], v[208:211], v[84:87], 0
  v_cvt_pk_bf16_f32 v134, v134, v135
  v_perm_b32 v88, v134, v134, v140
  v_mfma_f32_16x16x32_bf16 v[104:107], v[214:217], v[84:87], 0
  v_perm_b32 v89, v134, v134, v141
  v_perm_b32 v90, v134, v134, v142
  v_perm_b32 v91, v134, v134, v143
  v_mul_f32 v136, v136, v56
  v_mul_f32 v137, v137, v56
  v_mfma_f32_16x16x32_bf16 v[108:111], v[214:217], v[88:91], 0
  v_cvt_pk_bf16_f32 v136, v136, v137
  v_perm_b32 v92, v136, v136, v140
  v_mfma_f32_16x16x32_bf16 v[112:115], v[220:223], v[88:91], 0
  v_perm_b32 v93, v136, v136, v141
  v_perm_b32 v94, v136, v136, v142
  v_perm_b32 v95, v136, v136, v143
  v_mul_f32 v138, v138, v57
  v_mul_f32 v139, v139, v57
  v_mfma_f32_16x16x32_bf16 v[116:119], v[220:223], v[92:95], 0
  v_cvt_pk_bf16_f32 v138, v138, v139
  v_perm_b32 v96, v138, v138, v140
  v_mfma_f32_16x16x32_bf16 v[120:123], v[226:229], v[92:95], 0
  v_perm_b32 v97, v138, v138, v141
  v_perm_b32 v98, v138, v138, v142
  v_perm_b32 v99, v138, v138, v143
  v_cvt_pk_bf16_f32 v100, v100, v101
  v_cndmask_b32 v246, v50, v100, s[74:75]
  v_mfma_f32_16x16x32_bf16 v[124:127], v[226:229], v[96:99], 0
  v_cvt_pk_bf16_f32 v102, v102, v103
  v_cndmask_b32 v247, v51, v102, s[74:75]
  v_mfma_f32_16x16x32_bf16 v[128:131], v[232:235], v[96:99], 0
  v_cvt_pk_bf16_f32 v50, v104, v105
  v_cvt_pk_bf16_f32 v51, v106, v107
  v_cvt_pk_bf16_f32 v108, v108, v109
  v_cndmask_b32 v248, v50, v108, s[76:77]
  v_cvt_pk_bf16_f32 v110, v110, v111
  v_cndmask_b32 v249, v51, v110, s[74:75]
  v_cvt_pk_bf16_f32 v50, v112, v113
  v_cvt_pk_bf16_f32 v51, v114, v115
  v_cvt_pk_bf16_f32 v116, v116, v117
  v_cndmask_b32 v250, v50, v116, s[76:77]
  v_cvt_pk_bf16_f32 v118, v118, v119
  v_cndmask_b32 v251, v51, v118, s[76:77]
  v_cvt_pk_bf16_f32 v50, v120, v121
  v_cvt_pk_bf16_f32 v51, v122, v123
  v_cvt_pk_bf16_f32 v124, v124, v125
  v_mov_b32 v252, v50
  v_cvt_pk_bf16_f32 v126, v126, v127
  v_cndmask_b32 v253, v51, v126, s[76:77]
  v_cvt_pk_bf16_f32 v254, v128, v129
  v_cvt_pk_bf16_f32 v255, v130, v131
  v_bfe_u32 v84, v1, 3, 2
  v_xor_b32 v84, 0, v84
  v_lshlrev_b32 v84, 5, v84
  v_lshrrev_b32 v85, 2, v1
  v_lshl_add_u32 v84, v85, 7, v84
  v_and_b32 v85, 3, v1
  v_lshl_add_u32 v8, v85, 3, v84
  v_xor_b32 v9, 32, v8
  v_xor_b32 v10, 64, v8
  v_xor_b32 v11, 96, v8
  v_add_u32 v12, 49152, v8
  v_add_u32 v13, 49152, v9
  v_add_u32 v14, 49152, v10
  v_add_u32 v15, 49152, v11
  v_add_u32 v16, 49152, v12
  v_add_u32 v17, 49152, v13
  v_add_u32 v18, 49152, v14
  v_add_u32 v19, 49152, v15
  v_lshlrev_b32 v22, 4, v1
  v_add_u32 v23, 294912, v22
  s_nop 0
  s_barrier
  ds_read_b64_tr_b16 v[32:33], v12 offset:0
  ds_read_b64_tr_b16 v[34:35], v12 offset:2048
  ds_read_b64_tr_b16 v[36:37], v12 offset:4096
  ds_read_b64_tr_b16 v[38:39], v12 offset:6144
  ds_read_b64_tr_b16 v[40:41], v12 offset:8192
  ds_read_b64_tr_b16 v[42:43], v12 offset:10240
  ds_read_b64_tr_b16 v[44:45], v12 offset:12288
  ds_read_b64_tr_b16 v[46:47], v12 offset:14336
  ds_read_b64_tr_b16 v[48:49], v12 offset:16384
  ds_read_b64_tr_b16 v[148:149], v13 offset:0
  ds_read_b64_tr_b16 v[150:151], v13 offset:2048
  ds_read_b64_tr_b16 v[152:153], v13 offset:4096
  ds_read_b64_tr_b16 v[154:155], v13 offset:6144
  ds_read_b64_tr_b16 v[156:157], v13 offset:8192
  ds_read_b64_tr_b16 v[158:159], v13 offset:10240
  ds_read_b64_tr_b16 v[160:161], v13 offset:12288
  ds_read_b64_tr_b16 v[162:163], v13 offset:14336
  ds_read_b64_tr_b16 v[164:165], v13 offset:16384
  s_waitcnt lgkmcnt(9)
  v_add_u32 v22, s67, v22
  v_add_u32 v23, s67, v23
  v_mfma_f32_16x16x16_bf16 v[188:191], v[48:49], v[80:81], 0
  ds_read_b64_tr_b16 v[166:167], v14 offset:0
  v_mfma_f32_16x16x32_bf16 v[184:187], v[32:35], v[238:241], 0
  ds_read_b64_tr_b16 v[168:169], v14 offset:2048
  v_mfma_f32_16x16x32_bf16 v[184:187], v[36:39], v[242:245], v[184:187]
  ds_read_b64_tr_b16 v[170:171], v14 offset:4096
  v_mfma_f32_16x16x32_bf16 v[184:187], v[40:43], v[246:249], v[184:187]
  ds_read_b64_tr_b16 v[172:173], v14 offset:6144
  v_mfma_f32_16x16x32_bf16 v[184:187], v[44:47], v[250:253], v[184:187]
  ds_read_b64_tr_b16 v[174:175], v14 offset:8192
  v_mfma_f32_16x16x32_bf16 v[188:191], v[32:35], v[64:67], v[188:191]
  ds_read_b64_tr_b16 v[176:177], v14 offset:10240
  v_mfma_f32_16x16x32_bf16 v[188:191], v[36:39], v[68:71], v[188:191]
  ds_read_b64_tr_b16 v[178:179], v14 offset:12288
  v_mfma_f32_16x16x32_bf16 v[188:191], v[40:43], v[72:75], v[188:191]
  ds_read_b64_tr_b16 v[180:181], v14 offset:14336
  v_mfma_f32_16x16x32_bf16 v[188:191], v[44:47], v[76:79], v[188:191]
  ds_read_b64_tr_b16 v[182:183], v14 offset:16384
  v_mfma_f32_16x16x16_bf16 v[184:187], v[48:49], v[254:255], v[184:187]
  s_waitcnt lgkmcnt(9)
  v_mfma_f32_16x16x16_bf16 v[196:199], v[164:165], v[80:81], 0
  ds_read_b64_tr_b16 v[32:33], v15 offset:0
  v_mfma_f32_16x16x32_bf16 v[192:195], v[148:151], v[238:241], 0
  ds_read_b64_tr_b16 v[34:35], v15 offset:2048
  v_mfma_f32_16x16x32_bf16 v[192:195], v[152:155], v[242:245], v[192:195]
  ds_read_b64_tr_b16 v[36:37], v15 offset:4096
  v_mfma_f32_16x16x32_bf16 v[192:195], v[156:159], v[246:249], v[192:195]
  ds_read_b64_tr_b16 v[38:39], v15 offset:6144
  v_mfma_f32_16x16x32_bf16 v[192:195], v[160:163], v[250:253], v[192:195]
  ds_read_b64_tr_b16 v[40:41], v15 offset:8192
  v_mfma_f32_16x16x32_bf16 v[196:199], v[148:151], v[64:67], v[196:199]
  ds_read_b64_tr_b16 v[42:43], v15 offset:10240
  v_mfma_f32_16x16x32_bf16 v[196:199], v[152:155], v[68:71], v[196:199]
  ds_read_b64_tr_b16 v[44:45], v15 offset:12288
  v_mfma_f32_16x16x32_bf16 v[196:199], v[156:159], v[72:75], v[196:199]
  ds_read_b64_tr_b16 v[46:47], v15 offset:14336
  v_mfma_f32_16x16x32_bf16 v[196:199], v[160:163], v[76:79], v[196:199]
  ds_read_b64_tr_b16 v[48:49], v15 offset:16384
  v_mfma_f32_16x16x16_bf16 v[192:195], v[164:165], v[254:255], v[192:195]
  s_waitcnt lgkmcnt(9)
  v_mfma_f32_16x16x16_bf16 v[204:207], v[182:183], v[80:81], 0
  ds_read_b64_tr_b16 v[148:149], v12 offset:24576
  v_mfma_f32_16x16x32_bf16 v[200:203], v[166:169], v[238:241], 0
  ds_read_b64_tr_b16 v[150:151], v12 offset:26624
  v_mfma_f32_16x16x32_bf16 v[200:203], v[170:173], v[242:245], v[200:203]
  ds_read_b64_tr_b16 v[152:153], v12 offset:28672
  v_mfma_f32_16x16x32_bf16 v[200:203], v[174:177], v[246:249], v[200:203]
  ds_read_b64_tr_b16 v[154:155], v12 offset:30720
  s_mul_i32 s58, s80, 256
  v_mfma_f32_16x16x32_bf16 v[200:203], v[178:181], v[250:253], v[200:203]
  ds_read_b64_tr_b16 v[156:157], v12 offset:32768
  v_cvt_pk_bf16_f32 v216, v184, v185
  v_mfma_f32_16x16x32_bf16 v[204:207], v[166:169], v[64:67], v[204:207]
  ds_read_b64_tr_b16 v[158:159], v12 offset:34816
  v_cvt_pk_bf16_f32 v217, v186, v187
  v_mfma_f32_16x16x32_bf16 v[204:207], v[170:173], v[68:71], v[204:207]
  ds_read_b64_tr_b16 v[160:161], v12 offset:36864
  v_cvt_pk_bf16_f32 v218, v192, v193
  v_mfma_f32_16x16x32_bf16 v[204:207], v[174:177], v[72:75], v[204:207]
  ds_read_b64_tr_b16 v[162:163], v12 offset:38912
  v_cvt_pk_bf16_f32 v219, v194, v195
  v_mfma_f32_16x16x32_bf16 v[204:207], v[178:181], v[76:79], v[204:207]
  ds_read_b64_tr_b16 v[164:165], v12 offset:40960
  buffer_store_dwordx4 v[216:219], v22, s[40:43], s58 offen sc1
  v_mfma_f32_16x16x16_bf16 v[200:203], v[182:183], v[254:255], v[200:203]
  v_cvt_pk_bf16_f32 v220, v188, v189
  s_waitcnt lgkmcnt(9)
  v_mfma_f32_16x16x16_bf16 v[212:215], v[48:49], v[80:81], 0
  ds_read_b64_tr_b16 v[166:167], v13 offset:24576
  v_cvt_pk_bf16_f32 v221, v190, v191
  v_mfma_f32_16x16x32_bf16 v[208:211], v[32:35], v[238:241], 0
  ds_read_b64_tr_b16 v[168:169], v13 offset:26624
  v_cvt_pk_bf16_f32 v222, v196, v197
  v_mfma_f32_16x16x32_bf16 v[208:211], v[36:39], v[242:245], v[208:211]
  ds_read_b64_tr_b16 v[170:171], v13 offset:28672
  v_cvt_pk_bf16_f32 v223, v198, v199
  v_mfma_f32_16x16x32_bf16 v[208:211], v[40:43], v[246:249], v[208:211]
  ds_read_b64_tr_b16 v[172:173], v13 offset:30720
  buffer_store_dwordx4 v[220:223], v23, s[40:43], s58 offen sc1
  v_mfma_f32_16x16x32_bf16 v[208:211], v[44:47], v[250:253], v[208:211]
  ds_read_b64_tr_b16 v[174:175], v13 offset:32768
  v_mfma_f32_16x16x32_bf16 v[212:215], v[32:35], v[64:67], v[212:215]
  ds_read_b64_tr_b16 v[176:177], v13 offset:34816
  v_mfma_f32_16x16x32_bf16 v[212:215], v[36:39], v[68:71], v[212:215]
  ds_read_b64_tr_b16 v[178:179], v13 offset:36864
  v_mfma_f32_16x16x32_bf16 v[212:215], v[40:43], v[72:75], v[212:215]
  ds_read_b64_tr_b16 v[180:181], v13 offset:38912
  v_mfma_f32_16x16x32_bf16 v[212:215], v[44:47], v[76:79], v[212:215]
  ds_read_b64_tr_b16 v[182:183], v13 offset:40960
  v_mfma_f32_16x16x16_bf16 v[208:211], v[48:49], v[254:255], v[208:211]
  s_waitcnt lgkmcnt(9)
  v_mfma_f32_16x16x16_bf16 v[188:191], v[164:165], v[80:81], 0
  ds_read_b64_tr_b16 v[32:33], v14 offset:24576
  v_mfma_f32_16x16x32_bf16 v[184:187], v[148:151], v[238:241], 0
  ds_read_b64_tr_b16 v[34:35], v14 offset:26624
  v_mfma_f32_16x16x32_bf16 v[184:187], v[152:155], v[242:245], v[184:187]
  ds_read_b64_tr_b16 v[36:37], v14 offset:28672
  v_mfma_f32_16x16x32_bf16 v[184:187], v[156:159], v[246:249], v[184:187]
  ds_read_b64_tr_b16 v[38:39], v14 offset:30720
  s_bitset1_b32 s58, 14
  v_mfma_f32_16x16x32_bf16 v[184:187], v[160:163], v[250:253], v[184:187]
  ds_read_b64_tr_b16 v[40:41], v14 offset:32768
  v_cvt_pk_bf16_f32 v216, v200, v201
  v_mfma_f32_16x16x32_bf16 v[188:191], v[148:151], v[64:67], v[188:191]
  ds_read_b64_tr_b16 v[42:43], v14 offset:34816
  v_cvt_pk_bf16_f32 v217, v202, v203
  v_mfma_f32_16x16x32_bf16 v[188:191], v[152:155], v[68:71], v[188:191]
  ds_read_b64_tr_b16 v[44:45], v14 offset:36864
  v_cvt_pk_bf16_f32 v218, v208, v209
  v_mfma_f32_16x16x32_bf16 v[188:191], v[156:159], v[72:75], v[188:191]
  ds_read_b64_tr_b16 v[46:47], v14 offset:38912
  v_cvt_pk_bf16_f32 v219, v210, v211
  v_mfma_f32_16x16x32_bf16 v[188:191], v[160:163], v[76:79], v[188:191]
  ds_read_b64_tr_b16 v[48:49], v14 offset:40960
  buffer_store_dwordx4 v[216:219], v22, s[40:43], s58 offen sc1
  v_mfma_f32_16x16x16_bf16 v[184:187], v[164:165], v[254:255], v[184:187]
  v_cvt_pk_bf16_f32 v220, v204, v205
  s_waitcnt lgkmcnt(9)
  v_mfma_f32_16x16x16_bf16 v[196:199], v[182:183], v[80:81], 0
  ds_read_b64_tr_b16 v[148:149], v15 offset:24576
  v_cvt_pk_bf16_f32 v221, v206, v207
  v_mfma_f32_16x16x32_bf16 v[192:195], v[166:169], v[238:241], 0
  ds_read_b64_tr_b16 v[150:151], v15 offset:26624
  v_cvt_pk_bf16_f32 v222, v212, v213
  v_mfma_f32_16x16x32_bf16 v[192:195], v[170:173], v[242:245], v[192:195]
  ds_read_b64_tr_b16 v[152:153], v15 offset:28672
  v_cvt_pk_bf16_f32 v223, v214, v215
  v_mfma_f32_16x16x32_bf16 v[192:195], v[174:177], v[246:249], v[192:195]
  ds_read_b64_tr_b16 v[154:155], v15 offset:30720
  buffer_store_dwordx4 v[220:223], v23, s[40:43], s58 offen sc1
  v_mfma_f32_16x16x32_bf16 v[192:195], v[178:181], v[250:253], v[192:195]
  ds_read_b64_tr_b16 v[156:157], v15 offset:32768
  v_mfma_f32_16x16x32_bf16 v[196:199], v[166:169], v[64:67], v[196:199]
  ds_read_b64_tr_b16 v[158:159], v15 offset:34816
  v_mfma_f32_16x16x32_bf16 v[196:199], v[170:173], v[68:71], v[196:199]
  ds_read_b64_tr_b16 v[160:161], v15 offset:36864
  v_mfma_f32_16x16x32_bf16 v[196:199], v[174:177], v[72:75], v[196:199]
  ds_read_b64_tr_b16 v[162:163], v15 offset:38912
  v_mfma_f32_16x16x32_bf16 v[196:199], v[178:181], v[76:79], v[196:199]
  ds_read_b64_tr_b16 v[164:165], v15 offset:40960
  v_mfma_f32_16x16x16_bf16 v[192:195], v[182:183], v[254:255], v[192:195]
  s_waitcnt vmcnt(7) lgkmcnt(9)
  s_barrier
  v_mfma_f32_16x16x16_bf16 v[204:207], v[48:49], v[80:81], 0
  ds_read_b64_tr_b16 v[166:167], v16 offset:0
  s_add_u32 s56, s54, s86
  v_mfma_f32_16x16x32_bf16 v[200:203], v[32:35], v[238:241], 0
  ds_read_b64_tr_b16 v[168:169], v16 offset:2048
  s_addc_u32 s57, s55, 0
  v_mfma_f32_16x16x32_bf16 v[200:203], v[36:39], v[242:245], v[200:203]
  ds_read_b64_tr_b16 v[170:171], v16 offset:4096
  s_add_u32 m0, s51, 49152
  v_mfma_f32_16x16x32_bf16 v[200:203], v[40:43], v[246:249], v[200:203]
  ds_read_b64_tr_b16 v[172:173], v16 offset:6144
  global_load_lds_dwordx4 v2, s[56:57] offset:0
  v_mfma_f32_16x16x32_bf16 v[200:203], v[44:47], v[250:253], v[200:203]
  ds_read_b64_tr_b16 v[174:175], v16 offset:8192
  s_mul_i32 s58, s81, 256
  v_mfma_f32_16x16x32_bf16 v[204:207], v[32:35], v[64:67], v[204:207]
  ds_read_b64_tr_b16 v[176:177], v16 offset:10240
  v_cvt_pk_bf16_f32 v216, v184, v185
  v_mfma_f32_16x16x32_bf16 v[204:207], v[36:39], v[68:71], v[204:207]
  ds_read_b64_tr_b16 v[178:179], v16 offset:12288
  v_cvt_pk_bf16_f32 v217, v186, v187
  v_mfma_f32_16x16x32_bf16 v[204:207], v[40:43], v[72:75], v[204:207]
  ds_read_b64_tr_b16 v[180:181], v16 offset:14336
  v_cvt_pk_bf16_f32 v218, v192, v193
  v_mfma_f32_16x16x32_bf16 v[204:207], v[44:47], v[76:79], v[204:207]
  ds_read_b64_tr_b16 v[182:183], v16 offset:16384
  v_cvt_pk_bf16_f32 v219, v194, v195
  v_mfma_f32_16x16x16_bf16 v[200:203], v[48:49], v[254:255], v[200:203]
  buffer_store_dwordx4 v[216:219], v22, s[40:43], s58 offen sc1
  s_waitcnt lgkmcnt(9)
  v_mfma_f32_16x16x16_bf16 v[212:215], v[164:165], v[80:81], 0
  ds_read_b64_tr_b16 v[32:33], v17 offset:0
  global_load_lds_dwordx4 v3, s[56:57] offset:1024
  v_mfma_f32_16x16x32_bf16 v[208:211], v[148:151], v[238:241], 0
  ds_read_b64_tr_b16 v[34:35], v17 offset:2048
  v_cvt_pk_bf16_f32 v220, v188, v189
  v_mfma_f32_16x16x32_bf16 v[208:211], v[152:155], v[242:245], v[208:211]
  ds_read_b64_tr_b16 v[36:37], v17 offset:4096
  v_cvt_pk_bf16_f32 v221, v190, v191
  v_mfma_f32_16x16x32_bf16 v[208:211], v[156:159], v[246:249], v[208:211]
  ds_read_b64_tr_b16 v[38:39], v17 offset:6144
  v_cvt_pk_bf16_f32 v222, v196, v197
  v_mfma_f32_16x16x32_bf16 v[208:211], v[160:163], v[250:253], v[208:211]
  ds_read_b64_tr_b16 v[40:41], v17 offset:8192
  v_cvt_pk_bf16_f32 v223, v198, v199
  v_mfma_f32_16x16x32_bf16 v[212:215], v[148:151], v[64:67], v[212:215]
  ds_read_b64_tr_b16 v[42:43], v17 offset:10240
  buffer_store_dwordx4 v[220:223], v23, s[40:43], s58 offen sc1
  v_mfma_f32_16x16x32_bf16 v[212:215], v[152:155], v[68:71], v[212:215]
  ds_read_b64_tr_b16 v[44:45], v17 offset:12288
  v_mfma_f32_16x16x32_bf16 v[212:215], v[156:159], v[72:75], v[212:215]
  ds_read_b64_tr_b16 v[46:47], v17 offset:14336
  v_mfma_f32_16x16x32_bf16 v[212:215], v[160:163], v[76:79], v[212:215]
  ds_read_b64_tr_b16 v[48:49], v17 offset:16384
  v_mfma_f32_16x16x16_bf16 v[208:211], v[164:165], v[254:255], v[208:211]
  s_waitcnt lgkmcnt(9)
  v_mfma_f32_16x16x16_bf16 v[188:191], v[182:183], v[80:81], 0
  ds_read_b64_tr_b16 v[148:149], v18 offset:0
  global_load_lds_dwordx4 v4, s[56:57] offset:2048
  v_mfma_f32_16x16x32_bf16 v[184:187], v[166:169], v[238:241], 0
  ds_read_b64_tr_b16 v[150:151], v18 offset:2048
  v_mfma_f32_16x16x32_bf16 v[184:187], v[170:173], v[242:245], v[184:187]
  ds_read_b64_tr_b16 v[152:153], v18 offset:4096
  v_mfma_f32_16x16x32_bf16 v[184:187], v[174:177], v[246:249], v[184:187]
  ds_read_b64_tr_b16 v[154:155], v18 offset:6144
  s_bitset1_b32 s58, 14
  v_mfma_f32_16x16x32_bf16 v[184:187], v[178:181], v[250:253], v[184:187]
  ds_read_b64_tr_b16 v[156:157], v18 offset:8192
  v_cvt_pk_bf16_f32 v216, v200, v201
  v_mfma_f32_16x16x32_bf16 v[188:191], v[166:169], v[64:67], v[188:191]
  ds_read_b64_tr_b16 v[158:159], v18 offset:10240
  v_cvt_pk_bf16_f32 v217, v202, v203
  v_mfma_f32_16x16x32_bf16 v[188:191], v[170:173], v[68:71], v[188:191]
  ds_read_b64_tr_b16 v[160:161], v18 offset:12288
  v_cvt_pk_bf16_f32 v218, v208, v209
  v_mfma_f32_16x16x32_bf16 v[188:191], v[174:177], v[72:75], v[188:191]
  ds_read_b64_tr_b16 v[162:163], v18 offset:14336
  v_cvt_pk_bf16_f32 v219, v210, v211
  v_mfma_f32_16x16x32_bf16 v[188:191], v[178:181], v[76:79], v[188:191]
  ds_read_b64_tr_b16 v[164:165], v18 offset:16384
  buffer_store_dwordx4 v[216:219], v22, s[40:43], s58 offen sc1
  v_mfma_f32_16x16x16_bf16 v[184:187], v[182:183], v[254:255], v[184:187]
  v_cvt_pk_bf16_f32 v220, v204, v205
  s_waitcnt lgkmcnt(9)
  v_mfma_f32_16x16x16_bf16 v[196:199], v[48:49], v[80:81], 0
  ds_read_b64_tr_b16 v[166:167], v19 offset:0
  global_load_lds_dwordx4 v5, s[56:57] offset:3072
  v_mfma_f32_16x16x32_bf16 v[192:195], v[32:35], v[238:241], 0
  ds_read_b64_tr_b16 v[168:169], v19 offset:2048
  v_cvt_pk_bf16_f32 v221, v206, v207
  v_mfma_f32_16x16x32_bf16 v[192:195], v[36:39], v[242:245], v[192:195]
  ds_read_b64_tr_b16 v[170:171], v19 offset:4096
  v_cvt_pk_bf16_f32 v222, v212, v213
  v_mfma_f32_16x16x32_bf16 v[192:195], v[40:43], v[246:249], v[192:195]
  ds_read_b64_tr_b16 v[172:173], v19 offset:6144
  v_cvt_pk_bf16_f32 v223, v214, v215
  v_mfma_f32_16x16x32_bf16 v[192:195], v[44:47], v[250:253], v[192:195]
  ds_read_b64_tr_b16 v[174:175], v19 offset:8192
  buffer_store_dwordx4 v[220:223], v23, s[40:43], s58 offen sc1
  v_mfma_f32_16x16x32_bf16 v[196:199], v[32:35], v[64:67], v[196:199]
  ds_read_b64_tr_b16 v[176:177], v19 offset:10240
  v_mfma_f32_16x16x32_bf16 v[196:199], v[36:39], v[68:71], v[196:199]
  ds_read_b64_tr_b16 v[178:179], v19 offset:12288
  v_mfma_f32_16x16x32_bf16 v[196:199], v[40:43], v[72:75], v[196:199]
  ds_read_b64_tr_b16 v[180:181], v19 offset:14336
  v_mfma_f32_16x16x32_bf16 v[196:199], v[44:47], v[76:79], v[196:199]
  ds_read_b64_tr_b16 v[182:183], v19 offset:16384
  v_mfma_f32_16x16x16_bf16 v[192:195], v[48:49], v[254:255], v[192:195]
  s_waitcnt lgkmcnt(9)
  v_mfma_f32_16x16x16_bf16 v[204:207], v[164:165], v[80:81], 0
  ds_read_b64_tr_b16 v[32:33], v8 offset:0
  s_add_u32 m0, s51, 53248
  v_mfma_f32_16x16x32_bf16 v[200:203], v[148:151], v[238:241], 0
  ds_read_b64_tr_b16 v[34:35], v8 offset:2048
  global_load_lds_dwordx4 v6, s[56:57] offset:0
  v_mfma_f32_16x16x32_bf16 v[200:203], v[152:155], v[242:245], v[200:203]
  ds_read_b64_tr_b16 v[36:37], v8 offset:4096
  v_mfma_f32_16x16x32_bf16 v[200:203], v[156:159], v[246:249], v[200:203]
  ds_read_b64_tr_b16 v[38:39], v8 offset:6144
  s_mul_i32 s58, s82, 256
  v_mfma_f32_16x16x32_bf16 v[200:203], v[160:163], v[250:253], v[200:203]
  ds_read_b64_tr_b16 v[40:41], v8 offset:8192
  v_cvt_pk_bf16_f32 v216, v184, v185
  v_mfma_f32_16x16x32_bf16 v[204:207], v[148:151], v[64:67], v[204:207]
  ds_read_b64_tr_b16 v[42:43], v8 offset:10240
  v_cvt_pk_bf16_f32 v217, v186, v187
  v_mfma_f32_16x16x32_bf16 v[204:207], v[152:155], v[68:71], v[204:207]
  ds_read_b64_tr_b16 v[44:45], v8 offset:12288
  v_cvt_pk_bf16_f32 v218, v192, v193
  v_mfma_f32_16x16x32_bf16 v[204:207], v[156:159], v[72:75], v[204:207]
  ds_read_b64_tr_b16 v[46:47], v8 offset:14336
  v_cvt_pk_bf16_f32 v219, v194, v195
  v_mfma_f32_16x16x32_bf16 v[204:207], v[160:163], v[76:79], v[204:207]
  ds_read_b64_tr_b16 v[48:49], v8 offset:16384
  buffer_store_dwordx4 v[216:219], v22, s[40:43], s58 offen sc1
  v_mfma_f32_16x16x16_bf16 v[200:203], v[164:165], v[254:255], v[200:203]
  v_cvt_pk_bf16_f32 v220, v188, v189
  s_waitcnt lgkmcnt(9)
  v_mfma_f32_16x16x16_bf16 v[212:215], v[182:183], v[80:81], 0
  ds_read_b64_tr_b16 v[148:149], v9 offset:0
  v_cvt_pk_bf16_f32 v221, v190, v191
  v_mfma_f32_16x16x32_bf16 v[208:211], v[166:169], v[238:241], 0
  ds_read_b64_tr_b16 v[150:151], v9 offset:2048
  v_cvt_pk_bf16_f32 v222, v196, v197
  v_mfma_f32_16x16x32_bf16 v[208:211], v[170:173], v[242:245], v[208:211]
  ds_read_b64_tr_b16 v[152:153], v9 offset:4096
  v_cvt_pk_bf16_f32 v223, v198, v199
  v_mfma_f32_16x16x32_bf16 v[208:211], v[174:177], v[246:249], v[208:211]
  ds_read_b64_tr_b16 v[154:155], v9 offset:6144
  buffer_store_dwordx4 v[220:223], v23, s[40:43], s58 offen sc1
  v_mfma_f32_16x16x32_bf16 v[208:211], v[178:181], v[250:253], v[208:211]
  ds_read_b64_tr_b16 v[156:157], v9 offset:8192
  v_mfma_f32_16x16x32_bf16 v[212:215], v[166:169], v[64:67], v[212:215]
  ds_read_b64_tr_b16 v[158:159], v9 offset:10240
  v_mfma_f32_16x16x32_bf16 v[212:215], v[170:173], v[68:71], v[212:215]
  ds_read_b64_tr_b16 v[160:161], v9 offset:12288
  v_mfma_f32_16x16x32_bf16 v[212:215], v[174:177], v[72:75], v[212:215]
  ds_read_b64_tr_b16 v[162:163], v9 offset:14336
  v_mfma_f32_16x16x32_bf16 v[212:215], v[178:181], v[76:79], v[212:215]
  ds_read_b64_tr_b16 v[164:165], v9 offset:16384
  v_mfma_f32_16x16x16_bf16 v[208:211], v[182:183], v[254:255], v[208:211]
  s_waitcnt lgkmcnt(9)
  v_mfma_f32_16x16x16_bf16 v[188:191], v[48:49], v[80:81], 0
  ds_read_b64_tr_b16 v[166:167], v10 offset:0
  v_mfma_f32_16x16x32_bf16 v[184:187], v[32:35], v[238:241], 0
  ds_read_b64_tr_b16 v[168:169], v10 offset:2048
  v_mfma_f32_16x16x32_bf16 v[184:187], v[36:39], v[242:245], v[184:187]
  ds_read_b64_tr_b16 v[170:171], v10 offset:4096
  v_mfma_f32_16x16x32_bf16 v[184:187], v[40:43], v[246:249], v[184:187]
  ds_read_b64_tr_b16 v[172:173], v10 offset:6144
  s_bitset1_b32 s58, 14
  v_mfma_f32_16x16x32_bf16 v[184:187], v[44:47], v[250:253], v[184:187]
  ds_read_b64_tr_b16 v[174:175], v10 offset:8192
  v_cvt_pk_bf16_f32 v216, v200, v201
  v_mfma_f32_16x16x32_bf16 v[188:191], v[32:35], v[64:67], v[188:191]
  ds_read_b64_tr_b16 v[176:177], v10 offset:10240
  v_cvt_pk_bf16_f32 v217, v202, v203
  v_mfma_f32_16x16x32_bf16 v[188:191], v[36:39], v[68:71], v[188:191]
  ds_read_b64_tr_b16 v[178:179], v10 offset:12288
  v_cvt_pk_bf16_f32 v218, v208, v209
  v_mfma_f32_16x16x32_bf16 v[188:191], v[40:43], v[72:75], v[188:191]
  ds_read_b64_tr_b16 v[180:181], v10 offset:14336
  v_cvt_pk_bf16_f32 v219, v210, v211
  v_mfma_f32_16x16x32_bf16 v[188:191], v[44:47], v[76:79], v[188:191]
  ds_read_b64_tr_b16 v[182:183], v10 offset:16384
  buffer_store_dwordx4 v[216:219], v22, s[40:43], s58 offen sc1
  v_mfma_f32_16x16x16_bf16 v[184:187], v[48:49], v[254:255], v[184:187]
  v_cvt_pk_bf16_f32 v220, v204, v205
  s_waitcnt lgkmcnt(9)
  v_mfma_f32_16x16x16_bf16 v[196:199], v[164:165], v[80:81], 0
  ds_read_b64_tr_b16 v[32:33], v11 offset:0
  v_cvt_pk_bf16_f32 v221, v206, v207
  v_mfma_f32_16x16x32_bf16 v[192:195], v[148:151], v[238:241], 0
  ds_read_b64_tr_b16 v[34:35], v11 offset:2048
  v_cvt_pk_bf16_f32 v222, v212, v213
  v_mfma_f32_16x16x32_bf16 v[192:195], v[152:155], v[242:245], v[192:195]
  ds_read_b64_tr_b16 v[36:37], v11 offset:4096
  v_cvt_pk_bf16_f32 v223, v214, v215
  v_mfma_f32_16x16x32_bf16 v[192:195], v[156:159], v[246:249], v[192:195]
  ds_read_b64_tr_b16 v[38:39], v11 offset:6144
  buffer_store_dwordx4 v[220:223], v23, s[40:43], s58 offen sc1
  v_mfma_f32_16x16x32_bf16 v[192:195], v[160:163], v[250:253], v[192:195]
  ds_read_b64_tr_b16 v[40:41], v11 offset:8192
  v_mfma_f32_16x16x32_bf16 v[196:199], v[148:151], v[64:67], v[196:199]
  ds_read_b64_tr_b16 v[42:43], v11 offset:10240
  v_mfma_f32_16x16x32_bf16 v[196:199], v[152:155], v[68:71], v[196:199]
  ds_read_b64_tr_b16 v[44:45], v11 offset:12288
  v_mfma_f32_16x16x32_bf16 v[196:199], v[156:159], v[72:75], v[196:199]
  ds_read_b64_tr_b16 v[46:47], v11 offset:14336
  v_mfma_f32_16x16x32_bf16 v[196:199], v[160:163], v[76:79], v[196:199]
  ds_read_b64_tr_b16 v[48:49], v11 offset:16384
  v_mfma_f32_16x16x16_bf16 v[192:195], v[164:165], v[254:255], v[192:195]
  s_waitcnt lgkmcnt(9)
  s_barrier
  v_mfma_f32_16x16x16_bf16 v[204:207], v[182:183], v[80:81], 0
  ds_read_b64_tr_b16 v[148:149], v8 offset:24576
  s_add_u32 s56, s54, s87
  v_mfma_f32_16x16x32_bf16 v[200:203], v[166:169], v[238:241], 0
  ds_read_b64_tr_b16 v[150:151], v8 offset:26624
  s_addc_u32 s57, s55, 0
  v_mfma_f32_16x16x32_bf16 v[200:203], v[170:173], v[242:245], v[200:203]
  ds_read_b64_tr_b16 v[152:153], v8 offset:28672
  s_add_u32 m0, s51, 73728
  v_mfma_f32_16x16x32_bf16 v[200:203], v[174:177], v[246:249], v[200:203]
  ds_read_b64_tr_b16 v[154:155], v8 offset:30720
  global_load_lds_dwordx4 v2, s[56:57] offset:0
  v_mfma_f32_16x16x32_bf16 v[200:203], v[178:181], v[250:253], v[200:203]
  ds_read_b64_tr_b16 v[156:157], v8 offset:32768
  s_mul_i32 s58, s83, 256
  v_mfma_f32_16x16x32_bf16 v[204:207], v[166:169], v[64:67], v[204:207]
  ds_read_b64_tr_b16 v[158:159], v8 offset:34816
  v_cvt_pk_bf16_f32 v216, v184, v185
  v_mfma_f32_16x16x32_bf16 v[204:207], v[170:173], v[68:71], v[204:207]
  ds_read_b64_tr_b16 v[160:161], v8 offset:36864
  global_load_lds_dwordx4 v3, s[56:57] offset:1024
  v_mfma_f32_16x16x32_bf16 v[204:207], v[174:177], v[72:75], v[204:207]
  ds_read_b64_tr_b16 v[162:163], v8 offset:38912
  v_cvt_pk_bf16_f32 v217, v186, v187
  v_mfma_f32_16x16x32_bf16 v[204:207], v[178:181], v[76:79], v[204:207]
  ds_read_b64_tr_b16 v[164:165], v8 offset:40960
  v_cvt_pk_bf16_f32 v218, v192, v193
  v_mfma_f32_16x16x16_bf16 v[200:203], v[182:183], v[254:255], v[200:203]
  v_cvt_pk_bf16_f32 v219, v194, v195
  s_waitcnt lgkmcnt(9)
  v_mfma_f32_16x16x16_bf16 v[212:215], v[48:49], v[80:81], 0
  ds_read_b64_tr_b16 v[166:167], v9 offset:24576
  buffer_store_dwordx4 v[216:219], v22, s[40:43], s58 offen sc1
  v_mfma_f32_16x16x32_bf16 v[208:211], v[32:35], v[238:241], 0
  ds_read_b64_tr_b16 v[168:169], v9 offset:26624
  v_cvt_pk_bf16_f32 v220, v188, v189
  v_mfma_f32_16x16x32_bf16 v[208:211], v[36:39], v[242:245], v[208:211]
  ds_read_b64_tr_b16 v[170:171], v9 offset:28672
  global_load_lds_dwordx4 v4, s[56:57] offset:2048
  v_mfma_f32_16x16x32_bf16 v[208:211], v[40:43], v[246:249], v[208:211]
  ds_read_b64_tr_b16 v[172:173], v9 offset:30720
  v_cvt_pk_bf16_f32 v221, v190, v191
  v_mfma_f32_16x16x32_bf16 v[208:211], v[44:47], v[250:253], v[208:211]
  ds_read_b64_tr_b16 v[174:175], v9 offset:32768
  v_cvt_pk_bf16_f32 v222, v196, v197
  v_mfma_f32_16x16x32_bf16 v[212:215], v[32:35], v[64:67], v[212:215]
  ds_read_b64_tr_b16 v[176:177], v9 offset:34816
  v_cvt_pk_bf16_f32 v223, v198, v199
  v_mfma_f32_16x16x32_bf16 v[212:215], v[36:39], v[68:71], v[212:215]
  ds_read_b64_tr_b16 v[178:179], v9 offset:36864
  buffer_store_dwordx4 v[220:223], v23, s[40:43], s58 offen sc1
  v_mfma_f32_16x16x32_bf16 v[212:215], v[40:43], v[72:75], v[212:215]
  ds_read_b64_tr_b16 v[180:181], v9 offset:38912
  v_mfma_f32_16x16x32_bf16 v[212:215], v[44:47], v[76:79], v[212:215]
  ds_read_b64_tr_b16 v[182:183], v9 offset:40960
  global_load_lds_dwordx4 v5, s[56:57] offset:3072
  v_mfma_f32_16x16x16_bf16 v[208:211], v[48:49], v[254:255], v[208:211]
  s_waitcnt lgkmcnt(9)
  v_mfma_f32_16x16x16_bf16 v[188:191], v[164:165], v[80:81], 0
  ds_read_b64_tr_b16 v[32:33], v10 offset:24576
  v_mfma_f32_16x16x32_bf16 v[184:187], v[148:151], v[238:241], 0
  ds_read_b64_tr_b16 v[34:35], v10 offset:26624
  v_mfma_f32_16x16x32_bf16 v[184:187], v[152:155], v[242:245], v[184:187]
  ds_read_b64_tr_b16 v[36:37], v10 offset:28672
  v_mfma_f32_16x16x32_bf16 v[184:187], v[156:159], v[246:249], v[184:187]
  ds_read_b64_tr_b16 v[38:39], v10 offset:30720
  s_bitset1_b32 s58, 14
  v_mfma_f32_16x16x32_bf16 v[184:187], v[160:163], v[250:253], v[184:187]
  ds_read_b64_tr_b16 v[40:41], v10 offset:32768
  s_add_u32 m0, s51, 77824
  v_mfma_f32_16x16x32_bf16 v[188:191], v[148:151], v[64:67], v[188:191]
  ds_read_b64_tr_b16 v[42:43], v10 offset:34816
  global_load_lds_dwordx4 v6, s[56:57] offset:0
  v_mfma_f32_16x16x32_bf16 v[188:191], v[152:155], v[68:71], v[188:191]
  ds_read_b64_tr_b16 v[44:45], v10 offset:36864
  v_cvt_pk_bf16_f32 v216, v200, v201
  v_mfma_f32_16x16x32_bf16 v[188:191], v[156:159], v[72:75], v[188:191]
  ds_read_b64_tr_b16 v[46:47], v10 offset:38912
  v_cvt_pk_bf16_f32 v217, v202, v203
  v_mfma_f32_16x16x32_bf16 v[188:191], v[160:163], v[76:79], v[188:191]
  ds_read_b64_tr_b16 v[48:49], v10 offset:40960
  v_cvt_pk_bf16_f32 v218, v208, v209
  v_mfma_f32_16x16x16_bf16 v[184:187], v[164:165], v[254:255], v[184:187]
  v_cvt_pk_bf16_f32 v219, v210, v211
  s_waitcnt lgkmcnt(9)
  v_mfma_f32_16x16x16_bf16 v[196:199], v[182:183], v[80:81], 0
  ds_read_b64_tr_b16 v[148:149], v11 offset:24576
  s_add_u32 s56, s54, s88
  v_mfma_f32_16x16x32_bf16 v[192:195], v[166:169], v[238:241], 0
  ds_read_b64_tr_b16 v[150:151], v11 offset:26624
  s_addc_u32 s57, s55, 0
  v_mfma_f32_16x16x32_bf16 v[192:195], v[170:173], v[242:245], v[192:195]
  ds_read_b64_tr_b16 v[152:153], v11 offset:28672
  s_add_u32 m0, s51, 98304
  v_mfma_f32_16x16x32_bf16 v[192:195], v[174:177], v[246:249], v[192:195]
  ds_read_b64_tr_b16 v[154:155], v11 offset:30720
  global_load_lds_dwordx4 v2, s[56:57] offset:0
  v_mfma_f32_16x16x32_bf16 v[192:195], v[178:181], v[250:253], v[192:195]
  ds_read_b64_tr_b16 v[156:157], v11 offset:32768
  buffer_store_dwordx4 v[216:219], v22, s[40:43], s58 offen sc1
  v_mfma_f32_16x16x32_bf16 v[196:199], v[166:169], v[64:67], v[196:199]
  ds_read_b64_tr_b16 v[158:159], v11 offset:34816
  v_cvt_pk_bf16_f32 v220, v204, v205
  v_mfma_f32_16x16x32_bf16 v[196:199], v[170:173], v[68:71], v[196:199]
  ds_read_b64_tr_b16 v[160:161], v11 offset:36864
  global_load_lds_dwordx4 v3, s[56:57] offset:1024
  v_mfma_f32_16x16x32_bf16 v[196:199], v[174:177], v[72:75], v[196:199]
  ds_read_b64_tr_b16 v[162:163], v11 offset:38912
  v_cvt_pk_bf16_f32 v221, v206, v207
  v_mfma_f32_16x16x32_bf16 v[196:199], v[178:181], v[76:79], v[196:199]
  ds_read_b64_tr_b16 v[164:165], v11 offset:40960
  v_cvt_pk_bf16_f32 v222, v212, v213
  v_mfma_f32_16x16x16_bf16 v[192:195], v[182:183], v[254:255], v[192:195]
  v_cvt_pk_bf16_f32 v223, v214, v215
  buffer_store_dwordx4 v[220:223], v23, s[40:43], s58 offen sc1
  s_waitcnt lgkmcnt(9)
  v_mfma_f32_16x16x16_bf16 v[204:207], v[48:49], v[80:81], 0
  ds_read_b64_tr_b16 v[166:167], v16 offset:24576
  v_mfma_f32_16x16x32_bf16 v[200:203], v[32:35], v[238:241], 0
  ds_read_b64_tr_b16 v[168:169], v16 offset:26624
  v_mfma_f32_16x16x32_bf16 v[200:203], v[36:39], v[242:245], v[200:203]
  ds_read_b64_tr_b16 v[170:171], v16 offset:28672
  global_load_lds_dwordx4 v4, s[56:57] offset:2048
  v_mfma_f32_16x16x32_bf16 v[200:203], v[40:43], v[246:249], v[200:203]
  ds_read_b64_tr_b16 v[172:173], v16 offset:30720
  s_mul_i32 s58, s84, 256
  v_mfma_f32_16x16x32_bf16 v[200:203], v[44:47], v[250:253], v[200:203]
  ds_read_b64_tr_b16 v[174:175], v16 offset:32768
  v_cvt_pk_bf16_f32 v216, v184, v185
  v_mfma_f32_16x16x32_bf16 v[204:207], v[32:35], v[64:67], v[204:207]
  ds_read_b64_tr_b16 v[176:177], v16 offset:34816
  v_cvt_pk_bf16_f32 v217, v186, v187
  v_mfma_f32_16x16x32_bf16 v[204:207], v[36:39], v[68:71], v[204:207]
  ds_read_b64_tr_b16 v[178:179], v16 offset:36864
  v_cvt_pk_bf16_f32 v218, v192, v193
  v_mfma_f32_16x16x32_bf16 v[204:207], v[40:43], v[72:75], v[204:207]
  ds_read_b64_tr_b16 v[180:181], v16 offset:38912
  v_cvt_pk_bf16_f32 v219, v194, v195
  v_mfma_f32_16x16x32_bf16 v[204:207], v[44:47], v[76:79], v[204:207]
  ds_read_b64_tr_b16 v[182:183], v16 offset:40960
  global_load_lds_dwordx4 v5, s[56:57] offset:3072
  v_mfma_f32_16x16x16_bf16 v[200:203], v[48:49], v[254:255], v[200:203]
  buffer_store_dwordx4 v[216:219], v22, s[40:43], s58 offen sc1
  s_waitcnt lgkmcnt(9)
  v_mfma_f32_16x16x16_bf16 v[212:215], v[164:165], v[80:81], 0
  ds_read_b64_tr_b16 v[32:33], v17 offset:24576
  v_cvt_pk_bf16_f32 v220, v188, v189
  v_mfma_f32_16x16x32_bf16 v[208:211], v[148:151], v[238:241], 0
  ds_read_b64_tr_b16 v[34:35], v17 offset:26624
  v_cvt_pk_bf16_f32 v221, v190, v191
  v_mfma_f32_16x16x32_bf16 v[208:211], v[152:155], v[242:245], v[208:211]
  ds_read_b64_tr_b16 v[36:37], v17 offset:28672
  v_cvt_pk_bf16_f32 v222, v196, v197
  v_mfma_f32_16x16x32_bf16 v[208:211], v[156:159], v[246:249], v[208:211]
  ds_read_b64_tr_b16 v[38:39], v17 offset:30720
  v_cvt_pk_bf16_f32 v223, v198, v199
  v_mfma_f32_16x16x32_bf16 v[208:211], v[160:163], v[250:253], v[208:211]
  ds_read_b64_tr_b16 v[40:41], v17 offset:32768
  s_add_u32 m0, s51, 102400
  v_mfma_f32_16x16x32_bf16 v[212:215], v[148:151], v[64:67], v[212:215]
  ds_read_b64_tr_b16 v[42:43], v17 offset:34816
  global_load_lds_dwordx4 v6, s[56:57] offset:0
  v_mfma_f32_16x16x32_bf16 v[212:215], v[152:155], v[68:71], v[212:215]
  ds_read_b64_tr_b16 v[44:45], v17 offset:36864
  buffer_store_dwordx4 v[220:223], v23, s[40:43], s58 offen sc1
  v_mfma_f32_16x16x32_bf16 v[212:215], v[156:159], v[72:75], v[212:215]
  ds_read_b64_tr_b16 v[46:47], v17 offset:38912
  v_mfma_f32_16x16x32_bf16 v[212:215], v[160:163], v[76:79], v[212:215]
  ds_read_b64_tr_b16 v[48:49], v17 offset:40960
  v_mfma_f32_16x16x16_bf16 v[208:211], v[164:165], v[254:255], v[208:211]
  s_waitcnt lgkmcnt(9)
  v_mfma_f32_16x16x16_bf16 v[188:191], v[182:183], v[80:81], 0
  ds_read_b64_tr_b16 v[148:149], v18 offset:24576
  v_mfma_f32_16x16x32_bf16 v[184:187], v[166:169], v[238:241], 0
  ds_read_b64_tr_b16 v[150:151], v18 offset:26624
  v_mfma_f32_16x16x32_bf16 v[184:187], v[170:173], v[242:245], v[184:187]
  ds_read_b64_tr_b16 v[152:153], v18 offset:28672
  v_mfma_f32_16x16x32_bf16 v[184:187], v[174:177], v[246:249], v[184:187]
  ds_read_b64_tr_b16 v[154:155], v18 offset:30720
  s_bitset1_b32 s58, 14
  v_mfma_f32_16x16x32_bf16 v[184:187], v[178:181], v[250:253], v[184:187]
  ds_read_b64_tr_b16 v[156:157], v18 offset:32768
  v_cvt_pk_bf16_f32 v216, v200, v201
  v_mfma_f32_16x16x32_bf16 v[188:191], v[166:169], v[64:67], v[188:191]
  ds_read_b64_tr_b16 v[158:159], v18 offset:34816
  v_cvt_pk_bf16_f32 v217, v202, v203
  v_mfma_f32_16x16x32_bf16 v[188:191], v[170:173], v[68:71], v[188:191]
  ds_read_b64_tr_b16 v[160:161], v18 offset:36864
  v_cvt_pk_bf16_f32 v218, v208, v209
  v_mfma_f32_16x16x32_bf16 v[188:191], v[174:177], v[72:75], v[188:191]
  ds_read_b64_tr_b16 v[162:163], v18 offset:38912
  v_cvt_pk_bf16_f32 v219, v210, v211
  v_mfma_f32_16x16x32_bf16 v[188:191], v[178:181], v[76:79], v[188:191]
  ds_read_b64_tr_b16 v[164:165], v18 offset:40960
  buffer_store_dwordx4 v[216:219], v22, s[40:43], s58 offen sc1
  v_mfma_f32_16x16x16_bf16 v[184:187], v[182:183], v[254:255], v[184:187]
  v_cvt_pk_bf16_f32 v220, v204, v205
  s_waitcnt lgkmcnt(9)
  v_mfma_f32_16x16x16_bf16 v[196:199], v[48:49], v[80:81], 0
  ds_read_b64_tr_b16 v[166:167], v19 offset:24576
  v_cvt_pk_bf16_f32 v221, v206, v207
  v_mfma_f32_16x16x32_bf16 v[192:195], v[32:35], v[238:241], 0
  ds_read_b64_tr_b16 v[168:169], v19 offset:26624
  v_cvt_pk_bf16_f32 v222, v212, v213
  v_mfma_f32_16x16x32_bf16 v[192:195], v[36:39], v[242:245], v[192:195]
  ds_read_b64_tr_b16 v[170:171], v19 offset:28672
  v_cvt_pk_bf16_f32 v223, v214, v215
  v_mfma_f32_16x16x32_bf16 v[192:195], v[40:43], v[246:249], v[192:195]
  ds_read_b64_tr_b16 v[172:173], v19 offset:30720
  buffer_store_dwordx4 v[220:223], v23, s[40:43], s58 offen sc1
  v_mfma_f32_16x16x32_bf16 v[192:195], v[44:47], v[250:253], v[192:195]
  ds_read_b64_tr_b16 v[174:175], v19 offset:32768
  v_mfma_f32_16x16x32_bf16 v[196:199], v[32:35], v[64:67], v[196:199]
  ds_read_b64_tr_b16 v[176:177], v19 offset:34816
  v_mfma_f32_16x16x32_bf16 v[196:199], v[36:39], v[68:71], v[196:199]
  ds_read_b64_tr_b16 v[178:179], v19 offset:36864
  v_mfma_f32_16x16x32_bf16 v[196:199], v[40:43], v[72:75], v[196:199]
  ds_read_b64_tr_b16 v[180:181], v19 offset:38912
  v_mfma_f32_16x16x32_bf16 v[196:199], v[44:47], v[76:79], v[196:199]
  ds_read_b64_tr_b16 v[182:183], v19 offset:40960
  v_mfma_f32_16x16x16_bf16 v[192:195], v[48:49], v[254:255], v[192:195]
  s_waitcnt vmcnt(22) lgkmcnt(9)
  s_barrier
  v_mfma_f32_16x16x16_bf16 v[204:207], v[164:165], v[80:81], 0
  ds_read_b64_tr_b16 v[32:33], v12 offset:0
  v_mfma_f32_16x16x32_bf16 v[200:203], v[148:151], v[238:241], 0
  ds_read_b64_tr_b16 v[34:35], v12 offset:2048
  v_mfma_f32_16x16x32_bf16 v[200:203], v[152:155], v[242:245], v[200:203]
  ds_read_b64_tr_b16 v[36:37], v12 offset:4096
  v_mfma_f32_16x16x32_bf16 v[200:203], v[156:159], v[246:249], v[200:203]
  ds_read_b64_tr_b16 v[38:39], v12 offset:6144
  s_mul_i32 s58, s85, 256
  v_mfma_f32_16x16x32_bf16 v[200:203], v[160:163], v[250:253], v[200:203]
  ds_read_b64_tr_b16 v[40:41], v12 offset:8192
  v_cvt_pk_bf16_f32 v216, v184, v185
  v_mfma_f32_16x16x32_bf16 v[204:207], v[148:151], v[64:67], v[204:207]
  ds_read_b64_tr_b16 v[42:43], v12 offset:10240
  v_cvt_pk_bf16_f32 v217, v186, v187
  v_mfma_f32_16x16x32_bf16 v[204:207], v[152:155], v[68:71], v[204:207]
  ds_read_b64_tr_b16 v[44:45], v12 offset:12288
  v_cvt_pk_bf16_f32 v218, v192, v193
  v_mfma_f32_16x16x32_bf16 v[204:207], v[156:159], v[72:75], v[204:207]
  ds_read_b64_tr_b16 v[46:47], v12 offset:14336
  v_cvt_pk_bf16_f32 v219, v194, v195
  v_mfma_f32_16x16x32_bf16 v[204:207], v[160:163], v[76:79], v[204:207]
  ds_read_b64_tr_b16 v[48:49], v12 offset:16384
  buffer_store_dwordx4 v[216:219], v22, s[40:43], s58 offen sc1
  v_mfma_f32_16x16x16_bf16 v[200:203], v[164:165], v[254:255], v[200:203]
  v_cvt_pk_bf16_f32 v220, v188, v189
  s_waitcnt lgkmcnt(9)
  v_mfma_f32_16x16x16_bf16 v[212:215], v[182:183], v[80:81], 0
  ds_read_b64_tr_b16 v[148:149], v13 offset:0
  v_cvt_pk_bf16_f32 v221, v190, v191
  v_mfma_f32_16x16x32_bf16 v[208:211], v[166:169], v[238:241], 0
  ds_read_b64_tr_b16 v[150:151], v13 offset:2048
  v_cvt_pk_bf16_f32 v222, v196, v197
  v_mfma_f32_16x16x32_bf16 v[208:211], v[170:173], v[242:245], v[208:211]
  ds_read_b64_tr_b16 v[152:153], v13 offset:4096
  v_cvt_pk_bf16_f32 v223, v198, v199
  v_mfma_f32_16x16x32_bf16 v[208:211], v[174:177], v[246:249], v[208:211]
  ds_read_b64_tr_b16 v[154:155], v13 offset:6144
  buffer_store_dwordx4 v[220:223], v23, s[40:43], s58 offen sc1
  v_mfma_f32_16x16x32_bf16 v[208:211], v[178:181], v[250:253], v[208:211]
  ds_read_b64_tr_b16 v[156:157], v13 offset:8192
  v_mfma_f32_16x16x32_bf16 v[212:215], v[166:169], v[64:67], v[212:215]
  ds_read_b64_tr_b16 v[158:159], v13 offset:10240
  v_mfma_f32_16x16x32_bf16 v[212:215], v[170:173], v[68:71], v[212:215]
  ds_read_b64_tr_b16 v[160:161], v13 offset:12288
  v_mfma_f32_16x16x32_bf16 v[212:215], v[174:177], v[72:75], v[212:215]
  ds_read_b64_tr_b16 v[162:163], v13 offset:14336
  v_mfma_f32_16x16x32_bf16 v[212:215], v[178:181], v[76:79], v[212:215]
  ds_read_b64_tr_b16 v[164:165], v13 offset:16384
  v_mfma_f32_16x16x16_bf16 v[208:211], v[182:183], v[254:255], v[208:211]
  s_waitcnt lgkmcnt(9)
  v_mfma_f32_16x16x16_bf16 v[188:191], v[48:49], v[80:81], 0
  ds_read_b64_tr_b16 v[166:167], v14 offset:0
  v_mfma_f32_16x16x32_bf16 v[184:187], v[32:35], v[238:241], 0
  ds_read_b64_tr_b16 v[168:169], v14 offset:2048
  v_mfma_f32_16x16x32_bf16 v[184:187], v[36:39], v[242:245], v[184:187]
  ds_read_b64_tr_b16 v[170:171], v14 offset:4096
  v_mfma_f32_16x16x32_bf16 v[184:187], v[40:43], v[246:249], v[184:187]
  ds_read_b64_tr_b16 v[172:173], v14 offset:6144
  s_bitset1_b32 s58, 14
  v_mfma_f32_16x16x32_bf16 v[184:187], v[44:47], v[250:253], v[184:187]
  ds_read_b64_tr_b16 v[174:175], v14 offset:8192
  v_cvt_pk_bf16_f32 v216, v200, v201
  v_mfma_f32_16x16x32_bf16 v[188:191], v[32:35], v[64:67], v[188:191]
  ds_read_b64_tr_b16 v[176:177], v14 offset:10240
  v_cvt_pk_bf16_f32 v217, v202, v203
  v_mfma_f32_16x16x32_bf16 v[188:191], v[36:39], v[68:71], v[188:191]
  ds_read_b64_tr_b16 v[178:179], v14 offset:12288
  v_cvt_pk_bf16_f32 v218, v208, v209
  v_mfma_f32_16x16x32_bf16 v[188:191], v[40:43], v[72:75], v[188:191]
  ds_read_b64_tr_b16 v[180:181], v14 offset:14336
  v_cvt_pk_bf16_f32 v219, v210, v211
  v_mfma_f32_16x16x32_bf16 v[188:191], v[44:47], v[76:79], v[188:191]
  ds_read_b64_tr_b16 v[182:183], v14 offset:16384
  buffer_store_dwordx4 v[216:219], v22, s[40:43], s58 offen sc1
  v_mfma_f32_16x16x16_bf16 v[184:187], v[48:49], v[254:255], v[184:187]
  v_cvt_pk_bf16_f32 v220, v204, v205
  s_waitcnt lgkmcnt(9)
  v_mfma_f32_16x16x16_bf16 v[196:199], v[164:165], v[80:81], 0
  ds_read_b64_tr_b16 v[32:33], v15 offset:0
  v_cvt_pk_bf16_f32 v221, v206, v207
  v_mfma_f32_16x16x32_bf16 v[192:195], v[148:151], v[238:241], 0
  ds_read_b64_tr_b16 v[34:35], v15 offset:2048
  v_cvt_pk_bf16_f32 v222, v212, v213
  v_mfma_f32_16x16x32_bf16 v[192:195], v[152:155], v[242:245], v[192:195]
  ds_read_b64_tr_b16 v[36:37], v15 offset:4096
  v_cvt_pk_bf16_f32 v223, v214, v215
  v_mfma_f32_16x16x32_bf16 v[192:195], v[156:159], v[246:249], v[192:195]
  ds_read_b64_tr_b16 v[38:39], v15 offset:6144
  buffer_store_dwordx4 v[220:223], v23, s[40:43], s58 offen sc1
  v_mfma_f32_16x16x32_bf16 v[192:195], v[160:163], v[250:253], v[192:195]
  ds_read_b64_tr_b16 v[40:41], v15 offset:8192
  v_mfma_f32_16x16x32_bf16 v[196:199], v[148:151], v[64:67], v[196:199]
  ds_read_b64_tr_b16 v[42:43], v15 offset:10240
  v_mfma_f32_16x16x32_bf16 v[196:199], v[152:155], v[68:71], v[196:199]
  ds_read_b64_tr_b16 v[44:45], v15 offset:12288
  v_mfma_f32_16x16x32_bf16 v[196:199], v[156:159], v[72:75], v[196:199]
  ds_read_b64_tr_b16 v[46:47], v15 offset:14336
  v_mfma_f32_16x16x32_bf16 v[196:199], v[160:163], v[76:79], v[196:199]
  ds_read_b64_tr_b16 v[48:49], v15 offset:16384
  v_mfma_f32_16x16x16_bf16 v[192:195], v[164:165], v[254:255], v[192:195]
  s_waitcnt vmcnt(7) lgkmcnt(9)
  s_barrier
  v_mfma_f32_16x16x16_bf16 v[204:207], v[182:183], v[80:81], 0
  ds_read_b64_tr_b16 v[148:149], v12 offset:24576
  v_mfma_f32_16x16x32_bf16 v[200:203], v[166:169], v[238:241], 0
  ds_read_b64_tr_b16 v[150:151], v12 offset:26624
  v_mfma_f32_16x16x32_bf16 v[200:203], v[170:173], v[242:245], v[200:203]
  ds_read_b64_tr_b16 v[152:153], v12 offset:28672
  v_mfma_f32_16x16x32_bf16 v[200:203], v[174:177], v[246:249], v[200:203]
  ds_read_b64_tr_b16 v[154:155], v12 offset:30720
  s_mul_i32 s58, s86, 256
  v_mfma_f32_16x16x32_bf16 v[200:203], v[178:181], v[250:253], v[200:203]
  ds_read_b64_tr_b16 v[156:157], v12 offset:32768
  v_cvt_pk_bf16_f32 v216, v184, v185
  v_mfma_f32_16x16x32_bf16 v[204:207], v[166:169], v[64:67], v[204:207]
  ds_read_b64_tr_b16 v[158:159], v12 offset:34816
  v_cvt_pk_bf16_f32 v217, v186, v187
  v_mfma_f32_16x16x32_bf16 v[204:207], v[170:173], v[68:71], v[204:207]
  ds_read_b64_tr_b16 v[160:161], v12 offset:36864
  v_cvt_pk_bf16_f32 v218, v192, v193
  v_mfma_f32_16x16x32_bf16 v[204:207], v[174:177], v[72:75], v[204:207]
  ds_read_b64_tr_b16 v[162:163], v12 offset:38912
  v_cvt_pk_bf16_f32 v219, v194, v195
  v_mfma_f32_16x16x32_bf16 v[204:207], v[178:181], v[76:79], v[204:207]
  ds_read_b64_tr_b16 v[164:165], v12 offset:40960
  buffer_store_dwordx4 v[216:219], v22, s[40:43], s58 offen sc1
  v_mfma_f32_16x16x16_bf16 v[200:203], v[182:183], v[254:255], v[200:203]
  v_cvt_pk_bf16_f32 v220, v188, v189
  s_waitcnt lgkmcnt(9)
  v_mfma_f32_16x16x16_bf16 v[212:215], v[48:49], v[80:81], 0
  ds_read_b64_tr_b16 v[166:167], v13 offset:24576
  v_cvt_pk_bf16_f32 v221, v190, v191
  v_mfma_f32_16x16x32_bf16 v[208:211], v[32:35], v[238:241], 0
  ds_read_b64_tr_b16 v[168:169], v13 offset:26624
  v_cvt_pk_bf16_f32 v222, v196, v197
  v_mfma_f32_16x16x32_bf16 v[208:211], v[36:39], v[242:245], v[208:211]
  ds_read_b64_tr_b16 v[170:171], v13 offset:28672
  v_cvt_pk_bf16_f32 v223, v198, v199
  v_mfma_f32_16x16x32_bf16 v[208:211], v[40:43], v[246:249], v[208:211]
  ds_read_b64_tr_b16 v[172:173], v13 offset:30720
  buffer_store_dwordx4 v[220:223], v23, s[40:43], s58 offen sc1
  v_mfma_f32_16x16x32_bf16 v[208:211], v[44:47], v[250:253], v[208:211]
  ds_read_b64_tr_b16 v[174:175], v13 offset:32768
  v_mfma_f32_16x16x32_bf16 v[212:215], v[32:35], v[64:67], v[212:215]
  ds_read_b64_tr_b16 v[176:177], v13 offset:34816
  v_mfma_f32_16x16x32_bf16 v[212:215], v[36:39], v[68:71], v[212:215]
  ds_read_b64_tr_b16 v[178:179], v13 offset:36864
  v_mfma_f32_16x16x32_bf16 v[212:215], v[40:43], v[72:75], v[212:215]
  ds_read_b64_tr_b16 v[180:181], v13 offset:38912
  v_mfma_f32_16x16x32_bf16 v[212:215], v[44:47], v[76:79], v[212:215]
  ds_read_b64_tr_b16 v[182:183], v13 offset:40960
  v_mfma_f32_16x16x16_bf16 v[208:211], v[48:49], v[254:255], v[208:211]
  s_waitcnt lgkmcnt(9)
  v_mfma_f32_16x16x16_bf16 v[188:191], v[164:165], v[80:81], 0
  ds_read_b64_tr_b16 v[32:33], v14 offset:24576
  v_mfma_f32_16x16x32_bf16 v[184:187], v[148:151], v[238:241], 0
  ds_read_b64_tr_b16 v[34:35], v14 offset:26624
  v_mfma_f32_16x16x32_bf16 v[184:187], v[152:155], v[242:245], v[184:187]
  ds_read_b64_tr_b16 v[36:37], v14 offset:28672
  v_mfma_f32_16x16x32_bf16 v[184:187], v[156:159], v[246:249], v[184:187]
  ds_read_b64_tr_b16 v[38:39], v14 offset:30720
  s_bitset1_b32 s58, 14
  v_mfma_f32_16x16x32_bf16 v[184:187], v[160:163], v[250:253], v[184:187]
  ds_read_b64_tr_b16 v[40:41], v14 offset:32768
  v_cvt_pk_bf16_f32 v216, v200, v201
  v_mfma_f32_16x16x32_bf16 v[188:191], v[148:151], v[64:67], v[188:191]
  ds_read_b64_tr_b16 v[42:43], v14 offset:34816
  v_cvt_pk_bf16_f32 v217, v202, v203
  v_mfma_f32_16x16x32_bf16 v[188:191], v[152:155], v[68:71], v[188:191]
  ds_read_b64_tr_b16 v[44:45], v14 offset:36864
  v_cvt_pk_bf16_f32 v218, v208, v209
  v_mfma_f32_16x16x32_bf16 v[188:191], v[156:159], v[72:75], v[188:191]
  ds_read_b64_tr_b16 v[46:47], v14 offset:38912
  v_cvt_pk_bf16_f32 v219, v210, v211
  v_mfma_f32_16x16x32_bf16 v[188:191], v[160:163], v[76:79], v[188:191]
  ds_read_b64_tr_b16 v[48:49], v14 offset:40960
  buffer_store_dwordx4 v[216:219], v22, s[40:43], s58 offen sc1
  v_mfma_f32_16x16x16_bf16 v[184:187], v[164:165], v[254:255], v[184:187]
  v_cvt_pk_bf16_f32 v220, v204, v205
  s_waitcnt lgkmcnt(9)
  v_mfma_f32_16x16x16_bf16 v[196:199], v[182:183], v[80:81], 0
  ds_read_b64_tr_b16 v[148:149], v15 offset:24576
  v_cvt_pk_bf16_f32 v221, v206, v207
  v_mfma_f32_16x16x32_bf16 v[192:195], v[166:169], v[238:241], 0
  ds_read_b64_tr_b16 v[150:151], v15 offset:26624
  v_cvt_pk_bf16_f32 v222, v212, v213
  v_mfma_f32_16x16x32_bf16 v[192:195], v[170:173], v[242:245], v[192:195]
  ds_read_b64_tr_b16 v[152:153], v15 offset:28672
  v_cvt_pk_bf16_f32 v223, v214, v215
  v_mfma_f32_16x16x32_bf16 v[192:195], v[174:177], v[246:249], v[192:195]
  ds_read_b64_tr_b16 v[154:155], v15 offset:30720
  buffer_store_dwordx4 v[220:223], v23, s[40:43], s58 offen sc1
  v_mfma_f32_16x16x32_bf16 v[192:195], v[178:181], v[250:253], v[192:195]
  ds_read_b64_tr_b16 v[156:157], v15 offset:32768
  v_mfma_f32_16x16x32_bf16 v[196:199], v[166:169], v[64:67], v[196:199]
  ds_read_b64_tr_b16 v[158:159], v15 offset:34816
  v_mfma_f32_16x16x32_bf16 v[196:199], v[170:173], v[68:71], v[196:199]
  ds_read_b64_tr_b16 v[160:161], v15 offset:36864
  v_mfma_f32_16x16x32_bf16 v[196:199], v[174:177], v[72:75], v[196:199]
  ds_read_b64_tr_b16 v[162:163], v15 offset:38912
  v_mfma_f32_16x16x32_bf16 v[196:199], v[178:181], v[76:79], v[196:199]
  ds_read_b64_tr_b16 v[164:165], v15 offset:40960
  v_mfma_f32_16x16x16_bf16 v[192:195], v[182:183], v[254:255], v[192:195]
  s_waitcnt lgkmcnt(9)
  v_mfma_f32_16x16x16_bf16 v[204:207], v[48:49], v[80:81], 0
  ds_read_b64_tr_b16 v[166:167], v16 offset:0
  v_mfma_f32_16x16x32_bf16 v[200:203], v[32:35], v[238:241], 0
  ds_read_b64_tr_b16 v[168:169], v16 offset:2048
  v_mfma_f32_16x16x32_bf16 v[200:203], v[36:39], v[242:245], v[200:203]
  ds_read_b64_tr_b16 v[170:171], v16 offset:4096
  v_mfma_f32_16x16x32_bf16 v[200:203], v[40:43], v[246:249], v[200:203]
  ds_read_b64_tr_b16 v[172:173], v16 offset:6144
  s_mul_i32 s58, s87, 256
  v_mfma_f32_16x16x32_bf16 v[200:203], v[44:47], v[250:253], v[200:203]
  ds_read_b64_tr_b16 v[174:175], v16 offset:8192
  v_cvt_pk_bf16_f32 v216, v184, v185
  v_mfma_f32_16x16x32_bf16 v[204:207], v[32:35], v[64:67], v[204:207]
  ds_read_b64_tr_b16 v[176:177], v16 offset:10240
  v_cvt_pk_bf16_f32 v217, v186, v187
  v_mfma_f32_16x16x32_bf16 v[204:207], v[36:39], v[68:71], v[204:207]
  ds_read_b64_tr_b16 v[178:179], v16 offset:12288
  v_cvt_pk_bf16_f32 v218, v192, v193
  v_mfma_f32_16x16x32_bf16 v[204:207], v[40:43], v[72:75], v[204:207]
  ds_read_b64_tr_b16 v[180:181], v16 offset:14336
  v_cvt_pk_bf16_f32 v219, v194, v195
  v_mfma_f32_16x16x32_bf16 v[204:207], v[44:47], v[76:79], v[204:207]
  ds_read_b64_tr_b16 v[182:183], v16 offset:16384
  buffer_store_dwordx4 v[216:219], v22, s[40:43], s58 offen sc1
  v_mfma_f32_16x16x16_bf16 v[200:203], v[48:49], v[254:255], v[200:203]
  v_cvt_pk_bf16_f32 v220, v188, v189
  s_waitcnt lgkmcnt(9)
  v_mfma_f32_16x16x16_bf16 v[212:215], v[164:165], v[80:81], 0
  ds_read_b64_tr_b16 v[32:33], v17 offset:0
  v_cvt_pk_bf16_f32 v221, v190, v191
  v_mfma_f32_16x16x32_bf16 v[208:211], v[148:151], v[238:241], 0
  ds_read_b64_tr_b16 v[34:35], v17 offset:2048
  v_cvt_pk_bf16_f32 v222, v196, v197
  v_mfma_f32_16x16x32_bf16 v[208:211], v[152:155], v[242:245], v[208:211]
  ds_read_b64_tr_b16 v[36:37], v17 offset:4096
  v_cvt_pk_bf16_f32 v223, v198, v199
  v_mfma_f32_16x16x32_bf16 v[208:211], v[156:159], v[246:249], v[208:211]
  ds_read_b64_tr_b16 v[38:39], v17 offset:6144
  buffer_store_dwordx4 v[220:223], v23, s[40:43], s58 offen sc1
  v_mfma_f32_16x16x32_bf16 v[208:211], v[160:163], v[250:253], v[208:211]
  ds_read_b64_tr_b16 v[40:41], v17 offset:8192
  v_mfma_f32_16x16x32_bf16 v[212:215], v[148:151], v[64:67], v[212:215]
  ds_read_b64_tr_b16 v[42:43], v17 offset:10240
  v_mfma_f32_16x16x32_bf16 v[212:215], v[152:155], v[68:71], v[212:215]
  ds_read_b64_tr_b16 v[44:45], v17 offset:12288
  v_mfma_f32_16x16x32_bf16 v[212:215], v[156:159], v[72:75], v[212:215]
  ds_read_b64_tr_b16 v[46:47], v17 offset:14336
  v_mfma_f32_16x16x32_bf16 v[212:215], v[160:163], v[76:79], v[212:215]
  ds_read_b64_tr_b16 v[48:49], v17 offset:16384
  v_mfma_f32_16x16x16_bf16 v[208:211], v[164:165], v[254:255], v[208:211]
  s_waitcnt lgkmcnt(9)
  v_mfma_f32_16x16x16_bf16 v[188:191], v[182:183], v[80:81], 0
  ds_read_b64_tr_b16 v[148:149], v18 offset:0
  v_mfma_f32_16x16x32_bf16 v[184:187], v[166:169], v[238:241], 0
  ds_read_b64_tr_b16 v[150:151], v18 offset:2048
  v_mfma_f32_16x16x32_bf16 v[184:187], v[170:173], v[242:245], v[184:187]
  ds_read_b64_tr_b16 v[152:153], v18 offset:4096
  v_mfma_f32_16x16x32_bf16 v[184:187], v[174:177], v[246:249], v[184:187]
  ds_read_b64_tr_b16 v[154:155], v18 offset:6144
  s_bitset1_b32 s58, 14
  v_mfma_f32_16x16x32_bf16 v[184:187], v[178:181], v[250:253], v[184:187]
  ds_read_b64_tr_b16 v[156:157], v18 offset:8192
  v_cvt_pk_bf16_f32 v216, v200, v201
  v_mfma_f32_16x16x32_bf16 v[188:191], v[166:169], v[64:67], v[188:191]
  ds_read_b64_tr_b16 v[158:159], v18 offset:10240
  v_cvt_pk_bf16_f32 v217, v202, v203
  v_mfma_f32_16x16x32_bf16 v[188:191], v[170:173], v[68:71], v[188:191]
  ds_read_b64_tr_b16 v[160:161], v18 offset:12288
  v_cvt_pk_bf16_f32 v218, v208, v209
  v_mfma_f32_16x16x32_bf16 v[188:191], v[174:177], v[72:75], v[188:191]
  ds_read_b64_tr_b16 v[162:163], v18 offset:14336
  v_cvt_pk_bf16_f32 v219, v210, v211
  v_mfma_f32_16x16x32_bf16 v[188:191], v[178:181], v[76:79], v[188:191]
  ds_read_b64_tr_b16 v[164:165], v18 offset:16384
  buffer_store_dwordx4 v[216:219], v22, s[40:43], s58 offen sc1
  v_mfma_f32_16x16x16_bf16 v[184:187], v[182:183], v[254:255], v[184:187]
  v_cvt_pk_bf16_f32 v220, v204, v205
  s_waitcnt lgkmcnt(9)
  v_mfma_f32_16x16x16_bf16 v[196:199], v[48:49], v[80:81], 0
  ds_read_b64_tr_b16 v[166:167], v19 offset:0
  v_cvt_pk_bf16_f32 v221, v206, v207
  v_mfma_f32_16x16x32_bf16 v[192:195], v[32:35], v[238:241], 0
  ds_read_b64_tr_b16 v[168:169], v19 offset:2048
  v_cvt_pk_bf16_f32 v222, v212, v213
  v_mfma_f32_16x16x32_bf16 v[192:195], v[36:39], v[242:245], v[192:195]
  ds_read_b64_tr_b16 v[170:171], v19 offset:4096
  v_cvt_pk_bf16_f32 v223, v214, v215
  v_mfma_f32_16x16x32_bf16 v[192:195], v[40:43], v[246:249], v[192:195]
  ds_read_b64_tr_b16 v[172:173], v19 offset:6144
  buffer_store_dwordx4 v[220:223], v23, s[40:43], s58 offen sc1
  v_mfma_f32_16x16x32_bf16 v[192:195], v[44:47], v[250:253], v[192:195]
  ds_read_b64_tr_b16 v[174:175], v19 offset:8192
  v_mfma_f32_16x16x32_bf16 v[196:199], v[32:35], v[64:67], v[196:199]
  ds_read_b64_tr_b16 v[176:177], v19 offset:10240
  v_mfma_f32_16x16x32_bf16 v[196:199], v[36:39], v[68:71], v[196:199]
  ds_read_b64_tr_b16 v[178:179], v19 offset:12288
  v_mfma_f32_16x16x32_bf16 v[196:199], v[40:43], v[72:75], v[196:199]
  ds_read_b64_tr_b16 v[180:181], v19 offset:14336
  v_mfma_f32_16x16x32_bf16 v[196:199], v[44:47], v[76:79], v[196:199]
  ds_read_b64_tr_b16 v[182:183], v19 offset:16384
  v_mfma_f32_16x16x16_bf16 v[192:195], v[48:49], v[254:255], v[192:195]
  s_waitcnt lgkmcnt(9)
  v_mfma_f32_16x16x16_bf16 v[204:207], v[164:165], v[80:81], 0
  v_mfma_f32_16x16x32_bf16 v[200:203], v[148:151], v[238:241], 0
  s_nop 1
  v_mfma_f32_16x16x32_bf16 v[200:203], v[152:155], v[242:245], v[200:203]
  v_mfma_f32_16x16x32_bf16 v[200:203], v[156:159], v[246:249], v[200:203]
  s_mul_i32 s58, s88, 256
  v_cvt_pk_bf16_f32 v216, v184, v185
  v_mfma_f32_16x16x32_bf16 v[200:203], v[160:163], v[250:253], v[200:203]
  v_cvt_pk_bf16_f32 v217, v186, v187
  v_cvt_pk_bf16_f32 v218, v192, v193
  v_mfma_f32_16x16x32_bf16 v[204:207], v[148:151], v[64:67], v[204:207]
  v_cvt_pk_bf16_f32 v219, v194, v195
  v_mfma_f32_16x16x32_bf16 v[204:207], v[152:155], v[68:71], v[204:207]
  buffer_store_dwordx4 v[216:219], v22, s[40:43], s58 offen sc1
  s_nop 1
  v_mfma_f32_16x16x32_bf16 v[204:207], v[156:159], v[72:75], v[204:207]
  v_cvt_pk_bf16_f32 v220, v188, v189
  v_cvt_pk_bf16_f32 v221, v190, v191
  v_mfma_f32_16x16x32_bf16 v[204:207], v[160:163], v[76:79], v[204:207]
  v_cvt_pk_bf16_f32 v222, v196, v197
  v_cvt_pk_bf16_f32 v223, v198, v199
  v_mfma_f32_16x16x16_bf16 v[200:203], v[164:165], v[254:255], v[200:203]
  buffer_store_dwordx4 v[220:223], v23, s[40:43], s58 offen sc1
  s_waitcnt lgkmcnt(0)
  v_mfma_f32_16x16x16_bf16 v[212:215], v[182:183], v[80:81], 0
  v_mfma_f32_16x16x32_bf16 v[208:211], v[166:169], v[238:241], 0
  s_nop 1
  v_mfma_f32_16x16x32_bf16 v[208:211], v[170:173], v[242:245], v[208:211]
  v_mfma_f32_16x16x32_bf16 v[208:211], v[174:177], v[246:249], v[208:211]
  v_mfma_f32_16x16x32_bf16 v[208:211], v[178:181], v[250:253], v[208:211]
  v_mfma_f32_16x16x32_bf16 v[212:215], v[166:169], v[64:67], v[212:215]
  v_mfma_f32_16x16x32_bf16 v[212:215], v[170:173], v[68:71], v[212:215]
  s_nop 1
  v_mfma_f32_16x16x32_bf16 v[212:215], v[174:177], v[72:75], v[212:215]
  v_mfma_f32_16x16x32_bf16 v[212:215], v[178:181], v[76:79], v[212:215]
  v_mfma_f32_16x16x16_bf16 v[208:211], v[182:183], v[254:255], v[208:211]
  s_nop 7
  s_bitset1_b32 s58, 14
  v_cvt_pk_bf16_f32 v216, v200, v201
  v_cvt_pk_bf16_f32 v217, v202, v203
  v_cvt_pk_bf16_f32 v218, v208, v209
  v_cvt_pk_bf16_f32 v219, v210, v211
  buffer_store_dwordx4 v[216:219], v22, s[40:43], s58 offen sc1
  v_cvt_pk_bf16_f32 v220, v204, v205
  v_cvt_pk_bf16_f32 v221, v206, v207
  v_cvt_pk_bf16_f32 v222, v212, v213
  v_cvt_pk_bf16_f32 v223, v214, v215
  buffer_store_dwordx4 v[220:223], v23, s[40:43], s58 offen sc1
  s_sub_u32 s60, s46, 12
  s_and_b32 s61, s44, 1
  s_lshl1_add_u32 s60, s60, s61
  s_lshr_b32 s61, s44, 1
  v_mov_b32 v14, 1
  s_lshl_b32 s58, s45, 3
  s_add_u32 s58, s58, s60
  s_mul_i32 s69, s58, 18432
  s_lshl_b32 s59, s61, 6
  s_add_u32 s69, s69, s59
  s_mul_i32 s68, s58, 294912
  s_lshl_b32 s59, s61, 14
  s_add_u32 s68, s68, s59
  v_lshlrev_b32 v9, 4, v1
  v_and_b32 v32, 15, v1
  v_mul_u32_u24 v10, 1152, v32
  v_bfe_u32 v33, v1, 4, 1
  v_lshl_add_u32 v10, v33, 5, v10
  v_lshrrev_b32 v33, 5, v1
  v_lshl_add_u32 v10, v33, 4, v10
  s_lshr_b32 s58, s60, 2
  s_lshl_b32 s58, s58, 1
  s_add_u32 s58, s58, s61
  s_lshr_b32 s59, s60, 1
  v_cmp_eq_u32 vcc, 9, v1
  v_mov_b32 v33, s58
  v_mov_b32 v34, s59
  v_cndmask_b32 v33, v33, v34, vcc
  v_cndmask_b32 v12, 12, 4, vcc
  s_and_b32 s58, s46, 0
  s_lshl4_add_u32 s58, s58, s45
  s_lshl_b32 s58, s58, 9
  s_add_u32 s58, s58, 41943040
  v_lshl_add_u32 v32, v1, 2, s58
  v_lshl_add_u32 v11, v33, 7, v32
  v_add_u32 v32, 6, v1
  v_lshrrev_b32 v32, 4, v32
  v_lshl_or_b32 v11, v32, 28, v11
  s_waitcnt vmcnt(0)
  buffer_atomic_add v14, v24, s[40:43], 0 offen offset:36 sc1
  v_mov_b32 v13, 0
  buffer_atomic_or v13, v11, s[40:43], 0 offen sc0 sc1
  s_add_u32 s71, s69, s80
  buffer_load_dwordx4 v[76:79], v10, s[28:31], s71 offen
  s_add_u32 s72, s69, s81
  buffer_load_dwordx4 v[80:83], v10, s[28:31], s72 offen
  s_add_u32 s73, s69, s82
  buffer_load_dwordx4 v[84:87], v10, s[28:31], s73 offen
  s_add_u32 s74, s69, s83
  buffer_load_dwordx4 v[88:91], v10, s[28:31], s74 offen
  s_add_u32 s75, s69, s84
  buffer_load_dwordx4 v[92:95], v10, s[28:31], s75 offen
  s_add_u32 s51, s66, 8192
  s_add_u32 s58, s69, 46137344
  v_add_u32 v15, s58, v10
  s_add_u32 s58, s68, 12288
  v_add_u32 v8, s58, v9
  s_mul_i32 s8, s80, 256
  s_mul_i32 s9, s81, 256
  s_mul_i32 s10, s82, 256
  s_mul_i32 s11, s83, 256
  s_mul_i32 s12, s84, 256
  s_lshr_b32 s58, s46, 1
  s_lshl3_add_u32 s58, s45, s58
  s_mul_i32 s22, s58, 294912
  s_and_b32 s59, s44, 1
  s_lshr_b32 s60, s44, 1
  s_lshl_b32 s58, s59, 5
  s_add_u32 s58, s58, s60
  s_and_b32 s23, s46, 1
  s_lshl2_add_u32 s58, s58, s23
  s_lshl_b32 s58, s58, 7
  s_add_u32 s22, s22, s58
  s_lshl4_add_u32 s58, s45, s46
  s_mul_i32 s23, s58, 9216
  s_lshl2_add_u32 s60, s59, s60
  s_lshl4_add_u32 s23, s60, s23
  s_lshr_b32 s58, s58, 2
  s_and_b32 s58, s58, 62
  s_add_u32 s58, s58, s59
  s_lshl_b32 s24, s58, 7
  s_add_u32 s24, s24, 41943040
  s_bfe_u32 s58, s46, 0x18001
  s_lshl1_add_u32 s58, s59, s58
  s_lshl2_add_u32 s58, s45, s58
  s_lshl_b32 s58, s58, 7
  s_and_b32 s60, s46, 12
  s_add_u32 s58, s58, s60
  s_add_u32 s25, s58, 41951196
  s_mul_i32 s64, s85, 256
  s_mul_i32 s65, s86, 256
  s_mul_i32 s66, s87, 256
  s_mul_i32 s67, s88, 256
  v_lshrrev_b32 v247, 4, v1
  v_lshl_add_u32 v240, v247, 10, s22
  v_bfe_u32 v246, v1, 3, 1
  v_lshl_add_u32 v240, v246, 8, v240
  v_lshl_add_u32 v243, v246, 3, s23
  v_and_b32 v246, 7, v1
  v_lshl_add_u32 v240, v246, 4, v240
  v_mul_u32_u24 v246, 1152, v246
  v_add_u32 v243, v243, v246
  v_and_b32 v246, 32, v1
  v_add_u32 v243, v243, v246
  v_and_b32 v247, 1, v247
  v_lshl_add_u32 v243, v247, 2, v243
  v_add_u32 v244, 46137344, v243
  v_add_u32 v241, 4096, v240
  v_add_u32 v242, 8192, v240
  v_cmp_eq_u32 vcc, 9, v1
  v_mov_b32 v245, s24
  v_mov_b32 v247, s25
  v_cndmask_b32 v245, v245, v247, vcc
  v_cndmask_b32 v246, 12, 1, vcc
  v_lshl_add_u32 v245, v1, 2, v245
  v_add_u32 v247, 6, v1
  v_lshrrev_b32 v247, 4, v247
  v_lshl_or_b32 v245, v247, 28, v245
  buffer_load_dword v248, v243, s[28:31], s85 offen
  buffer_load_dword v249, v243, s[28:31], s86 offen
  buffer_load_dword v250, v243, s[28:31], s87 offen
  buffer_load_dword v251, v243, s[28:31], s88 offen
  s_waitcnt vmcnt(9)
  s_mov_b32 s70, 0
L_a_ss:
  v_cmp_lt_u32 vcc, v13, v12
  s_add_u32 s70, s70, 1
  s_cmp_ge_u32 s70, 200000
  s_cbranch_scc1 L_a_ss_x
  s_and_b32 s59, vcc_lo, 512
  s_cbranch_scc0 L_a_ss_x
  s_sleep 4
  v_mov_b32 v13, 0
  buffer_atomic_or v13, v11, s[40:43], 0 offen sc0 sc1
  s_waitcnt vmcnt(0)
  s_branch L_a_ss
L_a_ss_x:
  v_writelane_b32 v11, -16, 9
  buffer_load_dwordx4 v[96:99], v8, s[40:43], s64 offen offset:0 sc1
  buffer_load_dwordx4 v[100:103], v8, s[40:43], s64 offen offset:1024 sc1
  buffer_load_dwordx4 v[104:107], v8, s[40:43], s64 offen offset:2048 sc1
  buffer_load_dwordx4 v[108:111], v8, s[40:43], s64 offen offset:3072 sc1
  buffer_load_dwordx4 v[112:115], v8, s[40:43], s65 offen offset:0 sc1
  buffer_load_dwordx4 v[116:119], v8, s[40:43], s65 offen offset:1024 sc1
  buffer_load_dwordx4 v[120:123], v8, s[40:43], s65 offen offset:2048 sc1
  buffer_load_dwordx4 v[124:127], v8, s[40:43], s65 offen offset:3072 sc1
  buffer_load_dwordx4 v[128:131], v8, s[40:43], s66 offen offset:0 sc1
  buffer_load_dwordx4 v[132:135], v8, s[40:43], s66 offen offset:1024 sc1
  buffer_load_dwordx4 v[136:139], v8, s[40:43], s66 offen offset:2048 sc1
  buffer_load_dwordx4 v[140:143], v8, s[40:43], s66 offen offset:3072 sc1
  s_waitcnt vmcnt(11)
  buffer_load_dwordx4 v[144:147], v8, s[40:43], s67 offen offset:0 sc1
  v_lshlrev_b32 v16, 16, v96
  v_and_b32 v17, s3, v96
  v_lshlrev_b32 v18, 16, v97
  v_and_b32 v19, s3, v97
  v_lshlrev_b32 v20, 16, v98
  v_and_b32 v21, s3, v98
  v_lshlrev_b32 v22, 16, v99
  v_and_b32 v23, s3, v99
  s_waitcnt vmcnt(11)
  buffer_load_dwordx4 v[148:151], v8, s[40:43], s67 offen offset:1024 sc1
  v_dot2c_f32_bf16 v16, s48, v100
  v_dot2c_f32_bf16 v17, s49, v100
  v_dot2c_f32_bf16 v18, s48, v101
  v_dot2c_f32_bf16 v19, s49, v101
  v_dot2c_f32_bf16 v20, s48, v102
  v_dot2c_f32_bf16 v21, s49, v102
  v_dot2c_f32_bf16 v22, s48, v103
  v_dot2c_f32_bf16 v23, s49, v103
  s_waitcnt vmcnt(11)
  buffer_load_dwordx4 v[152:155], v8, s[40:43], s67 offen offset:2048 sc1
  v_dot2c_f32_bf16 v16, s48, v104
  v_dot2c_f32_bf16 v17, s49, v104
  v_dot2c_f32_bf16 v18, s48, v105
  v_dot2c_f32_bf16 v19, s49, v105
  v_dot2c_f32_bf16 v20, s48, v106
  v_dot2c_f32_bf16 v21, s49, v106
  v_dot2c_f32_bf16 v22, s48, v107
  v_dot2c_f32_bf16 v23, s49, v107
  s_waitcnt vmcnt(11)
  buffer_load_dwordx4 v[156:159], v8, s[40:43], s67 offen offset:3072 sc1
  v_dot2c_f32_bf16 v16, s48, v108
  v_dot2c_f32_bf16 v17, s49, v108
  v_dot2c_f32_bf16 v18, s48, v109
  v_dot2c_f32_bf16 v19, s49, v109
  v_dot2c_f32_bf16 v20, s48, v110
  v_dot2c_f32_bf16 v21, s49, v110
  v_dot2c_f32_bf16 v22, s48, v111
  v_dot2c_f32_bf16 v23, s49, v111
  s_nop 1
  v_permlane16_swap_b32 v16, v20
  v_permlane16_swap_b32 v17, v21
  v_permlane16_swap_b32 v18, v22
  v_permlane16_swap_b32 v19, v23
  v_cvt_pk_bf16_f32 v28, v16, v17
  v_cvt_pk_bf16_f32 v29, v18, v19
  v_cvt_pk_bf16_f32 v30, v20, v21
  v_cvt_pk_bf16_f32 v31, v22, v23
  buffer_store_dwordx4 v[28:31], v15, s[40:43], s85 offen sc1
  s_waitcnt vmcnt(12)
  buffer_load_dwordx4 v[160:163], v8, s[40:43], s8 offen offset:0 sc1
  v_lshlrev_b32 v16, 16, v112
  v_and_b32 v17, s3, v112
  v_lshlrev_b32 v18, 16, v113
  v_and_b32 v19, s3, v113
  v_lshlrev_b32 v20, 16, v114
  v_and_b32 v21, s3, v114
  v_lshlrev_b32 v22, 16, v115
  v_and_b32 v23, s3, v115
  s_waitcnt vmcnt(12)
  buffer_load_dwordx4 v[164:167], v8, s[40:43], s8 offen offset:1024 sc1
  v_dot2c_f32_bf16 v16, s48, v116
  v_dot2c_f32_bf16 v17, s49, v116
  v_dot2c_f32_bf16 v18, s48, v117
  v_dot2c_f32_bf16 v19, s49, v117
  v_dot2c_f32_bf16 v20, s48, v118
  v_dot2c_f32_bf16 v21, s49, v118
  v_dot2c_f32_bf16 v22, s48, v119
  v_dot2c_f32_bf16 v23, s49, v119
  s_waitcnt vmcnt(12)
  buffer_load_dwordx4 v[168:171], v8, s[40:43], s8 offen offset:2048 sc1
  v_dot2c_f32_bf16 v16, s48, v120
  v_dot2c_f32_bf16 v17, s49, v120
  v_dot2c_f32_bf16 v18, s48, v121
  v_dot2c_f32_bf16 v19, s49, v121
  v_dot2c_f32_bf16 v20, s48, v122
  v_dot2c_f32_bf16 v21, s49, v122
  v_dot2c_f32_bf16 v22, s48, v123
  v_dot2c_f32_bf16 v23, s49, v123
  s_waitcnt vmcnt(12)
  buffer_load_dwordx4 v[172:175], v8, s[40:43], s8 offen offset:3072 sc1
  v_dot2c_f32_bf16 v16, s48, v124
  v_dot2c_f32_bf16 v17, s49, v124
  v_dot2c_f32_bf16 v18, s48, v125
  v_dot2c_f32_bf16 v19, s49, v125
  v_dot2c_f32_bf16 v20, s48, v126
  v_dot2c_f32_bf16 v21, s49, v126
  v_dot2c_f32_bf16 v22, s48, v127
  v_dot2c_f32_bf16 v23, s49, v127
  s_nop 1
  v_permlane16_swap_b32 v16, v20
  v_permlane16_swap_b32 v17, v21
  v_permlane16_swap_b32 v18, v22
  v_permlane16_swap_b32 v19, v23
  v_cvt_pk_bf16_f32 v32, v16, v17
  v_cvt_pk_bf16_f32 v33, v18, v19
  v_cvt_pk_bf16_f32 v34, v20, v21
  v_cvt_pk_bf16_f32 v35, v22, v23
  buffer_store_dwordx4 v[32:35], v15, s[40:43], s86 offen sc1
  s_waitcnt vmcnt(13)
  buffer_load_dwordx4 v[176:179], v8, s[40:43], s9 offen offset:0 sc1
  v_lshlrev_b32 v16, 16, v128
  v_and_b32 v17, s3, v128
  v_lshlrev_b32 v18, 16, v129
  v_and_b32 v19, s3, v129
  v_lshlrev_b32 v20, 16, v130
  v_and_b32 v21, s3, v130
  v_lshlrev_b32 v22, 16, v131
  v_and_b32 v23, s3, v131
  s_waitcnt vmcnt(13)
  buffer_load_dwordx4 v[180:183], v8, s[40:43], s9 offen offset:1024 sc1
  v_dot2c_f32_bf16 v16, s48, v132
  v_dot2c_f32_bf16 v17, s49, v132
  v_dot2c_f32_bf16 v18, s48, v133
  v_dot2c_f32_bf16 v19, s49, v133
  v_dot2c_f32_bf16 v20, s48, v134
  v_dot2c_f32_bf16 v21, s49, v134
  v_dot2c_f32_bf16 v22, s48, v135
  v_dot2c_f32_bf16 v23, s49, v135
  s_waitcnt vmcnt(13)
  buffer_load_dwordx4 v[184:187], v8, s[40:43], s9 offen offset:2048 sc1
  v_dot2c_f32_bf16 v16, s48, v136
  v_dot2c_f32_bf16 v17, s49, v136
  v_dot2c_f32_bf16 v18, s48, v137
  v_dot2c_f32_bf16 v19, s49, v137
  v_dot2c_f32_bf16 v20, s48, v138
  v_dot2c_f32_bf16 v21, s49, v138
  v_dot2c_f32_bf16 v22, s48, v139
  v_dot2c_f32_bf16 v23, s49, v139
  s_waitcnt vmcnt(13)
  buffer_load_dwordx4 v[188:191], v8, s[40:43], s9 offen offset:3072 sc1
  v_dot2c_f32_bf16 v16, s48, v140
  v_dot2c_f32_bf16 v17, s49, v140
  v_dot2c_f32_bf16 v18, s48, v141
  v_dot2c_f32_bf16 v19, s49, v141
  v_dot2c_f32_bf16 v20, s48, v142
  v_dot2c_f32_bf16 v21, s49, v142
  v_dot2c_f32_bf16 v22, s48, v143
  v_dot2c_f32_bf16 v23, s49, v143
  s_nop 1
  v_permlane16_swap_b32 v16, v20
  v_permlane16_swap_b32 v17, v21
  v_permlane16_swap_b32 v18, v22
  v_permlane16_swap_b32 v19, v23
  v_cvt_pk_bf16_f32 v28, v16, v17
  v_cvt_pk_bf16_f32 v29, v18, v19
  v_cvt_pk_bf16_f32 v30, v20, v21
  v_cvt_pk_bf16_f32 v31, v22, v23
  buffer_store_dwordx4 v[28:31], v15, s[40:43], s87 offen sc1
  s_waitcnt vmcnt(14)
  buffer_load_dwordx4 v[192:195], v8, s[40:43], s10 offen offset:0 sc1
  v_lshlrev_b32 v16, 16, v144
  v_and_b32 v17, s3, v144
  v_lshlrev_b32 v18, 16, v145
  v_and_b32 v19, s3, v145
  v_lshlrev_b32 v20, 16, v146
  v_and_b32 v21, s3, v146
  v_lshlrev_b32 v22, 16, v147
  v_and_b32 v23, s3, v147
  s_waitcnt vmcnt(14)
  buffer_load_dwordx4 v[196:199], v8, s[40:43], s10 offen offset:1024 sc1
  v_dot2c_f32_bf16 v16, s48, v148
  v_dot2c_f32_bf16 v17, s49, v148
  v_dot2c_f32_bf16 v18, s48, v149
  v_dot2c_f32_bf16 v19, s49, v149
  v_dot2c_f32_bf16 v20, s48, v150
  v_dot2c_f32_bf16 v21, s49, v150
  v_dot2c_f32_bf16 v22, s48, v151
  v_dot2c_f32_bf16 v23, s49, v151
  s_waitcnt vmcnt(14)
  buffer_load_dwordx4 v[200:203], v8, s[40:43], s10 offen offset:2048 sc1
  v_dot2c_f32_bf16 v16, s48, v152
  v_dot2c_f32_bf16 v17, s49, v152
  v_dot2c_f32_bf16 v18, s48, v153
  v_dot2c_f32_bf16 v19, s49, v153
  v_dot2c_f32_bf16 v20, s48, v154
  v_dot2c_f32_bf16 v21, s49, v154
  v_dot2c_f32_bf16 v22, s48, v155
  v_dot2c_f32_bf16 v23, s49, v155
  s_waitcnt vmcnt(14)
  buffer_load_dwordx4 v[204:207], v8, s[40:43], s10 offen offset:3072 sc1
  v_dot2c_f32_bf16 v16, s48, v156
  v_dot2c_f32_bf16 v17, s49, v156
  v_dot2c_f32_bf16 v18, s48, v157
  v_dot2c_f32_bf16 v19, s49, v157
  v_dot2c_f32_bf16 v20, s48, v158
  v_dot2c_f32_bf16 v21, s49, v158
  v_dot2c_f32_bf16 v22, s48, v159
  v_dot2c_f32_bf16 v23, s49, v159
  s_nop 1
  v_permlane16_swap_b32 v16, v20
  v_permlane16_swap_b32 v17, v21
  v_permlane16_swap_b32 v18, v22
  v_permlane16_swap_b32 v19, v23
  v_cvt_pk_bf16_f32 v32, v16, v17
  v_cvt_pk_bf16_f32 v33, v18, v19
  v_cvt_pk_bf16_f32 v34, v20, v21
  v_cvt_pk_bf16_f32 v35, v22, v23
  buffer_store_dwordx4 v[32:35], v15, s[40:43], s88 offen sc1
  s_waitcnt vmcnt(14)
  buffer_load_dwordx4 v[208:211], v8, s[40:43], s11 offen offset:0 sc1
  v_lshlrev_b32 v36, 16, v160
  v_and_b32 v37, s3, v160
  v_lshlrev_b32 v38, 16, v161
  v_and_b32 v39, s3, v161
  v_lshlrev_b32 v40, 16, v162
  v_and_b32 v41, s3, v162
  v_lshlrev_b32 v42, 16, v163
  v_and_b32 v43, s3, v163
  s_waitcnt vmcnt(14)
  buffer_load_dwordx4 v[212:215], v8, s[40:43], s11 offen offset:1024 sc1
  v_dot2c_f32_bf16 v36, s48, v164
  v_dot2c_f32_bf16 v37, s49, v164
  v_dot2c_f32_bf16 v38, s48, v165
  v_dot2c_f32_bf16 v39, s49, v165
  v_dot2c_f32_bf16 v40, s48, v166
  v_dot2c_f32_bf16 v41, s49, v166
  v_dot2c_f32_bf16 v42, s48, v167
  v_dot2c_f32_bf16 v43, s49, v167
  s_waitcnt vmcnt(14)
  buffer_load_dwordx4 v[216:219], v8, s[40:43], s11 offen offset:2048 sc1
  v_dot2c_f32_bf16 v36, s48, v168
  v_dot2c_f32_bf16 v37, s49, v168
  v_dot2c_f32_bf16 v38, s48, v169
  v_dot2c_f32_bf16 v39, s49, v169
  v_dot2c_f32_bf16 v40, s48, v170
  v_dot2c_f32_bf16 v41, s49, v170
  v_dot2c_f32_bf16 v42, s48, v171
  v_dot2c_f32_bf16 v43, s49, v171
  s_waitcnt vmcnt(14)
  buffer_load_dwordx4 v[220:223], v8, s[40:43], s11 offen offset:3072 sc1
  v_dot2c_f32_bf16 v36, s48, v172
  v_dot2c_f32_bf16 v37, s49, v172
  v_dot2c_f32_bf16 v38, s48, v173
  v_dot2c_f32_bf16 v39, s49, v173
  v_dot2c_f32_bf16 v40, s48, v174
  v_dot2c_f32_bf16 v41, s49, v174
  v_dot2c_f32_bf16 v42, s48, v175
  v_dot2c_f32_bf16 v43, s49, v175
  s_waitcnt vmcnt(13)
  buffer_load_dwordx4 v[224:227], v8, s[40:43], s12 offen offset:0 sc1
  v_lshlrev_b32 v44, 16, v176
  v_and_b32 v45, s3, v176
  v_lshlrev_b32 v46, 16, v177
  v_and_b32 v47, s3, v177
  v_lshlrev_b32 v48, 16, v178
  v_and_b32 v49, s3, v178
  v_lshlrev_b32 v50, 16, v179
  v_and_b32 v51, s3, v179
  s_waitcnt vmcnt(13)
  buffer_load_dwordx4 v[228:231], v8, s[40:43], s12 offen offset:1024 sc1
  v_dot2c_f32_bf16 v44, s48, v180
  v_dot2c_f32_bf16 v45, s49, v180
  v_dot2c_f32_bf16 v46, s48, v181
  v_dot2c_f32_bf16 v47, s49, v181
  v_dot2c_f32_bf16 v48, s48, v182
  v_dot2c_f32_bf16 v49, s49, v182
  v_dot2c_f32_bf16 v50, s48, v183
  v_dot2c_f32_bf16 v51, s49, v183
  s_waitcnt vmcnt(13)
  buffer_load_dwordx4 v[232:235], v8, s[40:43], s12 offen offset:2048 sc1
  v_dot2c_f32_bf16 v44, s48, v184
  v_dot2c_f32_bf16 v45, s49, v184
  v_dot2c_f32_bf16 v46, s48, v185
  v_dot2c_f32_bf16 v47, s49, v185
  v_dot2c_f32_bf16 v48, s48, v186
  v_dot2c_f32_bf16 v49, s49, v186
  v_dot2c_f32_bf16 v50, s48, v187
  v_dot2c_f32_bf16 v51, s49, v187
  s_waitcnt vmcnt(13)
  buffer_load_dwordx4 v[236:239], v8, s[40:43], s12 offen offset:3072 sc1
  v_dot2c_f32_bf16 v44, s48, v188
  v_dot2c_f32_bf16 v45, s49, v188
  v_dot2c_f32_bf16 v46, s48, v189
  v_dot2c_f32_bf16 v47, s49, v189
  v_dot2c_f32_bf16 v48, s48, v190
  v_dot2c_f32_bf16 v49, s49, v190
  v_dot2c_f32_bf16 v50, s48, v191
  v_dot2c_f32_bf16 v51, s49, v191
  v_mov_b32 v13, 0
  buffer_atomic_or v13, v11, s[40:43], 0 offen sc0 sc1
  s_waitcnt vmcnt(13)
  v_lshlrev_b32 v52, 16, v192
  v_and_b32 v53, s3, v192
  v_lshlrev_b32 v54, 16, v193
  v_and_b32 v55, s3, v193
  v_lshlrev_b32 v56, 16, v194
  v_and_b32 v57, s3, v194
  v_lshlrev_b32 v58, 16, v195
  v_and_b32 v59, s3, v195
  s_waitcnt vmcnt(12)
  v_dot2c_f32_bf16 v52, s48, v196
  v_dot2c_f32_bf16 v53, s49, v196
  v_dot2c_f32_bf16 v54, s48, v197
  v_dot2c_f32_bf16 v55, s49, v197
  v_dot2c_f32_bf16 v56, s48, v198
  v_dot2c_f32_bf16 v57, s49, v198
  v_dot2c_f32_bf16 v58, s48, v199
  v_dot2c_f32_bf16 v59, s49, v199
  s_waitcnt vmcnt(11)
  v_dot2c_f32_bf16 v52, s48, v200
  v_dot2c_f32_bf16 v53, s49, v200
  v_dot2c_f32_bf16 v54, s48, v201
  v_dot2c_f32_bf16 v55, s49, v201
  v_dot2c_f32_bf16 v56, s48, v202
  v_dot2c_f32_bf16 v57, s49, v202
  v_dot2c_f32_bf16 v58, s48, v203
  v_dot2c_f32_bf16 v59, s49, v203
  s_waitcnt vmcnt(10)
  v_dot2c_f32_bf16 v52, s48, v204
  v_dot2c_f32_bf16 v53, s49, v204
  v_dot2c_f32_bf16 v54, s48, v205
  v_dot2c_f32_bf16 v55, s49, v205
  v_dot2c_f32_bf16 v56, s48, v206
  v_dot2c_f32_bf16 v57, s49, v206
  v_dot2c_f32_bf16 v58, s48, v207
  v_dot2c_f32_bf16 v59, s49, v207
  s_waitcnt vmcnt(8)
  v_lshlrev_b32 v60, 16, v208
  v_and_b32 v61, s3, v208
  v_lshlrev_b32 v62, 16, v209
  v_and_b32 v63, s3, v209
  v_lshlrev_b32 v64, 16, v210
  v_and_b32 v65, s3, v210
  v_lshlrev_b32 v66, 16, v211
  v_and_b32 v67, s3, v211
  s_waitcnt vmcnt(7)
  v_dot2c_f32_bf16 v60, s48, v212
  v_dot2c_f32_bf16 v61, s49, v212
  v_dot2c_f32_bf16 v62, s48, v213
  v_dot2c_f32_bf16 v63, s49, v213
  v_dot2c_f32_bf16 v64, s48, v214
  v_dot2c_f32_bf16 v65, s49, v214
  v_dot2c_f32_bf16 v66, s48, v215
  v_dot2c_f32_bf16 v67, s49, v215
  s_waitcnt vmcnt(6)
  v_dot2c_f32_bf16 v60, s48, v216
  v_dot2c_f32_bf16 v61, s49, v216
  v_dot2c_f32_bf16 v62, s48, v217
  v_dot2c_f32_bf16 v63, s49, v217
  v_dot2c_f32_bf16 v64, s48, v218
  v_dot2c_f32_bf16 v65, s49, v218
  v_dot2c_f32_bf16 v66, s48, v219
  v_dot2c_f32_bf16 v67, s49, v219
  s_waitcnt vmcnt(5)
  v_dot2c_f32_bf16 v60, s48, v220
  v_dot2c_f32_bf16 v61, s49, v220
  v_dot2c_f32_bf16 v62, s48, v221
  v_dot2c_f32_bf16 v63, s49, v221
  v_dot2c_f32_bf16 v64, s48, v222
  v_dot2c_f32_bf16 v65, s49, v222
  v_dot2c_f32_bf16 v66, s48, v223
  v_dot2c_f32_bf16 v67, s49, v223
  s_waitcnt vmcnt(4)
  v_lshlrev_b32 v68, 16, v224
  v_and_b32 v69, s3, v224
  v_lshlrev_b32 v70, 16, v225
  v_and_b32 v71, s3, v225
  v_lshlrev_b32 v72, 16, v226
  v_and_b32 v73, s3, v226
  v_lshlrev_b32 v74, 16, v227
  v_and_b32 v75, s3, v227
  s_waitcnt vmcnt(3)
  v_dot2c_f32_bf16 v68, s48, v228
  v_dot2c_f32_bf16 v69, s49, v228
  v_dot2c_f32_bf16 v70, s48, v229
  v_dot2c_f32_bf16 v71, s49, v229
  v_dot2c_f32_bf16 v72, s48, v230
  v_dot2c_f32_bf16 v73, s49, v230
  v_dot2c_f32_bf16 v74, s48, v231
  v_dot2c_f32_bf16 v75, s49, v231
  s_waitcnt vmcnt(2)
  v_dot2c_f32_bf16 v68, s48, v232
  v_dot2c_f32_bf16 v69, s49, v232
  v_dot2c_f32_bf16 v70, s48, v233
  v_dot2c_f32_bf16 v71, s49, v233
  v_dot2c_f32_bf16 v72, s48, v234
  v_dot2c_f32_bf16 v73, s49, v234
  v_dot2c_f32_bf16 v74, s48, v235
  v_dot2c_f32_bf16 v75, s49, v235
  s_waitcnt vmcnt(1)
  v_dot2c_f32_bf16 v68, s48, v236
  v_dot2c_f32_bf16 v69, s49, v236
  v_dot2c_f32_bf16 v70, s48, v237
  v_dot2c_f32_bf16 v71, s49, v237
  v_dot2c_f32_bf16 v72, s48, v238
  v_dot2c_f32_bf16 v73, s49, v238
  v_dot2c_f32_bf16 v74, s48, v239
  v_dot2c_f32_bf16 v75, s49, v239
  s_nop 0
  buffer_atomic_add v14, v24, s[40:43], s51 offen offset:0 sc1
  s_waitcnt vmcnt(1)
  s_mov_b32 s70, 0
L_a_s0:
  v_cmp_lt_u32 vcc, v13, v12
  s_add_u32 s70, s70, 1
  s_cmp_ge_u32 s70, 200000
  s_cbranch_scc1 L_a_s0_x
  s_and_b32 s59, vcc_lo, 1
  s_cbranch_scc0 L_a_s0_x
  s_sleep 4
  v_mov_b32 v13, 0
  buffer_atomic_or v13, v11, s[40:43], 0 offen sc0 sc1
  s_waitcnt vmcnt(0)
  s_branch L_a_s0
L_a_s0_x:
  s_lshl_b32 s8, s80, 8
  s_add_u32 s8, s68, s8
  s_add_u32 s9, s8, 4096
  s_add_u32 s10, s8, 8192
  v_mov_b32 v13, 0
  buffer_atomic_or v13, v11, s[40:43], 0 offen sc0 sc1
  buffer_load_dwordx4 v[112:115], v9, s[40:43], s8 offen offset:0 sc1
  buffer_load_dwordx4 v[116:119], v9, s[40:43], s8 offen offset:1024 sc1
  buffer_load_dwordx4 v[120:123], v9, s[40:43], s8 offen offset:2048 sc1
  buffer_load_dwordx4 v[124:127], v9, s[40:43], s8 offen offset:3072 sc1
  buffer_load_dwordx4 v[128:131], v9, s[40:43], s9 offen offset:0 sc1
  buffer_load_dwordx4 v[132:135], v9, s[40:43], s9 offen offset:1024 sc1
  buffer_load_dwordx4 v[136:139], v9, s[40:43], s9 offen offset:2048 sc1
  buffer_load_dwordx4 v[140:143], v9, s[40:43], s9 offen offset:3072 sc1
  buffer_load_dwordx4 v[144:147], v9, s[40:43], s10 offen offset:0 sc1
  buffer_load_dwordx4 v[148:151], v9, s[40:43], s10 offen offset:1024 sc1
  buffer_load_dwordx4 v[152:155], v9, s[40:43], s10 offen offset:2048 sc1
  buffer_load_dwordx4 v[156:159], v9, s[40:43], s10 offen offset:3072 sc1
  s_lshl_b32 s12, s81, 8
  s_add_u32 s12, s68, s12
  s_add_u32 s13, s12, 4096
  s_add_u32 s14, s12, 8192
  s_waitcnt vmcnt(12)
  v_cmp_lt_u32 vcc, v13, v12
  s_nop 1
  s_and_b32 s59, vcc_lo, 2
  s_cbranch_scc1 L_a_w0
  v_mov_b32 v13, 0
  buffer_atomic_or v13, v11, s[40:43], 0 offen sc0 sc1
  s_waitcnt vmcnt(12)
  buffer_load_dwordx4 v[160:163], v9, s[40:43], s12 offen offset:0 sc1
  v_lshlrev_b32 v16, 16, v112
  v_and_b32 v17, s3, v112
  v_lshlrev_b32 v18, 16, v113
  v_and_b32 v19, s3, v113
  v_lshlrev_b32 v20, 16, v114
  v_and_b32 v21, s3, v114
  v_lshlrev_b32 v22, 16, v115
  v_and_b32 v23, s3, v115
  s_waitcnt vmcnt(12)
  buffer_load_dwordx4 v[164:167], v9, s[40:43], s12 offen offset:1024 sc1
  v_dot2c_f32_bf16 v16, s48, v116
  v_dot2c_f32_bf16 v17, s49, v116
  v_dot2c_f32_bf16 v18, s48, v117
  v_dot2c_f32_bf16 v19, s49, v117
  v_dot2c_f32_bf16 v20, s48, v118
  v_dot2c_f32_bf16 v21, s49, v118
  v_dot2c_f32_bf16 v22, s48, v119
  v_dot2c_f32_bf16 v23, s49, v119
  s_waitcnt vmcnt(12)
  buffer_load_dwordx4 v[168:171], v9, s[40:43], s12 offen offset:2048 sc1
  v_dot2c_f32_bf16 v16, s48, v120
  v_dot2c_f32_bf16 v17, s49, v120
  v_dot2c_f32_bf16 v18, s48, v121
  v_dot2c_f32_bf16 v19, s49, v121
  v_dot2c_f32_bf16 v20, s48, v122
  v_dot2c_f32_bf16 v21, s49, v122
  v_dot2c_f32_bf16 v22, s48, v123
  v_dot2c_f32_bf16 v23, s49, v123
  s_waitcnt vmcnt(12)
  buffer_load_dwordx4 v[172:175], v9, s[40:43], s12 offen offset:3072 sc1
  v_dot2c_f32_bf16 v16, s48, v124
  v_dot2c_f32_bf16 v17, s49, v124
  v_dot2c_f32_bf16 v18, s48, v125
  v_dot2c_f32_bf16 v19, s49, v125
  v_dot2c_f32_bf16 v20, s48, v126
  v_dot2c_f32_bf16 v21, s49, v126
  v_dot2c_f32_bf16 v22, s48, v127
  v_dot2c_f32_bf16 v23, s49, v127
  s_waitcnt vmcnt(12)
  buffer_load_dwordx4 v[176:179], v9, s[40:43], s13 offen offset:0 sc1
  v_dot2c_f32_bf16 v16, s48, v128
  v_dot2c_f32_bf16 v17, s49, v128
  v_dot2c_f32_bf16 v18, s48, v129
  v_dot2c_f32_bf16 v19, s49, v129
  v_dot2c_f32_bf16 v20, s48, v130
  v_dot2c_f32_bf16 v21, s49, v130
  v_dot2c_f32_bf16 v22, s48, v131
  v_dot2c_f32_bf16 v23, s49, v131
  s_waitcnt vmcnt(12)
  buffer_load_dwordx4 v[180:183], v9, s[40:43], s13 offen offset:1024 sc1
  v_dot2c_f32_bf16 v16, s48, v132
  v_dot2c_f32_bf16 v17, s49, v132
  v_dot2c_f32_bf16 v18, s48, v133
  v_dot2c_f32_bf16 v19, s49, v133
  v_dot2c_f32_bf16 v20, s48, v134
  v_dot2c_f32_bf16 v21, s49, v134
  v_dot2c_f32_bf16 v22, s48, v135
  v_dot2c_f32_bf16 v23, s49, v135
  s_waitcnt vmcnt(12)
  buffer_load_dwordx4 v[184:187], v9, s[40:43], s13 offen offset:2048 sc1
  v_dot2c_f32_bf16 v16, s48, v136
  v_dot2c_f32_bf16 v17, s49, v136
  v_dot2c_f32_bf16 v18, s48, v137
  v_dot2c_f32_bf16 v19, s49, v137
  v_dot2c_f32_bf16 v20, s48, v138
  v_dot2c_f32_bf16 v21, s49, v138
  v_dot2c_f32_bf16 v22, s48, v139
  v_dot2c_f32_bf16 v23, s49, v139
  s_waitcnt vmcnt(12)
  buffer_load_dwordx4 v[188:191], v9, s[40:43], s13 offen offset:3072 sc1
  v_dot2c_f32_bf16 v16, s48, v140
  v_dot2c_f32_bf16 v17, s49, v140
  v_dot2c_f32_bf16 v18, s48, v141
  v_dot2c_f32_bf16 v19, s49, v141
  v_dot2c_f32_bf16 v20, s48, v142
  v_dot2c_f32_bf16 v21, s49, v142
  v_dot2c_f32_bf16 v22, s48, v143
  v_dot2c_f32_bf16 v23, s49, v143
  s_waitcnt vmcnt(12)
  buffer_load_dwordx4 v[192:195], v9, s[40:43], s14 offen offset:0 sc1
  v_dot2c_f32_bf16 v16, s48, v144
  v_dot2c_f32_bf16 v17, s49, v144
  v_dot2c_f32_bf16 v18, s48, v145
  v_dot2c_f32_bf16 v19, s49, v145
  v_dot2c_f32_bf16 v20, s48, v146
  v_dot2c_f32_bf16 v21, s49, v146
  v_dot2c_f32_bf16 v22, s48, v147
  v_dot2c_f32_bf16 v23, s49, v147
  s_waitcnt vmcnt(12)
  buffer_load_dwordx4 v[196:199], v9, s[40:43], s14 offen offset:1024 sc1
  v_dot2c_f32_bf16 v16, s48, v148
  v_dot2c_f32_bf16 v17, s49, v148
  v_dot2c_f32_bf16 v18, s48, v149
  v_dot2c_f32_bf16 v19, s49, v149
  v_dot2c_f32_bf16 v20, s48, v150
  v_dot2c_f32_bf16 v21, s49, v150
  v_dot2c_f32_bf16 v22, s48, v151
  v_dot2c_f32_bf16 v23, s49, v151
  s_waitcnt vmcnt(12)
  buffer_load_dwordx4 v[200:203], v9, s[40:43], s14 offen offset:2048 sc1
  v_dot2c_f32_bf16 v16, s48, v152
  v_dot2c_f32_bf16 v17, s49, v152
  v_dot2c_f32_bf16 v18, s48, v153
  v_dot2c_f32_bf16 v19, s49, v153
  v_dot2c_f32_bf16 v20, s48, v154
  v_dot2c_f32_bf16 v21, s49, v154
  v_dot2c_f32_bf16 v22, s48, v155
  v_dot2c_f32_bf16 v23, s49, v155
  s_waitcnt vmcnt(12)
  buffer_load_dwordx4 v[204:207], v9, s[40:43], s14 offen offset:3072 sc1
  v_dot2c_f32_bf16 v16, s48, v156
  v_dot2c_f32_bf16 v17, s49, v156
  v_dot2c_f32_bf16 v18, s48, v157
  v_dot2c_f32_bf16 v19, s49, v157
  v_dot2c_f32_bf16 v20, s48, v158
  v_dot2c_f32_bf16 v21, s49, v158
  v_dot2c_f32_bf16 v22, s48, v159
  v_dot2c_f32_bf16 v23, s49, v159
  s_nop 0
  v_mul_f32 v24, 0xbfb8aa3b, v16
  v_mul_f32 v25, 0xbfb8aa3b, v17
  v_mul_f32 v26, 0xbfb8aa3b, v18
  v_mul_f32 v27, 0xbfb8aa3b, v19
  v_mul_f32 v28, 0xbfb8aa3b, v20
  v_mul_f32 v29, 0xbfb8aa3b, v21
  v_mul_f32 v30, 0xbfb8aa3b, v22
  v_mul_f32 v31, 0xbfb8aa3b, v23
  v_exp_f32 v24, v24
  v_exp_f32 v25, v25
  v_exp_f32 v26, v26
  v_exp_f32 v27, v27
  v_exp_f32 v28, v28
  v_exp_f32 v29, v29
  v_exp_f32 v30, v30
  v_exp_f32 v31, v31
  v_add_f32 v24, 1.0, v24
  v_add_f32 v25, 1.0, v25
  v_add_f32 v26, 1.0, v26
  v_add_f32 v27, 1.0, v27
  v_add_f32 v28, 1.0, v28
  v_add_f32 v29, 1.0, v29
  v_add_f32 v30, 1.0, v30
  v_add_f32 v31, 1.0, v31
  v_rcp_f32 v24, v24
  v_rcp_f32 v25, v25
  v_rcp_f32 v26, v26
  v_rcp_f32 v27, v27
  v_rcp_f32 v28, v28
  v_rcp_f32 v29, v29
  v_rcp_f32 v30, v30
  v_rcp_f32 v31, v31
  v_pk_mul_f32 v[16:17], v[16:17], v[36:37]
  v_pk_mul_f32 v[18:19], v[18:19], v[38:39]
  v_pk_mul_f32 v[20:21], v[20:21], v[40:41]
  v_pk_mul_f32 v[22:23], v[22:23], v[42:43]
  v_pk_mul_f32 v[16:17], v[16:17], v[24:25]
  v_pk_mul_f32 v[18:19], v[18:19], v[26:27]
  v_pk_mul_f32 v[20:21], v[20:21], v[28:29]
  v_pk_mul_f32 v[22:23], v[22:23], v[30:31]
  s_nop 1
  v_permlane16_swap_b32 v16, v20
  v_permlane16_swap_b32 v17, v21
  v_permlane16_swap_b32 v18, v22
  v_permlane16_swap_b32 v19, v23
  v_dot2c_f32_bf16 v16, s48, v76
  v_dot2c_f32_bf16 v17, s49, v76
  v_dot2c_f32_bf16 v18, s48, v77
  v_dot2c_f32_bf16 v19, s49, v77
  v_dot2c_f32_bf16 v20, s48, v78
  v_dot2c_f32_bf16 v21, s49, v78
  v_dot2c_f32_bf16 v22, s48, v79
  v_dot2c_f32_bf16 v23, s49, v79
  v_cvt_pk_bf16_f32 v24, v16, v17
  v_cvt_pk_bf16_f32 v25, v18, v19
  v_cvt_pk_bf16_f32 v26, v20, v21
  v_cvt_pk_bf16_f32 v27, v22, v23
  buffer_store_dwordx4 v[24:27], v10, s[32:35], s71 offen
L_a_j0:
  s_lshl_b32 s8, s82, 8
  s_add_u32 s8, s68, s8
  s_add_u32 s9, s8, 4096
  s_add_u32 s10, s8, 8192
  s_waitcnt vmcnt(13)
  v_cmp_lt_u32 vcc, v13, v12
  s_nop 1
  s_and_b32 s59, vcc_lo, 4
  s_cbranch_scc1 L_a_w1
  v_mov_b32 v13, 0
  buffer_atomic_or v13, v11, s[40:43], 0 offen sc0 sc1
  s_waitcnt vmcnt(13)
  buffer_load_dwordx4 v[112:115], v9, s[40:43], s8 offen offset:0 sc1
  v_lshlrev_b32 v16, 16, v160
  v_and_b32 v17, s3, v160
  v_lshlrev_b32 v18, 16, v161
  v_and_b32 v19, s3, v161
  v_lshlrev_b32 v20, 16, v162
  v_and_b32 v21, s3, v162
  v_lshlrev_b32 v22, 16, v163
  v_and_b32 v23, s3, v163
  s_waitcnt vmcnt(13)
  buffer_load_dwordx4 v[116:119], v9, s[40:43], s8 offen offset:1024 sc1
  v_dot2c_f32_bf16 v16, s48, v164
  v_dot2c_f32_bf16 v17, s49, v164
  v_dot2c_f32_bf16 v18, s48, v165
  v_dot2c_f32_bf16 v19, s49, v165
  v_dot2c_f32_bf16 v20, s48, v166
  v_dot2c_f32_bf16 v21, s49, v166
  v_dot2c_f32_bf16 v22, s48, v167
  v_dot2c_f32_bf16 v23, s49, v167
  s_waitcnt vmcnt(13)
  buffer_load_dwordx4 v[120:123], v9, s[40:43], s8 offen offset:2048 sc1
  v_dot2c_f32_bf16 v16, s48, v168
  v_dot2c_f32_bf16 v17, s49, v168
  v_dot2c_f32_bf16 v18, s48, v169
  v_dot2c_f32_bf16 v19, s49, v169
  v_dot2c_f32_bf16 v20, s48, v170
  v_dot2c_f32_bf16 v21, s49, v170
  v_dot2c_f32_bf16 v22, s48, v171
  v_dot2c_f32_bf16 v23, s49, v171
  s_waitcnt vmcnt(13)
  buffer_load_dwordx4 v[124:127], v9, s[40:43], s8 offen offset:3072 sc1
  v_dot2c_f32_bf16 v16, s48, v172
  v_dot2c_f32_bf16 v17, s49, v172
  v_dot2c_f32_bf16 v18, s48, v173
  v_dot2c_f32_bf16 v19, s49, v173
  v_dot2c_f32_bf16 v20, s48, v174
  v_dot2c_f32_bf16 v21, s49, v174
  v_dot2c_f32_bf16 v22, s48, v175
  v_dot2c_f32_bf16 v23, s49, v175
  s_waitcnt vmcnt(13)
  buffer_load_dwordx4 v[128:131], v9, s[40:43], s9 offen offset:0 sc1
  v_dot2c_f32_bf16 v16, s48, v176
  v_dot2c_f32_bf16 v17, s49, v176
  v_dot2c_f32_bf16 v18, s48, v177
  v_dot2c_f32_bf16 v19, s49, v177
  v_dot2c_f32_bf16 v20, s48, v178
  v_dot2c_f32_bf16 v21, s49, v178
  v_dot2c_f32_bf16 v22, s48, v179
  v_dot2c_f32_bf16 v23, s49, v179
  s_waitcnt vmcnt(13)
  buffer_load_dwordx4 v[132:135], v9, s[40:43], s9 offen offset:1024 sc1
  v_dot2c_f32_bf16 v16, s48, v180
  v_dot2c_f32_bf16 v17, s49, v180
  v_dot2c_f32_bf16 v18, s48, v181
  v_dot2c_f32_bf16 v19, s49, v181
  v_dot2c_f32_bf16 v20, s48, v182
  v_dot2c_f32_bf16 v21, s49, v182
  v_dot2c_f32_bf16 v22, s48, v183
  v_dot2c_f32_bf16 v23, s49, v183
  s_waitcnt vmcnt(13)
  buffer_load_dwordx4 v[136:139], v9, s[40:43], s9 offen offset:2048 sc1
  v_dot2c_f32_bf16 v16, s48, v184
  v_dot2c_f32_bf16 v17, s49, v184
  v_dot2c_f32_bf16 v18, s48, v185
  v_dot2c_f32_bf16 v19, s49, v185
  v_dot2c_f32_bf16 v20, s48, v186
  v_dot2c_f32_bf16 v21, s49, v186
  v_dot2c_f32_bf16 v22, s48, v187
  v_dot2c_f32_bf16 v23, s49, v187
  s_waitcnt vmcnt(13)
  buffer_load_dwordx4 v[140:143], v9, s[40:43], s9 offen offset:3072 sc1
  v_dot2c_f32_bf16 v16, s48, v188
  v_dot2c_f32_bf16 v17, s49, v188
  v_dot2c_f32_bf16 v18, s48, v189
  v_dot2c_f32_bf16 v19, s49, v189
  v_dot2c_f32_bf16 v20, s48, v190
  v_dot2c_f32_bf16 v21, s49, v190
  v_dot2c_f32_bf16 v22, s48, v191
  v_dot2c_f32_bf16 v23, s49, v191
  s_waitcnt vmcnt(13)
  buffer_load_dwordx4 v[144:147], v9, s[40:43], s10 offen offset:0 sc1
  v_dot2c_f32_bf16 v16, s48, v192
  v_dot2c_f32_bf16 v17, s49, v192
  v_dot2c_f32_bf16 v18, s48, v193
  v_dot2c_f32_bf16 v19, s49, v193
  v_dot2c_f32_bf16 v20, s48, v194
  v_dot2c_f32_bf16 v21, s49, v194
  v_dot2c_f32_bf16 v22, s48, v195
  v_dot2c_f32_bf16 v23, s49, v195
  s_waitcnt vmcnt(13)
  buffer_load_dwordx4 v[148:151], v9, s[40:43], s10 offen offset:1024 sc1
  v_dot2c_f32_bf16 v16, s48, v196
  v_dot2c_f32_bf16 v17, s49, v196
  v_dot2c_f32_bf16 v18, s48, v197
  v_dot2c_f32_bf16 v19, s49, v197
  v_dot2c_f32_bf16 v20, s48, v198
  v_dot2c_f32_bf16 v21, s49, v198
  v_dot2c_f32_bf16 v22, s48, v199
  v_dot2c_f32_bf16 v23, s49, v199
  s_waitcnt vmcnt(13)
  buffer_load_dwordx4 v[152:155], v9, s[40:43], s10 offen offset:2048 sc1
  v_dot2c_f32_bf16 v16, s48, v200
  v_dot2c_f32_bf16 v17, s49, v200
  v_dot2c_f32_bf16 v18, s48, v201
  v_dot2c_f32_bf16 v19, s49, v201
  v_dot2c_f32_bf16 v20, s48, v202
  v_dot2c_f32_bf16 v21, s49, v202
  v_dot2c_f32_bf16 v22, s48, v203
  v_dot2c_f32_bf16 v23, s49, v203
  s_waitcnt vmcnt(13)
  buffer_load_dwordx4 v[156:159], v9, s[40:43], s10 offen offset:3072 sc1
  v_dot2c_f32_bf16 v16, s48, v204
  v_dot2c_f32_bf16 v17, s49, v204
  v_dot2c_f32_bf16 v18, s48, v205
  v_dot2c_f32_bf16 v19, s49, v205
  v_dot2c_f32_bf16 v20, s48, v206
  v_dot2c_f32_bf16 v21, s49, v206
  v_dot2c_f32_bf16 v22, s48, v207
  v_dot2c_f32_bf16 v23, s49, v207
  s_nop 0
  v_mul_f32 v24, 0xbfb8aa3b, v16
  v_mul_f32 v25, 0xbfb8aa3b, v17
  v_mul_f32 v26, 0xbfb8aa3b, v18
  v_mul_f32 v27, 0xbfb8aa3b, v19
  v_mul_f32 v28, 0xbfb8aa3b, v20
  v_mul_f32 v29, 0xbfb8aa3b, v21
  v_mul_f32 v30, 0xbfb8aa3b, v22
  v_mul_f32 v31, 0xbfb8aa3b, v23
  v_exp_f32 v24, v24
  v_exp_f32 v25, v25
  v_exp_f32 v26, v26
  v_exp_f32 v27, v27
  v_exp_f32 v28, v28
  v_exp_f32 v29, v29
  v_exp_f32 v30, v30
  v_exp_f32 v31, v31
  v_add_f32 v24, 1.0, v24
  v_add_f32 v25, 1.0, v25
  v_add_f32 v26, 1.0, v26
  v_add_f32 v27, 1.0, v27
  v_add_f32 v28, 1.0, v28
  v_add_f32 v29, 1.0, v29
  v_add_f32 v30, 1.0, v30
  v_add_f32 v31, 1.0, v31
  v_rcp_f32 v24, v24
  v_rcp_f32 v25, v25
  v_rcp_f32 v26, v26
  v_rcp_f32 v27, v27
  v_rcp_f32 v28, v28
  v_rcp_f32 v29, v29
  v_rcp_f32 v30, v30
  v_rcp_f32 v31, v31
  v_pk_mul_f32 v[16:17], v[16:17], v[44:45]
  v_pk_mul_f32 v[18:19], v[18:19], v[46:47]
  v_pk_mul_f32 v[20:21], v[20:21], v[48:49]
  v_pk_mul_f32 v[22:23], v[22:23], v[50:51]
  v_pk_mul_f32 v[16:17], v[16:17], v[24:25]
  v_pk_mul_f32 v[18:19], v[18:19], v[26:27]
  v_pk_mul_f32 v[20:21], v[20:21], v[28:29]
  v_pk_mul_f32 v[22:23], v[22:23], v[30:31]
  s_nop 1
  v_permlane16_swap_b32 v16, v20
  v_permlane16_swap_b32 v17, v21
  v_permlane16_swap_b32 v18, v22
  v_permlane16_swap_b32 v19, v23
  v_dot2c_f32_bf16 v16, s48, v80
  v_dot2c_f32_bf16 v17, s49, v80
  v_dot2c_f32_bf16 v18, s48, v81
  v_dot2c_f32_bf16 v19, s49, v81
  v_dot2c_f32_bf16 v20, s48, v82
  v_dot2c_f32_bf16 v21, s49, v82
  v_dot2c_f32_bf16 v22, s48, v83
  v_dot2c_f32_bf16 v23, s49, v83
  v_cvt_pk_bf16_f32 v24, v16, v17
  v_cvt_pk_bf16_f32 v25, v18, v19
  v_cvt_pk_bf16_f32 v26, v20, v21
  v_cvt_pk_bf16_f32 v27, v22, v23
  buffer_store_dwordx4 v[24:27], v10, s[32:35], s72 offen
L_a_j1:
  s_lshl_b32 s12, s83, 8
  s_add_u32 s12, s68, s12
  s_add_u32 s13, s12, 4096
  s_add_u32 s14, s12, 8192
  s_waitcnt vmcnt(13)
  v_cmp_lt_u32 vcc, v13, v12
  s_nop 1
  s_and_b32 s59, vcc_lo, 8
  s_cbranch_scc1 L_a_w2
  v_mov_b32 v13, 0
  buffer_atomic_or v13, v11, s[40:43], 0 offen sc0 sc1
  s_waitcnt vmcnt(13)
  buffer_load_dwordx4 v[160:163], v9, s[40:43], s12 offen offset:0 sc1
  v_lshlrev_b32 v16, 16, v112
  v_and_b32 v17, s3, v112
  v_lshlrev_b32 v18, 16, v113
  v_and_b32 v19, s3, v113
  v_lshlrev_b32 v20, 16, v114
  v_and_b32 v21, s3, v114
  v_lshlrev_b32 v22, 16, v115
  v_and_b32 v23, s3, v115
  s_waitcnt vmcnt(13)
  buffer_load_dwordx4 v[164:167], v9, s[40:43], s12 offen offset:1024 sc1
  v_dot2c_f32_bf16 v16, s48, v116
  v_dot2c_f32_bf16 v17, s49, v116
  v_dot2c_f32_bf16 v18, s48, v117
  v_dot2c_f32_bf16 v19, s49, v117
  v_dot2c_f32_bf16 v20, s48, v118
  v_dot2c_f32_bf16 v21, s49, v118
  v_dot2c_f32_bf16 v22, s48, v119
  v_dot2c_f32_bf16 v23, s49, v119
  s_waitcnt vmcnt(13)
  buffer_load_dwordx4 v[168:171], v9, s[40:43], s12 offen offset:2048 sc1
  v_dot2c_f32_bf16 v16, s48, v120
  v_dot2c_f32_bf16 v17, s49, v120
  v_dot2c_f32_bf16 v18, s48, v121
  v_dot2c_f32_bf16 v19, s49, v121
  v_dot2c_f32_bf16 v20, s48, v122
  v_dot2c_f32_bf16 v21, s49, v122
  v_dot2c_f32_bf16 v22, s48, v123
  v_dot2c_f32_bf16 v23, s49, v123
  s_waitcnt vmcnt(13)
  buffer_load_dwordx4 v[172:175], v9, s[40:43], s12 offen offset:3072 sc1
  v_dot2c_f32_bf16 v16, s48, v124
  v_dot2c_f32_bf16 v17, s49, v124
  v_dot2c_f32_bf16 v18, s48, v125
  v_dot2c_f32_bf16 v19, s49, v125
  v_dot2c_f32_bf16 v20, s48, v126
  v_dot2c_f32_bf16 v21, s49, v126
  v_dot2c_f32_bf16 v22, s48, v127
  v_dot2c_f32_bf16 v23, s49, v127
  s_waitcnt vmcnt(13)
  buffer_load_dwordx4 v[176:179], v9, s[40:43], s13 offen offset:0 sc1
  v_dot2c_f32_bf16 v16, s48, v128
  v_dot2c_f32_bf16 v17, s49, v128
  v_dot2c_f32_bf16 v18, s48, v129
  v_dot2c_f32_bf16 v19, s49, v129
  v_dot2c_f32_bf16 v20, s48, v130
  v_dot2c_f32_bf16 v21, s49, v130
  v_dot2c_f32_bf16 v22, s48, v131
  v_dot2c_f32_bf16 v23, s49, v131
  s_waitcnt vmcnt(13)
  buffer_load_dwordx4 v[180:183], v9, s[40:43], s13 offen offset:1024 sc1
  v_dot2c_f32_bf16 v16, s48, v132
  v_dot2c_f32_bf16 v17, s49, v132
  v_dot2c_f32_bf16 v18, s48, v133
  v_dot2c_f32_bf16 v19, s49, v133
  v_dot2c_f32_bf16 v20, s48, v134
  v_dot2c_f32_bf16 v21, s49, v134
  v_dot2c_f32_bf16 v22, s48, v135
  v_dot2c_f32_bf16 v23, s49, v135
  s_waitcnt vmcnt(13)
  buffer_load_dwordx4 v[184:187], v9, s[40:43], s13 offen offset:2048 sc1
  v_dot2c_f32_bf16 v16, s48, v136
  v_dot2c_f32_bf16 v17, s49, v136
  v_dot2c_f32_bf16 v18, s48, v137
  v_dot2c_f32_bf16 v19, s49, v137
  v_dot2c_f32_bf16 v20, s48, v138
  v_dot2c_f32_bf16 v21, s49, v138
  v_dot2c_f32_bf16 v22, s48, v139
  v_dot2c_f32_bf16 v23, s49, v139
  s_waitcnt vmcnt(13)
  buffer_load_dwordx4 v[188:191], v9, s[40:43], s13 offen offset:3072 sc1
  v_dot2c_f32_bf16 v16, s48, v140
  v_dot2c_f32_bf16 v17, s49, v140
  v_dot2c_f32_bf16 v18, s48, v141
  v_dot2c_f32_bf16 v19, s49, v141
  v_dot2c_f32_bf16 v20, s48, v142
  v_dot2c_f32_bf16 v21, s49, v142
  v_dot2c_f32_bf16 v22, s48, v143
  v_dot2c_f32_bf16 v23, s49, v143
  s_waitcnt vmcnt(13)
  buffer_load_dwordx4 v[192:195], v9, s[40:43], s14 offen offset:0 sc1
  v_dot2c_f32_bf16 v16, s48, v144
  v_dot2c_f32_bf16 v17, s49, v144
  v_dot2c_f32_bf16 v18, s48, v145
  v_dot2c_f32_bf16 v19, s49, v145
  v_dot2c_f32_bf16 v20, s48, v146
  v_dot2c_f32_bf16 v21, s49, v146
  v_dot2c_f32_bf16 v22, s48, v147
  v_dot2c_f32_bf16 v23, s49, v147
  s_waitcnt vmcnt(13)
  buffer_load_dwordx4 v[196:199], v9, s[40:43], s14 offen offset:1024 sc1
  v_dot2c_f32_bf16 v16, s48, v148
  v_dot2c_f32_bf16 v17, s49, v148
  v_dot2c_f32_bf16 v18, s48, v149
  v_dot2c_f32_bf16 v19, s49, v149
  v_dot2c_f32_bf16 v20, s48, v150
  v_dot2c_f32_bf16 v21, s49, v150
  v_dot2c_f32_bf16 v22, s48, v151
  v_dot2c_f32_bf16 v23, s49, v151
  s_waitcnt vmcnt(13)
  buffer_load_dwordx4 v[200:203], v9, s[40:43], s14 offen offset:2048 sc1
  v_dot2c_f32_bf16 v16, s48, v152
  v_dot2c_f32_bf16 v17, s49, v152
  v_dot2c_f32_bf16 v18, s48, v153
  v_dot2c_f32_bf16 v19, s49, v153
  v_dot2c_f32_bf16 v20, s48, v154
  v_dot2c_f32_bf16 v21, s49, v154
  v_dot2c_f32_bf16 v22, s48, v155
  v_dot2c_f32_bf16 v23, s49, v155
  s_waitcnt vmcnt(13)
  buffer_load_dwordx4 v[204:207], v9, s[40:43], s14 offen offset:3072 sc1
  v_dot2c_f32_bf16 v16, s48, v156
  v_dot2c_f32_bf16 v17, s49, v156
  v_dot2c_f32_bf16 v18, s48, v157
  v_dot2c_f32_bf16 v19, s49, v157
  v_dot2c_f32_bf16 v20, s48, v158
  v_dot2c_f32_bf16 v21, s49, v158
  v_dot2c_f32_bf16 v22, s48, v159
  v_dot2c_f32_bf16 v23, s49, v159
  s_nop 0
  v_mul_f32 v24, 0xbfb8aa3b, v16
  v_mul_f32 v25, 0xbfb8aa3b, v17
  v_mul_f32 v26, 0xbfb8aa3b, v18
  v_mul_f32 v27, 0xbfb8aa3b, v19
  v_mul_f32 v28, 0xbfb8aa3b, v20
  v_mul_f32 v29, 0xbfb8aa3b, v21
  v_mul_f32 v30, 0xbfb8aa3b, v22
  v_mul_f32 v31, 0xbfb8aa3b, v23
  v_exp_f32 v24, v24
  v_exp_f32 v25, v25
  v_exp_f32 v26, v26
  v_exp_f32 v27, v27
  v_exp_f32 v28, v28
  v_exp_f32 v29, v29
  v_exp_f32 v30, v30
  v_exp_f32 v31, v31
  v_add_f32 v24, 1.0, v24
  v_add_f32 v25, 1.0, v25
  v_add_f32 v26, 1.0, v26
  v_add_f32 v27, 1.0, v27
  v_add_f32 v28, 1.0, v28
  v_add_f32 v29, 1.0, v29
  v_add_f32 v30, 1.0, v30
  v_add_f32 v31, 1.0, v31
  v_rcp_f32 v24, v24
  v_rcp_f32 v25, v25
  v_rcp_f32 v26, v26
  v_rcp_f32 v27, v27
  v_rcp_f32 v28, v28
  v_rcp_f32 v29, v29
  v_rcp_f32 v30, v30
  v_rcp_f32 v31, v31
  v_pk_mul_f32 v[16:17], v[16:17], v[52:53]
  v_pk_mul_f32 v[18:19], v[18:19], v[54:55]
  v_pk_mul_f32 v[20:21], v[20:21], v[56:57]
  v_pk_mul_f32 v[22:23], v[22:23], v[58:59]
  v_pk_mul_f32 v[16:17], v[16:17], v[24:25]
  v_pk_mul_f32 v[18:19], v[18:19], v[26:27]
  v_pk_mul_f32 v[20:21], v[20:21], v[28:29]
  v_pk_mul_f32 v[22:23], v[22:23], v[30:31]
  s_nop 1
  v_permlane16_swap_b32 v16, v20
  v_permlane16_swap_b32 v17, v21
  v_permlane16_swap_b32 v18, v22
  v_permlane16_swap_b32 v19, v23
  v_dot2c_f32_bf16 v16, s48, v84
  v_dot2c_f32_bf16 v17, s49, v84
  v_dot2c_f32_bf16 v18, s48, v85
  v_dot2c_f32_bf16 v19, s49, v85
  v_dot2c_f32_bf16 v20, s48, v86
  v_dot2c_f32_bf16 v21, s49, v86
  v_dot2c_f32_bf16 v22, s48, v87
  v_dot2c_f32_bf16 v23, s49, v87
  v_cvt_pk_bf16_f32 v24, v16, v17
  v_cvt_pk_bf16_f32 v25, v18, v19
  v_cvt_pk_bf16_f32 v26, v20, v21
  v_cvt_pk_bf16_f32 v27, v22, v23
  buffer_store_dwordx4 v[24:27], v10, s[32:35], s73 offen
L_a_j2:
  s_lshl_b32 s8, s84, 8
  s_add_u32 s8, s68, s8
  s_add_u32 s9, s8, 4096
  s_add_u32 s10, s8, 8192
  s_waitcnt vmcnt(13)
  v_cmp_lt_u32 vcc, v13, v12
  s_nop 1
  s_and_b32 s59, vcc_lo, 16
  s_cbranch_scc1 L_a_w3
  s_waitcnt vmcnt(12)
  buffer_load_dwordx4 v[112:115], v9, s[40:43], s8 offen offset:0 sc1
  v_lshlrev_b32 v16, 16, v160
  v_and_b32 v17, s3, v160
  v_lshlrev_b32 v18, 16, v161
  v_and_b32 v19, s3, v161
  v_lshlrev_b32 v20, 16, v162
  v_and_b32 v21, s3, v162
  v_lshlrev_b32 v22, 16, v163
  v_and_b32 v23, s3, v163
  s_waitcnt vmcnt(12)
  buffer_load_dwordx4 v[116:119], v9, s[40:43], s8 offen offset:1024 sc1
  v_dot2c_f32_bf16 v16, s48, v164
  v_dot2c_f32_bf16 v17, s49, v164
  v_dot2c_f32_bf16 v18, s48, v165
  v_dot2c_f32_bf16 v19, s49, v165
  v_dot2c_f32_bf16 v20, s48, v166
  v_dot2c_f32_bf16 v21, s49, v166
  v_dot2c_f32_bf16 v22, s48, v167
  v_dot2c_f32_bf16 v23, s49, v167
  s_waitcnt vmcnt(12)
  buffer_load_dwordx4 v[120:123], v9, s[40:43], s8 offen offset:2048 sc1
  v_dot2c_f32_bf16 v16, s48, v168
  v_dot2c_f32_bf16 v17, s49, v168
  v_dot2c_f32_bf16 v18, s48, v169
  v_dot2c_f32_bf16 v19, s49, v169
  v_dot2c_f32_bf16 v20, s48, v170
  v_dot2c_f32_bf16 v21, s49, v170
  v_dot2c_f32_bf16 v22, s48, v171
  v_dot2c_f32_bf16 v23, s49, v171
  s_waitcnt vmcnt(12)
  buffer_load_dwordx4 v[124:127], v9, s[40:43], s8 offen offset:3072 sc1
  v_dot2c_f32_bf16 v16, s48, v172
  v_dot2c_f32_bf16 v17, s49, v172
  v_dot2c_f32_bf16 v18, s48, v173
  v_dot2c_f32_bf16 v19, s49, v173
  v_dot2c_f32_bf16 v20, s48, v174
  v_dot2c_f32_bf16 v21, s49, v174
  v_dot2c_f32_bf16 v22, s48, v175
  v_dot2c_f32_bf16 v23, s49, v175
  s_waitcnt vmcnt(12)
  buffer_load_dwordx4 v[128:131], v9, s[40:43], s9 offen offset:0 sc1
  v_dot2c_f32_bf16 v16, s48, v176
  v_dot2c_f32_bf16 v17, s49, v176
  v_dot2c_f32_bf16 v18, s48, v177
  v_dot2c_f32_bf16 v19, s49, v177
  v_dot2c_f32_bf16 v20, s48, v178
  v_dot2c_f32_bf16 v21, s49, v178
  v_dot2c_f32_bf16 v22, s48, v179
  v_dot2c_f32_bf16 v23, s49, v179
  s_waitcnt vmcnt(12)
  buffer_load_dwordx4 v[132:135], v9, s[40:43], s9 offen offset:1024 sc1
  v_dot2c_f32_bf16 v16, s48, v180
  v_dot2c_f32_bf16 v17, s49, v180
  v_dot2c_f32_bf16 v18, s48, v181
  v_dot2c_f32_bf16 v19, s49, v181
  v_dot2c_f32_bf16 v20, s48, v182
  v_dot2c_f32_bf16 v21, s49, v182
  v_dot2c_f32_bf16 v22, s48, v183
  v_dot2c_f32_bf16 v23, s49, v183
  s_waitcnt vmcnt(12)
  buffer_load_dwordx4 v[136:139], v9, s[40:43], s9 offen offset:2048 sc1
  v_dot2c_f32_bf16 v16, s48, v184
  v_dot2c_f32_bf16 v17, s49, v184
  v_dot2c_f32_bf16 v18, s48, v185
  v_dot2c_f32_bf16 v19, s49, v185
  v_dot2c_f32_bf16 v20, s48, v186
  v_dot2c_f32_bf16 v21, s49, v186
  v_dot2c_f32_bf16 v22, s48, v187
  v_dot2c_f32_bf16 v23, s49, v187
  s_waitcnt vmcnt(12)
  buffer_load_dwordx4 v[140:143], v9, s[40:43], s9 offen offset:3072 sc1
  v_dot2c_f32_bf16 v16, s48, v188
  v_dot2c_f32_bf16 v17, s49, v188
  v_dot2c_f32_bf16 v18, s48, v189
  v_dot2c_f32_bf16 v19, s49, v189
  v_dot2c_f32_bf16 v20, s48, v190
  v_dot2c_f32_bf16 v21, s49, v190
  v_dot2c_f32_bf16 v22, s48, v191
  v_dot2c_f32_bf16 v23, s49, v191
  s_waitcnt vmcnt(12)
  buffer_load_dwordx4 v[144:147], v9, s[40:43], s10 offen offset:0 sc1
  v_dot2c_f32_bf16 v16, s48, v192
  v_dot2c_f32_bf16 v17, s49, v192
  v_dot2c_f32_bf16 v18, s48, v193
  v_dot2c_f32_bf16 v19, s49, v193
  v_dot2c_f32_bf16 v20, s48, v194
  v_dot2c_f32_bf16 v21, s49, v194
  v_dot2c_f32_bf16 v22, s48, v195
  v_dot2c_f32_bf16 v23, s49, v195
  s_waitcnt vmcnt(12)
  buffer_load_dwordx4 v[148:151], v9, s[40:43], s10 offen offset:1024 sc1
  v_dot2c_f32_bf16 v16, s48, v196
  v_dot2c_f32_bf16 v17, s49, v196
  v_dot2c_f32_bf16 v18, s48, v197
  v_dot2c_f32_bf16 v19, s49, v197
  v_dot2c_f32_bf16 v20, s48, v198
  v_dot2c_f32_bf16 v21, s49, v198
  v_dot2c_f32_bf16 v22, s48, v199
  v_dot2c_f32_bf16 v23, s49, v199
  s_waitcnt vmcnt(12)
  buffer_load_dwordx4 v[152:155], v9, s[40:43], s10 offen offset:2048 sc1
  v_dot2c_f32_bf16 v16, s48, v200
  v_dot2c_f32_bf16 v17, s49, v200
  v_dot2c_f32_bf16 v18, s48, v201
  v_dot2c_f32_bf16 v19, s49, v201
  v_dot2c_f32_bf16 v20, s48, v202
  v_dot2c_f32_bf16 v21, s49, v202
  v_dot2c_f32_bf16 v22, s48, v203
  v_dot2c_f32_bf16 v23, s49, v203
  s_waitcnt vmcnt(12)
  buffer_load_dwordx4 v[156:159], v9, s[40:43], s10 offen offset:3072 sc1
  v_dot2c_f32_bf16 v16, s48, v204
  v_dot2c_f32_bf16 v17, s49, v204
  v_dot2c_f32_bf16 v18, s48, v205
  v_dot2c_f32_bf16 v19, s49, v205
  v_dot2c_f32_bf16 v20, s48, v206
  v_dot2c_f32_bf16 v21, s49, v206
  v_dot2c_f32_bf16 v22, s48, v207
  v_dot2c_f32_bf16 v23, s49, v207
  s_nop 0
  v_mul_f32 v24, 0xbfb8aa3b, v16
  v_mul_f32 v25, 0xbfb8aa3b, v17
  v_mul_f32 v26, 0xbfb8aa3b, v18
  v_mul_f32 v27, 0xbfb8aa3b, v19
  v_mul_f32 v28, 0xbfb8aa3b, v20
  v_mul_f32 v29, 0xbfb8aa3b, v21
  v_mul_f32 v30, 0xbfb8aa3b, v22
  v_mul_f32 v31, 0xbfb8aa3b, v23
  v_exp_f32 v24, v24
  v_exp_f32 v25, v25
  v_exp_f32 v26, v26
  v_exp_f32 v27, v27
  v_exp_f32 v28, v28
  v_exp_f32 v29, v29
  v_exp_f32 v30, v30
  v_exp_f32 v31, v31
  v_add_f32 v24, 1.0, v24
  v_add_f32 v25, 1.0, v25
  v_add_f32 v26, 1.0, v26
  v_add_f32 v27, 1.0, v27
  v_add_f32 v28, 1.0, v28
  v_add_f32 v29, 1.0, v29
  v_add_f32 v30, 1.0, v30
  v_add_f32 v31, 1.0, v31
  v_rcp_f32 v24, v24
  v_rcp_f32 v25, v25
  v_rcp_f32 v26, v26
  v_rcp_f32 v27, v27
  v_rcp_f32 v28, v28
  v_rcp_f32 v29, v29
  v_rcp_f32 v30, v30
  v_rcp_f32 v31, v31
  v_pk_mul_f32 v[16:17], v[16:17], v[60:61]
  v_pk_mul_f32 v[18:19], v[18:19], v[62:63]
  v_pk_mul_f32 v[20:21], v[20:21], v[64:65]
  v_pk_mul_f32 v[22:23], v[22:23], v[66:67]
  v_pk_mul_f32 v[16:17], v[16:17], v[24:25]
  v_pk_mul_f32 v[18:19], v[18:19], v[26:27]
  v_pk_mul_f32 v[20:21], v[20:21], v[28:29]
  v_pk_mul_f32 v[22:23], v[22:23], v[30:31]
  s_nop 1
  v_permlane16_swap_b32 v16, v20
  v_permlane16_swap_b32 v17, v21
  v_permlane16_swap_b32 v18, v22
  v_permlane16_swap_b32 v19, v23
  v_dot2c_f32_bf16 v16, s48, v88
  v_dot2c_f32_bf16 v17, s49, v88
  v_dot2c_f32_bf16 v18, s48, v89
  v_dot2c_f32_bf16 v19, s49, v89
  v_dot2c_f32_bf16 v20, s48, v90
  v_dot2c_f32_bf16 v21, s49, v90
  v_dot2c_f32_bf16 v22, s48, v91
  v_dot2c_f32_bf16 v23, s49, v91
  v_cvt_pk_bf16_f32 v24, v16, v17
  v_cvt_pk_bf16_f32 v25, v18, v19
  v_cvt_pk_bf16_f32 v26, v20, v21
  v_cvt_pk_bf16_f32 v27, v22, v23
  buffer_store_dwordx4 v[24:27], v10, s[32:35], s74 offen
L_a_j3:
  v_mov_b32 v247, 0
  buffer_atomic_or v247, v245, s[40:43], 0 offen sc0 sc1
  s_waitcnt vmcnt(13)
  v_lshlrev_b32 v16, 16, v112
  v_and_b32 v17, s3, v112
  v_lshlrev_b32 v18, 16, v113
  v_and_b32 v19, s3, v113
  v_lshlrev_b32 v20, 16, v114
  v_and_b32 v21, s3, v114
  v_lshlrev_b32 v22, 16, v115
  v_and_b32 v23, s3, v115
  s_waitcnt vmcnt(12)
  v_dot2c_f32_bf16 v16, s48, v116
  v_dot2c_f32_bf16 v17, s49, v116
  v_dot2c_f32_bf16 v18, s48, v117
  v_dot2c_f32_bf16 v19, s49, v117
  v_dot2c_f32_bf16 v20, s48, v118
  v_dot2c_f32_bf16 v21, s49, v118
  v_dot2c_f32_bf16 v22, s48, v119
  v_dot2c_f32_bf16 v23, s49, v119
  s_waitcnt vmcnt(11)
  v_dot2c_f32_bf16 v16, s48, v120
  v_dot2c_f32_bf16 v17, s49, v120
  v_dot2c_f32_bf16 v18, s48, v121
  v_dot2c_f32_bf16 v19, s49, v121
  v_dot2c_f32_bf16 v20, s48, v122
  v_dot2c_f32_bf16 v21, s49, v122
  v_dot2c_f32_bf16 v22, s48, v123
  v_dot2c_f32_bf16 v23, s49, v123
  s_waitcnt vmcnt(10)
  v_dot2c_f32_bf16 v16, s48, v124
  v_dot2c_f32_bf16 v17, s49, v124
  v_dot2c_f32_bf16 v18, s48, v125
  v_dot2c_f32_bf16 v19, s49, v125
  v_dot2c_f32_bf16 v20, s48, v126
  v_dot2c_f32_bf16 v21, s49, v126
  v_dot2c_f32_bf16 v22, s48, v127
  v_dot2c_f32_bf16 v23, s49, v127
  s_waitcnt vmcnt(9)
  v_dot2c_f32_bf16 v16, s48, v128
  v_dot2c_f32_bf16 v17, s49, v128
  v_dot2c_f32_bf16 v18, s48, v129
  v_dot2c_f32_bf16 v19, s49, v129
  v_dot2c_f32_bf16 v20, s48, v130
  v_dot2c_f32_bf16 v21, s49, v130
  v_dot2c_f32_bf16 v22, s48, v131
  v_dot2c_f32_bf16 v23, s49, v131
  s_waitcnt vmcnt(8)
  v_dot2c_f32_bf16 v16, s48, v132
  v_dot2c_f32_bf16 v17, s49, v132
  v_dot2c_f32_bf16 v18, s48, v133
  v_dot2c_f32_bf16 v19, s49, v133
  v_dot2c_f32_bf16 v20, s48, v134
  v_dot2c_f32_bf16 v21, s49, v134
  v_dot2c_f32_bf16 v22, s48, v135
  v_dot2c_f32_bf16 v23, s49, v135
  s_waitcnt vmcnt(7)
  v_dot2c_f32_bf16 v16, s48, v136
  v_dot2c_f32_bf16 v17, s49, v136
  v_dot2c_f32_bf16 v18, s48, v137
  v_dot2c_f32_bf16 v19, s49, v137
  v_dot2c_f32_bf16 v20, s48, v138
  v_dot2c_f32_bf16 v21, s49, v138
  v_dot2c_f32_bf16 v22, s48, v139
  v_dot2c_f32_bf16 v23, s49, v139
  s_waitcnt vmcnt(6)
  v_dot2c_f32_bf16 v16, s48, v140
  v_dot2c_f32_bf16 v17, s49, v140
  v_dot2c_f32_bf16 v18, s48, v141
  v_dot2c_f32_bf16 v19, s49, v141
  v_dot2c_f32_bf16 v20, s48, v142
  v_dot2c_f32_bf16 v21, s49, v142
  v_dot2c_f32_bf16 v22, s48, v143
  v_dot2c_f32_bf16 v23, s49, v143
  s_waitcnt vmcnt(5)
  v_dot2c_f32_bf16 v16, s48, v144
  v_dot2c_f32_bf16 v17, s49, v144
  v_dot2c_f32_bf16 v18, s48, v145
  v_dot2c_f32_bf16 v19, s49, v145
  v_dot2c_f32_bf16 v20, s48, v146
  v_dot2c_f32_bf16 v21, s49, v146
  v_dot2c_f32_bf16 v22, s48, v147
  v_dot2c_f32_bf16 v23, s49, v147
  s_waitcnt vmcnt(4)
  v_dot2c_f32_bf16 v16, s48, v148
  v_dot2c_f32_bf16 v17, s49, v148
  v_dot2c_f32_bf16 v18, s48, v149
  v_dot2c_f32_bf16 v19, s49, v149
  v_dot2c_f32_bf16 v20, s48, v150
  v_dot2c_f32_bf16 v21, s49, v150
  v_dot2c_f32_bf16 v22, s48, v151
  v_dot2c_f32_bf16 v23, s49, v151
  s_waitcnt vmcnt(3)
  v_dot2c_f32_bf16 v16, s48, v152
  v_dot2c_f32_bf16 v17, s49, v152
  v_dot2c_f32_bf16 v18, s48, v153
  v_dot2c_f32_bf16 v19, s49, v153
  v_dot2c_f32_bf16 v20, s48, v154
  v_dot2c_f32_bf16 v21, s49, v154
  v_dot2c_f32_bf16 v22, s48, v155
  v_dot2c_f32_bf16 v23, s49, v155
  s_waitcnt vmcnt(2)
  v_dot2c_f32_bf16 v16, s48, v156
  v_dot2c_f32_bf16 v17, s49, v156
  v_dot2c_f32_bf16 v18, s48, v157
  v_dot2c_f32_bf16 v19, s49, v157
  v_dot2c_f32_bf16 v20, s48, v158
  v_dot2c_f32_bf16 v21, s49, v158
  v_dot2c_f32_bf16 v22, s48, v159
  v_dot2c_f32_bf16 v23, s49, v159
  s_nop 0
  v_mul_f32 v24, 0xbfb8aa3b, v16
  v_mul_f32 v25, 0xbfb8aa3b, v17
  v_mul_f32 v26, 0xbfb8aa3b, v18
  v_mul_f32 v27, 0xbfb8aa3b, v19
  v_mul_f32 v28, 0xbfb8aa3b, v20
  v_mul_f32 v29, 0xbfb8aa3b, v21
  v_mul_f32 v30, 0xbfb8aa3b, v22
  v_mul_f32 v31, 0xbfb8aa3b, v23
  v_exp_f32 v24, v24
  v_exp_f32 v25, v25
  v_exp_f32 v26, v26
  v_exp_f32 v27, v27
  v_exp_f32 v28, v28
  v_exp_f32 v29, v29
  v_exp_f32 v30, v30
  v_exp_f32 v31, v31
  v_add_f32 v24, 1.0, v24
  v_add_f32 v25, 1.0, v25
  v_add_f32 v26, 1.0, v26
  v_add_f32 v27, 1.0, v27
  v_add_f32 v28, 1.0, v28
  v_add_f32 v29, 1.0, v29
  v_add_f32 v30, 1.0, v30
  v_add_f32 v31, 1.0, v31
  v_rcp_f32 v24, v24
  v_rcp_f32 v25, v25
  v_rcp_f32 v26, v26
  v_rcp_f32 v27, v27
  v_rcp_f32 v28, v28
  v_rcp_f32 v29, v29
  v_rcp_f32 v30, v30
  v_rcp_f32 v31, v31
  v_pk_mul_f32 v[16:17], v[16:17], v[68:69]
  v_pk_mul_f32 v[18:19], v[18:19], v[70:71]
  v_pk_mul_f32 v[20:21], v[20:21], v[72:73]
  v_pk_mul_f32 v[22:23], v[22:23], v[74:75]
  v_pk_mul_f32 v[16:17], v[16:17], v[24:25]
  v_pk_mul_f32 v[18:19], v[18:19], v[26:27]
  v_pk_mul_f32 v[20:21], v[20:21], v[28:29]
  v_pk_mul_f32 v[22:23], v[22:23], v[30:31]
  s_nop 1
  v_permlane16_swap_b32 v16, v20
  v_permlane16_swap_b32 v17, v21
  v_permlane16_swap_b32 v18, v22
  v_permlane16_swap_b32 v19, v23
  v_dot2c_f32_bf16 v16, s48, v92
  v_dot2c_f32_bf16 v17, s49, v92
  v_dot2c_f32_bf16 v18, s48, v93
  v_dot2c_f32_bf16 v19, s49, v93
  v_dot2c_f32_bf16 v20, s48, v94
  v_dot2c_f32_bf16 v21, s49, v94
  v_dot2c_f32_bf16 v22, s48, v95
  v_dot2c_f32_bf16 v23, s49, v95
  v_cvt_pk_bf16_f32 v24, v16, v17
  v_cvt_pk_bf16_f32 v25, v18, v19
  v_cvt_pk_bf16_f32 v26, v20, v21
  v_cvt_pk_bf16_f32 v27, v22, v23
  buffer_store_dwordx4 v[24:27], v10, s[32:35], s75 offen
  s_waitcnt vmcnt(1)
  s_mov_b32 s70, 0
L_a_qe:
  v_cmp_lt_u32 vcc, v247, v246
  s_add_u32 s70, s70, 1
  s_cmp_ge_u32 s70, 200000
  s_cbranch_scc1 L_a_qe_x
  s_and_b32 s59, vcc_lo, 608
  s_cbranch_scc0 L_a_qe_x
  v_mov_b32 v247, 0
  buffer_atomic_or v247, v245, s[40:43], 0 offen sc0 sc1
  s_waitcnt vmcnt(0)
  s_branch L_a_qe
L_a_qe_x:
  buffer_load_dword v252, v244, s[40:43], s85 offen sc1
  buffer_load_dword v253, v244, s[40:43], s86 offen sc1
  buffer_load_dword v254, v244, s[40:43], s87 offen sc1
  buffer_load_dword v255, v244, s[40:43], s88 offen sc1
  v_writelane_b32 v245, -16, 9
  buffer_load_dwordx4 v[112:115], v240, s[40:43], s64 offen sc1
  buffer_load_dwordx4 v[116:119], v241, s[40:43], s64 offen sc1
  buffer_load_dwordx4 v[120:123], v242, s[40:43], s64 offen sc1
  buffer_load_dwordx4 v[124:127], v240, s[40:43], s65 offen sc1
  buffer_load_dwordx4 v[128:131], v241, s[40:43], s65 offen sc1
  buffer_load_dwordx4 v[132:135], v242, s[40:43], s65 offen sc1
  v_mov_b32 v247, 0
  buffer_atomic_or v247, v245, s[40:43], 0 offen sc0 sc1
  s_waitcnt vmcnt(0)
  v_cmp_lt_u32 vcc, v247, v246
  s_nop 1
  s_and_b32 s59, vcc_lo, 0x180
  s_cbranch_scc1 L_a_wait
  buffer_load_dwordx4 v[136:139], v240, s[40:43], s66 offen sc1
  buffer_load_dwordx4 v[140:143], v241, s[40:43], s66 offen sc1
  buffer_load_dwordx4 v[144:147], v242, s[40:43], s66 offen sc1
  buffer_load_dwordx4 v[148:151], v240, s[40:43], s67 offen sc1
  buffer_load_dwordx4 v[152:155], v241, s[40:43], s67 offen sc1
  buffer_load_dwordx4 v[156:159], v242, s[40:43], s67 offen sc1
  s_nop 0
  v_lshlrev_b32 v16, 16, v112
  v_and_b32 v17, s3, v112
  v_lshlrev_b32 v18, 16, v113
  v_and_b32 v19, s3, v113
  v_lshlrev_b32 v20, 16, v114
  v_and_b32 v21, s3, v114
  v_lshlrev_b32 v22, 16, v115
  v_and_b32 v23, s3, v115
  s_nop 0
  v_dot2c_f32_bf16 v16, s48, v116
  v_dot2c_f32_bf16 v17, s49, v116
  v_dot2c_f32_bf16 v18, s48, v117
  v_dot2c_f32_bf16 v19, s49, v117
  v_dot2c_f32_bf16 v20, s48, v118
  v_dot2c_f32_bf16 v21, s49, v118
  v_dot2c_f32_bf16 v22, s48, v119
  v_dot2c_f32_bf16 v23, s49, v119
  s_nop 0
  v_dot2c_f32_bf16 v16, s48, v120
  v_dot2c_f32_bf16 v17, s49, v120
  v_dot2c_f32_bf16 v18, s48, v121
  v_dot2c_f32_bf16 v19, s49, v121
  v_dot2c_f32_bf16 v20, s48, v122
  v_dot2c_f32_bf16 v21, s49, v122
  v_dot2c_f32_bf16 v22, s48, v123
  v_dot2c_f32_bf16 v23, s49, v123
  s_nop 0
  v_lshlrev_b32 v24, 16, v124
  v_and_b32 v25, s3, v124
  v_lshlrev_b32 v26, 16, v125
  v_and_b32 v27, s3, v125
  v_lshlrev_b32 v28, 16, v126
  v_and_b32 v29, s3, v126
  v_lshlrev_b32 v30, 16, v127
  v_and_b32 v31, s3, v127
  s_nop 0
  v_dot2c_f32_bf16 v24, s48, v128
  v_dot2c_f32_bf16 v25, s49, v128
  v_dot2c_f32_bf16 v26, s48, v129
  v_dot2c_f32_bf16 v27, s49, v129
  v_dot2c_f32_bf16 v28, s48, v130
  v_dot2c_f32_bf16 v29, s49, v130
  v_dot2c_f32_bf16 v30, s48, v131
  v_dot2c_f32_bf16 v31, s49, v131
  s_nop 0
  v_dot2c_f32_bf16 v24, s48, v132
  v_dot2c_f32_bf16 v25, s49, v132
  v_dot2c_f32_bf16 v26, s48, v133
  v_dot2c_f32_bf16 v27, s49, v133
  v_dot2c_f32_bf16 v28, s48, v134
  v_dot2c_f32_bf16 v29, s49, v134
  v_dot2c_f32_bf16 v30, s48, v135
  v_dot2c_f32_bf16 v31, s49, v135
  v_permlane32_swap_b32 v16, v20
  v_permlane32_swap_b32 v17, v21
  v_permlane32_swap_b32 v18, v22
  v_permlane32_swap_b32 v19, v23
  v_add_f32 v16, v16, v20
  v_add_f32 v17, v17, v21
  v_add_f32 v18, v18, v22
  v_add_f32 v19, v19, v23
  v_permlane32_swap_b32 v24, v28
  v_permlane32_swap_b32 v25, v29
  v_permlane32_swap_b32 v26, v30
  v_permlane32_swap_b32 v27, v31
  v_add_f32 v24, v24, v28
  v_add_f32 v25, v25, v29
  v_add_f32 v26, v26, v30
  v_add_f32 v27, v27, v31
  v_permlane16_swap_b32 v16, v18
  v_permlane16_swap_b32 v17, v19
  v_add_f32 v16, v16, v18
  v_add_f32 v17, v17, v19
  v_permlane16_swap_b32 v24, v26
  v_permlane16_swap_b32 v25, v27
  v_add_f32 v24, v24, v26
  v_add_f32 v25, v25, v27
  v_mul_f32 v18, 0xbfb8aa3b, v16
  v_mul_f32 v19, 0xbfb8aa3b, v17
  v_exp_f32 v18, v18
  v_exp_f32 v19, v19
  v_lshlrev_b32 v20, 16, v252
  v_and_b32 v21, s3, v252
  v_add_f32 v18, 1.0, v18
  v_add_f32 v19, 1.0, v19
  v_rcp_f32 v18, v18
  v_rcp_f32 v19, v19
  v_mul_f32 v16, v16, v20
  v_mul_f32 v17, v17, v21
  v_lshlrev_b32 v22, 16, v248
  v_and_b32 v23, s3, v248
  v_fmac_f32 v22, v16, v18
  v_fmac_f32 v23, v17, v19
  v_cvt_pk_bf16_f32 v248, v22, v23
  buffer_store_dword v248, v243, s[32:35], s85 offen
  v_mul_f32 v26, 0xbfb8aa3b, v24
  v_mul_f32 v27, 0xbfb8aa3b, v25
  v_exp_f32 v26, v26
  v_exp_f32 v27, v27
  v_lshlrev_b32 v28, 16, v253
  v_and_b32 v29, s3, v253
  v_add_f32 v26, 1.0, v26
  v_add_f32 v27, 1.0, v27
  v_rcp_f32 v26, v26
  v_rcp_f32 v27, v27
  v_mul_f32 v24, v24, v28
  v_mul_f32 v25, v25, v29
  v_lshlrev_b32 v30, 16, v249
  v_and_b32 v31, s3, v249
  v_fmac_f32 v30, v24, v26
  v_fmac_f32 v31, v25, v27
  v_cvt_pk_bf16_f32 v249, v30, v31
  buffer_store_dword v249, v243, s[32:35], s86 offen
  s_waitcnt vmcnt(7)
  v_lshlrev_b32 v16, 16, v136
  v_and_b32 v17, s3, v136
  v_lshlrev_b32 v18, 16, v137
  v_and_b32 v19, s3, v137
  v_lshlrev_b32 v20, 16, v138
  v_and_b32 v21, s3, v138
  v_lshlrev_b32 v22, 16, v139
  v_and_b32 v23, s3, v139
  s_waitcnt vmcnt(6)
  v_dot2c_f32_bf16 v16, s48, v140
  v_dot2c_f32_bf16 v17, s49, v140
  v_dot2c_f32_bf16 v18, s48, v141
  v_dot2c_f32_bf16 v19, s49, v141
  v_dot2c_f32_bf16 v20, s48, v142
  v_dot2c_f32_bf16 v21, s49, v142
  v_dot2c_f32_bf16 v22, s48, v143
  v_dot2c_f32_bf16 v23, s49, v143
  s_waitcnt vmcnt(5)
  v_dot2c_f32_bf16 v16, s48, v144
  v_dot2c_f32_bf16 v17, s49, v144
  v_dot2c_f32_bf16 v18, s48, v145
  v_dot2c_f32_bf16 v19, s49, v145
  v_dot2c_f32_bf16 v20, s48, v146
  v_dot2c_f32_bf16 v21, s49, v146
  v_dot2c_f32_bf16 v22, s48, v147
  v_dot2c_f32_bf16 v23, s49, v147
  s_waitcnt vmcnt(4)
  v_lshlrev_b32 v24, 16, v148
  v_and_b32 v25, s3, v148
  v_lshlrev_b32 v26, 16, v149
  v_and_b32 v27, s3, v149
  v_lshlrev_b32 v28, 16, v150
  v_and_b32 v29, s3, v150
  v_lshlrev_b32 v30, 16, v151
  v_and_b32 v31, s3, v151
  s_waitcnt vmcnt(3)
  v_dot2c_f32_bf16 v24, s48, v152
  v_dot2c_f32_bf16 v25, s49, v152
  v_dot2c_f32_bf16 v26, s48, v153
  v_dot2c_f32_bf16 v27, s49, v153
  v_dot2c_f32_bf16 v28, s48, v154
  v_dot2c_f32_bf16 v29, s49, v154
  v_dot2c_f32_bf16 v30, s48, v155
  v_dot2c_f32_bf16 v31, s49, v155
  s_waitcnt vmcnt(2)
  v_dot2c_f32_bf16 v24, s48, v156
  v_dot2c_f32_bf16 v25, s49, v156
  v_dot2c_f32_bf16 v26, s48, v157
  v_dot2c_f32_bf16 v27, s49, v157
  v_dot2c_f32_bf16 v28, s48, v158
  v_dot2c_f32_bf16 v29, s49, v158
  v_dot2c_f32_bf16 v30, s48, v159
  v_dot2c_f32_bf16 v31, s49, v159
  v_permlane32_swap_b32 v16, v20
  v_permlane32_swap_b32 v17, v21
  v_permlane32_swap_b32 v18, v22
  v_permlane32_swap_b32 v19, v23
  v_add_f32 v16, v16, v20
  v_add_f32 v17, v17, v21
  v_add_f32 v18, v18, v22
  v_add_f32 v19, v19, v23
  v_permlane32_swap_b32 v24, v28
  v_permlane32_swap_b32 v25, v29
  v_permlane32_swap_b32 v26, v30
  v_permlane32_swap_b32 v27, v31
  v_add_f32 v24, v24, v28
  v_add_f32 v25, v25, v29
  v_add_f32 v26, v26, v30
  v_add_f32 v27, v27, v31
  v_permlane16_swap_b32 v16, v18
  v_permlane16_swap_b32 v17, v19
  v_add_f32 v16, v16, v18
  v_add_f32 v17, v17, v19
  v_permlane16_swap_b32 v24, v26
  v_permlane16_swap_b32 v25, v27
  v_add_f32 v24, v24, v26
  v_add_f32 v25, v25, v27
  v_mul_f32 v18, 0xbfb8aa3b, v16
  v_mul_f32 v19, 0xbfb8aa3b, v17
  v_exp_f32 v18, v18
  v_exp_f32 v19, v19
  v_lshlrev_b32 v20, 16, v254
  v_and_b32 v21, s3, v254
  v_add_f32 v18, 1.0, v18
  v_add_f32 v19, 1.0, v19
  v_rcp_f32 v18, v18
  v_rcp_f32 v19, v19
  v_mul_f32 v16, v16, v20
  v_mul_f32 v17, v17, v21
  v_lshlrev_b32 v22, 16, v250
  v_and_b32 v23, s3, v250
  v_fmac_f32 v22, v16, v18
  v_fmac_f32 v23, v17, v19
  v_cvt_pk_bf16_f32 v250, v22, v23
  buffer_store_dword v250, v243, s[32:35], s87 offen
  v_mul_f32 v26, 0xbfb8aa3b, v24
  v_mul_f32 v27, 0xbfb8aa3b, v25
  v_exp_f32 v26, v26
  v_exp_f32 v27, v27
  v_lshlrev_b32 v28, 16, v255
  v_and_b32 v29, s3, v255
  v_add_f32 v26, 1.0, v26
  v_add_f32 v27, 1.0, v27
  v_rcp_f32 v26, v26
  v_rcp_f32 v27, v27
  v_mul_f32 v24, v24, v28
  v_mul_f32 v25, v25, v29
  v_lshlrev_b32 v30, 16, v251
  v_and_b32 v31, s3, v251
  v_fmac_f32 v30, v24, v26
  v_fmac_f32 v31, v25, v27
  v_cvt_pk_bf16_f32 v251, v30, v31
  buffer_store_dword v251, v243, s[32:35], s88 offen
L_a_done:
  s_endpgm
L_a_w0:
  s_waitcnt vmcnt(11)
  v_lshlrev_b32 v16, 16, v112
  v_and_b32 v17, s3, v112
  v_lshlrev_b32 v18, 16, v113
  v_and_b32 v19, s3, v113
  v_lshlrev_b32 v20, 16, v114
  v_and_b32 v21, s3, v114
  v_lshlrev_b32 v22, 16, v115
  v_and_b32 v23, s3, v115
  s_waitcnt vmcnt(10)
  v_dot2c_f32_bf16 v16, s48, v116
  v_dot2c_f32_bf16 v17, s49, v116
  v_dot2c_f32_bf16 v18, s48, v117
  v_dot2c_f32_bf16 v19, s49, v117
  v_dot2c_f32_bf16 v20, s48, v118
  v_dot2c_f32_bf16 v21, s49, v118
  v_dot2c_f32_bf16 v22, s48, v119
  v_dot2c_f32_bf16 v23, s49, v119
  s_waitcnt vmcnt(9)
  v_dot2c_f32_bf16 v16, s48, v120
  v_dot2c_f32_bf16 v17, s49, v120
  v_dot2c_f32_bf16 v18, s48, v121
  v_dot2c_f32_bf16 v19, s49, v121
  v_dot2c_f32_bf16 v20, s48, v122
  v_dot2c_f32_bf16 v21, s49, v122
  v_dot2c_f32_bf16 v22, s48, v123
  v_dot2c_f32_bf16 v23, s49, v123
  s_waitcnt vmcnt(8)
  v_dot2c_f32_bf16 v16, s48, v124
  v_dot2c_f32_bf16 v17, s49, v124
  v_dot2c_f32_bf16 v18, s48, v125
  v_dot2c_f32_bf16 v19, s49, v125
  v_dot2c_f32_bf16 v20, s48, v126
  v_dot2c_f32_bf16 v21, s49, v126
  v_dot2c_f32_bf16 v22, s48, v127
  v_dot2c_f32_bf16 v23, s49, v127
  s_waitcnt vmcnt(7)
  v_dot2c_f32_bf16 v16, s48, v128
  v_dot2c_f32_bf16 v17, s49, v128
  v_dot2c_f32_bf16 v18, s48, v129
  v_dot2c_f32_bf16 v19, s49, v129
  v_dot2c_f32_bf16 v20, s48, v130
  v_dot2c_f32_bf16 v21, s49, v130
  v_dot2c_f32_bf16 v22, s48, v131
  v_dot2c_f32_bf16 v23, s49, v131
  s_waitcnt vmcnt(6)
  v_dot2c_f32_bf16 v16, s48, v132
  v_dot2c_f32_bf16 v17, s49, v132
  v_dot2c_f32_bf16 v18, s48, v133
  v_dot2c_f32_bf16 v19, s49, v133
  v_dot2c_f32_bf16 v20, s48, v134
  v_dot2c_f32_bf16 v21, s49, v134
  v_dot2c_f32_bf16 v22, s48, v135
  v_dot2c_f32_bf16 v23, s49, v135
  s_waitcnt vmcnt(5)
  v_dot2c_f32_bf16 v16, s48, v136
  v_dot2c_f32_bf16 v17, s49, v136
  v_dot2c_f32_bf16 v18, s48, v137
  v_dot2c_f32_bf16 v19, s49, v137
  v_dot2c_f32_bf16 v20, s48, v138
  v_dot2c_f32_bf16 v21, s49, v138
  v_dot2c_f32_bf16 v22, s48, v139
  v_dot2c_f32_bf16 v23, s49, v139
  s_waitcnt vmcnt(4)
  v_dot2c_f32_bf16 v16, s48, v140
  v_dot2c_f32_bf16 v17, s49, v140
  v_dot2c_f32_bf16 v18, s48, v141
  v_dot2c_f32_bf16 v19, s49, v141
  v_dot2c_f32_bf16 v20, s48, v142
  v_dot2c_f32_bf16 v21, s49, v142
  v_dot2c_f32_bf16 v22, s48, v143
  v_dot2c_f32_bf16 v23, s49, v143
  s_waitcnt vmcnt(3)
  v_dot2c_f32_bf16 v16, s48, v144
  v_dot2c_f32_bf16 v17, s49, v144
  v_dot2c_f32_bf16 v18, s48, v145
  v_dot2c_f32_bf16 v19, s49, v145
  v_dot2c_f32_bf16 v20, s48, v146
  v_dot2c_f32_bf16 v21, s49, v146
  v_dot2c_f32_bf16 v22, s48, v147
  v_dot2c_f32_bf16 v23, s49, v147
  s_waitcnt vmcnt(2)
  v_dot2c_f32_bf16 v16, s48, v148
  v_dot2c_f32_bf16 v17, s49, v148
  v_dot2c_f32_bf16 v18, s48, v149
  v_dot2c_f32_bf16 v19, s49, v149
  v_dot2c_f32_bf16 v20, s48, v150
  v_dot2c_f32_bf16 v21, s49, v150
  v_dot2c_f32_bf16 v22, s48, v151
  v_dot2c_f32_bf16 v23, s49, v151
  s_waitcnt vmcnt(1)
  v_dot2c_f32_bf16 v16, s48, v152
  v_dot2c_f32_bf16 v17, s49, v152
  v_dot2c_f32_bf16 v18, s48, v153
  v_dot2c_f32_bf16 v19, s49, v153
  v_dot2c_f32_bf16 v20, s48, v154
  v_dot2c_f32_bf16 v21, s49, v154
  v_dot2c_f32_bf16 v22, s48, v155
  v_dot2c_f32_bf16 v23, s49, v155
  s_waitcnt vmcnt(0)
  v_dot2c_f32_bf16 v16, s48, v156
  v_dot2c_f32_bf16 v17, s49, v156
  v_dot2c_f32_bf16 v18, s48, v157
  v_dot2c_f32_bf16 v19, s49, v157
  v_dot2c_f32_bf16 v20, s48, v158
  v_dot2c_f32_bf16 v21, s49, v158
  v_dot2c_f32_bf16 v22, s48, v159
  v_dot2c_f32_bf16 v23, s49, v159
  v_mov_b32 v13, 0
  buffer_atomic_or v13, v11, s[40:43], 0 offen sc0 sc1
  s_nop 0
  v_mul_f32 v24, 0xbfb8aa3b, v16
  v_mul_f32 v25, 0xbfb8aa3b, v17
  v_mul_f32 v26, 0xbfb8aa3b, v18
  v_mul_f32 v27, 0xbfb8aa3b, v19
  v_mul_f32 v28, 0xbfb8aa3b, v20
  v_mul_f32 v29, 0xbfb8aa3b, v21
  v_mul_f32 v30, 0xbfb8aa3b, v22
  v_mul_f32 v31, 0xbfb8aa3b, v23
  v_exp_f32 v24, v24
  v_exp_f32 v25, v25
  v_exp_f32 v26, v26
  v_exp_f32 v27, v27
  v_exp_f32 v28, v28
  v_exp_f32 v29, v29
  v_exp_f32 v30, v30
  v_exp_f32 v31, v31
  v_add_f32 v24, 1.0, v24
  v_add_f32 v25, 1.0, v25
  v_add_f32 v26, 1.0, v26
  v_add_f32 v27, 1.0, v27
  v_add_f32 v28, 1.0, v28
  v_add_f32 v29, 1.0, v29
  v_add_f32 v30, 1.0, v30
  v_add_f32 v31, 1.0, v31
  v_rcp_f32 v24, v24
  v_rcp_f32 v25, v25
  v_rcp_f32 v26, v26
  v_rcp_f32 v27, v27
  v_rcp_f32 v28, v28
  v_rcp_f32 v29, v29
  v_rcp_f32 v30, v30
  v_rcp_f32 v31, v31
  v_pk_mul_f32 v[16:17], v[16:17], v[36:37]
  v_pk_mul_f32 v[18:19], v[18:19], v[38:39]
  v_pk_mul_f32 v[20:21], v[20:21], v[40:41]
  v_pk_mul_f32 v[22:23], v[22:23], v[42:43]
  v_pk_mul_f32 v[16:17], v[16:17], v[24:25]
  v_pk_mul_f32 v[18:19], v[18:19], v[26:27]
  v_pk_mul_f32 v[20:21], v[20:21], v[28:29]
  v_pk_mul_f32 v[22:23], v[22:23], v[30:31]
  s_nop 1
  v_permlane16_swap_b32 v16, v20
  v_permlane16_swap_b32 v17, v21
  v_permlane16_swap_b32 v18, v22
  v_permlane16_swap_b32 v19, v23
  v_dot2c_f32_bf16 v16, s48, v76
  v_dot2c_f32_bf16 v17, s49, v76
  v_dot2c_f32_bf16 v18, s48, v77
  v_dot2c_f32_bf16 v19, s49, v77
  v_dot2c_f32_bf16 v20, s48, v78
  v_dot2c_f32_bf16 v21, s49, v78
  v_dot2c_f32_bf16 v22, s48, v79
  v_dot2c_f32_bf16 v23, s49, v79
  v_cvt_pk_bf16_f32 v24, v16, v17
  v_cvt_pk_bf16_f32 v25, v18, v19
  v_cvt_pk_bf16_f32 v26, v20, v21
  v_cvt_pk_bf16_f32 v27, v22, v23
  s_waitcnt vmcnt(0)
  s_mov_b32 s70, 0
L_a_s1:
  v_cmp_lt_u32 vcc, v13, v12
  s_add_u32 s70, s70, 1
  s_cmp_ge_u32 s70, 200000
  s_cbranch_scc1 L_a_s1_x
  s_and_b32 s59, vcc_lo, 2
  s_cbranch_scc0 L_a_s1_x
  s_sleep 4
  v_mov_b32 v13, 0
  buffer_atomic_or v13, v11, s[40:43], 0 offen sc0 sc1
  s_waitcnt vmcnt(0)
  s_branch L_a_s1
L_a_s1_x:
  v_mov_b32 v13, 0
  buffer_atomic_or v13, v11, s[40:43], 0 offen sc0 sc1
  buffer_load_dwordx4 v[160:163], v9, s[40:43], s12 offen offset:0 sc1
  buffer_load_dwordx4 v[164:167], v9, s[40:43], s12 offen offset:1024 sc1
  buffer_load_dwordx4 v[168:171], v9, s[40:43], s12 offen offset:2048 sc1
  buffer_load_dwordx4 v[172:175], v9, s[40:43], s12 offen offset:3072 sc1
  buffer_load_dwordx4 v[176:179], v9, s[40:43], s13 offen offset:0 sc1
  buffer_load_dwordx4 v[180:183], v9, s[40:43], s13 offen offset:1024 sc1
  buffer_load_dwordx4 v[184:187], v9, s[40:43], s13 offen offset:2048 sc1
  buffer_load_dwordx4 v[188:191], v9, s[40:43], s13 offen offset:3072 sc1
  buffer_load_dwordx4 v[192:195], v9, s[40:43], s14 offen offset:0 sc1
  buffer_load_dwordx4 v[196:199], v9, s[40:43], s14 offen offset:1024 sc1
  buffer_load_dwordx4 v[200:203], v9, s[40:43], s14 offen offset:2048 sc1
  buffer_load_dwordx4 v[204:207], v9, s[40:43], s14 offen offset:3072 sc1
  buffer_store_dwordx4 v[24:27], v10, s[32:35], s71 offen
  s_branch L_a_j0
L_a_w1:
  s_waitcnt vmcnt(12)
  v_lshlrev_b32 v16, 16, v160
  v_and_b32 v17, s3, v160
  v_lshlrev_b32 v18, 16, v161
  v_and_b32 v19, s3, v161
  v_lshlrev_b32 v20, 16, v162
  v_and_b32 v21, s3, v162
  v_lshlrev_b32 v22, 16, v163
  v_and_b32 v23, s3, v163
  s_waitcnt vmcnt(11)
  v_dot2c_f32_bf16 v16, s48, v164
  v_dot2c_f32_bf16 v17, s49, v164
  v_dot2c_f32_bf16 v18, s48, v165
  v_dot2c_f32_bf16 v19, s49, v165
  v_dot2c_f32_bf16 v20, s48, v166
  v_dot2c_f32_bf16 v21, s49, v166
  v_dot2c_f32_bf16 v22, s48, v167
  v_dot2c_f32_bf16 v23, s49, v167
  s_waitcnt vmcnt(10)
  v_dot2c_f32_bf16 v16, s48, v168
  v_dot2c_f32_bf16 v17, s49, v168
  v_dot2c_f32_bf16 v18, s48, v169
  v_dot2c_f32_bf16 v19, s49, v169
  v_dot2c_f32_bf16 v20, s48, v170
  v_dot2c_f32_bf16 v21, s49, v170
  v_dot2c_f32_bf16 v22, s48, v171
  v_dot2c_f32_bf16 v23, s49, v171
  s_waitcnt vmcnt(9)
  v_dot2c_f32_bf16 v16, s48, v172
  v_dot2c_f32_bf16 v17, s49, v172
  v_dot2c_f32_bf16 v18, s48, v173
  v_dot2c_f32_bf16 v19, s49, v173
  v_dot2c_f32_bf16 v20, s48, v174
  v_dot2c_f32_bf16 v21, s49, v174
  v_dot2c_f32_bf16 v22, s48, v175
  v_dot2c_f32_bf16 v23, s49, v175
  s_waitcnt vmcnt(8)
  v_dot2c_f32_bf16 v16, s48, v176
  v_dot2c_f32_bf16 v17, s49, v176
  v_dot2c_f32_bf16 v18, s48, v177
  v_dot2c_f32_bf16 v19, s49, v177
  v_dot2c_f32_bf16 v20, s48, v178
  v_dot2c_f32_bf16 v21, s49, v178
  v_dot2c_f32_bf16 v22, s48, v179
  v_dot2c_f32_bf16 v23, s49, v179
  s_waitcnt vmcnt(7)
  v_dot2c_f32_bf16 v16, s48, v180
  v_dot2c_f32_bf16 v17, s49, v180
  v_dot2c_f32_bf16 v18, s48, v181
  v_dot2c_f32_bf16 v19, s49, v181
  v_dot2c_f32_bf16 v20, s48, v182
  v_dot2c_f32_bf16 v21, s49, v182
  v_dot2c_f32_bf16 v22, s48, v183
  v_dot2c_f32_bf16 v23, s49, v183
  s_waitcnt vmcnt(6)
  v_dot2c_f32_bf16 v16, s48, v184
  v_dot2c_f32_bf16 v17, s49, v184
  v_dot2c_f32_bf16 v18, s48, v185
  v_dot2c_f32_bf16 v19, s49, v185
  v_dot2c_f32_bf16 v20, s48, v186
  v_dot2c_f32_bf16 v21, s49, v186
  v_dot2c_f32_bf16 v22, s48, v187
  v_dot2c_f32_bf16 v23, s49, v187
  s_waitcnt vmcnt(5)
  v_dot2c_f32_bf16 v16, s48, v188
  v_dot2c_f32_bf16 v17, s49, v188
  v_dot2c_f32_bf16 v18, s48, v189
  v_dot2c_f32_bf16 v19, s49, v189
  v_dot2c_f32_bf16 v20, s48, v190
  v_dot2c_f32_bf16 v21, s49, v190
  v_dot2c_f32_bf16 v22, s48, v191
  v_dot2c_f32_bf16 v23, s49, v191
  s_waitcnt vmcnt(4)
  v_dot2c_f32_bf16 v16, s48, v192
  v_dot2c_f32_bf16 v17, s49, v192
  v_dot2c_f32_bf16 v18, s48, v193
  v_dot2c_f32_bf16 v19, s49, v193
  v_dot2c_f32_bf16 v20, s48, v194
  v_dot2c_f32_bf16 v21, s49, v194
  v_dot2c_f32_bf16 v22, s48, v195
  v_dot2c_f32_bf16 v23, s49, v195
  s_waitcnt vmcnt(3)
  v_dot2c_f32_bf16 v16, s48, v196
  v_dot2c_f32_bf16 v17, s49, v196
  v_dot2c_f32_bf16 v18, s48, v197
  v_dot2c_f32_bf16 v19, s49, v197
  v_dot2c_f32_bf16 v20, s48, v198
  v_dot2c_f32_bf16 v21, s49, v198
  v_dot2c_f32_bf16 v22, s48, v199
  v_dot2c_f32_bf16 v23, s49, v199
  s_waitcnt vmcnt(2)
  v_dot2c_f32_bf16 v16, s48, v200
  v_dot2c_f32_bf16 v17, s49, v200
  v_dot2c_f32_bf16 v18, s48, v201
  v_dot2c_f32_bf16 v19, s49, v201
  v_dot2c_f32_bf16 v20, s48, v202
  v_dot2c_f32_bf16 v21, s49, v202
  v_dot2c_f32_bf16 v22, s48, v203
  v_dot2c_f32_bf16 v23, s49, v203
  s_waitcnt vmcnt(1)
  v_dot2c_f32_bf16 v16, s48, v204
  v_dot2c_f32_bf16 v17, s49, v204
  v_dot2c_f32_bf16 v18, s48, v205
  v_dot2c_f32_bf16 v19, s49, v205
  v_dot2c_f32_bf16 v20, s48, v206
  v_dot2c_f32_bf16 v21, s49, v206
  v_dot2c_f32_bf16 v22, s48, v207
  v_dot2c_f32_bf16 v23, s49, v207
  v_mov_b32 v13, 0
  buffer_atomic_or v13, v11, s[40:43], 0 offen sc0 sc1
  s_nop 0
  v_mul_f32 v24, 0xbfb8aa3b, v16
  v_mul_f32 v25, 0xbfb8aa3b, v17
  v_mul_f32 v26, 0xbfb8aa3b, v18
  v_mul_f32 v27, 0xbfb8aa3b, v19
  v_mul_f32 v28, 0xbfb8aa3b, v20
  v_mul_f32 v29, 0xbfb8aa3b, v21
  v_mul_f32 v30, 0xbfb8aa3b, v22
  v_mul_f32 v31, 0xbfb8aa3b, v23
  v_exp_f32 v24, v24
  v_exp_f32 v25, v25
  v_exp_f32 v26, v26
  v_exp_f32 v27, v27
  v_exp_f32 v28, v28
  v_exp_f32 v29, v29
  v_exp_f32 v30, v30
  v_exp_f32 v31, v31
  v_add_f32 v24, 1.0, v24
  v_add_f32 v25, 1.0, v25
  v_add_f32 v26, 1.0, v26
  v_add_f32 v27, 1.0, v27
  v_add_f32 v28, 1.0, v28
  v_add_f32 v29, 1.0, v29
  v_add_f32 v30, 1.0, v30
  v_add_f32 v31, 1.0, v31
  v_rcp_f32 v24, v24
  v_rcp_f32 v25, v25
  v_rcp_f32 v26, v26
  v_rcp_f32 v27, v27
  v_rcp_f32 v28, v28
  v_rcp_f32 v29, v29
  v_rcp_f32 v30, v30
  v_rcp_f32 v31, v31
  v_pk_mul_f32 v[16:17], v[16:17], v[44:45]
  v_pk_mul_f32 v[18:19], v[18:19], v[46:47]
  v_pk_mul_f32 v[20:21], v[20:21], v[48:49]
  v_pk_mul_f32 v[22:23], v[22:23], v[50:51]
  v_pk_mul_f32 v[16:17], v[16:17], v[24:25]
  v_pk_mul_f32 v[18:19], v[18:19], v[26:27]
  v_pk_mul_f32 v[20:21], v[20:21], v[28:29]
  v_pk_mul_f32 v[22:23], v[22:23], v[30:31]
  s_nop 1
  v_permlane16_swap_b32 v16, v20
  v_permlane16_swap_b32 v17, v21
  v_permlane16_swap_b32 v18, v22
  v_permlane16_swap_b32 v19, v23
  v_dot2c_f32_bf16 v16, s48, v80
  v_dot2c_f32_bf16 v17, s49, v80
  v_dot2c_f32_bf16 v18, s48, v81
  v_dot2c_f32_bf16 v19, s49, v81
  v_dot2c_f32_bf16 v20, s48, v82
  v_dot2c_f32_bf16 v21, s49, v82
  v_dot2c_f32_bf16 v22, s48, v83
  v_dot2c_f32_bf16 v23, s49, v83
  v_cvt_pk_bf16_f32 v24, v16, v17
  v_cvt_pk_bf16_f32 v25, v18, v19
  v_cvt_pk_bf16_f32 v26, v20, v21
  v_cvt_pk_bf16_f32 v27, v22, v23
  s_waitcnt vmcnt(0)
  s_mov_b32 s70, 0
L_a_s2:
  v_cmp_lt_u32 vcc, v13, v12
  s_add_u32 s70, s70, 1
  s_cmp_ge_u32 s70, 200000
  s_cbranch_scc1 L_a_s2_x
  s_and_b32 s59, vcc_lo, 4
  s_cbranch_scc0 L_a_s2_x
  s_sleep 4
  v_mov_b32 v13, 0
  buffer_atomic_or v13, v11, s[40:43], 0 offen sc0 sc1
  s_waitcnt vmcnt(0)
  s_branch L_a_s2
L_a_s2_x:
  v_mov_b32 v13, 0
  buffer_atomic_or v13, v11, s[40:43], 0 offen sc0 sc1
  buffer_load_dwordx4 v[112:115], v9, s[40:43], s8 offen offset:0 sc1
  buffer_load_dwordx4 v[116:119], v9, s[40:43], s8 offen offset:1024 sc1
  buffer_load_dwordx4 v[120:123], v9, s[40:43], s8 offen offset:2048 sc1
  buffer_load_dwordx4 v[124:127], v9, s[40:43], s8 offen offset:3072 sc1
  buffer_load_dwordx4 v[128:131], v9, s[40:43], s9 offen offset:0 sc1
  buffer_load_dwordx4 v[132:135], v9, s[40:43], s9 offen offset:1024 sc1
  buffer_load_dwordx4 v[136:139], v9, s[40:43], s9 offen offset:2048 sc1
  buffer_load_dwordx4 v[140:143], v9, s[40:43], s9 offen offset:3072 sc1
  buffer_load_dwordx4 v[144:147], v9, s[40:43], s10 offen offset:0 sc1
  buffer_load_dwordx4 v[148:151], v9, s[40:43], s10 offen offset:1024 sc1
  buffer_load_dwordx4 v[152:155], v9, s[40:43], s10 offen offset:2048 sc1
  buffer_load_dwordx4 v[156:159], v9, s[40:43], s10 offen offset:3072 sc1
  buffer_store_dwordx4 v[24:27], v10, s[32:35], s72 offen
  s_branch L_a_j1
L_a_w2:
  s_waitcnt vmcnt(12)
  v_lshlrev_b32 v16, 16, v112
  v_and_b32 v17, s3, v112
  v_lshlrev_b32 v18, 16, v113
  v_and_b32 v19, s3, v113
  v_lshlrev_b32 v20, 16, v114
  v_and_b32 v21, s3, v114
  v_lshlrev_b32 v22, 16, v115
  v_and_b32 v23, s3, v115
  s_waitcnt vmcnt(11)
  v_dot2c_f32_bf16 v16, s48, v116
  v_dot2c_f32_bf16 v17, s49, v116
  v_dot2c_f32_bf16 v18, s48, v117
  v_dot2c_f32_bf16 v19, s49, v117
  v_dot2c_f32_bf16 v20, s48, v118
  v_dot2c_f32_bf16 v21, s49, v118
  v_dot2c_f32_bf16 v22, s48, v119
  v_dot2c_f32_bf16 v23, s49, v119
  s_waitcnt vmcnt(10)
  v_dot2c_f32_bf16 v16, s48, v120
  v_dot2c_f32_bf16 v17, s49, v120
  v_dot2c_f32_bf16 v18, s48, v121
  v_dot2c_f32_bf16 v19, s49, v121
  v_dot2c_f32_bf16 v20, s48, v122
  v_dot2c_f32_bf16 v21, s49, v122
  v_dot2c_f32_bf16 v22, s48, v123
  v_dot2c_f32_bf16 v23, s49, v123
  s_waitcnt vmcnt(9)
  v_dot2c_f32_bf16 v16, s48, v124
  v_dot2c_f32_bf16 v17, s49, v124
  v_dot2c_f32_bf16 v18, s48, v125
  v_dot2c_f32_bf16 v19, s49, v125
  v_dot2c_f32_bf16 v20, s48, v126
  v_dot2c_f32_bf16 v21, s49, v126
  v_dot2c_f32_bf16 v22, s48, v127
  v_dot2c_f32_bf16 v23, s49, v127
  s_waitcnt vmcnt(8)
  v_dot2c_f32_bf16 v16, s48, v128
  v_dot2c_f32_bf16 v17, s49, v128
  v_dot2c_f32_bf16 v18, s48, v129
  v_dot2c_f32_bf16 v19, s49, v129
  v_dot2c_f32_bf16 v20, s48, v130
  v_dot2c_f32_bf16 v21, s49, v130
  v_dot2c_f32_bf16 v22, s48, v131
  v_dot2c_f32_bf16 v23, s49, v131
  s_waitcnt vmcnt(7)
  v_dot2c_f32_bf16 v16, s48, v132
  v_dot2c_f32_bf16 v17, s49, v132
  v_dot2c_f32_bf16 v18, s48, v133
  v_dot2c_f32_bf16 v19, s49, v133
  v_dot2c_f32_bf16 v20, s48, v134
  v_dot2c_f32_bf16 v21, s49, v134
  v_dot2c_f32_bf16 v22, s48, v135
  v_dot2c_f32_bf16 v23, s49, v135
  s_waitcnt vmcnt(6)
  v_dot2c_f32_bf16 v16, s48, v136
  v_dot2c_f32_bf16 v17, s49, v136
  v_dot2c_f32_bf16 v18, s48, v137
  v_dot2c_f32_bf16 v19, s49, v137
  v_dot2c_f32_bf16 v20, s48, v138
  v_dot2c_f32_bf16 v21, s49, v138
  v_dot2c_f32_bf16 v22, s48, v139
  v_dot2c_f32_bf16 v23, s49, v139
  s_waitcnt vmcnt(5)
  v_dot2c_f32_bf16 v16, s48, v140
  v_dot2c_f32_bf16 v17, s49, v140
  v_dot2c_f32_bf16 v18, s48, v141
  v_dot2c_f32_bf16 v19, s49, v141
  v_dot2c_f32_bf16 v20, s48, v142
  v_dot2c_f32_bf16 v21, s49, v142
  v_dot2c_f32_bf16 v22, s48, v143
  v_dot2c_f32_bf16 v23, s49, v143
  s_waitcnt vmcnt(4)
  v_dot2c_f32_bf16 v16, s48, v144
  v_dot2c_f32_bf16 v17, s49, v144
  v_dot2c_f32_bf16 v18, s48, v145
  v_dot2c_f32_bf16 v19, s49, v145
  v_dot2c_f32_bf16 v20, s48, v146
  v_dot2c_f32_bf16 v21, s49, v146
  v_dot2c_f32_bf16 v22, s48, v147
  v_dot2c_f32_bf16 v23, s49, v147
  s_waitcnt vmcnt(3)
  v_dot2c_f32_bf16 v16, s48, v148
  v_dot2c_f32_bf16 v17, s49, v148
  v_dot2c_f32_bf16 v18, s48, v149
  v_dot2c_f32_bf16 v19, s49, v149
  v_dot2c_f32_bf16 v20, s48, v150
  v_dot2c_f32_bf16 v21, s49, v150
  v_dot2c_f32_bf16 v22, s48, v151
  v_dot2c_f32_bf16 v23, s49, v151
  s_waitcnt vmcnt(2)
  v_dot2c_f32_bf16 v16, s48, v152
  v_dot2c_f32_bf16 v17, s49, v152
  v_dot2c_f32_bf16 v18, s48, v153
  v_dot2c_f32_bf16 v19, s49, v153
  v_dot2c_f32_bf16 v20, s48, v154
  v_dot2c_f32_bf16 v21, s49, v154
  v_dot2c_f32_bf16 v22, s48, v155
  v_dot2c_f32_bf16 v23, s49, v155
  s_waitcnt vmcnt(1)
  v_dot2c_f32_bf16 v16, s48, v156
  v_dot2c_f32_bf16 v17, s49, v156
  v_dot2c_f32_bf16 v18, s48, v157
  v_dot2c_f32_bf16 v19, s49, v157
  v_dot2c_f32_bf16 v20, s48, v158
  v_dot2c_f32_bf16 v21, s49, v158
  v_dot2c_f32_bf16 v22, s48, v159
  v_dot2c_f32_bf16 v23, s49, v159
  v_mov_b32 v13, 0
  buffer_atomic_or v13, v11, s[40:43], 0 offen sc0 sc1
  s_nop 0
  v_mul_f32 v24, 0xbfb8aa3b, v16
  v_mul_f32 v25, 0xbfb8aa3b, v17
  v_mul_f32 v26, 0xbfb8aa3b, v18
  v_mul_f32 v27, 0xbfb8aa3b, v19
  v_mul_f32 v28, 0xbfb8aa3b, v20
  v_mul_f32 v29, 0xbfb8aa3b, v21
  v_mul_f32 v30, 0xbfb8aa3b, v22
  v_mul_f32 v31, 0xbfb8aa3b, v23
  v_exp_f32 v24, v24
  v_exp_f32 v25, v25
  v_exp_f32 v26, v26
  v_exp_f32 v27, v27
  v_exp_f32 v28, v28
  v_exp_f32 v29, v29
  v_exp_f32 v30, v30
  v_exp_f32 v31, v31
  v_add_f32 v24, 1.0, v24
  v_add_f32 v25, 1.0, v25
  v_add_f32 v26, 1.0, v26
  v_add_f32 v27, 1.0, v27
  v_add_f32 v28, 1.0, v28
  v_add_f32 v29, 1.0, v29
  v_add_f32 v30, 1.0, v30
  v_add_f32 v31, 1.0, v31
  v_rcp_f32 v24, v24
  v_rcp_f32 v25, v25
  v_rcp_f32 v26, v26
  v_rcp_f32 v27, v27
  v_rcp_f32 v28, v28
  v_rcp_f32 v29, v29
  v_rcp_f32 v30, v30
  v_rcp_f32 v31, v31
  v_pk_mul_f32 v[16:17], v[16:17], v[52:53]
  v_pk_mul_f32 v[18:19], v[18:19], v[54:55]
  v_pk_mul_f32 v[20:21], v[20:21], v[56:57]
  v_pk_mul_f32 v[22:23], v[22:23], v[58:59]
  v_pk_mul_f32 v[16:17], v[16:17], v[24:25]
  v_pk_mul_f32 v[18:19], v[18:19], v[26:27]
  v_pk_mul_f32 v[20:21], v[20:21], v[28:29]
  v_pk_mul_f32 v[22:23], v[22:23], v[30:31]
  s_nop 1
  v_permlane16_swap_b32 v16, v20
  v_permlane16_swap_b32 v17, v21
  v_permlane16_swap_b32 v18, v22
  v_permlane16_swap_b32 v19, v23
  v_dot2c_f32_bf16 v16, s48, v84
  v_dot2c_f32_bf16 v17, s49, v84
  v_dot2c_f32_bf16 v18, s48, v85
  v_dot2c_f32_bf16 v19, s49, v85
  v_dot2c_f32_bf16 v20, s48, v86
  v_dot2c_f32_bf16 v21, s49, v86
  v_dot2c_f32_bf16 v22, s48, v87
  v_dot2c_f32_bf16 v23, s49, v87
  v_cvt_pk_bf16_f32 v24, v16, v17
  v_cvt_pk_bf16_f32 v25, v18, v19
  v_cvt_pk_bf16_f32 v26, v20, v21
  v_cvt_pk_bf16_f32 v27, v22, v23
  s_waitcnt vmcnt(0)
  s_mov_b32 s70, 0
L_a_s3:
  v_cmp_lt_u32 vcc, v13, v12
  s_add_u32 s70, s70, 1
  s_cmp_ge_u32 s70, 200000
  s_cbranch_scc1 L_a_s3_x
  s_and_b32 s59, vcc_lo, 8
  s_cbranch_scc0 L_a_s3_x
  s_sleep 4
  v_mov_b32 v13, 0
  buffer_atomic_or v13, v11, s[40:43], 0 offen sc0 sc1
  s_waitcnt vmcnt(0)
  s_branch L_a_s3
L_a_s3_x:
  v_mov_b32 v13, 0
  buffer_atomic_or v13, v11, s[40:43], 0 offen sc0 sc1
  buffer_load_dwordx4 v[160:163], v9, s[40:43], s12 offen offset:0 sc1
  buffer_load_dwordx4 v[164:167], v9, s[40:43], s12 offen offset:1024 sc1
  buffer_load_dwordx4 v[168:171], v9, s[40:43], s12 offen offset:2048 sc1
  buffer_load_dwordx4 v[172:175], v9, s[40:43], s12 offen offset:3072 sc1
  buffer_load_dwordx4 v[176:179], v9, s[40:43], s13 offen offset:0 sc1
  buffer_load_dwordx4 v[180:183], v9, s[40:43], s13 offen offset:1024 sc1
  buffer_load_dwordx4 v[184:187], v9, s[40:43], s13 offen offset:2048 sc1
  buffer_load_dwordx4 v[188:191], v9, s[40:43], s13 offen offset:3072 sc1
  buffer_load_dwordx4 v[192:195], v9, s[40:43], s14 offen offset:0 sc1
  buffer_load_dwordx4 v[196:199], v9, s[40:43], s14 offen offset:1024 sc1
  buffer_load_dwordx4 v[200:203], v9, s[40:43], s14 offen offset:2048 sc1
  buffer_load_dwordx4 v[204:207], v9, s[40:43], s14 offen offset:3072 sc1
  buffer_store_dwordx4 v[24:27], v10, s[32:35], s73 offen
  s_branch L_a_j2
L_a_w3:
  s_waitcnt vmcnt(12)
  v_lshlrev_b32 v16, 16, v160
  v_and_b32 v17, s3, v160
  v_lshlrev_b32 v18, 16, v161
  v_and_b32 v19, s3, v161
  v_lshlrev_b32 v20, 16, v162
  v_and_b32 v21, s3, v162
  v_lshlrev_b32 v22, 16, v163
  v_and_b32 v23, s3, v163
  s_waitcnt vmcnt(11)
  v_dot2c_f32_bf16 v16, s48, v164
  v_dot2c_f32_bf16 v17, s49, v164
  v_dot2c_f32_bf16 v18, s48, v165
  v_dot2c_f32_bf16 v19, s49, v165
  v_dot2c_f32_bf16 v20, s48, v166
  v_dot2c_f32_bf16 v21, s49, v166
  v_dot2c_f32_bf16 v22, s48, v167
  v_dot2c_f32_bf16 v23, s49, v167
  s_waitcnt vmcnt(10)
  v_dot2c_f32_bf16 v16, s48, v168
  v_dot2c_f32_bf16 v17, s49, v168
  v_dot2c_f32_bf16 v18, s48, v169
  v_dot2c_f32_bf16 v19, s49, v169
  v_dot2c_f32_bf16 v20, s48, v170
  v_dot2c_f32_bf16 v21, s49, v170
  v_dot2c_f32_bf16 v22, s48, v171
  v_dot2c_f32_bf16 v23, s49, v171
  s_waitcnt vmcnt(9)
  v_dot2c_f32_bf16 v16, s48, v172
  v_dot2c_f32_bf16 v17, s49, v172
  v_dot2c_f32_bf16 v18, s48, v173
  v_dot2c_f32_bf16 v19, s49, v173
  v_dot2c_f32_bf16 v20, s48, v174
  v_dot2c_f32_bf16 v21, s49, v174
  v_dot2c_f32_bf16 v22, s48, v175
  v_dot2c_f32_bf16 v23, s49, v175
  s_waitcnt vmcnt(8)
  v_dot2c_f32_bf16 v16, s48, v176
  v_dot2c_f32_bf16 v17, s49, v176
  v_dot2c_f32_bf16 v18, s48, v177
  v_dot2c_f32_bf16 v19, s49, v177
  v_dot2c_f32_bf16 v20, s48, v178
  v_dot2c_f32_bf16 v21, s49, v178
  v_dot2c_f32_bf16 v22, s48, v179
  v_dot2c_f32_bf16 v23, s49, v179
  s_waitcnt vmcnt(7)
  v_dot2c_f32_bf16 v16, s48, v180
  v_dot2c_f32_bf16 v17, s49, v180
  v_dot2c_f32_bf16 v18, s48, v181
  v_dot2c_f32_bf16 v19, s49, v181
  v_dot2c_f32_bf16 v20, s48, v182
  v_dot2c_f32_bf16 v21, s49, v182
  v_dot2c_f32_bf16 v22, s48, v183
  v_dot2c_f32_bf16 v23, s49, v183
  s_waitcnt vmcnt(6)
  v_dot2c_f32_bf16 v16, s48, v184
  v_dot2c_f32_bf16 v17, s49, v184
  v_dot2c_f32_bf16 v18, s48, v185
  v_dot2c_f32_bf16 v19, s49, v185
  v_dot2c_f32_bf16 v20, s48, v186
  v_dot2c_f32_bf16 v21, s49, v186
  v_dot2c_f32_bf16 v22, s48, v187
  v_dot2c_f32_bf16 v23, s49, v187
  s_waitcnt vmcnt(5)
  v_dot2c_f32_bf16 v16, s48, v188
  v_dot2c_f32_bf16 v17, s49, v188
  v_dot2c_f32_bf16 v18, s48, v189
  v_dot2c_f32_bf16 v19, s49, v189
  v_dot2c_f32_bf16 v20, s48, v190
  v_dot2c_f32_bf16 v21, s49, v190
  v_dot2c_f32_bf16 v22, s48, v191
  v_dot2c_f32_bf16 v23, s49, v191
  s_waitcnt vmcnt(4)
  v_dot2c_f32_bf16 v16, s48, v192
  v_dot2c_f32_bf16 v17, s49, v192
  v_dot2c_f32_bf16 v18, s48, v193
  v_dot2c_f32_bf16 v19, s49, v193
  v_dot2c_f32_bf16 v20, s48, v194
  v_dot2c_f32_bf16 v21, s49, v194
  v_dot2c_f32_bf16 v22, s48, v195
  v_dot2c_f32_bf16 v23, s49, v195
  s_waitcnt vmcnt(3)
  v_dot2c_f32_bf16 v16, s48, v196
  v_dot2c_f32_bf16 v17, s49, v196
  v_dot2c_f32_bf16 v18, s48, v197
  v_dot2c_f32_bf16 v19, s49, v197
  v_dot2c_f32_bf16 v20, s48, v198
  v_dot2c_f32_bf16 v21, s49, v198
  v_dot2c_f32_bf16 v22, s48, v199
  v_dot2c_f32_bf16 v23, s49, v199
  s_waitcnt vmcnt(2)
  v_dot2c_f32_bf16 v16, s48, v200
  v_dot2c_f32_bf16 v17, s49, v200
  v_dot2c_f32_bf16 v18, s48, v201
  v_dot2c_f32_bf16 v19, s49, v201
  v_dot2c_f32_bf16 v20, s48, v202
  v_dot2c_f32_bf16 v21, s49, v202
  v_dot2c_f32_bf16 v22, s48, v203
  v_dot2c_f32_bf16 v23, s49, v203
  s_waitcnt vmcnt(1)
  v_dot2c_f32_bf16 v16, s48, v204
  v_dot2c_f32_bf16 v17, s49, v204
  v_dot2c_f32_bf16 v18, s48, v205
  v_dot2c_f32_bf16 v19, s49, v205
  v_dot2c_f32_bf16 v20, s48, v206
  v_dot2c_f32_bf16 v21, s49, v206
  v_dot2c_f32_bf16 v22, s48, v207
  v_dot2c_f32_bf16 v23, s49, v207
  v_mov_b32 v13, 0
  buffer_atomic_or v13, v11, s[40:43], 0 offen sc0 sc1
  s_nop 0
  v_mul_f32 v24, 0xbfb8aa3b, v16
  v_mul_f32 v25, 0xbfb8aa3b, v17
  v_mul_f32 v26, 0xbfb8aa3b, v18
  v_mul_f32 v27, 0xbfb8aa3b, v19
  v_mul_f32 v28, 0xbfb8aa3b, v20
  v_mul_f32 v29, 0xbfb8aa3b, v21
  v_mul_f32 v30, 0xbfb8aa3b, v22
  v_mul_f32 v31, 0xbfb8aa3b, v23
  v_exp_f32 v24, v24
  v_exp_f32 v25, v25
  v_exp_f32 v26, v26
  v_exp_f32 v27, v27
  v_exp_f32 v28, v28
  v_exp_f32 v29, v29
  v_exp_f32 v30, v30
  v_exp_f32 v31, v31
  v_add_f32 v24, 1.0, v24
  v_add_f32 v25, 1.0, v25
  v_add_f32 v26, 1.0, v26
  v_add_f32 v27, 1.0, v27
  v_add_f32 v28, 1.0, v28
  v_add_f32 v29, 1.0, v29
  v_add_f32 v30, 1.0, v30
  v_add_f32 v31, 1.0, v31
  v_rcp_f32 v24, v24
  v_rcp_f32 v25, v25
  v_rcp_f32 v26, v26
  v_rcp_f32 v27, v27
  v_rcp_f32 v28, v28
  v_rcp_f32 v29, v29
  v_rcp_f32 v30, v30
  v_rcp_f32 v31, v31
  v_pk_mul_f32 v[16:17], v[16:17], v[60:61]
  v_pk_mul_f32 v[18:19], v[18:19], v[62:63]
  v_pk_mul_f32 v[20:21], v[20:21], v[64:65]
  v_pk_mul_f32 v[22:23], v[22:23], v[66:67]
  v_pk_mul_f32 v[16:17], v[16:17], v[24:25]
  v_pk_mul_f32 v[18:19], v[18:19], v[26:27]
  v_pk_mul_f32 v[20:21], v[20:21], v[28:29]
  v_pk_mul_f32 v[22:23], v[22:23], v[30:31]
  s_nop 1
  v_permlane16_swap_b32 v16, v20
  v_permlane16_swap_b32 v17, v21
  v_permlane16_swap_b32 v18, v22
  v_permlane16_swap_b32 v19, v23
  v_dot2c_f32_bf16 v16, s48, v88
  v_dot2c_f32_bf16 v17, s49, v88
  v_dot2c_f32_bf16 v18, s48, v89
  v_dot2c_f32_bf16 v19, s49, v89
  v_dot2c_f32_bf16 v20, s48, v90
  v_dot2c_f32_bf16 v21, s49, v90
  v_dot2c_f32_bf16 v22, s48, v91
  v_dot2c_f32_bf16 v23, s49, v91
  v_cvt_pk_bf16_f32 v24, v16, v17
  v_cvt_pk_bf16_f32 v25, v18, v19
  v_cvt_pk_bf16_f32 v26, v20, v21
  v_cvt_pk_bf16_f32 v27, v22, v23
  s_waitcnt vmcnt(0)
  s_mov_b32 s70, 0
L_a_s4:
  v_cmp_lt_u32 vcc, v13, v12
  s_add_u32 s70, s70, 1
  s_cmp_ge_u32 s70, 200000
  s_cbranch_scc1 L_a_s4_x
  s_and_b32 s59, vcc_lo, 16
  s_cbranch_scc0 L_a_s4_x
  s_sleep 4
  v_mov_b32 v13, 0
  buffer_atomic_or v13, v11, s[40:43], 0 offen sc0 sc1
  s_waitcnt vmcnt(0)
  s_branch L_a_s4
L_a_s4_x:
  buffer_load_dwordx4 v[112:115], v9, s[40:43], s8 offen offset:0 sc1
  buffer_load_dwordx4 v[116:119], v9, s[40:43], s8 offen offset:1024 sc1
  buffer_load_dwordx4 v[120:123], v9, s[40:43], s8 offen offset:2048 sc1
  buffer_load_dwordx4 v[124:127], v9, s[40:43], s8 offen offset:3072 sc1
  buffer_load_dwordx4 v[128:131], v9, s[40:43], s9 offen offset:0 sc1
  buffer_load_dwordx4 v[132:135], v9, s[40:43], s9 offen offset:1024 sc1
  buffer_load_dwordx4 v[136:139], v9, s[40:43], s9 offen offset:2048 sc1
  buffer_load_dwordx4 v[140:143], v9, s[40:43], s9 offen offset:3072 sc1
  buffer_load_dwordx4 v[144:147], v9, s[40:43], s10 offen offset:0 sc1
  buffer_load_dwordx4 v[148:151], v9, s[40:43], s10 offen offset:1024 sc1
  buffer_load_dwordx4 v[152:155], v9, s[40:43], s10 offen offset:2048 sc1
  buffer_load_dwordx4 v[156:159], v9, s[40:43], s10 offen offset:3072 sc1
  buffer_store_dwordx4 v[24:27], v10, s[32:35], s74 offen
  s_branch L_a_j3
L_a_wait:
  v_mov_b32 v247, 0
  buffer_atomic_or v247, v245, s[40:43], 0 offen sc0 sc1
  s_nop 0
  v_lshlrev_b32 v16, 16, v112
  v_and_b32 v17, s3, v112
  v_lshlrev_b32 v18, 16, v113
  v_and_b32 v19, s3, v113
  v_lshlrev_b32 v20, 16, v114
  v_and_b32 v21, s3, v114
  v_lshlrev_b32 v22, 16, v115
  v_and_b32 v23, s3, v115
  s_nop 0
  v_dot2c_f32_bf16 v16, s48, v116
  v_dot2c_f32_bf16 v17, s49, v116
  v_dot2c_f32_bf16 v18, s48, v117
  v_dot2c_f32_bf16 v19, s49, v117
  v_dot2c_f32_bf16 v20, s48, v118
  v_dot2c_f32_bf16 v21, s49, v118
  v_dot2c_f32_bf16 v22, s48, v119
  v_dot2c_f32_bf16 v23, s49, v119
  s_nop 0
  v_dot2c_f32_bf16 v16, s48, v120
  v_dot2c_f32_bf16 v17, s49, v120
  v_dot2c_f32_bf16 v18, s48, v121
  v_dot2c_f32_bf16 v19, s49, v121
  v_dot2c_f32_bf16 v20, s48, v122
  v_dot2c_f32_bf16 v21, s49, v122
  v_dot2c_f32_bf16 v22, s48, v123
  v_dot2c_f32_bf16 v23, s49, v123
  s_nop 0
  v_lshlrev_b32 v24, 16, v124
  v_and_b32 v25, s3, v124
  v_lshlrev_b32 v26, 16, v125
  v_and_b32 v27, s3, v125
  v_lshlrev_b32 v28, 16, v126
  v_and_b32 v29, s3, v126
  v_lshlrev_b32 v30, 16, v127
  v_and_b32 v31, s3, v127
  s_nop 0
  v_dot2c_f32_bf16 v24, s48, v128
  v_dot2c_f32_bf16 v25, s49, v128
  v_dot2c_f32_bf16 v26, s48, v129
  v_dot2c_f32_bf16 v27, s49, v129
  v_dot2c_f32_bf16 v28, s48, v130
  v_dot2c_f32_bf16 v29, s49, v130
  v_dot2c_f32_bf16 v30, s48, v131
  v_dot2c_f32_bf16 v31, s49, v131
  s_nop 0
  v_dot2c_f32_bf16 v24, s48, v132
  v_dot2c_f32_bf16 v25, s49, v132
  v_dot2c_f32_bf16 v26, s48, v133
  v_dot2c_f32_bf16 v27, s49, v133
  v_dot2c_f32_bf16 v28, s48, v134
  v_dot2c_f32_bf16 v29, s49, v134
  v_dot2c_f32_bf16 v30, s48, v135
  v_dot2c_f32_bf16 v31, s49, v135
  v_permlane32_swap_b32 v16, v20
  v_permlane32_swap_b32 v17, v21
  v_permlane32_swap_b32 v18, v22
  v_permlane32_swap_b32 v19, v23
  v_add_f32 v16, v16, v20
  v_add_f32 v17, v17, v21
  v_add_f32 v18, v18, v22
  v_add_f32 v19, v19, v23
  v_permlane32_swap_b32 v24, v28
  v_permlane32_swap_b32 v25, v29
  v_permlane32_swap_b32 v26, v30
  v_permlane32_swap_b32 v27, v31
  v_add_f32 v24, v24, v28
  v_add_f32 v25, v25, v29
  v_add_f32 v26, v26, v30
  v_add_f32 v27, v27, v31
  v_permlane16_swap_b32 v16, v18
  v_permlane16_swap_b32 v17, v19
  v_add_f32 v16, v16, v18
  v_add_f32 v17, v17, v19
  v_permlane16_swap_b32 v24, v26
  v_permlane16_swap_b32 v25, v27
  v_add_f32 v24, v24, v26
  v_add_f32 v25, v25, v27
  v_mul_f32 v18, 0xbfb8aa3b, v16
  v_mul_f32 v19, 0xbfb8aa3b, v17
  v_exp_f32 v18, v18
  v_exp_f32 v19, v19
  v_lshlrev_b32 v20, 16, v252
  v_and_b32 v21, s3, v252
  v_add_f32 v18, 1.0, v18
  v_add_f32 v19, 1.0, v19
  v_rcp_f32 v18, v18
  v_rcp_f32 v19, v19
  v_mul_f32 v16, v16, v20
  v_mul_f32 v17, v17, v21
  v_lshlrev_b32 v22, 16, v248
  v_and_b32 v23, s3, v248
  v_fmac_f32 v22, v16, v18
  v_fmac_f32 v23, v17, v19
  v_cvt_pk_bf16_f32 v248, v22, v23
  buffer_store_dword v248, v243, s[32:35], s85 offen
  v_mul_f32 v26, 0xbfb8aa3b, v24
  v_mul_f32 v27, 0xbfb8aa3b, v25
  v_exp_f32 v26, v26
  v_exp_f32 v27, v27
  v_lshlrev_b32 v28, 16, v253
  v_and_b32 v29, s3, v253
  v_add_f32 v26, 1.0, v26
  v_add_f32 v27, 1.0, v27
  v_rcp_f32 v26, v26
  v_rcp_f32 v27, v27
  v_mul_f32 v24, v24, v28
  v_mul_f32 v25, v25, v29
  v_lshlrev_b32 v30, 16, v249
  v_and_b32 v31, s3, v249
  v_fmac_f32 v30, v24, v26
  v_fmac_f32 v31, v25, v27
  v_cvt_pk_bf16_f32 v249, v30, v31
  buffer_store_dword v249, v243, s[32:35], s86 offen
  s_waitcnt vmcnt(2)
  s_mov_b32 s70, 0
L_a_waits:
  v_cmp_lt_u32 vcc, v247, v246
  s_add_u32 s70, s70, 1
  s_cmp_ge_u32 s70, 200000
  s_cbranch_scc1 L_a_waits_x
  s_and_b32 s59, vcc_lo, 384
  s_cbranch_scc0 L_a_waits_x
  v_mov_b32 v247, 0
  buffer_atomic_or v247, v245, s[40:43], 0 offen sc0 sc1
  s_waitcnt vmcnt(0)
  s_branch L_a_waits
L_a_waits_x:
  buffer_load_dwordx4 v[136:139], v240, s[40:43], s66 offen sc1
  buffer_load_dwordx4 v[140:143], v241, s[40:43], s66 offen sc1
  buffer_load_dwordx4 v[144:147], v242, s[40:43], s66 offen sc1
  buffer_load_dwordx4 v[148:151], v240, s[40:43], s67 offen sc1
  buffer_load_dwordx4 v[152:155], v241, s[40:43], s67 offen sc1
  buffer_load_dwordx4 v[156:159], v242, s[40:43], s67 offen sc1
  s_waitcnt vmcnt(5)
  v_lshlrev_b32 v16, 16, v136
  v_and_b32 v17, s3, v136
  v_lshlrev_b32 v18, 16, v137
  v_and_b32 v19, s3, v137
  v_lshlrev_b32 v20, 16, v138
  v_and_b32 v21, s3, v138
  v_lshlrev_b32 v22, 16, v139
  v_and_b32 v23, s3, v139
  s_waitcnt vmcnt(4)
  v_dot2c_f32_bf16 v16, s48, v140
  v_dot2c_f32_bf16 v17, s49, v140
  v_dot2c_f32_bf16 v18, s48, v141
  v_dot2c_f32_bf16 v19, s49, v141
  v_dot2c_f32_bf16 v20, s48, v142
  v_dot2c_f32_bf16 v21, s49, v142
  v_dot2c_f32_bf16 v22, s48, v143
  v_dot2c_f32_bf16 v23, s49, v143
  s_waitcnt vmcnt(3)
  v_dot2c_f32_bf16 v16, s48, v144
  v_dot2c_f32_bf16 v17, s49, v144
  v_dot2c_f32_bf16 v18, s48, v145
  v_dot2c_f32_bf16 v19, s49, v145
  v_dot2c_f32_bf16 v20, s48, v146
  v_dot2c_f32_bf16 v21, s49, v146
  v_dot2c_f32_bf16 v22, s48, v147
  v_dot2c_f32_bf16 v23, s49, v147
  s_waitcnt vmcnt(2)
  v_lshlrev_b32 v24, 16, v148
  v_and_b32 v25, s3, v148
  v_lshlrev_b32 v26, 16, v149
  v_and_b32 v27, s3, v149
  v_lshlrev_b32 v28, 16, v150
  v_and_b32 v29, s3, v150
  v_lshlrev_b32 v30, 16, v151
  v_and_b32 v31, s3, v151
  s_waitcnt vmcnt(1)
  v_dot2c_f32_bf16 v24, s48, v152
  v_dot2c_f32_bf16 v25, s49, v152
  v_dot2c_f32_bf16 v26, s48, v153
  v_dot2c_f32_bf16 v27, s49, v153
  v_dot2c_f32_bf16 v28, s48, v154
  v_dot2c_f32_bf16 v29, s49, v154
  v_dot2c_f32_bf16 v30, s48, v155
  v_dot2c_f32_bf16 v31, s49, v155
  s_waitcnt vmcnt(0)
  v_dot2c_f32_bf16 v24, s48, v156
  v_dot2c_f32_bf16 v25, s49, v156
  v_dot2c_f32_bf16 v26, s48, v157
  v_dot2c_f32_bf16 v27, s49, v157
  v_dot2c_f32_bf16 v28, s48, v158
  v_dot2c_f32_bf16 v29, s49, v158
  v_dot2c_f32_bf16 v30, s48, v159
  v_dot2c_f32_bf16 v31, s49, v159
  v_permlane32_swap_b32 v16, v20
  v_permlane32_swap_b32 v17, v21
  v_permlane32_swap_b32 v18, v22
  v_permlane32_swap_b32 v19, v23
  v_add_f32 v16, v16, v20
  v_add_f32 v17, v17, v21
  v_add_f32 v18, v18, v22
  v_add_f32 v19, v19, v23
  v_permlane32_swap_b32 v24, v28
  v_permlane32_swap_b32 v25, v29
  v_permlane32_swap_b32 v26, v30
  v_permlane32_swap_b32 v27, v31
  v_add_f32 v24, v24, v28
  v_add_f32 v25, v25, v29
  v_add_f32 v26, v26, v30
  v_add_f32 v27, v27, v31
  v_permlane16_swap_b32 v16, v18
  v_permlane16_swap_b32 v17, v19
  v_add_f32 v16, v16, v18
  v_add_f32 v17, v17, v19
  v_permlane16_swap_b32 v24, v26
  v_permlane16_swap_b32 v25, v27
  v_add_f32 v24, v24, v26
  v_add_f32 v25, v25, v27
  v_mul_f32 v18, 0xbfb8aa3b, v16
  v_mul_f32 v19, 0xbfb8aa3b, v17
  v_exp_f32 v18, v18
  v_exp_f32 v19, v19
  v_lshlrev_b32 v20, 16, v254
  v_and_b32 v21, s3, v254
  v_add_f32 v18, 1.0, v18
  v_add_f32 v19, 1.0, v19
  v_rcp_f32 v18, v18
  v_rcp_f32 v19, v19
  v_mul_f32 v16, v16, v20
  v_mul_f32 v17, v17, v21
  v_lshlrev_b32 v22, 16, v250
  v_and_b32 v23, s3, v250
  v_fmac_f32 v22, v16, v18
  v_fmac_f32 v23, v17, v19
  v_cvt_pk_bf16_f32 v250, v22, v23
  buffer_store_dword v250, v243, s[32:35], s87 offen
  v_mul_f32 v26, 0xbfb8aa3b, v24
  v_mul_f32 v27, 0xbfb8aa3b, v25
  v_exp_f32 v26, v26
  v_exp_f32 v27, v27
  v_lshlrev_b32 v28, 16, v255
  v_and_b32 v29, s3, v255
  v_add_f32 v26, 1.0, v26
  v_add_f32 v27, 1.0, v27
  v_rcp_f32 v26, v26
  v_rcp_f32 v27, v27
  v_mul_f32 v24, v24, v28
  v_mul_f32 v25, v25, v29
  v_lshlrev_b32 v30, 16, v251
  v_and_b32 v31, s3, v251
  v_fmac_f32 v30, v24, v26
  v_fmac_f32 v31, v25, v27
  v_cvt_pk_bf16_f32 v251, v30, v31
  buffer_store_dword v251, v243, s[32:35], s88 offen
  s_endpgm
L_a_dbg_slow:
  s_mov_b32 s70, 0
L_a_dbg:
  buffer_load_dword v137, v136, s[36:39], 0 offen sc1
  s_add_u32 s70, s70, 1
  s_waitcnt vmcnt(0)
  v_cmp_eq_u32 vcc, 0, v137
  s_cmp_ge_u32 s70, 200000
  s_cbranch_scc1 L_a_dbg_x
  s_cmp_lg_u64 vcc, 0
  s_cbranch_scc1 L_a_dbg
L_a_dbg_x:
  s_branch L_a_dbgok
L_exit:
  s_endpgm
L_code_end:
.section .rodata,"a"
.p2align 6
.amdhsa_kernel recurrent_scan__sliding_local_dilated__glu_gated_glu__prompt_kernel
  .amdhsa_next_free_vgpr 512
  .amdhsa_next_free_sgpr 102
  .amdhsa_accum_offset 256
  .amdhsa_group_segment_fixed_size 0
  .amdhsa_kernarg_size 80
  .amdhsa_user_sgpr_count 2
  .amdhsa_user_sgpr_kernarg_segment_ptr 1
  .amdhsa_system_sgpr_workgroup_id_x 1
  .amdhsa_float_denorm_mode_32 3
.end_amdhsa_kernel
```
